```python
import torch

def _softmax(x, axis=-1):
    return torch.softmax(x, dim=axis)
def _gelu(x):
    return torch.nn.functional.gelu(x, approximate="tanh")
def _silu(x):
    return torch.nn.functional.silu(x)
def _sigmoid(x):
    return torch.sigmoid(x)
def _layernorm(x, axis=-1, eps=1e-5):
    m = x.mean(dim=axis, keepdim=True)
    v = x.var(dim=axis, keepdim=True, unbiased=False)
    return (x - m) / torch.sqrt(v + eps)
def _scatter_add(tgt, idx, src, axis=0):
    return tgt.clone().index_add_(axis, idx, src)
def _segment_sum(src, seg, n):
    out = torch.zeros((n,) + src.shape[1:], dtype=src.dtype)
    return out.index_add_(0, seg, src)
def _pad(x, pw):
    flat = tuple(v for pair in reversed(pw) for v in pair)
    return torch.nn.functional.pad(x, flat)

kernel_name = 'standalone__gqa_softmax__near_ridge'

def setup_inputs():

    _w = (lambda a: (lambda t: t.to(torch.bfloat16) if t.is_floating_point() else t)(torch.as_tensor(a)))
    B, Hq, Hkv, Sq, Sk, D = 16, 32, 32, 848, 512, 128
    return {
        "q": _w((lambda *s: torch.randn(*s, dtype=torch.bfloat16) * 0.8)(B, Hq, Sq, D)),
        "k": _w((lambda *s: torch.randn(*s, dtype=torch.bfloat16) * 0.8)(B, Hkv, Sk, D)),
        "v": _w((lambda *s: torch.randn(*s, dtype=torch.bfloat16) * 0.05)(B, Hkv, Sk, D)),
    }

def reference(q, k, v):
    B, Hq, Sq, D = q.shape
    Hkv = k.shape[1]
    rep = Hq // Hkv
    k = (lambda x, n, axis: torch.repeat_interleave(x, n, dim=axis))(k, rep, axis=1)
    v = (lambda x, n, axis: torch.repeat_interleave(x, n, dim=axis))(v, rep, axis=1)
    scale = D ** -0.5
    scores = torch.einsum("bhqd,bhkd->bhqk", q, k) * scale
    p = _softmax(scores, axis=-1)
    return torch.einsum("bhqk,bhkd->bhqd", p, v)
```

```asm
; @launch grid=(256,1,1) block=(256,1,1) lds=163840
.amdgcn_target "amdgcn-amd-amdhsa--gfx950"
.text
.globl standalone__gqa_softmax__near_ridge_kernel
.p2align 8
.type standalone__gqa_softmax__near_ridge_kernel,@function
standalone__gqa_softmax__near_ridge_kernel:
    s_cmp_ge_u32 s2, 256
    s_cbranch_scc1 L_exit
    s_load_dwordx4 s[80:83], s[0:1], 0
    s_load_dwordx4 s[84:87], s[0:1], 16
    s_getpc_b64 s[100:101]
L_pf:
    s_bfe_u32 s39, s2, 0x30003
    s_lshl_b32 s39, s39, 12
    v_lshrrev_b32 v253, 3, v0
    v_lshl_add_u32 v253, v253, 7, s39
    v_lshrrev_b32 v20, 6, v0
    v_and_b32 v21, 63, v0
    v_min_u32 v254, L_job7-L_pf, v253
    v_mov_b32 v255, 0
    v_lshl_add_u64 v[254:255], v[254:255], 0, s[100:101]
    global_load_dword v0, v[254:255], off
    s_add_u32 s52, s100, L_job7-L_pf
    s_addc_u32 s53, s101, 0
    s_add_u32 s54, s100, L_end_code-L_pf
    s_addc_u32 s55, s101, 0
    v_readfirstlane_b32 s21, v20
    s_and_b32 s39, s2, 7
    s_lshr_b32 s40, s2, 3
    s_and_b32 s38, s40, 1
    s_lshr_b32 s40, s40, 1
    s_lshl_b32 s39, s39, 4
    s_add_u32 s39, s39, s40
    s_mul_i32 s40, s39, 868352
    s_lshl_b32 s39, s39, 19
    v_lshrrev_b32 v22, 3, v21
    v_and_b32 v23, 7, v21
    v_bfe_u32 v24, v22, 1, 1
    v_lshrrev_b32 v25, 3, v22
    v_xor_b32 v25, v25, v22
    v_and_b32 v25, 1, v25
    v_lshl_or_b32 v24, v25, 1, v24
    v_and_b32 v25, 4, v22
    v_or_b32 v24, v24, v25
    v_xor_b32 v24, v24, v23
    v_lshlrev_b32 v24, 4, v24
    v_lshl_add_u32 v5, v22, 8, v24
    v_xor_b32 v24, v22, v23
    v_lshlrev_b32 v24, 4, v24
    v_lshl_add_u32 v6, v22, 8, v24
    s_and_b32 s41, s21, 1
    s_lshl_b32 s41, s41, 5
    s_lshl_b32 s42, s21, 11
    s_lshl_b32 s43, s21, 12
    v_xor_b32 v5, s41, v5
    v_add_u32 v5, s42, v5
    s_mul_i32 s44, s21, 24576
    s_min_u32 s45, s21, 3
    s_cselect_b32 s50, 1, 0
    s_lshl_b32 s45, s45, 12
    s_add_u32 s45, s45, s44
    s_add_u32 s45, s45, 0
    s_min_u32 s46, s21, 2
    s_cselect_b32 s51, 1, 0
    s_lshl_b32 s46, s46, 12
    s_add_u32 s46, s46, s44
    s_add_u32 s46, s46, 110592
    s_add_u32 s44, s44, 65536
    s_mov_b32 s22, -1
    s_add_u32 s41, s22, 1
    s_xor_b32 s42, s41, s38
    s_and_b32 s42, s42, 1
    s_cselect_b32 s34, s46, s45
    s_cselect_b32 s36, s51, s50
    s_mul_i32 s41, s41, 217088
    s_add_u32 s34, s34, s41
    s_waitcnt lgkmcnt(0)
    s_add_u32 s8, s82, s39
    s_addc_u32 s9, s83, 0
    s_mov_b32 s10, 524288
    s_mov_b32 s11, 0x20000
    s_add_u32 s12, s84, s39
    s_addc_u32 s13, s85, 0
    s_mov_b32 s14, 524288
    s_mov_b32 s15, 0x20000
    s_add_u32 s4, s80, s40
    s_addc_u32 s5, s81, 0
    s_mov_b32 s6, 868352
    s_mov_b32 s7, 0x20000
    s_add_u32 s16, s86, s40
    s_addc_u32 s17, s87, 0
    s_mov_b32 s18, 868352
    s_mov_b32 s19, 0x20000
    s_add_u32 m0, s43, 49152
    s_mov_b32 s39, 0
    buffer_load_dwordx4 v5, s[8:11], s39 offen lds
    s_add_u32 m0, s43, 50048
    s_mov_b32 s39, 0
    buffer_load_dwordx4 v5, s[8:11], s39 offen offset:128 lds
    s_add_u32 m0, s43, 0
    s_mov_b32 s39, 8192
    buffer_load_dwordx4 v5, s[8:11], s39 offen lds
    s_add_u32 m0, s43, 896
    s_mov_b32 s39, 8192
    buffer_load_dwordx4 v5, s[8:11], s39 offen offset:128 lds
    s_add_u32 m0, s43, 2944
    s_mov_b32 s39, 0
    buffer_load_dwordx4 v5, s[12:15], s39 offen offset:128 lds
    s_add_u32 m0, s44, 0
    s_add_u32 s40, s34, 0
    buffer_load_dwordx4 v6, s[4:7], s40 offen nt lds
    buffer_load_dwordx4 v6, s[4:7], s40 offen offset:2048 nt lds
    s_add_u32 m0, s44, 896
    s_add_u32 s40, s34, 0
    buffer_load_dwordx4 v6, s[4:7], s40 offen offset:128 nt lds
    buffer_load_dwordx4 v6, s[4:7], s40 offen offset:2176 nt lds
    s_add_u32 m0, s43, 16384
    s_mov_b32 s39, 16384
    buffer_load_dwordx4 v5, s[8:11], s39 offen lds
    s_add_u32 m0, s43, 17280
    s_mov_b32 s39, 16384
    buffer_load_dwordx4 v5, s[8:11], s39 offen offset:128 lds
    s_add_u32 m0, s43, 18432
    s_mov_b32 s39, 0
    buffer_load_dwordx4 v5, s[12:15], s39 offen lds
    s_add_u32 m0, s43, 19456
    s_mov_b32 s39, 8192
    buffer_load_dwordx4 v5, s[12:15], s39 offen lds
    s_add_u32 m0, s44, 4096
    s_add_u32 s40, s34, 4096
    buffer_load_dwordx4 v6, s[4:7], s40 offen nt lds
    buffer_load_dwordx4 v6, s[4:7], s40 offen offset:2048 nt lds
    s_add_u32 m0, s44, 4992
    s_add_u32 s40, s34, 4096
    buffer_load_dwordx4 v6, s[4:7], s40 offen offset:128 nt lds
    buffer_load_dwordx4 v6, s[4:7], s40 offen offset:2176 nt lds
    v_and_b32 v22, 15, v21
    v_lshrrev_b32 v23, 4, v21
    v_bfe_u32 v24, v22, 1, 1
    v_lshrrev_b32 v25, 3, v22
    v_xor_b32 v25, v25, v22
    v_and_b32 v25, 1, v25
    v_lshl_or_b32 v24, v25, 1, v24
    v_and_b32 v25, 4, v22
    v_or_b32 v24, v24, v25
    v_xor_b32 v24, v24, v23
    v_lshlrev_b32 v24, 4, v24
    v_and_b32 v25, 7, v22
    v_lshl_add_u32 v24, v25, 7, v24
    v_lshrrev_b32 v25, 3, v22
    v_lshl_add_u32 v1, v25, 12, v24
    v_xor_b32 v2, 64, v1
    v_and_b32 v25, 7, v22
    v_xor_b32 v24, v25, v23
    v_lshlrev_b32 v24, 4, v24
    v_lshl_add_u32 v24, v25, 7, v24
    v_lshrrev_b32 v25, 1, v22
    v_xor_b32 v25, v25, v22
    v_bfe_u32 v25, v25, 2, 1
    v_lshl_add_u32 v24, v25, 11, v24
    v_add_u32 v8, s44, v24
    v_xor_b32 v9, 64, v8
    s_add_u32 s41, s43, 49152
    v_add_u32 v10, s41, v24
    v_xor_b32 v11, 64, v10
    v_lshl_add_u32 v7, v21, 4, s44
    v_add_u32 v7, 24576, v7
    v_lshrrev_b32 v22, 2, v21
    v_and_b32 v23, 3, v21
    v_bfe_u32 v24, v22, 1, 1
    v_lshrrev_b32 v25, 3, v22
    v_xor_b32 v25, v25, v22
    v_and_b32 v25, 1, v25
    v_lshl_or_b32 v24, v25, 1, v24
    v_and_b32 v25, 4, v22
    v_or_b32 v24, v24, v25
    v_xor_b32 v24, v24, v23
    v_lshlrev_b32 v24, 4, v24
    v_and_b32 v25, 7, v22
    v_lshl_add_u32 v24, v25, 7, v24
    v_lshrrev_b32 v25, 3, v22
    v_lshl_add_u32 v3, v25, 12, v24
    v_xor_b32 v4, 64, v3
    s_mov_b32 s20, 0x3e0293ee
    s_mov_b32 s48, 0x4e800000
    s_mov_b32 s37, 0
    s_add_u32 s68, s12, 32768
    s_addc_u32 s69, s13, 0
    s_mov_b32 s70, 8192
    s_add_u32 s88, s12, 40960
    s_addc_u32 s89, s13, 0
    s_mov_b32 s90, 8192
    s_add_u32 s64, s8, 49152
    s_addc_u32 s65, s9, 0
    s_mov_b32 s66, 8192
    s_mov_b32 s67, 0x20000
    s_mov_b32 s71, 0x20000
    s_mov_b32 s91, 0x20000
    s_mov_b32 s75, 0x20000
    s_mov_b32 s79, 0x20000
    s_mov_b32 s23, 6
    s_add_u32 s27, s43, 16384
    s_mov_b32 s33, 0
    s_mov_b32 s78, 4096
    v_and_b32 v22, 1, v21
    v_mul_u32_u24 v22, 0xaaaa, v22
    v_add_u32 v252, 0x4444, v22
    v_lshl_or_b32 v252, v252, 16, v252
    v_lshrrev_b32 v22, 4, v21
    v_xor_b32 v22, v22, v21
    v_and_b32 v23, 2, v22
    v_cmp_eq_u32 vcc, 0, v23
    v_mov_b32 v24, 0x3f803f80
    s_nop 0
    v_cndmask_b32 v22, 0, v24, vcc
    v_mov_b32 v16, v22
    v_mov_b32 v17, v22
    v_mov_b32 v18, v22
    v_mov_b32 v19, v22
    v_accvgpr_write_b32 a176, 0
    v_accvgpr_write_b32 a177, 0
    v_accvgpr_write_b32 a178, 0
    v_accvgpr_write_b32 a179, 0
    v_accvgpr_write_b32 a180, 0
    v_accvgpr_write_b32 a181, 0
    v_accvgpr_write_b32 a182, 0
    v_accvgpr_write_b32 a183, 0
    v_accvgpr_write_b32 a184, 0
    v_accvgpr_write_b32 a185, 0
    v_accvgpr_write_b32 a186, 0
    v_accvgpr_write_b32 a187, 0
    v_accvgpr_write_b32 a188, 0
    v_accvgpr_write_b32 a189, 0
    v_accvgpr_write_b32 a190, 0
    v_accvgpr_write_b32 a191, 0
    s_lshl_b32 s49, 1, s22
    s_add_u32 s22, s22, 1
    s_mov_b32 s30, s33
    s_mov_b32 s33, s34
    s_mov_b32 s35, s36
    s_add_u32 s41, s22, 1
    s_xor_b32 s42, s41, s38
    s_and_b32 s42, s42, 1
    s_cselect_b32 s34, s46, s45
    s_cselect_b32 s36, s51, s50
    s_mul_i32 s41, s41, 217088
    s_add_u32 s34, s34, s41
    s_add_u32 s72, s4, s34
    s_addc_u32 s73, s5, 0
    s_cmp_lt_u32 s22, 3
    s_cselect_b32 s74, 4096, 0
    s_add_u32 s76, s16, s30
    s_addc_u32 s77, s17, 0
    s_mov_b32 s29, 128
    s_mov_b32 s31, s44
    s_mov_b32 s32, 5
    s_mov_b32 s32, 4
    s_mov_b32 s28, 0
    s_waitcnt vmcnt(12)
    s_barrier
    s_add_u32 m0, s44, 8192
    s_add_u32 s40, s33, 8192
    buffer_load_dwordx4 v6, s[4:7], s40 offen nt lds
    buffer_load_dwordx4 v6, s[4:7], s40 offen offset:2048 nt lds
    s_add_u32 m0, s44, 9088
    s_add_u32 s40, s33, 8192
    buffer_load_dwordx4 v6, s[4:7], s40 offen offset:128 nt lds
    buffer_load_dwordx4 v6, s[4:7], s40 offen offset:2176 nt lds
    ds_read_b128 a[192:195], v1 offset:49152
    ds_read_b128 a[196:199], v2 offset:49152
    ds_read_b128 a[200:203], v1 offset:50176
    ds_read_b128 a[204:207], v2 offset:50176
    ds_read_b128 a[220:223], v2 offset:58368
    ds_read_b128 a[216:219], v1 offset:58368
    ds_read_b128 a[212:215], v2 offset:57344
    ds_read_b128 a[208:211], v1 offset:57344
    ds_read_b128 a[224:227], v1
    ds_read_b128 a[228:231], v2
    ds_read_b128 a[232:235], v1 offset:1024
    ds_read_b128 a[236:239], v2 offset:1024
    ds_read_b128 a[252:255], v2 offset:9216
    ds_read_b128 a[248:251], v1 offset:9216
    ds_read_b128 a[244:247], v2 offset:8192
    ds_read_b128 a[240:243], v1 offset:8192
    ds_read_b64_tr_b16 v[220:221], v3 offset:3072
    ds_read_b64_tr_b16 v[222:223], v3 offset:11264
    ds_read_b64_tr_b16 v[224:225], v3 offset:3080
    ds_read_b64_tr_b16 v[226:227], v3 offset:11272
    ds_read_b64_tr_b16 v[228:229], v4 offset:3072
    ds_read_b64_tr_b16 v[230:231], v4 offset:11264
    ds_read_b64_tr_b16 v[232:233], v4 offset:3080
    ds_read_b64_tr_b16 v[234:235], v4 offset:11272
    s_waitcnt vmcnt(12)
    ds_read_b128 a[0:3], v8
    ds_read_b128 a[4:7], v9
    ds_read_b128 a[8:11], v8 offset:1024
    ds_read_b128 a[12:15], v9 offset:1024
    s_add_u32 m0, s44, 12288
    s_add_u32 s40, s33, 12288
    buffer_load_dwordx4 v6, s[4:7], s40 offen nt lds
    buffer_load_dwordx4 v6, s[4:7], s40 offen offset:2048 nt lds
    s_add_u32 m0, s44, 13184
    s_add_u32 s40, s33, 12288
    buffer_load_dwordx4 v6, s[4:7], s40 offen offset:128 nt lds
    buffer_load_dwordx4 v6, s[4:7], s40 offen offset:2176 nt lds
    s_waitcnt lgkmcnt(3)
    v_mfma_f32_16x16x32_bf16 v[20:23], a[192:195], a[0:3], 0
    s_waitcnt lgkmcnt(0)
    v_mfma_f32_16x16x32_bf16 v[20:23], a[196:199], a[4:7], v[20:23]
    v_mfma_f32_16x16x32_bf16 v[20:23], a[200:203], a[8:11], v[20:23]
    v_mfma_f32_16x16x32_bf16 v[20:23], a[204:207], a[12:15], v[20:23]
    s_nop 2
    v_mfma_f32_16x16x32_bf16 v[24:27], a[220:223], a[12:15], 0
    s_nop 2
    v_mfma_f32_16x16x32_bf16 v[24:27], a[216:219], a[8:11], v[24:27]
    v_mul_f32 v20, s20, v20
    v_mul_f32 v21, s20, v21
    v_mfma_f32_16x16x32_bf16 v[24:27], a[212:215], a[4:7], v[24:27]
    v_exp_f32 v20, v20
    v_mfma_f32_16x16x32_bf16 v[24:27], a[208:211], a[0:3], v[24:27]
    v_exp_f32 v21, v21
    v_mfma_f32_16x16x32_bf16 v[28:31], a[224:227], a[0:3], 0
    v_mul_f32 v22, s20, v22
    v_mul_f32 v23, s20, v23
    v_mfma_f32_16x16x32_bf16 v[28:31], a[228:231], a[4:7], v[28:31]
    v_exp_f32 v22, v22
    v_mfma_f32_16x16x32_bf16 v[28:31], a[232:235], a[8:11], v[28:31]
    v_exp_f32 v23, v23
    v_mfma_f32_16x16x32_bf16 v[28:31], a[236:239], a[12:15], v[28:31]
    v_cvt_pk_bf16_f32 v36, v20, v21
    v_cvt_pk_bf16_f32 v37, v22, v23
    v_mul_f32 v24, s20, v24
    v_mul_f32 v25, s20, v25
    v_exp_f32 v24, v24
    v_mfma_f32_16x16x32_bf16 v[32:35], a[252:255], a[12:15], 0
    v_exp_f32 v25, v25
    v_mfma_f32_16x16x32_bf16 v[32:35], a[248:251], a[8:11], v[32:35]
    v_mul_f32 v26, s20, v26
    v_mul_f32 v27, s20, v27
    v_mfma_f32_16x16x32_bf16 v[32:35], a[244:247], a[4:7], v[32:35]
    v_exp_f32 v26, v26
    v_mfma_f32_16x16x32_bf16 v[32:35], a[240:243], a[0:3], v[32:35]
    v_exp_f32 v27, v27
    v_cvt_pk_bf16_f32 v38, v24, v25
    v_cvt_pk_bf16_f32 v39, v26, v27
    v_mul_f32 v28, s20, v28
    v_mul_f32 v29, s20, v29
    v_exp_f32 v28, v28
    v_exp_f32 v29, v29
    v_mul_f32 v30, s20, v30
    v_mul_f32 v31, s20, v31
    v_exp_f32 v30, v30
    v_exp_f32 v31, v31
    v_cvt_pk_bf16_f32 v68, v28, v29
    v_cvt_pk_bf16_f32 v69, v30, v31
    v_mul_f32 v32, s20, v32
    v_mul_f32 v33, s20, v33
    v_exp_f32 v32, v32
    v_exp_f32 v33, v33
    v_mul_f32 v34, s20, v34
    v_mul_f32 v35, s20, v35
    v_exp_f32 v34, v34
    v_exp_f32 v35, v35
    v_cvt_pk_bf16_f32 v70, v32, v33
    v_cvt_pk_bf16_f32 v71, v34, v35
    s_waitcnt vmcnt(12)
    s_barrier
    s_add_u32 m0, s44, 16384
    s_add_u32 s40, s33, 16384
    buffer_load_dwordx4 v6, s[4:7], s40 offen nt lds
    buffer_load_dwordx4 v6, s[4:7], s40 offen offset:2048 nt lds
    s_add_u32 m0, s44, 17280
    s_add_u32 s40, s33, 16384
    buffer_load_dwordx4 v6, s[4:7], s40 offen offset:128 nt lds
    buffer_load_dwordx4 v6, s[4:7], s40 offen offset:2176 nt lds
    ds_read_b64_tr_b16 a[144:145], v3 offset:18432
    ds_read_b64_tr_b16 a[146:147], v3 offset:26624
    ds_read_b64_tr_b16 a[148:149], v3 offset:19456
    ds_read_b64_tr_b16 a[150:151], v3 offset:27648
    ds_read_b64_tr_b16 a[156:157], v3 offset:19464
    ds_read_b64_tr_b16 a[158:159], v3 offset:27656
    ds_read_b64_tr_b16 a[152:153], v3 offset:18440
    ds_read_b64_tr_b16 a[154:155], v3 offset:26632
    ds_read_b64_tr_b16 a[160:161], v4 offset:18432
    ds_read_b64_tr_b16 a[162:163], v4 offset:26624
    ds_read_b64_tr_b16 a[164:165], v4 offset:19456
    ds_read_b64_tr_b16 a[166:167], v4 offset:27648
    ds_read_b64_tr_b16 a[172:173], v4 offset:19464
    ds_read_b64_tr_b16 a[174:175], v4 offset:27656
    ds_read_b64_tr_b16 a[168:169], v4 offset:18440
    ds_read_b64_tr_b16 a[170:171], v4 offset:26632
    ds_read_b128 a[112:115], v1 offset:16384
    ds_read_b128 a[116:119], v2 offset:16384
    ds_read_b128 a[120:123], v1 offset:17408
    ds_read_b128 a[124:127], v2 offset:17408
    ds_read_b128 a[140:143], v2 offset:25600
    ds_read_b128 a[136:139], v1 offset:25600
    ds_read_b128 a[132:135], v2 offset:24576
    ds_read_b128 a[128:131], v1 offset:24576
    v_xor_b32 v1, 0x8000, v1
    v_xor_b32 v2, 0x8000, v2
    v_xor_b32 v3, 0x8000, v3
    v_xor_b32 v4, 0x8000, v4
    s_waitcnt vmcnt(12)
    ds_read_b128 a[16:19], v8 offset:4096
    ds_read_b128 a[20:23], v9 offset:4096
    ds_read_b128 a[24:27], v8 offset:5120
    ds_read_b128 a[28:31], v9 offset:5120
    s_add_u32 m0, s44, 20480
    s_add_u32 s40, s33, 20480
    buffer_load_dwordx4 v6, s[4:7], s40 offen nt lds
    buffer_load_dwordx4 v6, s[4:7], s40 offen offset:2048 nt lds
    s_add_u32 m0, s44, 21376
    s_add_u32 s40, s33, 20480
    buffer_load_dwordx4 v6, s[4:7], s40 offen offset:128 nt lds
    buffer_load_dwordx4 v6, s[4:7], s40 offen offset:2176 nt lds
    v_mfma_f32_16x16x32_bf16 v[108:111], v[220:223], v[36:39], 0
    v_mfma_f32_16x16x32_bf16 v[112:115], v[224:227], v[36:39], 0
    v_mfma_f32_16x16x32_bf16 v[116:119], v[228:231], v[36:39], 0
    v_mfma_f32_16x16x32_bf16 v[120:123], v[232:235], v[36:39], 0
    s_waitcnt lgkmcnt(15)
    v_mfma_f32_16x16x32_bf16 v[92:95], a[144:147], v[36:39], 0
    v_mfma_f32_16x16x32_bf16 v[92:95], a[148:151], v[68:71], v[92:95]
    v_mfma_f32_16x16x32_bf16 v[96:99], a[156:159], v[68:71], 0
    v_mfma_f32_16x16x32_bf16 v[96:99], a[152:155], v[36:39], v[96:99]
    v_mfma_f32_16x16x32_bf16 v[100:103], a[160:163], v[36:39], 0
    v_mfma_f32_16x16x32_bf16 v[100:103], a[164:167], v[68:71], v[100:103]
    s_waitcnt lgkmcnt(2)
    v_mfma_f32_16x16x32_bf16 v[104:107], a[172:175], v[68:71], 0
    v_mfma_f32_16x16x32_bf16 v[104:107], a[168:171], v[36:39], v[104:107]
    v_mfma_f32_16x16x32_bf16 v[20:23], a[192:195], a[16:19], 0
    v_mfma_f32_16x16x32_bf16 v[20:23], a[196:199], a[20:23], v[20:23]
    s_waitcnt lgkmcnt(0)
    v_mfma_f32_16x16x32_bf16 v[20:23], a[200:203], a[24:27], v[20:23]
    v_mfma_f32_16x16x32_bf16 v[20:23], a[204:207], a[28:31], v[20:23]
    s_nop 2
    v_mfma_f32_16x16x32_bf16 v[24:27], a[220:223], a[28:31], 0
    s_nop 2
    v_mfma_f32_16x16x32_bf16 v[24:27], a[216:219], a[24:27], v[24:27]
    v_mul_f32 v20, s20, v20
    v_mul_f32 v21, s20, v21
    v_mfma_f32_16x16x32_bf16 v[24:27], a[212:215], a[20:23], v[24:27]
    v_exp_f32 v20, v20
    v_mfma_f32_16x16x32_bf16 v[24:27], a[208:211], a[16:19], v[24:27]
    v_exp_f32 v21, v21
    v_mfma_f32_16x16x32_bf16 v[28:31], a[224:227], a[16:19], 0
    v_mul_f32 v22, s20, v22
    v_mul_f32 v23, s20, v23
    v_mfma_f32_16x16x32_bf16 v[28:31], a[228:231], a[20:23], v[28:31]
    v_exp_f32 v22, v22
    v_mfma_f32_16x16x32_bf16 v[28:31], a[232:235], a[24:27], v[28:31]
    v_exp_f32 v23, v23
    v_mfma_f32_16x16x32_bf16 v[28:31], a[236:239], a[28:31], v[28:31]
    v_cvt_pk_bf16_f32 v40, v20, v21
    v_cvt_pk_bf16_f32 v41, v22, v23
    v_mul_f32 v24, s20, v24
    v_mul_f32 v25, s20, v25
    v_exp_f32 v24, v24
    v_mfma_f32_16x16x32_bf16 v[32:35], a[252:255], a[28:31], 0
    v_exp_f32 v25, v25
    v_mfma_f32_16x16x32_bf16 v[32:35], a[248:251], a[24:27], v[32:35]
    v_mul_f32 v26, s20, v26
    v_mul_f32 v27, s20, v27
    v_mfma_f32_16x16x32_bf16 v[32:35], a[244:247], a[20:23], v[32:35]
    v_exp_f32 v26, v26
    v_mfma_f32_16x16x32_bf16 v[32:35], a[240:243], a[16:19], v[32:35]
    v_exp_f32 v27, v27
    v_cvt_pk_bf16_f32 v42, v24, v25
    v_cvt_pk_bf16_f32 v43, v26, v27
    v_mul_f32 v28, s20, v28
    v_mul_f32 v29, s20, v29
    v_exp_f32 v28, v28
    v_mfma_f32_16x16x32_bf16 v[140:143], v[220:223], v[40:43], 0
    v_exp_f32 v29, v29
    v_mfma_f32_16x16x32_bf16 v[144:147], v[224:227], v[40:43], 0
    v_mul_f32 v30, s20, v30
    v_mul_f32 v31, s20, v31
    v_mfma_f32_16x16x32_bf16 v[148:151], v[228:231], v[40:43], 0
    v_exp_f32 v30, v30
    v_mfma_f32_16x16x32_bf16 v[152:155], v[232:235], v[40:43], 0
    v_exp_f32 v31, v31
    v_mfma_f32_16x16x32_bf16 v[124:127], a[144:147], v[40:43], 0
    v_cvt_pk_bf16_f32 v72, v28, v29
    v_cvt_pk_bf16_f32 v73, v30, v31
    v_mul_f32 v32, s20, v32
    v_exp_f32 v32, v32
    v_mul_f32 v33, s20, v33
    v_exp_f32 v33, v33
    s_nop 0
    v_cvt_pk_bf16_f32 v74, v32, v33
    v_mul_f32 v34, s20, v34
    v_exp_f32 v34, v34
    v_mul_f32 v35, s20, v35
    v_exp_f32 v35, v35
    s_nop 0
    v_cvt_pk_bf16_f32 v75, v34, v35
    s_nop 1
    v_mfma_f32_16x16x32_bf16 v[124:127], a[148:151], v[72:75], v[124:127]
    v_mfma_f32_16x16x32_bf16 v[128:131], a[156:159], v[72:75], 0
    v_mfma_f32_16x16x32_bf16 v[128:131], a[152:155], v[40:43], v[128:131]
    v_mfma_f32_16x16x32_bf16 v[132:135], a[160:163], v[40:43], 0
    v_mfma_f32_16x16x32_bf16 v[132:135], a[164:167], v[72:75], v[132:135]
    v_mfma_f32_16x16x32_bf16 v[136:139], a[172:175], v[72:75], 0
    v_mfma_f32_16x16x32_bf16 v[136:139], a[168:171], v[40:43], v[136:139]
    v_smfmac_f32_16x16x64_bf16 a[176:179], v[16:19], v[36:43], v252
    v_smfmac_f32_16x16x64_bf16 a[176:179], v[16:19], v[68:75], v252
    v_mfma_f32_16x16x32_bf16 v[20:23], a[112:115], a[0:3], 0
    v_mfma_f32_16x16x32_bf16 v[20:23], a[116:119], a[4:7], v[20:23]
    v_mfma_f32_16x16x32_bf16 v[20:23], a[120:123], a[8:11], v[20:23]
    v_mfma_f32_16x16x32_bf16 v[20:23], a[124:127], a[12:15], v[20:23]
    s_nop 2
    v_mfma_f32_16x16x32_bf16 v[24:27], a[140:143], a[12:15], 0
    s_nop 2
    v_mfma_f32_16x16x32_bf16 v[24:27], a[136:139], a[8:11], v[24:27]
    v_mul_f32 v20, s20, v20
    v_mul_f32 v21, s20, v21
    v_mfma_f32_16x16x32_bf16 v[24:27], a[132:135], a[4:7], v[24:27]
    v_exp_f32 v20, v20
    v_mfma_f32_16x16x32_bf16 v[24:27], a[128:131], a[0:3], v[24:27]
    v_exp_f32 v21, v21
    v_mfma_f32_16x16x32_bf16 v[28:31], a[112:115], a[16:19], 0
    v_mul_f32 v22, s20, v22
    v_mul_f32 v23, s20, v23
    v_mfma_f32_16x16x32_bf16 v[28:31], a[116:119], a[20:23], v[28:31]
    v_exp_f32 v22, v22
    v_mfma_f32_16x16x32_bf16 v[28:31], a[120:123], a[24:27], v[28:31]
    v_exp_f32 v23, v23
    v_mfma_f32_16x16x32_bf16 v[28:31], a[124:127], a[28:31], v[28:31]
    v_cvt_pk_bf16_f32 v36, v20, v21
    v_cvt_pk_bf16_f32 v37, v22, v23
    v_mul_f32 v24, s20, v24
    v_mul_f32 v25, s20, v25
    v_exp_f32 v24, v24
    v_mfma_f32_16x16x32_bf16 v[32:35], a[140:143], a[28:31], 0
    v_exp_f32 v25, v25
    v_mfma_f32_16x16x32_bf16 v[32:35], a[136:139], a[24:27], v[32:35]
    v_mul_f32 v26, s20, v26
    v_mul_f32 v27, s20, v27
    v_mfma_f32_16x16x32_bf16 v[32:35], a[132:135], a[20:23], v[32:35]
    v_exp_f32 v26, v26
    v_mfma_f32_16x16x32_bf16 v[32:35], a[128:131], a[16:19], v[32:35]
    v_exp_f32 v27, v27
    v_cvt_pk_bf16_f32 v38, v24, v25
    v_cvt_pk_bf16_f32 v39, v26, v27
    v_mul_f32 v28, s20, v28
    v_mul_f32 v29, s20, v29
    v_exp_f32 v28, v28
    v_exp_f32 v29, v29
    v_mul_f32 v30, s20, v30
    v_mul_f32 v31, s20, v31
    v_exp_f32 v30, v30
    v_exp_f32 v31, v31
    v_cvt_pk_bf16_f32 v40, v28, v29
    v_cvt_pk_bf16_f32 v41, v30, v31
    v_mul_f32 v32, s20, v32
    v_mul_f32 v33, s20, v33
    v_exp_f32 v32, v32
    v_exp_f32 v33, v33
    v_mul_f32 v34, s20, v34
    v_mul_f32 v35, s20, v35
    v_exp_f32 v34, v34
    v_exp_f32 v35, v35
    v_cvt_pk_bf16_f32 v42, v32, v33
    v_cvt_pk_bf16_f32 v43, v34, v35
    s_waitcnt lgkmcnt(0)
    s_barrier
    s_waitcnt vmcnt(12)
    ds_read_b128 a[32:35], v8 offset:8192
    ds_read_b128 a[36:39], v9 offset:8192
    ds_read_b128 a[40:43], v8 offset:9216
    ds_read_b128 a[44:47], v9 offset:9216
    s_cmp_eq_u32 s35, 1
    s_cselect_b32 s24, s33, 0x100000
    s_add_u32 m0, s44, 4096
    s_add_u32 s40, s24, 24576
    buffer_load_dwordx4 v6, s[4:7], s40 offen nt lds
    buffer_load_dwordx4 v6, s[4:7], s40 offen offset:2048 nt lds
    s_add_u32 m0, s44, 4992
    s_add_u32 s40, s24, 24576
    buffer_load_dwordx4 v6, s[4:7], s40 offen offset:128 nt lds
    buffer_load_dwordx4 v6, s[4:7], s40 offen offset:2176 nt lds
    s_waitcnt lgkmcnt(3)
    v_mfma_f32_16x16x32_bf16 v[20:23], a[192:195], a[32:35], 0
    s_waitcnt lgkmcnt(0)
    v_mfma_f32_16x16x32_bf16 v[20:23], a[196:199], a[36:39], v[20:23]
    v_mfma_f32_16x16x32_bf16 v[20:23], a[200:203], a[40:43], v[20:23]
    v_mfma_f32_16x16x32_bf16 v[20:23], a[204:207], a[44:47], v[20:23]
    s_nop 2
    v_mfma_f32_16x16x32_bf16 v[24:27], a[220:223], a[44:47], 0
    s_nop 2
    v_mfma_f32_16x16x32_bf16 v[24:27], a[216:219], a[40:43], v[24:27]
    v_mul_f32 v20, s20, v20
    v_mul_f32 v21, s20, v21
    v_mfma_f32_16x16x32_bf16 v[24:27], a[212:215], a[36:39], v[24:27]
    v_exp_f32 v20, v20
    v_mfma_f32_16x16x32_bf16 v[24:27], a[208:211], a[32:35], v[24:27]
    v_exp_f32 v21, v21
    v_mfma_f32_16x16x32_bf16 v[28:31], a[224:227], a[32:35], 0
    v_mul_f32 v22, s20, v22
    v_mul_f32 v23, s20, v23
    v_mfma_f32_16x16x32_bf16 v[28:31], a[228:231], a[36:39], v[28:31]
    v_exp_f32 v22, v22
    v_mfma_f32_16x16x32_bf16 v[28:31], a[232:235], a[40:43], v[28:31]
    v_exp_f32 v23, v23
    v_mfma_f32_16x16x32_bf16 v[28:31], a[236:239], a[44:47], v[28:31]
    v_cvt_pk_bf16_f32 v44, v20, v21
    v_cvt_pk_bf16_f32 v45, v22, v23
    v_mul_f32 v24, s20, v24
    v_mul_f32 v25, s20, v25
    v_exp_f32 v24, v24
    v_mfma_f32_16x16x32_bf16 v[32:35], a[252:255], a[44:47], 0
    v_exp_f32 v25, v25
    v_mfma_f32_16x16x32_bf16 v[32:35], a[248:251], a[40:43], v[32:35]
    v_mul_f32 v26, s20, v26
    v_mul_f32 v27, s20, v27
    v_mfma_f32_16x16x32_bf16 v[32:35], a[244:247], a[36:39], v[32:35]
    v_exp_f32 v26, v26
    v_mfma_f32_16x16x32_bf16 v[32:35], a[240:243], a[32:35], v[32:35]
    v_exp_f32 v27, v27
    v_cvt_pk_bf16_f32 v46, v24, v25
    v_cvt_pk_bf16_f32 v47, v26, v27
    v_mul_f32 v28, s20, v28
    v_mul_f32 v29, s20, v29
    v_exp_f32 v28, v28
    v_mfma_f32_16x16x32_bf16 v[172:175], v[220:223], v[44:47], 0
    v_exp_f32 v29, v29
    v_mfma_f32_16x16x32_bf16 v[176:179], v[224:227], v[44:47], 0
    v_mul_f32 v30, s20, v30
    v_mul_f32 v31, s20, v31
    v_mfma_f32_16x16x32_bf16 v[180:183], v[228:231], v[44:47], 0
    v_exp_f32 v30, v30
    v_mfma_f32_16x16x32_bf16 v[184:187], v[232:235], v[44:47], 0
    v_exp_f32 v31, v31
    v_mfma_f32_16x16x32_bf16 v[156:159], a[144:147], v[44:47], 0
    v_cvt_pk_bf16_f32 v76, v28, v29
    v_cvt_pk_bf16_f32 v77, v30, v31
    v_mul_f32 v32, s20, v32
    v_exp_f32 v32, v32
    v_mul_f32 v33, s20, v33
    v_exp_f32 v33, v33
    s_nop 0
    v_cvt_pk_bf16_f32 v78, v32, v33
    v_mul_f32 v34, s20, v34
    v_exp_f32 v34, v34
    v_mul_f32 v35, s20, v35
    v_exp_f32 v35, v35
    s_nop 0
    v_cvt_pk_bf16_f32 v79, v34, v35
    s_nop 1
    v_mfma_f32_16x16x32_bf16 v[156:159], a[148:151], v[76:79], v[156:159]
    v_mfma_f32_16x16x32_bf16 v[160:163], a[156:159], v[76:79], 0
    v_mfma_f32_16x16x32_bf16 v[160:163], a[152:155], v[44:47], v[160:163]
    v_mfma_f32_16x16x32_bf16 v[164:167], a[160:163], v[44:47], 0
    v_mfma_f32_16x16x32_bf16 v[164:167], a[164:167], v[76:79], v[164:167]
    v_mfma_f32_16x16x32_bf16 v[168:171], a[172:175], v[76:79], 0
    v_mfma_f32_16x16x32_bf16 v[168:171], a[168:171], v[44:47], v[168:171]
    s_waitcnt vmcnt(12)
    ds_read_b128 a[48:51], v8 offset:12288
    ds_read_b128 a[52:55], v9 offset:12288
    ds_read_b128 a[56:59], v8 offset:13312
    ds_read_b128 a[60:63], v9 offset:13312
    s_add_u32 m0, s43, 32768
    s_mov_b32 s39, 24576
    buffer_load_dwordx4 v5, s[8:11], s39 offen lds
    s_add_u32 m0, s43, 33664
    s_mov_b32 s39, 24576
    buffer_load_dwordx4 v5, s[8:11], s39 offen offset:128 lds
    s_add_u32 m0, s43, 34688
    s_mov_b32 s39, 8192
    buffer_load_dwordx4 v5, s[12:15], s39 offen offset:128 lds
    s_add_u32 m0, s43, 35712
    s_mov_b32 s39, 16384
    buffer_load_dwordx4 v5, s[12:15], s39 offen offset:128 lds
    s_waitcnt lgkmcnt(3)
    v_mfma_f32_16x16x32_bf16 v[20:23], a[192:195], a[48:51], 0
    s_waitcnt lgkmcnt(0)
    v_mfma_f32_16x16x32_bf16 v[20:23], a[196:199], a[52:55], v[20:23]
    v_mfma_f32_16x16x32_bf16 v[20:23], a[200:203], a[56:59], v[20:23]
    v_mfma_f32_16x16x32_bf16 v[20:23], a[204:207], a[60:63], v[20:23]
    s_nop 2
    v_mfma_f32_16x16x32_bf16 v[24:27], a[220:223], a[60:63], 0
    s_nop 2
    v_mfma_f32_16x16x32_bf16 v[24:27], a[216:219], a[56:59], v[24:27]
    v_mul_f32 v20, s20, v20
    v_mul_f32 v21, s20, v21
    v_mfma_f32_16x16x32_bf16 v[24:27], a[212:215], a[52:55], v[24:27]
    v_exp_f32 v20, v20
    v_mfma_f32_16x16x32_bf16 v[24:27], a[208:211], a[48:51], v[24:27]
    v_exp_f32 v21, v21
    v_mfma_f32_16x16x32_bf16 v[28:31], a[224:227], a[48:51], 0
    v_mul_f32 v22, s20, v22
    v_mul_f32 v23, s20, v23
    v_mfma_f32_16x16x32_bf16 v[28:31], a[228:231], a[52:55], v[28:31]
    v_exp_f32 v22, v22
    v_mfma_f32_16x16x32_bf16 v[28:31], a[232:235], a[56:59], v[28:31]
    v_exp_f32 v23, v23
    v_mfma_f32_16x16x32_bf16 v[28:31], a[236:239], a[60:63], v[28:31]
    v_cvt_pk_bf16_f32 v48, v20, v21
    v_cvt_pk_bf16_f32 v49, v22, v23
    v_mul_f32 v24, s20, v24
    v_mul_f32 v25, s20, v25
    v_exp_f32 v24, v24
    v_mfma_f32_16x16x32_bf16 v[32:35], a[252:255], a[60:63], 0
    v_exp_f32 v25, v25
    v_mfma_f32_16x16x32_bf16 v[32:35], a[248:251], a[56:59], v[32:35]
    v_mul_f32 v26, s20, v26
    v_mul_f32 v27, s20, v27
    v_mfma_f32_16x16x32_bf16 v[32:35], a[244:247], a[52:55], v[32:35]
    v_exp_f32 v26, v26
    v_mfma_f32_16x16x32_bf16 v[32:35], a[240:243], a[48:51], v[32:35]
    v_exp_f32 v27, v27
    v_cvt_pk_bf16_f32 v50, v24, v25
    v_cvt_pk_bf16_f32 v51, v26, v27
    v_mul_f32 v28, s20, v28
    v_mul_f32 v29, s20, v29
    v_exp_f32 v28, v28
    v_mfma_f32_16x16x32_bf16 v[204:207], v[220:223], v[48:51], 0
    v_exp_f32 v29, v29
    v_mfma_f32_16x16x32_bf16 v[208:211], v[224:227], v[48:51], 0
    v_mul_f32 v30, s20, v30
    v_mul_f32 v31, s20, v31
    v_mfma_f32_16x16x32_bf16 v[212:215], v[228:231], v[48:51], 0
    v_exp_f32 v30, v30
    v_mfma_f32_16x16x32_bf16 v[216:219], v[232:235], v[48:51], 0
    v_exp_f32 v31, v31
    v_mfma_f32_16x16x32_bf16 v[188:191], a[144:147], v[48:51], 0
    v_cvt_pk_bf16_f32 v80, v28, v29
    v_cvt_pk_bf16_f32 v81, v30, v31
    v_mul_f32 v32, s20, v32
    v_exp_f32 v32, v32
    v_mul_f32 v33, s20, v33
    v_exp_f32 v33, v33
    s_nop 0
    v_cvt_pk_bf16_f32 v82, v32, v33
    v_mul_f32 v34, s20, v34
    v_exp_f32 v34, v34
    v_mul_f32 v35, s20, v35
    v_exp_f32 v35, v35
    s_nop 0
    v_cvt_pk_bf16_f32 v83, v34, v35
    s_nop 1
    v_mfma_f32_16x16x32_bf16 v[188:191], a[148:151], v[80:83], v[188:191]
    v_mfma_f32_16x16x32_bf16 v[192:195], a[156:159], v[80:83], 0
    v_mfma_f32_16x16x32_bf16 v[192:195], a[152:155], v[48:51], v[192:195]
    v_mfma_f32_16x16x32_bf16 v[196:199], a[160:163], v[48:51], 0
    v_mfma_f32_16x16x32_bf16 v[196:199], a[164:167], v[80:83], v[196:199]
    v_mfma_f32_16x16x32_bf16 v[200:203], a[172:175], v[80:83], 0
    v_mfma_f32_16x16x32_bf16 v[200:203], a[168:171], v[48:51], v[200:203]
    v_smfmac_f32_16x16x64_bf16 a[180:183], v[16:19], v[44:51], v252
    v_smfmac_f32_16x16x64_bf16 a[180:183], v[16:19], v[76:83], v252
    s_cmp_eq_u32 s35, 0
    s_cbranch_scc1 L_first6
L_first7:
    s_waitcnt vmcnt(12)
    ds_read_b128 a[64:67], v8 offset:16384
    ds_read_b128 a[68:71], v9 offset:16384
    ds_read_b128 a[72:75], v8 offset:17408
    ds_read_b128 a[76:79], v9 offset:17408
    s_add_u32 m0, s43, 49152
    s_mov_b32 s39, 32768
    buffer_load_dwordx4 v5, s[8:11], s39 offen lds
    s_add_u32 m0, s43, 50048
    s_mov_b32 s39, 32768
    buffer_load_dwordx4 v5, s[8:11], s39 offen offset:128 lds
    s_add_u32 m0, s43, 51200
    s_mov_b32 s39, 16384
    buffer_load_dwordx4 v5, s[12:15], s39 offen lds
    s_add_u32 m0, s43, 52224
    s_mov_b32 s39, 24576
    buffer_load_dwordx4 v5, s[12:15], s39 offen lds
    s_waitcnt lgkmcnt(3)
    v_mfma_f32_16x16x32_bf16 v[20:23], a[192:195], a[64:67], 0
    s_waitcnt lgkmcnt(0)
    v_mfma_f32_16x16x32_bf16 v[20:23], a[196:199], a[68:71], v[20:23]
    v_mfma_f32_16x16x32_bf16 v[20:23], a[200:203], a[72:75], v[20:23]
    v_mfma_f32_16x16x32_bf16 v[20:23], a[204:207], a[76:79], v[20:23]
    s_nop 2
    v_mfma_f32_16x16x32_bf16 v[24:27], a[220:223], a[76:79], 0
    s_nop 2
    v_mfma_f32_16x16x32_bf16 v[24:27], a[216:219], a[72:75], v[24:27]
    v_mul_f32 v20, s20, v20
    v_mul_f32 v21, s20, v21
    v_mfma_f32_16x16x32_bf16 v[24:27], a[212:215], a[68:71], v[24:27]
    v_exp_f32 v20, v20
    v_mfma_f32_16x16x32_bf16 v[24:27], a[208:211], a[64:67], v[24:27]
    v_exp_f32 v21, v21
    v_mfma_f32_16x16x32_bf16 v[28:31], a[224:227], a[64:67], 0
    v_mul_f32 v22, s20, v22
    v_mul_f32 v23, s20, v23
    v_mfma_f32_16x16x32_bf16 v[28:31], a[228:231], a[68:71], v[28:31]
    v_exp_f32 v22, v22
    v_mfma_f32_16x16x32_bf16 v[28:31], a[232:235], a[72:75], v[28:31]
    v_exp_f32 v23, v23
    v_mfma_f32_16x16x32_bf16 v[28:31], a[236:239], a[76:79], v[28:31]
    v_cvt_pk_bf16_f32 v52, v20, v21
    v_cvt_pk_bf16_f32 v53, v22, v23
    v_mul_f32 v24, s20, v24
    v_mul_f32 v25, s20, v25
    v_exp_f32 v24, v24
    v_mfma_f32_16x16x32_bf16 v[32:35], a[252:255], a[76:79], 0
    v_exp_f32 v25, v25
    v_mfma_f32_16x16x32_bf16 v[32:35], a[248:251], a[72:75], v[32:35]
    v_mul_f32 v26, s20, v26
    v_mul_f32 v27, s20, v27
    v_mfma_f32_16x16x32_bf16 v[32:35], a[244:247], a[68:71], v[32:35]
    v_exp_f32 v26, v26
    v_mfma_f32_16x16x32_bf16 v[32:35], a[240:243], a[64:67], v[32:35]
    v_exp_f32 v27, v27
    v_cvt_pk_bf16_f32 v54, v24, v25
    v_cvt_pk_bf16_f32 v55, v26, v27
    v_mul_f32 v28, s20, v28
    v_mul_f32 v29, s20, v29
    v_exp_f32 v28, v28
    v_mfma_f32_16x16x32_bf16 v[236:239], v[220:223], v[52:55], 0
    v_exp_f32 v29, v29
    v_mfma_f32_16x16x32_bf16 v[240:243], v[224:227], v[52:55], 0
    v_mul_f32 v30, s20, v30
    v_mul_f32 v31, s20, v31
    v_mfma_f32_16x16x32_bf16 v[244:247], v[228:231], v[52:55], 0
    v_exp_f32 v30, v30
    v_mfma_f32_16x16x32_bf16 v[248:251], v[232:235], v[52:55], 0
    v_exp_f32 v31, v31
    v_mfma_f32_16x16x32_bf16 v[20:23], a[112:115], a[32:35], 0
    v_cvt_pk_bf16_f32 v84, v28, v29
    v_cvt_pk_bf16_f32 v85, v30, v31
    v_mfma_f32_16x16x32_bf16 v[20:23], a[116:119], a[36:39], v[20:23]
    v_mul_f32 v32, s20, v32
    v_mul_f32 v33, s20, v33
    v_mfma_f32_16x16x32_bf16 v[20:23], a[120:123], a[40:43], v[20:23]
    v_exp_f32 v32, v32
    v_mfma_f32_16x16x32_bf16 v[20:23], a[124:127], a[44:47], v[20:23]
    v_exp_f32 v33, v33
    v_mfma_f32_16x16x32_bf16 v[24:27], a[140:143], a[44:47], 0
    v_mul_f32 v34, s20, v34
    v_mul_f32 v35, s20, v35
    v_mfma_f32_16x16x32_bf16 v[24:27], a[136:139], a[40:43], v[24:27]
    v_exp_f32 v34, v34
    v_mfma_f32_16x16x32_bf16 v[24:27], a[132:135], a[36:39], v[24:27]
    v_exp_f32 v35, v35
    v_mfma_f32_16x16x32_bf16 v[24:27], a[128:131], a[32:35], v[24:27]
    v_cvt_pk_bf16_f32 v86, v32, v33
    v_cvt_pk_bf16_f32 v87, v34, v35
    v_mul_f32 v20, s20, v20
    v_mul_f32 v21, s20, v21
    v_exp_f32 v20, v20
    v_exp_f32 v21, v21
    v_mul_f32 v22, s20, v22
    v_mul_f32 v23, s20, v23
    v_exp_f32 v22, v22
    v_exp_f32 v23, v23
    v_cvt_pk_bf16_f32 v44, v20, v21
    v_cvt_pk_bf16_f32 v45, v22, v23
    v_mul_f32 v24, s20, v24
    v_mul_f32 v25, s20, v25
    v_exp_f32 v24, v24
    v_exp_f32 v25, v25
    v_mul_f32 v26, s20, v26
    v_mul_f32 v27, s20, v27
    v_exp_f32 v26, v26
    v_exp_f32 v27, v27
    v_cvt_pk_bf16_f32 v46, v24, v25
    v_cvt_pk_bf16_f32 v47, v26, v27
    s_waitcnt vmcnt(12)
    ds_read_b128 a[80:83], v8 offset:20480
    ds_read_b128 a[84:87], v9 offset:20480
    ds_read_b128 a[88:91], v8 offset:21504
    ds_read_b128 a[92:95], v9 offset:21504
    s_add_u32 m0, s43, 0
    s_mov_b32 s39, 40960
    buffer_load_dwordx4 v5, s[8:11], s39 offen lds
    s_add_u32 m0, s43, 896
    s_mov_b32 s39, 40960
    buffer_load_dwordx4 v5, s[8:11], s39 offen offset:128 lds
    s_add_u32 m0, s43, 1920
    s_mov_b32 s39, 24576
    buffer_load_dwordx4 v5, s[12:15], s39 offen offset:128 lds
    s_add_u32 m0, s43, 2944
    s_mov_b32 s39, 32768
    buffer_load_dwordx4 v5, s[12:15], s39 offen offset:128 lds
    s_waitcnt lgkmcnt(3)
    v_mfma_f32_16x16x32_bf16 v[20:23], a[192:195], a[80:83], 0
    s_waitcnt lgkmcnt(0)
    v_mfma_f32_16x16x32_bf16 v[20:23], a[196:199], a[84:87], v[20:23]
    v_mfma_f32_16x16x32_bf16 v[20:23], a[200:203], a[88:91], v[20:23]
    v_mfma_f32_16x16x32_bf16 v[20:23], a[204:207], a[92:95], v[20:23]
    s_nop 2
    v_mfma_f32_16x16x32_bf16 v[24:27], a[220:223], a[92:95], 0
    s_nop 2
    v_mfma_f32_16x16x32_bf16 v[24:27], a[216:219], a[88:91], v[24:27]
    v_mul_f32 v20, s20, v20
    v_mul_f32 v21, s20, v21
    v_mfma_f32_16x16x32_bf16 v[24:27], a[212:215], a[84:87], v[24:27]
    v_exp_f32 v20, v20
    v_mfma_f32_16x16x32_bf16 v[24:27], a[208:211], a[80:83], v[24:27]
    v_exp_f32 v21, v21
    v_mfma_f32_16x16x32_bf16 v[28:31], a[224:227], a[80:83], 0
    v_mul_f32 v22, s20, v22
    v_mul_f32 v23, s20, v23
    v_mfma_f32_16x16x32_bf16 v[28:31], a[228:231], a[84:87], v[28:31]
    v_exp_f32 v22, v22
    v_mfma_f32_16x16x32_bf16 v[28:31], a[232:235], a[88:91], v[28:31]
    v_exp_f32 v23, v23
    v_mfma_f32_16x16x32_bf16 v[28:31], a[236:239], a[92:95], v[28:31]
    v_cvt_pk_bf16_f32 v56, v20, v21
    v_cvt_pk_bf16_f32 v57, v22, v23
    v_mul_f32 v24, s20, v24
    v_mul_f32 v25, s20, v25
    v_exp_f32 v24, v24
    v_mfma_f32_16x16x32_bf16 v[32:35], a[252:255], a[92:95], 0
    v_exp_f32 v25, v25
    v_mfma_f32_16x16x32_bf16 v[32:35], a[248:251], a[88:91], v[32:35]
    v_mul_f32 v26, s20, v26
    v_mul_f32 v27, s20, v27
    v_mfma_f32_16x16x32_bf16 v[32:35], a[244:247], a[84:87], v[32:35]
    v_exp_f32 v26, v26
    v_mfma_f32_16x16x32_bf16 v[32:35], a[240:243], a[80:83], v[32:35]
    v_exp_f32 v27, v27
    v_cvt_pk_bf16_f32 v58, v24, v25
    v_cvt_pk_bf16_f32 v59, v26, v27
    v_mul_f32 v28, s20, v28
    v_mul_f32 v29, s20, v29
    v_exp_f32 v28, v28
    v_smfmac_f32_16x16x64_bf16 a[184:187], v[16:19], v[52:59], v252
    v_mul_f32 v30, s20, v30
    v_exp_f32 v29, v29
    s_nop 0
    v_cvt_pk_bf16_f32 v88, v28, v29
    v_exp_f32 v30, v30
    v_mul_f32 v31, s20, v31
    v_exp_f32 v31, v31
    s_nop 0
    v_cvt_pk_bf16_f32 v89, v30, v31
    v_mul_f32 v32, s20, v32
    v_exp_f32 v32, v32
    v_mul_f32 v33, s20, v33
    v_exp_f32 v33, v33
    s_nop 0
    v_cvt_pk_bf16_f32 v90, v32, v33
    v_mul_f32 v34, s20, v34
    v_exp_f32 v34, v34
    v_mul_f32 v35, s20, v35
    v_exp_f32 v35, v35
    s_nop 0
    v_cvt_pk_bf16_f32 v91, v34, v35
    s_nop 1
    v_smfmac_f32_16x16x64_bf16 a[184:187], v[16:19], v[84:91], v252
    s_waitcnt vmcnt(12)
    ds_read_b128 a[96:99], v8 offset:4096
    ds_read_b128 a[100:103], v9 offset:4096
    ds_read_b128 a[104:107], v8 offset:5120
    ds_read_b128 a[108:111], v9 offset:5120
    s_waitcnt lgkmcnt(3)
    v_mfma_f32_16x16x32_bf16 v[20:23], a[192:195], a[96:99], 0
    s_waitcnt lgkmcnt(0)
    v_mfma_f32_16x16x32_bf16 v[20:23], a[196:199], a[100:103], v[20:23]
    v_mfma_f32_16x16x32_bf16 v[20:23], a[200:203], a[104:107], v[20:23]
    v_mfma_f32_16x16x32_bf16 v[20:23], a[204:207], a[108:111], v[20:23]
    s_nop 2
    v_mfma_f32_16x16x32_bf16 v[24:27], a[220:223], a[108:111], 0
    s_nop 2
    v_mfma_f32_16x16x32_bf16 v[24:27], a[216:219], a[104:107], v[24:27]
    v_mul_f32 v20, s20, v20
    v_mul_f32 v21, s20, v21
    v_mfma_f32_16x16x32_bf16 v[24:27], a[212:215], a[100:103], v[24:27]
    v_exp_f32 v20, v20
    v_mfma_f32_16x16x32_bf16 v[24:27], a[208:211], a[96:99], v[24:27]
    v_exp_f32 v21, v21
    v_mfma_f32_16x16x32_bf16 v[28:31], a[224:227], a[96:99], 0
    v_mul_f32 v22, s20, v22
    v_mul_f32 v23, s20, v23
    v_mfma_f32_16x16x32_bf16 v[28:31], a[228:231], a[100:103], v[28:31]
    v_exp_f32 v22, v22
    v_mfma_f32_16x16x32_bf16 v[28:31], a[232:235], a[104:107], v[28:31]
    v_exp_f32 v23, v23
    v_mfma_f32_16x16x32_bf16 v[28:31], a[236:239], a[108:111], v[28:31]
    v_cvt_pk_bf16_f32 v60, v20, v21
    v_cvt_pk_bf16_f32 v61, v22, v23
    v_mul_f32 v24, s20, v24
    v_mul_f32 v25, s20, v25
    v_exp_f32 v24, v24
    v_mfma_f32_16x16x32_bf16 v[32:35], a[252:255], a[108:111], 0
    v_exp_f32 v25, v25
    v_mfma_f32_16x16x32_bf16 v[32:35], a[248:251], a[104:107], v[32:35]
    v_mul_f32 v26, s20, v26
    v_mul_f32 v27, s20, v27
    v_mfma_f32_16x16x32_bf16 v[32:35], a[244:247], a[100:103], v[32:35]
    v_exp_f32 v26, v26
    v_mfma_f32_16x16x32_bf16 v[32:35], a[240:243], a[96:99], v[32:35]
    v_exp_f32 v27, v27
    v_cvt_pk_bf16_f32 v62, v24, v25
    v_cvt_pk_bf16_f32 v63, v26, v27
    v_mul_f32 v28, s20, v28
    v_mul_f32 v29, s20, v29
    v_exp_f32 v28, v28
    v_mfma_f32_16x16x32_bf16 a[208:211], v[220:223], v[56:59], 0
    v_exp_f32 v29, v29
    v_mfma_f32_16x16x32_bf16 a[212:215], v[224:227], v[56:59], 0
    v_mul_f32 v30, s20, v30
    v_mul_f32 v31, s20, v31
    v_mfma_f32_16x16x32_bf16 a[216:219], v[228:231], v[56:59], 0
    v_exp_f32 v30, v30
    v_mfma_f32_16x16x32_bf16 a[220:223], v[232:235], v[56:59], 0
    v_exp_f32 v31, v31
    v_mfma_f32_16x16x32_bf16 a[240:243], v[220:223], v[60:63], 0
    v_cvt_pk_bf16_f32 v64, v28, v29
    v_cvt_pk_bf16_f32 v65, v30, v31
    v_mfma_f32_16x16x32_bf16 a[244:247], v[224:227], v[60:63], 0
    v_mul_f32 v32, s20, v32
    v_mul_f32 v33, s20, v33
    v_mfma_f32_16x16x32_bf16 a[248:251], v[228:231], v[60:63], 0
    v_exp_f32 v32, v32
    v_mfma_f32_16x16x32_bf16 a[252:255], v[232:235], v[60:63], 0
    v_exp_f32 v33, v33
    v_mfma_f32_16x16x32_bf16 v[220:223], a[144:147], v[52:55], 0
    v_mul_f32 v34, s20, v34
    v_mul_f32 v35, s20, v35
    v_mfma_f32_16x16x32_bf16 v[220:223], a[148:151], v[84:87], v[220:223]
    v_exp_f32 v34, v34
    v_mfma_f32_16x16x32_bf16 v[224:227], a[156:159], v[84:87], 0
    v_exp_f32 v35, v35
    v_mfma_f32_16x16x32_bf16 v[224:227], a[152:155], v[52:55], v[224:227]
    v_cvt_pk_bf16_f32 v66, v32, v33
    v_cvt_pk_bf16_f32 v67, v34, v35
    v_mfma_f32_16x16x32_bf16 v[228:231], a[160:163], v[52:55], 0
    v_mfma_f32_16x16x32_bf16 v[228:231], a[164:167], v[84:87], v[228:231]
    v_mfma_f32_16x16x32_bf16 v[232:235], a[172:175], v[84:87], 0
    v_mfma_f32_16x16x32_bf16 v[232:235], a[168:171], v[52:55], v[232:235]
    v_mfma_f32_16x16x32_bf16 a[192:195], a[144:147], v[56:59], 0
    v_mfma_f32_16x16x32_bf16 a[192:195], a[148:151], v[88:91], a[192:195]
    v_mfma_f32_16x16x32_bf16 a[196:199], a[156:159], v[88:91], 0
    v_mfma_f32_16x16x32_bf16 a[196:199], a[152:155], v[56:59], a[196:199]
    v_mfma_f32_16x16x32_bf16 a[200:203], a[160:163], v[56:59], 0
    v_mfma_f32_16x16x32_bf16 a[200:203], a[164:167], v[88:91], a[200:203]
    v_mfma_f32_16x16x32_bf16 a[204:207], a[172:175], v[88:91], 0
    v_mfma_f32_16x16x32_bf16 a[204:207], a[168:171], v[56:59], a[204:207]
    v_mfma_f32_16x16x32_bf16 v[28:31], a[112:115], a[48:51], 0
    v_mfma_f32_16x16x32_bf16 v[28:31], a[116:119], a[52:55], v[28:31]
    v_mfma_f32_16x16x32_bf16 v[28:31], a[120:123], a[56:59], v[28:31]
    v_mfma_f32_16x16x32_bf16 v[28:31], a[124:127], a[60:63], v[28:31]
    s_nop 2
    v_mfma_f32_16x16x32_bf16 v[32:35], a[140:143], a[60:63], 0
    s_nop 2
    v_mfma_f32_16x16x32_bf16 v[32:35], a[136:139], a[56:59], v[32:35]
    s_waitcnt vmcnt(8)
    v_mul_f32 v28, s20, v28
    v_mul_f32 v29, s20, v29
    v_mfma_f32_16x16x32_bf16 v[32:35], a[132:135], a[52:55], v[32:35]
    s_barrier
    v_mul_f32 v30, s20, v30
    v_mfma_f32_16x16x32_bf16 v[32:35], a[128:131], a[48:51], v[32:35]
    v_exp_f32 v28, v28
    v_mfma_f32_16x16x32_bf16 a[224:227], a[144:147], v[60:63], 0
    ds_read_b64_tr_b16 a[144:145], v3 offset:2048
    ds_read_b64_tr_b16 a[146:147], v3 offset:10240
    v_mfma_f32_16x16x32_bf16 a[224:227], a[148:151], v[64:67], a[224:227]
    v_exp_f32 v29, v29
    v_mfma_f32_16x16x32_bf16 a[228:231], a[156:159], v[64:67], 0
    ds_read_b64_tr_b16 a[148:149], v3 offset:3072
    v_mul_f32 v31, s20, v31
    v_mfma_f32_16x16x32_bf16 a[228:231], a[152:155], v[60:63], a[228:231]
    ds_read_b64_tr_b16 a[150:151], v3 offset:11264
    v_cvt_pk_bf16_f32 v48, v28, v29
    v_mfma_f32_16x16x32_bf16 a[232:235], a[160:163], v[60:63], 0
    ds_read_b64_tr_b16 a[156:157], v3 offset:3080
    v_mul_f32 v32, s20, v32
    v_mfma_f32_16x16x32_bf16 a[232:235], a[164:167], v[64:67], a[232:235]
    ds_read_b64_tr_b16 a[158:159], v3 offset:11272
    v_mul_f32 v33, s20, v33
    v_mfma_f32_16x16x32_bf16 a[236:239], a[172:175], v[64:67], 0
    ds_read_b64_tr_b16 a[152:153], v3 offset:2056
    v_mul_f32 v34, s20, v34
    v_mfma_f32_16x16x32_bf16 a[236:239], a[168:171], v[60:63], a[236:239]
    ds_read_b64_tr_b16 a[154:155], v3 offset:10248
    v_mul_f32 v35, s20, v35
    v_smfmac_f32_16x16x64_bf16 a[188:191], v[16:19], v[60:67], v252
    ds_read_b64_tr_b16 a[160:161], v4 offset:2048
    v_mfma_f32_16x16x32_bf16 v[20:23], a[112:115], a[64:67], 0
    ds_read_b64_tr_b16 a[162:163], v4 offset:10240
    v_mfma_f32_16x16x32_bf16 v[20:23], a[116:119], a[68:71], v[20:23]
    ds_read_b64_tr_b16 a[164:165], v4 offset:3072
    v_mfma_f32_16x16x32_bf16 v[20:23], a[120:123], a[72:75], v[20:23]
    ds_read_b64_tr_b16 a[166:167], v4 offset:11264
    v_mfma_f32_16x16x32_bf16 v[20:23], a[124:127], a[76:79], v[20:23]
    ds_read_b64_tr_b16 a[172:173], v4 offset:3080
    v_mfma_f32_16x16x32_bf16 v[24:27], a[140:143], a[76:79], 0
    ds_read_b64_tr_b16 a[174:175], v4 offset:11272
    v_mfma_f32_16x16x32_bf16 v[24:27], a[136:139], a[72:75], v[24:27]
    ds_read_b64_tr_b16 a[168:169], v4 offset:2056
    v_mfma_f32_16x16x32_bf16 v[24:27], a[132:135], a[68:71], v[24:27]
    ds_read_b64_tr_b16 a[170:171], v4 offset:10248
    s_nop 0
    v_mul_f32 v20, s20, v20
    v_mfma_f32_16x16x32_bf16 v[24:27], a[128:131], a[64:67], v[24:27]
    s_nop 4
L_bodyq7:
    s_waitcnt lgkmcnt(8)
    v_exp_f32 v30, v30
    v_mfma_f32_16x16x32_bf16 v[108:111], a[144:147], v[68:71], v[108:111]
    s_add_u32 m0, s27, 0
    v_exp_f32 v31, v31
    v_mfma_f32_16x16x32_bf16 v[108:111], a[148:151], v[36:39], v[108:111]
    v_cvt_pk_bf16_f32 v49, v30, v31
    v_mul_f32 v21, s20, v21
    v_mfma_f32_16x16x32_bf16 v[112:115], a[156:159], v[36:39], v[112:115]
    buffer_load_dwordx4 v5, s[64:67], 0 offen lds
    v_mul_f32 v22, s20, v22
    v_mfma_f32_16x16x32_bf16 v[112:115], a[152:155], v[68:71], v[112:115]
    s_waitcnt lgkmcnt(0)
    v_exp_f32 v32, v32
    v_mfma_f32_16x16x32_bf16 v[116:119], a[160:163], v[68:71], v[116:119]
    v_exp_f32 v33, v33
    v_mfma_f32_16x16x32_bf16 v[116:119], a[164:167], v[36:39], v[116:119]
    v_exp_f32 v34, v34
    v_mfma_f32_16x16x32_bf16 v[120:123], a[172:175], v[36:39], v[120:123]
    s_add_u32 m0, s27, 896
    v_exp_f32 v35, v35
    v_mfma_f32_16x16x32_bf16 v[120:123], a[168:171], v[68:71], v[120:123]
    v_cvt_pk_bf16_f32 v50, v32, v33
    v_cvt_pk_bf16_f32 v51, v34, v35
    v_mfma_f32_16x16x32_bf16 v[28:31], a[112:115], a[80:83], 0
    v_exp_f32 v20, v20
    v_mfma_f32_16x16x32_bf16 v[28:31], a[116:119], a[84:87], v[28:31]
    buffer_load_dwordx4 v5, s[64:67], 0 offen offset:128 lds
    v_mul_f32 v23, s20, v23
    v_mfma_f32_16x16x32_bf16 v[28:31], a[120:123], a[88:91], v[28:31]
    v_exp_f32 v21, v21
    v_mfma_f32_16x16x32_bf16 v[28:31], a[124:127], a[92:95], v[28:31]
    v_exp_f32 v22, v22
    v_mfma_f32_16x16x32_bf16 v[32:35], a[140:143], a[92:95], 0
    v_exp_f32 v23, v23
    v_mfma_f32_16x16x32_bf16 v[32:35], a[136:139], a[88:91], v[32:35]
    s_add_u32 m0, s27, 2048
    v_cvt_pk_bf16_f32 v52, v20, v21
    v_cvt_pk_bf16_f32 v53, v22, v23
    v_mfma_f32_16x16x32_bf16 v[32:35], a[132:135], a[84:87], v[32:35]
    v_mul_f32 v24, s20, v24
    v_mul_f32 v25, s20, v25
    v_mfma_f32_16x16x32_bf16 v[32:35], a[128:131], a[80:83], v[32:35]
    v_exp_f32 v24, v24
    v_mfma_f32_16x16x32_bf16 v[140:143], a[144:147], v[72:75], v[140:143]
    buffer_load_dwordx4 v5, s[68:71], 0 offen lds
    v_mul_f32 v26, s20, v26
    v_mfma_f32_16x16x32_bf16 v[140:143], a[148:151], v[40:43], v[140:143]
    v_exp_f32 v25, v25
    v_mfma_f32_16x16x32_bf16 v[144:147], a[156:159], v[40:43], v[144:147]
    v_mul_f32 v27, s20, v27
    v_cvt_pk_bf16_f32 v54, v24, v25
    v_mfma_f32_16x16x32_bf16 v[144:147], a[152:155], v[72:75], v[144:147]
    v_exp_f32 v26, v26
    v_mfma_f32_16x16x32_bf16 v[148:151], a[160:163], v[72:75], v[148:151]
    s_add_u32 m0, s27, 3072
    v_exp_f32 v27, v27
    v_mfma_f32_16x16x32_bf16 v[148:151], a[164:167], v[40:43], v[148:151]
    v_cvt_pk_bf16_f32 v55, v26, v27
    v_mul_f32 v28, s20, v28
    v_mfma_f32_16x16x32_bf16 v[152:155], a[172:175], v[40:43], v[152:155]
    v_mul_f32 v29, s20, v29
    v_mul_f32 v30, s20, v30
    v_mfma_f32_16x16x32_bf16 v[152:155], a[168:171], v[72:75], v[152:155]
    buffer_load_dwordx4 v5, s[88:91], 0 offen lds
    v_mul_f32 v31, s20, v31
    v_mfma_f32_16x16x32_bf16 v[20:23], a[112:115], a[96:99], 0
    s_add_u32 s27, s27, 16384
    ds_read_b128 a[112:115], v1
    v_mul_f32 v32, s20, v32
    v_mfma_f32_16x16x32_bf16 v[20:23], a[116:119], a[100:103], v[20:23]
    s_and_b32 s27, s27, 0xffff
    ds_read_b128 a[116:119], v2
    v_mul_f32 v33, s20, v33
    v_mfma_f32_16x16x32_bf16 v[20:23], a[120:123], a[104:107], v[20:23]
    s_mov_b64 s[68:69], s[88:89]
    v_exp_f32 v28, v28
    v_mfma_f32_16x16x32_bf16 v[20:23], a[124:127], a[108:111], v[20:23]
    s_mov_b32 s70, s90
    ds_read_b128 a[120:123], v1 offset:1024
    v_mul_f32 v34, s20, v34
    v_mfma_f32_16x16x32_bf16 v[24:27], a[140:143], a[108:111], 0
    s_add_u32 s88, s88, 8192
    ds_read_b128 a[124:127], v2 offset:1024
    v_mul_f32 v35, s20, v35
    v_mfma_f32_16x16x32_bf16 v[24:27], a[136:139], a[104:107], v[24:27]
    s_addc_u32 s89, s89, 0
    v_exp_f32 v29, v29
    v_mfma_f32_16x16x32_bf16 v[24:27], a[132:135], a[100:103], v[24:27]
    s_mov_b32 s90, s66
    ds_read_b128 a[140:143], v2 offset:9216
    v_cvt_pk_bf16_f32 v56, v28, v29
    v_mfma_f32_16x16x32_bf16 v[24:27], a[128:131], a[96:99], v[24:27]
    s_add_u32 s64, s64, 8192
    ds_read_b128 a[136:139], v1 offset:9216
    v_mul_f32 v20, s20, v20
    v_mfma_f32_16x16x32_bf16 v[172:175], a[144:147], v[76:79], v[172:175]
    s_addc_u32 s65, s65, 0
    v_exp_f32 v30, v30
    v_mfma_f32_16x16x32_bf16 v[172:175], a[148:151], v[44:47], v[172:175]
    s_add_u32 s23, s23, 1
    ds_read_b128 a[132:135], v2 offset:8192
    v_mul_f32 v21, s20, v21
    v_mfma_f32_16x16x32_bf16 v[176:179], a[156:159], v[44:47], v[176:179]
    s_cmp_lt_u32 s23, 64
    ds_read_b128 a[128:131], v1 offset:8192
    v_mul_f32 v22, s20, v22
    v_mfma_f32_16x16x32_bf16 v[176:179], a[152:155], v[76:79], v[176:179]
    s_cselect_b32 s66, 8192, 0
    v_exp_f32 v31, v31
    v_mfma_f32_16x16x32_bf16 v[180:183], a[160:163], v[76:79], v[180:183]
    v_cvt_pk_bf16_f32 v57, v30, v31
    v_mul_f32 v23, s20, v23
    v_mfma_f32_16x16x32_bf16 v[180:183], a[164:167], v[44:47], v[180:183]
    v_exp_f32 v32, v32
    v_mfma_f32_16x16x32_bf16 v[184:187], a[172:175], v[44:47], v[184:187]
    v_exp_f32 v33, v33
    v_mfma_f32_16x16x32_bf16 v[184:187], a[168:171], v[76:79], v[184:187]
    s_waitcnt lgkmcnt(4)
    v_exp_f32 v34, v34
    v_mfma_f32_16x16x32_bf16 v[28:31], a[112:115], a[0:3], 0
    v_exp_f32 v35, v35
    v_mfma_f32_16x16x32_bf16 v[28:31], a[116:119], a[4:7], v[28:31]
    v_cvt_pk_bf16_f32 v58, v32, v33
    v_cvt_pk_bf16_f32 v59, v34, v35
    v_mfma_f32_16x16x32_bf16 v[28:31], a[120:123], a[8:11], v[28:31]
    v_exp_f32 v20, v20
    v_mfma_f32_16x16x32_bf16 v[28:31], a[124:127], a[12:15], v[28:31]
    s_waitcnt lgkmcnt(0)
    v_exp_f32 v21, v21
    v_mfma_f32_16x16x32_bf16 v[32:35], a[140:143], a[12:15], 0
    v_exp_f32 v22, v22
    v_mfma_f32_16x16x32_bf16 v[32:35], a[136:139], a[8:11], v[32:35]
    v_exp_f32 v23, v23
    v_mfma_f32_16x16x32_bf16 v[32:35], a[132:135], a[4:7], v[32:35]
    v_cvt_pk_bf16_f32 v60, v20, v21
    v_cvt_pk_bf16_f32 v61, v22, v23
    v_mfma_f32_16x16x32_bf16 v[32:35], a[128:131], a[0:3], v[32:35]
    v_mul_f32 v24, s20, v24
    v_mul_f32 v25, s20, v25
    v_mfma_f32_16x16x32_bf16 v[204:207], a[144:147], v[80:83], v[204:207]
    v_exp_f32 v24, v24
    v_mfma_f32_16x16x32_bf16 v[204:207], a[148:151], v[48:51], v[204:207]
    v_exp_f32 v25, v25
    v_mfma_f32_16x16x32_bf16 v[208:211], a[156:159], v[48:51], v[208:211]
    v_mul_f32 v26, s20, v26
    v_mul_f32 v27, s20, v27
    v_mfma_f32_16x16x32_bf16 v[208:211], a[152:155], v[80:83], v[208:211]
    v_exp_f32 v26, v26
    v_mfma_f32_16x16x32_bf16 v[212:215], a[160:163], v[80:83], v[212:215]
    v_exp_f32 v27, v27
    v_mfma_f32_16x16x32_bf16 v[212:215], a[164:167], v[48:51], v[212:215]
    v_cvt_pk_bf16_f32 v62, v24, v25
    v_cvt_pk_bf16_f32 v63, v26, v27
    v_mfma_f32_16x16x32_bf16 v[216:219], a[172:175], v[48:51], v[216:219]
    v_mul_f32 v28, s20, v28
    v_mul_f32 v29, s20, v29
    v_mfma_f32_16x16x32_bf16 v[216:219], a[168:171], v[80:83], v[216:219]
    v_exp_f32 v28, v28
    v_mfma_f32_16x16x32_bf16 v[20:23], a[112:115], a[16:19], 0
    v_exp_f32 v29, v29
    v_mfma_f32_16x16x32_bf16 v[20:23], a[116:119], a[20:23], v[20:23]
    v_mul_f32 v30, s20, v30
    v_mul_f32 v31, s20, v31
    v_mfma_f32_16x16x32_bf16 v[20:23], a[120:123], a[24:27], v[20:23]
    v_exp_f32 v30, v30
    v_mfma_f32_16x16x32_bf16 v[20:23], a[124:127], a[28:31], v[20:23]
    v_exp_f32 v31, v31
    v_mfma_f32_16x16x32_bf16 v[24:27], a[140:143], a[28:31], 0
    v_cvt_pk_bf16_f32 v68, v28, v29
    v_cvt_pk_bf16_f32 v69, v30, v31
    v_mfma_f32_16x16x32_bf16 v[24:27], a[136:139], a[24:27], v[24:27]
    v_mul_f32 v32, s20, v32
    v_mul_f32 v33, s20, v33
    v_mfma_f32_16x16x32_bf16 v[24:27], a[132:135], a[20:23], v[24:27]
    v_exp_f32 v32, v32
    v_mfma_f32_16x16x32_bf16 v[24:27], a[128:131], a[16:19], v[24:27]
    v_exp_f32 v33, v33
    v_mfma_f32_16x16x32_bf16 v[236:239], a[144:147], v[84:87], v[236:239]
    v_mul_f32 v34, s20, v34
    v_mul_f32 v35, s20, v35
    v_mfma_f32_16x16x32_bf16 v[236:239], a[148:151], v[52:55], v[236:239]
    v_exp_f32 v34, v34
    v_mfma_f32_16x16x32_bf16 v[240:243], a[156:159], v[52:55], v[240:243]
    v_exp_f32 v35, v35
    v_mfma_f32_16x16x32_bf16 v[240:243], a[152:155], v[84:87], v[240:243]
    v_cvt_pk_bf16_f32 v70, v32, v33
    v_cvt_pk_bf16_f32 v71, v34, v35
    v_mfma_f32_16x16x32_bf16 v[244:247], a[160:163], v[84:87], v[244:247]
    v_mul_f32 v20, s20, v20
    v_mul_f32 v21, s20, v21
    v_mfma_f32_16x16x32_bf16 v[244:247], a[164:167], v[52:55], v[244:247]
    v_exp_f32 v20, v20
    v_mfma_f32_16x16x32_bf16 v[248:251], a[172:175], v[52:55], v[248:251]
    v_exp_f32 v21, v21
    v_mfma_f32_16x16x32_bf16 v[248:251], a[168:171], v[84:87], v[248:251]
    v_mul_f32 v22, s20, v22
    v_mul_f32 v23, s20, v23
    v_mfma_f32_16x16x32_bf16 v[28:31], a[112:115], a[32:35], 0
    v_exp_f32 v22, v22
    v_mfma_f32_16x16x32_bf16 v[28:31], a[116:119], a[36:39], v[28:31]
    v_exp_f32 v23, v23
    v_mfma_f32_16x16x32_bf16 v[28:31], a[120:123], a[40:43], v[28:31]
    v_cvt_pk_bf16_f32 v72, v20, v21
    v_cvt_pk_bf16_f32 v73, v22, v23
    v_mfma_f32_16x16x32_bf16 v[28:31], a[124:127], a[44:47], v[28:31]
    v_mul_f32 v24, s20, v24
    v_mul_f32 v25, s20, v25
    v_mfma_f32_16x16x32_bf16 v[32:35], a[140:143], a[44:47], 0
    v_exp_f32 v24, v24
    v_mfma_f32_16x16x32_bf16 v[32:35], a[136:139], a[40:43], v[32:35]
    v_exp_f32 v25, v25
    v_mfma_f32_16x16x32_bf16 v[32:35], a[132:135], a[36:39], v[32:35]
    v_mul_f32 v26, s20, v26
    v_mul_f32 v27, s20, v27
    v_mfma_f32_16x16x32_bf16 v[32:35], a[128:131], a[32:35], v[32:35]
    v_exp_f32 v26, v26
    v_mfma_f32_16x16x32_bf16 a[208:211], a[144:147], v[88:91], a[208:211]
    v_exp_f32 v27, v27
    v_mfma_f32_16x16x32_bf16 a[208:211], a[148:151], v[56:59], a[208:211]
    v_cvt_pk_bf16_f32 v74, v24, v25
    v_cvt_pk_bf16_f32 v75, v26, v27
    v_mfma_f32_16x16x32_bf16 a[212:215], a[156:159], v[56:59], a[212:215]
    v_mul_f32 v28, s20, v28
    v_mul_f32 v29, s20, v29
    v_mfma_f32_16x16x32_bf16 a[212:215], a[152:155], v[88:91], a[212:215]
    v_exp_f32 v28, v28
    v_mfma_f32_16x16x32_bf16 a[216:219], a[160:163], v[88:91], a[216:219]
    v_exp_f32 v29, v29
    v_mfma_f32_16x16x32_bf16 a[216:219], a[164:167], v[56:59], a[216:219]
    v_mul_f32 v30, s20, v30
    v_mul_f32 v31, s20, v31
    v_mfma_f32_16x16x32_bf16 a[220:223], a[172:175], v[56:59], a[220:223]
    v_exp_f32 v30, v30
    v_mfma_f32_16x16x32_bf16 a[220:223], a[168:171], v[88:91], a[220:223]
    v_exp_f32 v31, v31
    v_mfma_f32_16x16x32_bf16 v[20:23], a[112:115], a[48:51], 0
    v_cvt_pk_bf16_f32 v76, v28, v29
    v_cvt_pk_bf16_f32 v77, v30, v31
    v_mfma_f32_16x16x32_bf16 v[20:23], a[116:119], a[52:55], v[20:23]
    v_mul_f32 v32, s20, v32
    v_mul_f32 v33, s20, v33
    v_mfma_f32_16x16x32_bf16 v[20:23], a[120:123], a[56:59], v[20:23]
    v_exp_f32 v32, v32
    v_mfma_f32_16x16x32_bf16 v[20:23], a[124:127], a[60:63], v[20:23]
    v_exp_f32 v33, v33
    v_mfma_f32_16x16x32_bf16 v[24:27], a[140:143], a[60:63], 0
    v_mul_f32 v34, s20, v34
    v_mul_f32 v35, s20, v35
    v_mfma_f32_16x16x32_bf16 v[24:27], a[136:139], a[56:59], v[24:27]
    s_waitcnt vmcnt(8) lgkmcnt(0)
    v_exp_f32 v34, v34
    v_mfma_f32_16x16x32_bf16 v[24:27], a[132:135], a[52:55], v[24:27]
    s_barrier
    v_cvt_pk_bf16_f32 v78, v32, v33
    v_mfma_f32_16x16x32_bf16 v[24:27], a[128:131], a[48:51], v[24:27]
    v_exp_f32 v35, v35
    v_mfma_f32_16x16x32_bf16 a[240:243], a[144:147], v[64:67], a[240:243]
    ds_read_b64_tr_b16 a[144:145], v3 offset:18432
    v_cvt_pk_bf16_f32 v79, v34, v35
    v_mfma_f32_16x16x32_bf16 a[240:243], a[148:151], v[60:63], a[240:243]
    ds_read_b64_tr_b16 a[146:147], v3 offset:26624
    v_mul_f32 v20, s20, v20
    v_mfma_f32_16x16x32_bf16 a[244:247], a[156:159], v[60:63], a[244:247]
    ds_read_b64_tr_b16 a[148:149], v3 offset:19456
    v_mul_f32 v21, s20, v21
    v_mfma_f32_16x16x32_bf16 a[244:247], a[152:155], v[64:67], a[244:247]
    ds_read_b64_tr_b16 a[150:151], v3 offset:27648
    v_mul_f32 v22, s20, v22
    v_mfma_f32_16x16x32_bf16 a[248:251], a[160:163], v[64:67], a[248:251]
    ds_read_b64_tr_b16 a[156:157], v3 offset:19464
    v_mul_f32 v23, s20, v23
    v_mfma_f32_16x16x32_bf16 a[248:251], a[164:167], v[60:63], a[248:251]
    ds_read_b64_tr_b16 a[158:159], v3 offset:27656
    v_mul_f32 v24, s20, v24
    v_mfma_f32_16x16x32_bf16 a[252:255], a[172:175], v[60:63], a[252:255]
    ds_read_b64_tr_b16 a[152:153], v3 offset:18440
    v_mul_f32 v25, s20, v25
    v_mfma_f32_16x16x32_bf16 a[252:255], a[168:171], v[64:67], a[252:255]
    ds_read_b64_tr_b16 a[154:155], v3 offset:26632
    v_mul_f32 v26, s20, v26
    v_mfma_f32_16x16x32_bf16 v[28:31], a[112:115], a[64:67], 0
    ds_read_b64_tr_b16 a[160:161], v4 offset:18432
    v_mul_f32 v27, s20, v27
    v_mfma_f32_16x16x32_bf16 v[28:31], a[116:119], a[68:71], v[28:31]
    ds_read_b64_tr_b16 a[162:163], v4 offset:26624
    ds_read_b64_tr_b16 a[164:165], v4 offset:19456
    v_mfma_f32_16x16x32_bf16 v[28:31], a[120:123], a[72:75], v[28:31]
    v_exp_f32 v20, v20
    v_mfma_f32_16x16x32_bf16 v[28:31], a[124:127], a[76:79], v[28:31]
    ds_read_b64_tr_b16 a[166:167], v4 offset:27648
    ds_read_b64_tr_b16 a[172:173], v4 offset:19464
    v_mfma_f32_16x16x32_bf16 v[32:35], a[140:143], a[76:79], 0
    v_exp_f32 v21, v21
    v_mfma_f32_16x16x32_bf16 v[32:35], a[136:139], a[72:75], v[32:35]
    ds_read_b64_tr_b16 a[174:175], v4 offset:27656
    v_cvt_pk_bf16_f32 v80, v20, v21
    v_mfma_f32_16x16x32_bf16 v[32:35], a[132:135], a[68:71], v[32:35]
    ds_read_b64_tr_b16 a[168:169], v4 offset:18440
    v_mul_f32 v28, s20, v28
    v_mfma_f32_16x16x32_bf16 v[32:35], a[128:131], a[64:67], v[32:35]
    s_waitcnt lgkmcnt(7)
    ds_read_b64_tr_b16 a[170:171], v4 offset:26632
    v_mul_f32 v29, s20, v29
    v_mfma_f32_16x16x32_bf16 v[92:95], a[144:147], v[36:39], v[92:95]
    s_add_u32 m0, s27, 0
    v_xor_b32 v3, 0x8000, v3
    v_xor_b32 v4, 0x8000, v4
    v_mfma_f32_16x16x32_bf16 v[92:95], a[148:151], v[68:71], v[92:95]
    v_exp_f32 v22, v22
    v_mfma_f32_16x16x32_bf16 v[96:99], a[156:159], v[68:71], v[96:99]
    buffer_load_dwordx4 v5, s[64:67], 0 offen lds
    v_mul_f32 v30, s20, v30
    v_mfma_f32_16x16x32_bf16 v[96:99], a[152:155], v[36:39], v[96:99]
    s_waitcnt lgkmcnt(0)
    v_exp_f32 v23, v23
    v_mfma_f32_16x16x32_bf16 v[100:103], a[160:163], v[36:39], v[100:103]
    v_cvt_pk_bf16_f32 v81, v22, v23
    v_mul_f32 v31, s20, v31
    v_mfma_f32_16x16x32_bf16 v[100:103], a[164:167], v[68:71], v[100:103]
    v_exp_f32 v24, v24
    v_mfma_f32_16x16x32_bf16 v[104:107], a[172:175], v[68:71], v[104:107]
    s_add_u32 m0, s27, 896
    v_exp_f32 v25, v25
    v_mfma_f32_16x16x32_bf16 v[104:107], a[168:171], v[36:39], v[104:107]
    v_exp_f32 v26, v26
    v_mfma_f32_16x16x32_bf16 v[20:23], a[112:115], a[80:83], 0
    v_exp_f32 v27, v27
    v_mfma_f32_16x16x32_bf16 v[20:23], a[116:119], a[84:87], v[20:23]
    buffer_load_dwordx4 v5, s[64:67], 0 offen offset:128 lds
    v_cvt_pk_bf16_f32 v82, v24, v25
    v_mfma_f32_16x16x32_bf16 v[20:23], a[120:123], a[88:91], v[20:23]
    v_cvt_pk_bf16_f32 v83, v26, v27
    v_mul_f32 v32, s20, v32
    v_mfma_f32_16x16x32_bf16 v[20:23], a[124:127], a[92:95], v[20:23]
    v_exp_f32 v28, v28
    v_mfma_f32_16x16x32_bf16 v[24:27], a[140:143], a[92:95], 0
    v_exp_f32 v29, v29
    v_mfma_f32_16x16x32_bf16 v[24:27], a[136:139], a[88:91], v[24:27]
    s_add_u32 m0, s27, 1920
    v_exp_f32 v30, v30
    v_mfma_f32_16x16x32_bf16 v[24:27], a[132:135], a[84:87], v[24:27]
    v_exp_f32 v31, v31
    v_mfma_f32_16x16x32_bf16 v[24:27], a[128:131], a[80:83], v[24:27]
    v_cvt_pk_bf16_f32 v84, v28, v29
    v_cvt_pk_bf16_f32 v85, v30, v31
    v_mfma_f32_16x16x32_bf16 v[124:127], a[144:147], v[40:43], v[124:127]
    buffer_load_dwordx4 v5, s[68:71], 0 offen offset:128 lds
    v_mul_f32 v33, s20, v33
    v_mfma_f32_16x16x32_bf16 v[124:127], a[148:151], v[72:75], v[124:127]
    v_exp_f32 v32, v32
    v_mfma_f32_16x16x32_bf16 v[128:131], a[156:159], v[72:75], v[128:131]
    v_exp_f32 v33, v33
    v_mfma_f32_16x16x32_bf16 v[128:131], a[152:155], v[40:43], v[128:131]
    v_mul_f32 v34, s20, v34
    v_mul_f32 v35, s20, v35
    v_mfma_f32_16x16x32_bf16 v[132:135], a[160:163], v[40:43], v[132:135]
    s_add_u32 m0, s27, 2944
    v_exp_f32 v34, v34
    v_mfma_f32_16x16x32_bf16 v[132:135], a[164:167], v[72:75], v[132:135]
    v_exp_f32 v35, v35
    v_mfma_f32_16x16x32_bf16 v[136:139], a[172:175], v[72:75], v[136:139]
    v_cvt_pk_bf16_f32 v86, v32, v33
    v_cvt_pk_bf16_f32 v87, v34, v35
    v_mfma_f32_16x16x32_bf16 v[136:139], a[168:171], v[40:43], v[136:139]
    buffer_load_dwordx4 v5, s[88:91], 0 offen offset:128 lds
    v_mul_f32 v20, s20, v20
    v_smfmac_f32_16x16x64_bf16 a[176:179], v[16:19], v[36:43], v252
    s_add_u32 s27, s27, 16384
    v_mul_f32 v21, s20, v21
    v_smfmac_f32_16x16x64_bf16 a[176:179], v[16:19], v[68:75], v252
    s_and_b32 s27, s27, 0xffff
    v_mul_f32 v22, s20, v22
    v_mfma_f32_16x16x32_bf16 v[28:31], a[112:115], a[96:99], 0
    s_mov_b64 s[68:69], s[88:89]
    ds_read_b128 a[112:115], v1 offset:16384
    v_mul_f32 v23, s20, v23
    v_mfma_f32_16x16x32_bf16 v[28:31], a[116:119], a[100:103], v[28:31]
    s_mov_b32 s70, s90
    ds_read_b128 a[116:119], v2 offset:16384
    v_mul_f32 v24, s20, v24
    v_mfma_f32_16x16x32_bf16 v[28:31], a[120:123], a[104:107], v[28:31]
    s_add_u32 s88, s88, 8192
    v_exp_f32 v20, v20
    v_mfma_f32_16x16x32_bf16 v[28:31], a[124:127], a[108:111], v[28:31]
    s_addc_u32 s89, s89, 0
    ds_read_b128 a[120:123], v1 offset:17408
    v_mul_f32 v25, s20, v25
    v_mfma_f32_16x16x32_bf16 v[32:35], a[140:143], a[108:111], 0
    s_mov_b32 s90, s66
    ds_read_b128 a[124:127], v2 offset:17408
    v_mul_f32 v26, s20, v26
    v_mfma_f32_16x16x32_bf16 v[32:35], a[136:139], a[104:107], v[32:35]
    s_add_u32 s64, s64, 8192
    v_exp_f32 v21, v21
    v_mfma_f32_16x16x32_bf16 v[32:35], a[132:135], a[100:103], v[32:35]
    s_addc_u32 s65, s65, 0
    ds_read_b128 a[140:143], v2 offset:25600
    v_cvt_pk_bf16_f32 v88, v20, v21
    v_mfma_f32_16x16x32_bf16 v[32:35], a[128:131], a[96:99], v[32:35]
    s_add_u32 s23, s23, 1
    ds_read_b128 a[136:139], v1 offset:25600
    v_mul_f32 v27, s20, v27
    v_mfma_f32_16x16x32_bf16 v[156:159], a[144:147], v[44:47], v[156:159]
    s_cmp_lt_u32 s23, 64
    v_exp_f32 v22, v22
    v_mfma_f32_16x16x32_bf16 v[156:159], a[148:151], v[76:79], v[156:159]
    s_cselect_b32 s66, 8192, 0
    ds_read_b128 a[132:135], v2 offset:24576
    v_xor_b32 v2, 0x8000, v2
    v_mfma_f32_16x16x32_bf16 v[160:163], a[156:159], v[76:79], v[160:163]
    ds_read_b128 a[128:131], v1 offset:24576
    v_xor_b32 v1, 0x8000, v1
    v_mfma_f32_16x16x32_bf16 v[160:163], a[152:155], v[44:47], v[160:163]
    s_mov_b32 m0, s31
    v_exp_f32 v23, v23
    v_mfma_f32_16x16x32_bf16 v[164:167], a[160:163], v[44:47], v[164:167]
    v_cvt_pk_bf16_f32 v89, v22, v23
    v_mul_f32 v28, s20, v28
    v_mfma_f32_16x16x32_bf16 v[164:167], a[164:167], v[76:79], v[164:167]
    v_exp_f32 v24, v24
    v_mfma_f32_16x16x32_bf16 v[168:171], a[172:175], v[76:79], v[168:171]
    buffer_load_dwordx4 v6, s[72:75], 0 offen nt lds
    v_mul_f32 v29, s20, v29
    v_mfma_f32_16x16x32_bf16 v[168:171], a[168:171], v[44:47], v[168:171]
    s_waitcnt lgkmcnt(4)
    v_exp_f32 v25, v25
    v_mfma_f32_16x16x32_bf16 v[20:23], a[112:115], a[0:3], 0
    s_add_u32 s72, s72, s29
    v_exp_f32 v26, v26
    v_mfma_f32_16x16x32_bf16 v[20:23], a[116:119], a[4:7], v[20:23]
    s_addc_u32 s73, s73, 0
    v_exp_f32 v27, v27
    v_mfma_f32_16x16x32_bf16 v[20:23], a[120:123], a[8:11], v[20:23]
    s_xor_b32 s29, s29, 0x700
    v_cvt_pk_bf16_f32 v90, v24, v25
    v_cvt_pk_bf16_f32 v91, v26, v27
    v_mfma_f32_16x16x32_bf16 v[20:23], a[124:127], a[12:15], v[20:23]
    s_waitcnt lgkmcnt(0)
    v_exp_f32 v28, v28
    v_mfma_f32_16x16x32_bf16 v[24:27], a[140:143], a[12:15], 0
    s_add_u32 s31, s31, 1024
    v_exp_f32 v29, v29
    v_mfma_f32_16x16x32_bf16 v[24:27], a[136:139], a[8:11], v[24:27]
    s_mov_b32 m0, s31
    v_mul_f32 v30, s20, v30
    v_mul_f32 v31, s20, v31
    v_mfma_f32_16x16x32_bf16 v[24:27], a[132:135], a[4:7], v[24:27]
    buffer_load_dwordx4 v6, s[72:75], 0 offen nt lds
    v_cvt_pk_bf16_f32 v64, v28, v29
    v_mfma_f32_16x16x32_bf16 v[24:27], a[128:131], a[0:3], v[24:27]
    s_add_u32 s72, s72, s29
    v_exp_f32 v30, v30
    v_exp_f32 v31, v31
    v_mfma_f32_16x16x32_bf16 v[188:191], a[144:147], v[48:51], v[188:191]
    s_addc_u32 s73, s73, 0
    v_cvt_pk_bf16_f32 v65, v30, v31
    v_mul_f32 v32, s20, v32
    v_mfma_f32_16x16x32_bf16 v[188:191], a[148:151], v[80:83], v[188:191]
    s_xor_b32 s29, s29, 0x700
    v_mul_f32 v33, s20, v33
    v_mul_f32 v34, s20, v34
    v_mfma_f32_16x16x32_bf16 v[192:195], a[156:159], v[80:83], v[192:195]
    s_add_u32 s31, s31, 1024
    v_exp_f32 v32, v32
    v_mfma_f32_16x16x32_bf16 v[192:195], a[152:155], v[48:51], v[192:195]
    s_mov_b32 m0, s31
    v_exp_f32 v33, v33
    v_mfma_f32_16x16x32_bf16 v[196:199], a[160:163], v[48:51], v[196:199]
    buffer_load_dwordx4 v6, s[72:75], 0 offen nt lds
    v_mul_f32 v35, s20, v35
    v_mfma_f32_16x16x32_bf16 v[196:199], a[164:167], v[80:83], v[196:199]
    s_add_u32 s72, s72, s29
    v_exp_f32 v34, v34
    v_mfma_f32_16x16x32_bf16 v[200:203], a[172:175], v[80:83], v[200:203]
    s_addc_u32 s73, s73, 0
    v_exp_f32 v35, v35
    v_mfma_f32_16x16x32_bf16 v[200:203], a[168:171], v[48:51], v[200:203]
    s_xor_b32 s29, s29, 0x700
    v_cvt_pk_bf16_f32 v66, v32, v33
    v_cvt_pk_bf16_f32 v67, v34, v35
    v_smfmac_f32_16x16x64_bf16 a[180:183], v[16:19], v[44:51], v252
    s_add_u32 s31, s31, 1024
    v_mul_f32 v20, s20, v20
    v_smfmac_f32_16x16x64_bf16 a[180:183], v[16:19], v[76:83], v252
    s_mov_b32 m0, s31
    v_mul_f32 v21, s20, v21
    v_mfma_f32_16x16x32_bf16 v[28:31], a[112:115], a[16:19], 0
    v_exp_f32 v20, v20
    v_mfma_f32_16x16x32_bf16 v[28:31], a[116:119], a[20:23], v[28:31]
    buffer_load_dwordx4 v6, s[72:75], 0 offen nt lds
    v_mul_f32 v22, s20, v22
    v_mfma_f32_16x16x32_bf16 v[28:31], a[120:123], a[24:27], v[28:31]
    s_add_u32 s72, s72, s29
    v_exp_f32 v21, v21
    v_mfma_f32_16x16x32_bf16 v[28:31], a[124:127], a[28:31], v[28:31]
    s_addc_u32 s73, s73, 0
    v_mul_f32 v23, s20, v23
    v_cvt_pk_bf16_f32 v36, v20, v21
    v_mfma_f32_16x16x32_bf16 v[32:35], a[140:143], a[28:31], 0
    s_xor_b32 s29, s29, 0x700
    v_exp_f32 v22, v22
    v_mfma_f32_16x16x32_bf16 v[32:35], a[136:139], a[24:27], v[32:35]
    s_add_u32 s31, s31, 1024
    v_exp_f32 v23, v23
    v_mfma_f32_16x16x32_bf16 v[32:35], a[132:135], a[20:23], v[32:35]
    v_cvt_pk_bf16_f32 v37, v22, v23
    v_mul_f32 v24, s20, v24
    v_mfma_f32_16x16x32_bf16 v[32:35], a[128:131], a[16:19], v[32:35]
    v_mul_f32 v25, s20, v25
    v_mul_f32 v26, s20, v26
    v_mfma_f32_16x16x32_bf16 v[220:223], a[144:147], v[52:55], v[220:223]
    v_exp_f32 v24, v24
    v_mfma_f32_16x16x32_bf16 v[220:223], a[148:151], v[84:87], v[220:223]
    v_exp_f32 v25, v25
    v_mfma_f32_16x16x32_bf16 v[224:227], a[156:159], v[84:87], v[224:227]
    v_mul_f32 v27, s20, v27
    v_cvt_pk_bf16_f32 v38, v24, v25
    v_mfma_f32_16x16x32_bf16 v[224:227], a[152:155], v[52:55], v[224:227]
    v_exp_f32 v26, v26
    v_mfma_f32_16x16x32_bf16 v[228:231], a[160:163], v[52:55], v[228:231]
    v_exp_f32 v27, v27
    v_mfma_f32_16x16x32_bf16 v[228:231], a[164:167], v[84:87], v[228:231]
    v_cvt_pk_bf16_f32 v39, v26, v27
    v_mul_f32 v28, s20, v28
    v_mfma_f32_16x16x32_bf16 v[232:235], a[172:175], v[84:87], v[232:235]
    v_mul_f32 v29, s20, v29
    v_mul_f32 v30, s20, v30
    v_mfma_f32_16x16x32_bf16 v[232:235], a[168:171], v[52:55], v[232:235]
    v_exp_f32 v28, v28
    v_mfma_f32_16x16x32_bf16 v[20:23], a[112:115], a[32:35], 0
    v_exp_f32 v29, v29
    v_mfma_f32_16x16x32_bf16 v[20:23], a[116:119], a[36:39], v[20:23]
    v_mul_f32 v31, s20, v31
    v_cvt_pk_bf16_f32 v40, v28, v29
    v_mfma_f32_16x16x32_bf16 v[20:23], a[120:123], a[40:43], v[20:23]
    v_exp_f32 v30, v30
    v_mfma_f32_16x16x32_bf16 v[20:23], a[124:127], a[44:47], v[20:23]
    v_exp_f32 v31, v31
    v_mfma_f32_16x16x32_bf16 v[24:27], a[140:143], a[44:47], 0
    v_cvt_pk_bf16_f32 v41, v30, v31
    v_mul_f32 v32, s20, v32
    v_mfma_f32_16x16x32_bf16 v[24:27], a[136:139], a[40:43], v[24:27]
    v_mul_f32 v33, s20, v33
    v_mul_f32 v34, s20, v34
    v_mfma_f32_16x16x32_bf16 v[24:27], a[132:135], a[36:39], v[24:27]
    v_exp_f32 v32, v32
    v_mfma_f32_16x16x32_bf16 v[24:27], a[128:131], a[32:35], v[24:27]
    v_exp_f32 v33, v33
    v_mfma_f32_16x16x32_bf16 a[192:195], a[144:147], v[56:59], a[192:195]
    v_mul_f32 v35, s20, v35
    v_cvt_pk_bf16_f32 v42, v32, v33
    v_mfma_f32_16x16x32_bf16 a[192:195], a[148:151], v[88:91], a[192:195]
    v_exp_f32 v34, v34
    v_mfma_f32_16x16x32_bf16 a[196:199], a[156:159], v[88:91], a[196:199]
    v_exp_f32 v35, v35
    v_mfma_f32_16x16x32_bf16 a[196:199], a[152:155], v[56:59], a[196:199]
    v_cvt_pk_bf16_f32 v43, v34, v35
    v_mul_f32 v20, s20, v20
    v_mfma_f32_16x16x32_bf16 a[200:203], a[160:163], v[56:59], a[200:203]
    v_mul_f32 v21, s20, v21
    v_mul_f32 v22, s20, v22
    v_mfma_f32_16x16x32_bf16 a[200:203], a[164:167], v[88:91], a[200:203]
    v_exp_f32 v20, v20
    v_mfma_f32_16x16x32_bf16 a[204:207], a[172:175], v[88:91], a[204:207]
    v_exp_f32 v21, v21
    v_mfma_f32_16x16x32_bf16 a[204:207], a[168:171], v[56:59], a[204:207]
    v_mul_f32 v23, s20, v23
    v_cvt_pk_bf16_f32 v44, v20, v21
    v_smfmac_f32_16x16x64_bf16 a[184:187], v[16:19], v[52:59], v252
    v_mul_f32 v24, s20, v24
    v_smfmac_f32_16x16x64_bf16 a[184:187], v[16:19], v[84:91], v252
    v_mul_f32 v25, s20, v25
    v_mfma_f32_16x16x32_bf16 v[28:31], a[112:115], a[48:51], 0
    v_exp_f32 v22, v22
    v_mfma_f32_16x16x32_bf16 v[28:31], a[116:119], a[52:55], v[28:31]
    v_exp_f32 v23, v23
    v_mfma_f32_16x16x32_bf16 v[28:31], a[120:123], a[56:59], v[28:31]
    v_cvt_pk_bf16_f32 v45, v22, v23
    v_mul_f32 v26, s20, v26
    v_mfma_f32_16x16x32_bf16 v[28:31], a[124:127], a[60:63], v[28:31]
    v_exp_f32 v24, v24
    v_mfma_f32_16x16x32_bf16 v[32:35], a[140:143], a[60:63], 0
    v_exp_f32 v25, v25
    v_mfma_f32_16x16x32_bf16 v[32:35], a[136:139], a[56:59], v[32:35]
    s_waitcnt vmcnt(12) lgkmcnt(0)
    v_mul_f32 v27, s20, v27
    v_cvt_pk_bf16_f32 v46, v24, v25
    v_mfma_f32_16x16x32_bf16 v[32:35], a[132:135], a[52:55], v[32:35]
    s_barrier
    v_mul_f32 v28, s20, v28
    v_mfma_f32_16x16x32_bf16 v[32:35], a[128:131], a[48:51], v[32:35]
    v_exp_f32 v26, v26
    v_mfma_f32_16x16x32_bf16 a[224:227], a[144:147], v[60:63], a[224:227]
    ds_read_b64_tr_b16 a[144:145], v3 offset:2048
    v_mul_f32 v29, s20, v29
    v_mfma_f32_16x16x32_bf16 a[224:227], a[148:151], v[64:67], a[224:227]
    ds_read_b64_tr_b16 a[146:147], v3 offset:10240
    v_mul_f32 v30, s20, v30
    v_mfma_f32_16x16x32_bf16 a[228:231], a[156:159], v[64:67], a[228:231]
    ds_read_b64_tr_b16 a[148:149], v3 offset:3072
    v_mul_f32 v31, s20, v31
    v_mfma_f32_16x16x32_bf16 a[228:231], a[152:155], v[60:63], a[228:231]
    ds_read_b64_tr_b16 a[150:151], v3 offset:11264
    v_mul_f32 v32, s20, v32
    v_mfma_f32_16x16x32_bf16 a[232:235], a[160:163], v[60:63], a[232:235]
    ds_read_b64_tr_b16 a[156:157], v3 offset:3080
    v_mul_f32 v33, s20, v33
    v_mfma_f32_16x16x32_bf16 a[232:235], a[164:167], v[64:67], a[232:235]
    ds_read_b64_tr_b16 a[158:159], v3 offset:11272
    v_mul_f32 v34, s20, v34
    v_mfma_f32_16x16x32_bf16 a[236:239], a[172:175], v[64:67], a[236:239]
    ds_read_b64_tr_b16 a[152:153], v3 offset:2056
    v_mul_f32 v35, s20, v35
    v_mfma_f32_16x16x32_bf16 a[236:239], a[168:171], v[60:63], a[236:239]
    ds_read_b64_tr_b16 a[154:155], v3 offset:10248
    ds_read_b64_tr_b16 a[160:161], v4 offset:2048
    v_smfmac_f32_16x16x64_bf16 a[188:191], v[16:19], v[60:67], v252
    v_mfma_f32_16x16x32_bf16 v[20:23], a[112:115], a[64:67], 0
    ds_read_b64_tr_b16 a[162:163], v4 offset:10240
    ds_read_b64_tr_b16 a[164:165], v4 offset:3072
    v_mfma_f32_16x16x32_bf16 v[20:23], a[116:119], a[68:71], v[20:23]
    v_exp_f32 v27, v27
    v_mfma_f32_16x16x32_bf16 v[20:23], a[120:123], a[72:75], v[20:23]
    ds_read_b64_tr_b16 a[166:167], v4 offset:11264
    v_cvt_pk_bf16_f32 v47, v26, v27
    v_mfma_f32_16x16x32_bf16 v[20:23], a[124:127], a[76:79], v[20:23]
    s_sub_u32 s32, s32, 1
    ds_read_b64_tr_b16 a[172:173], v4 offset:3080
    ds_read_b64_tr_b16 a[174:175], v4 offset:11272
    v_mfma_f32_16x16x32_bf16 v[24:27], a[140:143], a[76:79], 0
    v_exp_f32 v28, v28
    v_mfma_f32_16x16x32_bf16 v[24:27], a[136:139], a[72:75], v[24:27]
    ds_read_b64_tr_b16 a[168:169], v4 offset:2056
    ds_read_b64_tr_b16 a[170:171], v4 offset:10248
    v_mfma_f32_16x16x32_bf16 v[24:27], a[132:135], a[68:71], v[24:27]
    v_exp_f32 v29, v29
    s_nop 0
    v_cvt_pk_bf16_f32 v48, v28, v29
    v_mul_f32 v20, s20, v20
    v_mfma_f32_16x16x32_bf16 v[24:27], a[128:131], a[64:67], v[24:27]
    s_cbranch_scc0 L_bodyq7
    s_xor_b32 s28, s28, 1
    s_cbranch_scc0 L_tail7
    v_min_u32 v254, L_end_code-L_job7, v253
    v_mov_b32 v255, 0
    v_lshl_add_u64 v[254:255], v[254:255], 0, s[52:53]
    global_load_dword v0, v[254:255], off
    s_mov_b32 s32, 0
    s_branch L_bodyq7
L_first6:
    s_waitcnt vmcnt(12)
    ds_read_b128 a[64:67], v8 offset:16384
    ds_read_b128 a[68:71], v9 offset:16384
    ds_read_b128 a[72:75], v8 offset:17408
    ds_read_b128 a[76:79], v9 offset:17408
    s_add_u32 m0, s43, 49152
    s_mov_b32 s39, 32768
    buffer_load_dwordx4 v5, s[8:11], s39 offen lds
    s_add_u32 m0, s43, 50048
    s_mov_b32 s39, 32768
    buffer_load_dwordx4 v5, s[8:11], s39 offen offset:128 lds
    s_add_u32 m0, s43, 51200
    s_mov_b32 s39, 16384
    buffer_load_dwordx4 v5, s[12:15], s39 offen lds
    s_add_u32 m0, s43, 52224
    s_mov_b32 s39, 24576
    buffer_load_dwordx4 v5, s[12:15], s39 offen lds
    s_waitcnt lgkmcnt(3)
    v_mfma_f32_16x16x32_bf16 v[20:23], a[192:195], a[64:67], 0
    s_waitcnt lgkmcnt(0)
    v_mfma_f32_16x16x32_bf16 v[20:23], a[196:199], a[68:71], v[20:23]
    v_mfma_f32_16x16x32_bf16 v[20:23], a[200:203], a[72:75], v[20:23]
    v_mfma_f32_16x16x32_bf16 v[20:23], a[204:207], a[76:79], v[20:23]
    s_nop 2
    v_mfma_f32_16x16x32_bf16 v[24:27], a[220:223], a[76:79], 0
    s_nop 2
    v_mfma_f32_16x16x32_bf16 v[24:27], a[216:219], a[72:75], v[24:27]
    v_mul_f32 v20, s20, v20
    v_mul_f32 v21, s20, v21
    v_mfma_f32_16x16x32_bf16 v[24:27], a[212:215], a[68:71], v[24:27]
    v_exp_f32 v20, v20
    v_mfma_f32_16x16x32_bf16 v[24:27], a[208:211], a[64:67], v[24:27]
    v_exp_f32 v21, v21
    v_mfma_f32_16x16x32_bf16 v[28:31], a[224:227], a[64:67], 0
    v_mul_f32 v22, s20, v22
    v_mul_f32 v23, s20, v23
    v_mfma_f32_16x16x32_bf16 v[28:31], a[228:231], a[68:71], v[28:31]
    v_exp_f32 v22, v22
    v_mfma_f32_16x16x32_bf16 v[28:31], a[232:235], a[72:75], v[28:31]
    v_exp_f32 v23, v23
    v_mfma_f32_16x16x32_bf16 v[28:31], a[236:239], a[76:79], v[28:31]
    v_cvt_pk_bf16_f32 v52, v20, v21
    v_cvt_pk_bf16_f32 v53, v22, v23
    v_mul_f32 v24, s20, v24
    v_mul_f32 v25, s20, v25
    v_exp_f32 v24, v24
    v_mfma_f32_16x16x32_bf16 v[32:35], a[252:255], a[76:79], 0
    v_exp_f32 v25, v25
    v_mfma_f32_16x16x32_bf16 v[32:35], a[248:251], a[72:75], v[32:35]
    v_mul_f32 v26, s20, v26
    v_mul_f32 v27, s20, v27
    v_mfma_f32_16x16x32_bf16 v[32:35], a[244:247], a[68:71], v[32:35]
    v_exp_f32 v26, v26
    v_mfma_f32_16x16x32_bf16 v[32:35], a[240:243], a[64:67], v[32:35]
    v_exp_f32 v27, v27
    v_cvt_pk_bf16_f32 v54, v24, v25
    v_cvt_pk_bf16_f32 v55, v26, v27
    v_mul_f32 v28, s20, v28
    v_mul_f32 v29, s20, v29
    v_exp_f32 v28, v28
    v_mfma_f32_16x16x32_bf16 v[236:239], v[220:223], v[52:55], 0
    v_exp_f32 v29, v29
    v_mfma_f32_16x16x32_bf16 v[240:243], v[224:227], v[52:55], 0
    v_mul_f32 v30, s20, v30
    v_mul_f32 v31, s20, v31
    v_mfma_f32_16x16x32_bf16 v[244:247], v[228:231], v[52:55], 0
    v_exp_f32 v30, v30
    v_mfma_f32_16x16x32_bf16 v[248:251], v[232:235], v[52:55], 0
    v_exp_f32 v31, v31
    v_cvt_pk_bf16_f32 v84, v28, v29
    v_cvt_pk_bf16_f32 v85, v30, v31
    v_mul_f32 v32, s20, v32
    v_mul_f32 v33, s20, v33
    v_exp_f32 v32, v32
    v_exp_f32 v33, v33
    v_mul_f32 v34, s20, v34
    v_mul_f32 v35, s20, v35
    v_exp_f32 v34, v34
    v_exp_f32 v35, v35
    v_cvt_pk_bf16_f32 v86, v32, v33
    v_cvt_pk_bf16_f32 v87, v34, v35
    s_waitcnt vmcnt(12)
    ds_read_b128 a[80:83], v8 offset:20480
    ds_read_b128 a[84:87], v9 offset:20480
    ds_read_b128 a[88:91], v8 offset:21504
    ds_read_b128 a[92:95], v9 offset:21504
    s_add_u32 m0, s43, 0
    s_mov_b32 s39, 40960
    buffer_load_dwordx4 v5, s[8:11], s39 offen lds
    s_add_u32 m0, s43, 896
    s_mov_b32 s39, 40960
    buffer_load_dwordx4 v5, s[8:11], s39 offen offset:128 lds
    s_add_u32 m0, s43, 1920
    s_mov_b32 s39, 24576
    buffer_load_dwordx4 v5, s[12:15], s39 offen offset:128 lds
    s_add_u32 m0, s43, 2944
    s_mov_b32 s39, 32768
    buffer_load_dwordx4 v5, s[12:15], s39 offen offset:128 lds
    s_waitcnt lgkmcnt(3)
    v_mfma_f32_16x16x32_bf16 v[20:23], a[192:195], a[80:83], 0
    s_waitcnt lgkmcnt(0)
    v_mfma_f32_16x16x32_bf16 v[20:23], a[196:199], a[84:87], v[20:23]
    v_mfma_f32_16x16x32_bf16 v[20:23], a[200:203], a[88:91], v[20:23]
    v_mfma_f32_16x16x32_bf16 v[20:23], a[204:207], a[92:95], v[20:23]
    s_nop 2
    v_mfma_f32_16x16x32_bf16 v[24:27], a[220:223], a[92:95], 0
    s_nop 2
    v_mfma_f32_16x16x32_bf16 v[24:27], a[216:219], a[88:91], v[24:27]
    v_mul_f32 v20, s20, v20
    v_mul_f32 v21, s20, v21
    v_mfma_f32_16x16x32_bf16 v[24:27], a[212:215], a[84:87], v[24:27]
    v_exp_f32 v20, v20
    v_mfma_f32_16x16x32_bf16 v[24:27], a[208:211], a[80:83], v[24:27]
    v_exp_f32 v21, v21
    v_mfma_f32_16x16x32_bf16 v[28:31], a[224:227], a[80:83], 0
    v_mul_f32 v22, s20, v22
    v_mul_f32 v23, s20, v23
    v_mfma_f32_16x16x32_bf16 v[28:31], a[228:231], a[84:87], v[28:31]
    v_exp_f32 v22, v22
    v_mfma_f32_16x16x32_bf16 v[28:31], a[232:235], a[88:91], v[28:31]
    v_exp_f32 v23, v23
    v_mfma_f32_16x16x32_bf16 v[28:31], a[236:239], a[92:95], v[28:31]
    v_cvt_pk_bf16_f32 v56, v20, v21
    v_cvt_pk_bf16_f32 v57, v22, v23
    v_mul_f32 v24, s20, v24
    v_mul_f32 v25, s20, v25
    v_exp_f32 v24, v24
    v_mfma_f32_16x16x32_bf16 v[32:35], a[252:255], a[92:95], 0
    v_exp_f32 v25, v25
    v_mfma_f32_16x16x32_bf16 v[32:35], a[248:251], a[88:91], v[32:35]
    v_mul_f32 v26, s20, v26
    v_mul_f32 v27, s20, v27
    v_mfma_f32_16x16x32_bf16 v[32:35], a[244:247], a[84:87], v[32:35]
    v_exp_f32 v26, v26
    v_mfma_f32_16x16x32_bf16 v[32:35], a[240:243], a[80:83], v[32:35]
    v_exp_f32 v27, v27
    v_cvt_pk_bf16_f32 v58, v24, v25
    v_cvt_pk_bf16_f32 v59, v26, v27
    v_mul_f32 v28, s20, v28
    v_mul_f32 v29, s20, v29
    v_exp_f32 v28, v28
    v_mfma_f32_16x16x32_bf16 a[208:211], v[220:223], v[56:59], 0
    v_exp_f32 v29, v29
    v_mfma_f32_16x16x32_bf16 a[212:215], v[224:227], v[56:59], 0
    v_mul_f32 v30, s20, v30
    v_mul_f32 v31, s20, v31
    v_mfma_f32_16x16x32_bf16 a[216:219], v[228:231], v[56:59], 0
    v_exp_f32 v30, v30
    v_mfma_f32_16x16x32_bf16 a[220:223], v[232:235], v[56:59], 0
    v_exp_f32 v31, v31
    v_mfma_f32_16x16x32_bf16 v[220:223], a[144:147], v[52:55], 0
    v_cvt_pk_bf16_f32 v88, v28, v29
    v_cvt_pk_bf16_f32 v89, v30, v31
    v_mfma_f32_16x16x32_bf16 v[220:223], a[148:151], v[84:87], v[220:223]
    v_mul_f32 v32, s20, v32
    v_mul_f32 v33, s20, v33
    v_mfma_f32_16x16x32_bf16 v[224:227], a[156:159], v[84:87], 0
    v_exp_f32 v32, v32
    v_mfma_f32_16x16x32_bf16 v[224:227], a[152:155], v[52:55], v[224:227]
    v_exp_f32 v33, v33
    v_mfma_f32_16x16x32_bf16 v[228:231], a[160:163], v[52:55], 0
    v_mul_f32 v34, s20, v34
    v_mul_f32 v35, s20, v35
    v_mfma_f32_16x16x32_bf16 v[228:231], a[164:167], v[84:87], v[228:231]
    v_exp_f32 v34, v34
    v_mfma_f32_16x16x32_bf16 v[232:235], a[172:175], v[84:87], 0
    v_exp_f32 v35, v35
    v_mfma_f32_16x16x32_bf16 v[232:235], a[168:171], v[52:55], v[232:235]
    v_cvt_pk_bf16_f32 v90, v32, v33
    v_cvt_pk_bf16_f32 v91, v34, v35
    v_mfma_f32_16x16x32_bf16 v[20:23], a[112:115], a[32:35], 0
    v_mfma_f32_16x16x32_bf16 v[20:23], a[116:119], a[36:39], v[20:23]
    v_mfma_f32_16x16x32_bf16 v[20:23], a[120:123], a[40:43], v[20:23]
    v_mfma_f32_16x16x32_bf16 v[20:23], a[124:127], a[44:47], v[20:23]
    s_nop 2
    v_mfma_f32_16x16x32_bf16 v[24:27], a[140:143], a[44:47], 0
    s_nop 2
    v_mfma_f32_16x16x32_bf16 v[24:27], a[136:139], a[40:43], v[24:27]
    s_waitcnt vmcnt(8)
    v_mul_f32 v20, s20, v20
    v_mul_f32 v21, s20, v21
    v_mfma_f32_16x16x32_bf16 v[24:27], a[132:135], a[36:39], v[24:27]
    s_barrier
    v_mul_f32 v22, s20, v22
    v_mfma_f32_16x16x32_bf16 v[24:27], a[128:131], a[32:35], v[24:27]
    v_exp_f32 v20, v20
    v_mfma_f32_16x16x32_bf16 a[192:195], a[144:147], v[56:59], 0
    ds_read_b64_tr_b16 a[144:145], v3 offset:2048
    ds_read_b64_tr_b16 a[146:147], v3 offset:10240
    v_mfma_f32_16x16x32_bf16 a[192:195], a[148:151], v[88:91], a[192:195]
    v_exp_f32 v21, v21
    v_mfma_f32_16x16x32_bf16 a[196:199], a[156:159], v[88:91], 0
    ds_read_b64_tr_b16 a[148:149], v3 offset:3072
    v_mul_f32 v23, s20, v23
    v_mfma_f32_16x16x32_bf16 a[196:199], a[152:155], v[56:59], a[196:199]
    ds_read_b64_tr_b16 a[150:151], v3 offset:11264
    v_mul_f32 v24, s20, v24
    v_mfma_f32_16x16x32_bf16 a[200:203], a[160:163], v[56:59], 0
    ds_read_b64_tr_b16 a[156:157], v3 offset:3080
    v_mul_f32 v25, s20, v25
    v_mfma_f32_16x16x32_bf16 a[200:203], a[164:167], v[88:91], a[200:203]
    ds_read_b64_tr_b16 a[158:159], v3 offset:11272
    v_mul_f32 v26, s20, v26
    v_mfma_f32_16x16x32_bf16 a[204:207], a[172:175], v[88:91], 0
    ds_read_b64_tr_b16 a[152:153], v3 offset:2056
    v_mul_f32 v27, s20, v27
    v_mfma_f32_16x16x32_bf16 a[204:207], a[168:171], v[56:59], a[204:207]
    ds_read_b64_tr_b16 a[154:155], v3 offset:10248
    v_smfmac_f32_16x16x64_bf16 a[184:187], v[16:19], v[52:59], v252
    ds_read_b64_tr_b16 a[160:161], v4 offset:2048
    v_smfmac_f32_16x16x64_bf16 a[184:187], v[16:19], v[84:91], v252
    ds_read_b64_tr_b16 a[162:163], v4 offset:10240
    v_mfma_f32_16x16x32_bf16 v[28:31], a[112:115], a[48:51], 0
    ds_read_b64_tr_b16 a[164:165], v4 offset:3072
    v_mfma_f32_16x16x32_bf16 v[28:31], a[116:119], a[52:55], v[28:31]
    ds_read_b64_tr_b16 a[166:167], v4 offset:11264
    v_mfma_f32_16x16x32_bf16 v[28:31], a[120:123], a[56:59], v[28:31]
    ds_read_b64_tr_b16 a[172:173], v4 offset:3080
    v_mfma_f32_16x16x32_bf16 v[28:31], a[124:127], a[60:63], v[28:31]
    ds_read_b64_tr_b16 a[174:175], v4 offset:11272
    v_mfma_f32_16x16x32_bf16 v[32:35], a[140:143], a[60:63], 0
    ds_read_b64_tr_b16 a[168:169], v4 offset:2056
    v_mfma_f32_16x16x32_bf16 v[32:35], a[136:139], a[56:59], v[32:35]
    ds_read_b64_tr_b16 a[170:171], v4 offset:10248
    v_mfma_f32_16x16x32_bf16 v[32:35], a[132:135], a[52:55], v[32:35]
    s_nop 0
    s_nop 0
    v_mul_f32 v28, s20, v28
    v_mfma_f32_16x16x32_bf16 v[32:35], a[128:131], a[48:51], v[32:35]
    s_nop 4
    s_nop 0
L_bodyq6:
    s_waitcnt lgkmcnt(8)
    v_exp_f32 v22, v22
    v_mfma_f32_16x16x32_bf16 v[108:111], a[144:147], v[68:71], v[108:111]
    v_exp_f32 v23, v23
    v_mfma_f32_16x16x32_bf16 v[108:111], a[148:151], v[36:39], v[108:111]
    v_cvt_pk_bf16_f32 v44, v20, v21
    v_cvt_pk_bf16_f32 v45, v22, v23
    v_mfma_f32_16x16x32_bf16 v[112:115], a[156:159], v[36:39], v[112:115]
    s_add_u32 m0, s27, 0
    v_exp_f32 v24, v24
    v_mfma_f32_16x16x32_bf16 v[112:115], a[152:155], v[68:71], v[112:115]
    s_waitcnt lgkmcnt(0)
    v_exp_f32 v25, v25
    v_mfma_f32_16x16x32_bf16 v[116:119], a[160:163], v[68:71], v[116:119]
    v_exp_f32 v26, v26
    v_mfma_f32_16x16x32_bf16 v[116:119], a[164:167], v[36:39], v[116:119]
    buffer_load_dwordx4 v5, s[64:67], 0 offen lds
    v_cvt_pk_bf16_f32 v46, v24, v25
    v_mfma_f32_16x16x32_bf16 v[120:123], a[172:175], v[36:39], v[120:123]
    v_exp_f32 v27, v27
    v_mfma_f32_16x16x32_bf16 v[120:123], a[168:171], v[68:71], v[120:123]
    v_cvt_pk_bf16_f32 v47, v26, v27
    v_mul_f32 v29, s20, v29
    v_mfma_f32_16x16x32_bf16 v[20:23], a[112:115], a[64:67], 0
    v_exp_f32 v28, v28
    v_mfma_f32_16x16x32_bf16 v[20:23], a[116:119], a[68:71], v[20:23]
    s_add_u32 m0, s27, 896
    v_exp_f32 v29, v29
    v_mfma_f32_16x16x32_bf16 v[20:23], a[120:123], a[72:75], v[20:23]
    v_mul_f32 v30, s20, v30
    v_mul_f32 v31, s20, v31
    v_mfma_f32_16x16x32_bf16 v[20:23], a[124:127], a[76:79], v[20:23]
    v_exp_f32 v30, v30
    v_mfma_f32_16x16x32_bf16 v[24:27], a[140:143], a[76:79], 0
    buffer_load_dwordx4 v5, s[64:67], 0 offen offset:128 lds
    v_cvt_pk_bf16_f32 v48, v28, v29
    v_mfma_f32_16x16x32_bf16 v[24:27], a[136:139], a[72:75], v[24:27]
    v_exp_f32 v31, v31
    v_mfma_f32_16x16x32_bf16 v[24:27], a[132:135], a[68:71], v[24:27]
    v_cvt_pk_bf16_f32 v49, v30, v31
    v_mul_f32 v32, s20, v32
    v_mfma_f32_16x16x32_bf16 v[24:27], a[128:131], a[64:67], v[24:27]
    v_mul_f32 v33, s20, v33
    v_mul_f32 v34, s20, v34
    v_mfma_f32_16x16x32_bf16 v[140:143], a[144:147], v[72:75], v[140:143]
    s_add_u32 m0, s27, 2048
    v_exp_f32 v32, v32
    v_mfma_f32_16x16x32_bf16 v[140:143], a[148:151], v[40:43], v[140:143]
    v_exp_f32 v33, v33
    v_mfma_f32_16x16x32_bf16 v[144:147], a[156:159], v[40:43], v[144:147]
    v_mul_f32 v35, s20, v35
    v_cvt_pk_bf16_f32 v50, v32, v33
    v_mfma_f32_16x16x32_bf16 v[144:147], a[152:155], v[72:75], v[144:147]
    buffer_load_dwordx4 v5, s[68:71], 0 offen lds
    v_mul_f32 v20, s20, v20
    v_mfma_f32_16x16x32_bf16 v[148:151], a[160:163], v[72:75], v[148:151]
    v_exp_f32 v34, v34
    v_mfma_f32_16x16x32_bf16 v[148:151], a[164:167], v[40:43], v[148:151]
    v_exp_f32 v35, v35
    v_mfma_f32_16x16x32_bf16 v[152:155], a[172:175], v[40:43], v[152:155]
    v_cvt_pk_bf16_f32 v51, v34, v35
    v_mul_f32 v21, s20, v21
    v_mfma_f32_16x16x32_bf16 v[152:155], a[168:171], v[72:75], v[152:155]
    s_add_u32 m0, s27, 3072
    v_exp_f32 v20, v20
    v_mfma_f32_16x16x32_bf16 v[28:31], a[112:115], a[80:83], 0
    ds_read_b128 a[112:115], v1
    v_mul_f32 v22, s20, v22
    v_mfma_f32_16x16x32_bf16 v[28:31], a[116:119], a[84:87], v[28:31]
    ds_read_b128 a[116:119], v2
    v_mul_f32 v23, s20, v23
    v_mfma_f32_16x16x32_bf16 v[28:31], a[120:123], a[88:91], v[28:31]
    buffer_load_dwordx4 v5, s[88:91], 0 offen lds
    v_mul_f32 v24, s20, v24
    v_mfma_f32_16x16x32_bf16 v[28:31], a[124:127], a[92:95], v[28:31]
    s_add_u32 s27, s27, 16384
    ds_read_b128 a[120:123], v1 offset:1024
    v_mul_f32 v25, s20, v25
    v_mfma_f32_16x16x32_bf16 v[32:35], a[140:143], a[92:95], 0
    s_and_b32 s27, s27, 0xffff
    ds_read_b128 a[124:127], v2 offset:1024
    v_mul_f32 v26, s20, v26
    v_mfma_f32_16x16x32_bf16 v[32:35], a[136:139], a[88:91], v[32:35]
    s_mov_b64 s[68:69], s[88:89]
    v_exp_f32 v21, v21
    v_mfma_f32_16x16x32_bf16 v[32:35], a[132:135], a[84:87], v[32:35]
    s_mov_b32 s70, s90
    ds_read_b128 a[140:143], v2 offset:9216
    v_cvt_pk_bf16_f32 v52, v20, v21
    v_mfma_f32_16x16x32_bf16 v[32:35], a[128:131], a[80:83], v[32:35]
    s_add_u32 s88, s88, 8192
    ds_read_b128 a[136:139], v1 offset:9216
    v_mul_f32 v27, s20, v27
    v_mfma_f32_16x16x32_bf16 v[172:175], a[144:147], v[76:79], v[172:175]
    s_addc_u32 s89, s89, 0
    v_exp_f32 v22, v22
    v_mfma_f32_16x16x32_bf16 v[172:175], a[148:151], v[44:47], v[172:175]
    s_mov_b32 s90, s66
    ds_read_b128 a[132:135], v2 offset:8192
    v_mul_f32 v28, s20, v28
    v_mfma_f32_16x16x32_bf16 v[176:179], a[156:159], v[44:47], v[176:179]
    s_add_u32 s64, s64, 8192
    ds_read_b128 a[128:131], v1 offset:8192
    v_mul_f32 v29, s20, v29
    v_mfma_f32_16x16x32_bf16 v[176:179], a[152:155], v[76:79], v[176:179]
    s_addc_u32 s65, s65, 0
    v_exp_f32 v23, v23
    v_mfma_f32_16x16x32_bf16 v[180:183], a[160:163], v[76:79], v[180:183]
    s_add_u32 s23, s23, 1
    v_cvt_pk_bf16_f32 v53, v22, v23
    v_mul_f32 v30, s20, v30
    v_mfma_f32_16x16x32_bf16 v[180:183], a[164:167], v[44:47], v[180:183]
    s_cmp_lt_u32 s23, 64
    v_exp_f32 v24, v24
    v_mfma_f32_16x16x32_bf16 v[184:187], a[172:175], v[44:47], v[184:187]
    s_cselect_b32 s66, 8192, 0
    v_exp_f32 v25, v25
    v_mfma_f32_16x16x32_bf16 v[184:187], a[168:171], v[76:79], v[184:187]
    s_waitcnt lgkmcnt(4)
    v_exp_f32 v26, v26
    v_mfma_f32_16x16x32_bf16 v[20:23], a[112:115], a[0:3], 0
    v_exp_f32 v27, v27
    v_mfma_f32_16x16x32_bf16 v[20:23], a[116:119], a[4:7], v[20:23]
    v_cvt_pk_bf16_f32 v54, v24, v25
    v_cvt_pk_bf16_f32 v55, v26, v27
    v_mfma_f32_16x16x32_bf16 v[20:23], a[120:123], a[8:11], v[20:23]
    v_exp_f32 v28, v28
    v_mfma_f32_16x16x32_bf16 v[20:23], a[124:127], a[12:15], v[20:23]
    s_waitcnt lgkmcnt(0)
    v_exp_f32 v29, v29
    v_mfma_f32_16x16x32_bf16 v[24:27], a[140:143], a[12:15], 0
    v_mul_f32 v31, s20, v31
    v_cvt_pk_bf16_f32 v56, v28, v29
    v_mfma_f32_16x16x32_bf16 v[24:27], a[136:139], a[8:11], v[24:27]
    v_exp_f32 v30, v30
    v_mfma_f32_16x16x32_bf16 v[24:27], a[132:135], a[4:7], v[24:27]
    v_exp_f32 v31, v31
    v_mfma_f32_16x16x32_bf16 v[24:27], a[128:131], a[0:3], v[24:27]
    v_cvt_pk_bf16_f32 v57, v30, v31
    v_mul_f32 v32, s20, v32
    v_mfma_f32_16x16x32_bf16 v[204:207], a[144:147], v[80:83], v[204:207]
    v_mul_f32 v33, s20, v33
    v_mul_f32 v34, s20, v34
    v_mfma_f32_16x16x32_bf16 v[204:207], a[148:151], v[48:51], v[204:207]
    v_exp_f32 v32, v32
    v_mfma_f32_16x16x32_bf16 v[208:211], a[156:159], v[48:51], v[208:211]
    v_exp_f32 v33, v33
    v_mfma_f32_16x16x32_bf16 v[208:211], a[152:155], v[80:83], v[208:211]
    v_mul_f32 v35, s20, v35
    v_cvt_pk_bf16_f32 v58, v32, v33
    v_mfma_f32_16x16x32_bf16 v[212:215], a[160:163], v[80:83], v[212:215]
    v_exp_f32 v34, v34
    v_mfma_f32_16x16x32_bf16 v[212:215], a[164:167], v[48:51], v[212:215]
    v_exp_f32 v35, v35
    v_mfma_f32_16x16x32_bf16 v[216:219], a[172:175], v[48:51], v[216:219]
    v_cvt_pk_bf16_f32 v59, v34, v35
    v_mul_f32 v20, s20, v20
    v_mfma_f32_16x16x32_bf16 v[216:219], a[168:171], v[80:83], v[216:219]
    v_mul_f32 v21, s20, v21
    v_mul_f32 v22, s20, v22
    v_mfma_f32_16x16x32_bf16 v[28:31], a[112:115], a[16:19], 0
    v_exp_f32 v20, v20
    v_mfma_f32_16x16x32_bf16 v[28:31], a[116:119], a[20:23], v[28:31]
    v_exp_f32 v21, v21
    v_mfma_f32_16x16x32_bf16 v[28:31], a[120:123], a[24:27], v[28:31]
    v_mul_f32 v23, s20, v23
    v_cvt_pk_bf16_f32 v68, v20, v21
    v_mfma_f32_16x16x32_bf16 v[28:31], a[124:127], a[28:31], v[28:31]
    v_exp_f32 v22, v22
    v_mfma_f32_16x16x32_bf16 v[32:35], a[140:143], a[28:31], 0
    v_exp_f32 v23, v23
    v_mfma_f32_16x16x32_bf16 v[32:35], a[136:139], a[24:27], v[32:35]
    v_cvt_pk_bf16_f32 v69, v22, v23
    v_mul_f32 v24, s20, v24
    v_mfma_f32_16x16x32_bf16 v[32:35], a[132:135], a[20:23], v[32:35]
    v_mul_f32 v25, s20, v25
    v_mul_f32 v26, s20, v26
    v_mfma_f32_16x16x32_bf16 v[32:35], a[128:131], a[16:19], v[32:35]
    v_exp_f32 v24, v24
    v_mfma_f32_16x16x32_bf16 v[236:239], a[144:147], v[84:87], v[236:239]
    v_exp_f32 v25, v25
    v_mfma_f32_16x16x32_bf16 v[236:239], a[148:151], v[52:55], v[236:239]
    v_mul_f32 v27, s20, v27
    v_cvt_pk_bf16_f32 v70, v24, v25
    v_mfma_f32_16x16x32_bf16 v[240:243], a[156:159], v[52:55], v[240:243]
    v_exp_f32 v26, v26
    v_mfma_f32_16x16x32_bf16 v[240:243], a[152:155], v[84:87], v[240:243]
    v_exp_f32 v27, v27
    v_mfma_f32_16x16x32_bf16 v[244:247], a[160:163], v[84:87], v[244:247]
    v_cvt_pk_bf16_f32 v71, v26, v27
    v_mul_f32 v28, s20, v28
    v_mfma_f32_16x16x32_bf16 v[244:247], a[164:167], v[52:55], v[244:247]
    v_mul_f32 v29, s20, v29
    v_mul_f32 v30, s20, v30
    v_mfma_f32_16x16x32_bf16 v[248:251], a[172:175], v[52:55], v[248:251]
    v_exp_f32 v28, v28
    v_mfma_f32_16x16x32_bf16 v[248:251], a[168:171], v[84:87], v[248:251]
    v_exp_f32 v29, v29
    v_mfma_f32_16x16x32_bf16 v[20:23], a[112:115], a[32:35], 0
    v_mul_f32 v31, s20, v31
    v_cvt_pk_bf16_f32 v72, v28, v29
    v_mfma_f32_16x16x32_bf16 v[20:23], a[116:119], a[36:39], v[20:23]
    v_exp_f32 v30, v30
    v_mfma_f32_16x16x32_bf16 v[20:23], a[120:123], a[40:43], v[20:23]
    v_exp_f32 v31, v31
    v_mfma_f32_16x16x32_bf16 v[20:23], a[124:127], a[44:47], v[20:23]
    v_cvt_pk_bf16_f32 v73, v30, v31
    v_mul_f32 v32, s20, v32
    v_mfma_f32_16x16x32_bf16 v[24:27], a[140:143], a[44:47], 0
    v_mul_f32 v33, s20, v33
    v_mul_f32 v34, s20, v34
    v_mfma_f32_16x16x32_bf16 v[24:27], a[136:139], a[40:43], v[24:27]
    s_waitcnt vmcnt(8) lgkmcnt(0)
    v_exp_f32 v32, v32
    v_mfma_f32_16x16x32_bf16 v[24:27], a[132:135], a[36:39], v[24:27]
    s_barrier
    v_mul_f32 v35, s20, v35
    v_mfma_f32_16x16x32_bf16 v[24:27], a[128:131], a[32:35], v[24:27]
    v_exp_f32 v33, v33
    v_mfma_f32_16x16x32_bf16 a[208:211], a[144:147], v[88:91], a[208:211]
    ds_read_b64_tr_b16 a[144:145], v3 offset:18432
    v_cvt_pk_bf16_f32 v74, v32, v33
    v_mfma_f32_16x16x32_bf16 a[208:211], a[148:151], v[56:59], a[208:211]
    ds_read_b64_tr_b16 a[146:147], v3 offset:26624
    v_mul_f32 v20, s20, v20
    v_mfma_f32_16x16x32_bf16 a[212:215], a[156:159], v[56:59], a[212:215]
    ds_read_b64_tr_b16 a[148:149], v3 offset:19456
    v_mul_f32 v21, s20, v21
    v_mfma_f32_16x16x32_bf16 a[212:215], a[152:155], v[88:91], a[212:215]
    ds_read_b64_tr_b16 a[150:151], v3 offset:27648
    v_mul_f32 v22, s20, v22
    v_mfma_f32_16x16x32_bf16 a[216:219], a[160:163], v[88:91], a[216:219]
    ds_read_b64_tr_b16 a[156:157], v3 offset:19464
    v_mul_f32 v23, s20, v23
    v_mfma_f32_16x16x32_bf16 a[216:219], a[164:167], v[56:59], a[216:219]
    ds_read_b64_tr_b16 a[158:159], v3 offset:27656
    v_mul_f32 v24, s20, v24
    v_mfma_f32_16x16x32_bf16 a[220:223], a[172:175], v[56:59], a[220:223]
    ds_read_b64_tr_b16 a[152:153], v3 offset:18440
    v_mul_f32 v25, s20, v25
    v_mfma_f32_16x16x32_bf16 a[220:223], a[168:171], v[88:91], a[220:223]
    ds_read_b64_tr_b16 a[154:155], v3 offset:26632
    v_mul_f32 v26, s20, v26
    v_mfma_f32_16x16x32_bf16 v[28:31], a[112:115], a[48:51], 0
    ds_read_b64_tr_b16 a[160:161], v4 offset:18432
    v_mul_f32 v27, s20, v27
    v_mfma_f32_16x16x32_bf16 v[28:31], a[116:119], a[52:55], v[28:31]
    ds_read_b64_tr_b16 a[162:163], v4 offset:26624
    ds_read_b64_tr_b16 a[164:165], v4 offset:19456
    v_mfma_f32_16x16x32_bf16 v[28:31], a[120:123], a[56:59], v[28:31]
    v_exp_f32 v34, v34
    v_mfma_f32_16x16x32_bf16 v[28:31], a[124:127], a[60:63], v[28:31]
    ds_read_b64_tr_b16 a[166:167], v4 offset:27648
    ds_read_b64_tr_b16 a[172:173], v4 offset:19464
    v_exp_f32 v35, v35
    s_nop 0
    v_cvt_pk_bf16_f32 v75, v34, v35
    v_mfma_f32_16x16x32_bf16 v[32:35], a[140:143], a[60:63], 0
    v_exp_f32 v20, v20
    v_mfma_f32_16x16x32_bf16 v[32:35], a[136:139], a[56:59], v[32:35]
    ds_read_b64_tr_b16 a[174:175], v4 offset:27656
    v_mul_f32 v28, s20, v28
    v_mfma_f32_16x16x32_bf16 v[32:35], a[132:135], a[52:55], v[32:35]
    ds_read_b64_tr_b16 a[168:169], v4 offset:18440
    v_mul_f32 v29, s20, v29
    v_mfma_f32_16x16x32_bf16 v[32:35], a[128:131], a[48:51], v[32:35]
    s_waitcnt lgkmcnt(7)
    ds_read_b64_tr_b16 a[170:171], v4 offset:26632
    v_mul_f32 v30, s20, v30
    v_mfma_f32_16x16x32_bf16 v[92:95], a[144:147], v[36:39], v[92:95]
    v_xor_b32 v3, 0x8000, v3
    v_xor_b32 v4, 0x8000, v4
    v_mfma_f32_16x16x32_bf16 v[92:95], a[148:151], v[68:71], v[92:95]
    v_exp_f32 v21, v21
    v_mfma_f32_16x16x32_bf16 v[96:99], a[156:159], v[68:71], v[96:99]
    s_add_u32 m0, s27, 0
    v_exp_f32 v22, v22
    v_mfma_f32_16x16x32_bf16 v[96:99], a[152:155], v[36:39], v[96:99]
    s_waitcnt lgkmcnt(0)
    v_exp_f32 v23, v23
    v_mfma_f32_16x16x32_bf16 v[100:103], a[160:163], v[36:39], v[100:103]
    v_cvt_pk_bf16_f32 v76, v20, v21
    v_cvt_pk_bf16_f32 v77, v22, v23
    v_mfma_f32_16x16x32_bf16 v[100:103], a[164:167], v[68:71], v[100:103]
    buffer_load_dwordx4 v5, s[64:67], 0 offen lds
    v_mul_f32 v31, s20, v31
    v_mfma_f32_16x16x32_bf16 v[104:107], a[172:175], v[68:71], v[104:107]
    v_exp_f32 v24, v24
    v_mfma_f32_16x16x32_bf16 v[104:107], a[168:171], v[36:39], v[104:107]
    v_exp_f32 v25, v25
    v_mfma_f32_16x16x32_bf16 v[20:23], a[112:115], a[64:67], 0
    v_exp_f32 v26, v26
    v_mfma_f32_16x16x32_bf16 v[20:23], a[116:119], a[68:71], v[20:23]
    s_add_u32 m0, s27, 896
    v_exp_f32 v27, v27
    v_mfma_f32_16x16x32_bf16 v[20:23], a[120:123], a[72:75], v[20:23]
    v_cvt_pk_bf16_f32 v78, v24, v25
    v_cvt_pk_bf16_f32 v79, v26, v27
    v_mfma_f32_16x16x32_bf16 v[20:23], a[124:127], a[76:79], v[20:23]
    v_exp_f32 v28, v28
    v_mfma_f32_16x16x32_bf16 v[24:27], a[140:143], a[76:79], 0
    buffer_load_dwordx4 v5, s[64:67], 0 offen offset:128 lds
    v_mul_f32 v32, s20, v32
    v_mfma_f32_16x16x32_bf16 v[24:27], a[136:139], a[72:75], v[24:27]
    v_exp_f32 v29, v29
    v_mfma_f32_16x16x32_bf16 v[24:27], a[132:135], a[68:71], v[24:27]
    v_exp_f32 v30, v30
    v_mfma_f32_16x16x32_bf16 v[24:27], a[128:131], a[64:67], v[24:27]
    v_exp_f32 v31, v31
    v_mfma_f32_16x16x32_bf16 v[124:127], a[144:147], v[40:43], v[124:127]
    s_add_u32 m0, s27, 1920
    v_cvt_pk_bf16_f32 v80, v28, v29
    v_cvt_pk_bf16_f32 v81, v30, v31
    v_mfma_f32_16x16x32_bf16 v[124:127], a[148:151], v[72:75], v[124:127]
    v_mul_f32 v33, s20, v33
    v_mul_f32 v34, s20, v34
    v_mfma_f32_16x16x32_bf16 v[128:131], a[156:159], v[72:75], v[128:131]
    v_exp_f32 v32, v32
    v_mfma_f32_16x16x32_bf16 v[128:131], a[152:155], v[40:43], v[128:131]
    buffer_load_dwordx4 v5, s[68:71], 0 offen offset:128 lds
    v_mul_f32 v35, s20, v35
    v_mfma_f32_16x16x32_bf16 v[132:135], a[160:163], v[40:43], v[132:135]
    v_exp_f32 v33, v33
    v_mfma_f32_16x16x32_bf16 v[132:135], a[164:167], v[72:75], v[132:135]
    v_exp_f32 v34, v34
    v_mfma_f32_16x16x32_bf16 v[136:139], a[172:175], v[72:75], v[136:139]
    v_exp_f32 v35, v35
    v_mfma_f32_16x16x32_bf16 v[136:139], a[168:171], v[40:43], v[136:139]
    s_add_u32 m0, s27, 2944
    v_cvt_pk_bf16_f32 v82, v32, v33
    v_cvt_pk_bf16_f32 v83, v34, v35
    v_smfmac_f32_16x16x64_bf16 a[176:179], v[16:19], v[36:43], v252
    v_mul_f32 v20, s20, v20
    v_smfmac_f32_16x16x64_bf16 a[176:179], v[16:19], v[68:75], v252
    v_mul_f32 v21, s20, v21
    v_mfma_f32_16x16x32_bf16 v[28:31], a[112:115], a[80:83], 0
    buffer_load_dwordx4 v5, s[88:91], 0 offen offset:128 lds
    v_mul_f32 v22, s20, v22
    v_mfma_f32_16x16x32_bf16 v[28:31], a[116:119], a[84:87], v[28:31]
    s_add_u32 s27, s27, 16384
    ds_read_b128 a[112:115], v1 offset:16384
    v_mul_f32 v23, s20, v23
    v_mfma_f32_16x16x32_bf16 v[28:31], a[120:123], a[88:91], v[28:31]
    s_and_b32 s27, s27, 0xffff
    ds_read_b128 a[116:119], v2 offset:16384
    v_mul_f32 v24, s20, v24
    v_mfma_f32_16x16x32_bf16 v[28:31], a[124:127], a[92:95], v[28:31]
    s_mov_b64 s[68:69], s[88:89]
    ds_read_b128 a[120:123], v1 offset:17408
    v_mul_f32 v25, s20, v25
    v_mfma_f32_16x16x32_bf16 v[32:35], a[140:143], a[92:95], 0
    s_mov_b32 s70, s90
    ds_read_b128 a[124:127], v2 offset:17408
    v_mul_f32 v26, s20, v26
    v_mfma_f32_16x16x32_bf16 v[32:35], a[136:139], a[88:91], v[32:35]
    s_add_u32 s88, s88, 8192
    v_exp_f32 v20, v20
    v_mfma_f32_16x16x32_bf16 v[32:35], a[132:135], a[84:87], v[32:35]
    s_addc_u32 s89, s89, 0
    ds_read_b128 a[140:143], v2 offset:25600
    v_mul_f32 v27, s20, v27
    v_mfma_f32_16x16x32_bf16 v[32:35], a[128:131], a[80:83], v[32:35]
    s_mov_b32 s90, s66
    ds_read_b128 a[136:139], v1 offset:25600
    v_mul_f32 v28, s20, v28
    v_exp_f32 v21, v21
    v_mfma_f32_16x16x32_bf16 v[156:159], a[144:147], v[44:47], v[156:159]
    s_add_u32 s64, s64, 8192
    v_exp_f32 v22, v22
    v_mfma_f32_16x16x32_bf16 v[156:159], a[148:151], v[76:79], v[156:159]
    s_addc_u32 s65, s65, 0
    ds_read_b128 a[132:135], v2 offset:24576
    v_xor_b32 v2, 0x8000, v2
    v_mfma_f32_16x16x32_bf16 v[160:163], a[156:159], v[76:79], v[160:163]
    s_add_u32 s23, s23, 1
    ds_read_b128 a[128:131], v1 offset:24576
    v_xor_b32 v1, 0x8000, v1
    v_mfma_f32_16x16x32_bf16 v[160:163], a[152:155], v[44:47], v[160:163]
    s_cmp_lt_u32 s23, 64
    v_exp_f32 v23, v23
    v_mfma_f32_16x16x32_bf16 v[164:167], a[160:163], v[44:47], v[164:167]
    s_cselect_b32 s66, 8192, 0
    v_cvt_pk_bf16_f32 v84, v20, v21
    v_cvt_pk_bf16_f32 v85, v22, v23
    v_mfma_f32_16x16x32_bf16 v[164:167], a[164:167], v[76:79], v[164:167]
    s_mov_b32 m0, s31
    v_exp_f32 v24, v24
    v_mfma_f32_16x16x32_bf16 v[168:171], a[172:175], v[76:79], v[168:171]
    buffer_load_dwordx4 v6, s[72:75], 0 offen nt lds
    v_mul_f32 v29, s20, v29
    v_mfma_f32_16x16x32_bf16 v[168:171], a[168:171], v[44:47], v[168:171]
    s_waitcnt lgkmcnt(4)
    v_exp_f32 v25, v25
    v_mfma_f32_16x16x32_bf16 v[20:23], a[112:115], a[0:3], 0
    s_add_u32 s72, s72, s29
    v_exp_f32 v26, v26
    v_mfma_f32_16x16x32_bf16 v[20:23], a[116:119], a[4:7], v[20:23]
    s_addc_u32 s73, s73, 0
    v_exp_f32 v27, v27
    v_mfma_f32_16x16x32_bf16 v[20:23], a[120:123], a[8:11], v[20:23]
    s_xor_b32 s29, s29, 0x700
    v_cvt_pk_bf16_f32 v86, v24, v25
    v_cvt_pk_bf16_f32 v87, v26, v27
    v_mfma_f32_16x16x32_bf16 v[20:23], a[124:127], a[12:15], v[20:23]
    s_waitcnt lgkmcnt(0)
    v_exp_f32 v28, v28
    v_mfma_f32_16x16x32_bf16 v[24:27], a[140:143], a[12:15], 0
    s_add_u32 s31, s31, 1024
    v_exp_f32 v29, v29
    v_mfma_f32_16x16x32_bf16 v[24:27], a[136:139], a[8:11], v[24:27]
    s_mov_b32 m0, s31
    v_mul_f32 v30, s20, v30
    v_mul_f32 v31, s20, v31
    v_mfma_f32_16x16x32_bf16 v[24:27], a[132:135], a[4:7], v[24:27]
    buffer_load_dwordx4 v6, s[72:75], 0 offen nt lds
    v_cvt_pk_bf16_f32 v88, v28, v29
    v_mfma_f32_16x16x32_bf16 v[24:27], a[128:131], a[0:3], v[24:27]
    s_add_u32 s72, s72, s29
    v_exp_f32 v30, v30
    v_exp_f32 v31, v31
    v_mfma_f32_16x16x32_bf16 v[188:191], a[144:147], v[48:51], v[188:191]
    s_addc_u32 s73, s73, 0
    v_cvt_pk_bf16_f32 v89, v30, v31
    v_mul_f32 v32, s20, v32
    v_mfma_f32_16x16x32_bf16 v[188:191], a[148:151], v[80:83], v[188:191]
    s_xor_b32 s29, s29, 0x700
    v_mul_f32 v33, s20, v33
    v_mul_f32 v34, s20, v34
    v_mfma_f32_16x16x32_bf16 v[192:195], a[156:159], v[80:83], v[192:195]
    s_add_u32 s31, s31, 1024
    v_exp_f32 v32, v32
    v_mfma_f32_16x16x32_bf16 v[192:195], a[152:155], v[48:51], v[192:195]
    s_mov_b32 m0, s31
    v_exp_f32 v33, v33
    v_mfma_f32_16x16x32_bf16 v[196:199], a[160:163], v[48:51], v[196:199]
    buffer_load_dwordx4 v6, s[72:75], 0 offen nt lds
    v_mul_f32 v35, s20, v35
    v_mfma_f32_16x16x32_bf16 v[196:199], a[164:167], v[80:83], v[196:199]
    s_add_u32 s72, s72, s29
    v_exp_f32 v34, v34
    v_mfma_f32_16x16x32_bf16 v[200:203], a[172:175], v[80:83], v[200:203]
    s_addc_u32 s73, s73, 0
    v_exp_f32 v35, v35
    v_mfma_f32_16x16x32_bf16 v[200:203], a[168:171], v[48:51], v[200:203]
    s_xor_b32 s29, s29, 0x700
    v_cvt_pk_bf16_f32 v90, v32, v33
    v_cvt_pk_bf16_f32 v91, v34, v35
    v_smfmac_f32_16x16x64_bf16 a[180:183], v[16:19], v[44:51], v252
    s_add_u32 s31, s31, 1024
    v_mul_f32 v20, s20, v20
    v_smfmac_f32_16x16x64_bf16 a[180:183], v[16:19], v[76:83], v252
    s_mov_b32 m0, s31
    v_mul_f32 v21, s20, v21
    v_mfma_f32_16x16x32_bf16 v[28:31], a[112:115], a[16:19], 0
    v_exp_f32 v20, v20
    v_mfma_f32_16x16x32_bf16 v[28:31], a[116:119], a[20:23], v[28:31]
    buffer_load_dwordx4 v6, s[72:75], 0 offen nt lds
    v_mul_f32 v22, s20, v22
    v_mfma_f32_16x16x32_bf16 v[28:31], a[120:123], a[24:27], v[28:31]
    s_add_u32 s72, s72, s29
    v_exp_f32 v21, v21
    v_mfma_f32_16x16x32_bf16 v[28:31], a[124:127], a[28:31], v[28:31]
    s_addc_u32 s73, s73, 0
    v_mul_f32 v23, s20, v23
    v_cvt_pk_bf16_f32 v36, v20, v21
    v_mfma_f32_16x16x32_bf16 v[32:35], a[140:143], a[28:31], 0
    s_xor_b32 s29, s29, 0x700
    v_exp_f32 v22, v22
    v_mfma_f32_16x16x32_bf16 v[32:35], a[136:139], a[24:27], v[32:35]
    s_add_u32 s31, s31, 1024
    v_exp_f32 v23, v23
    v_mfma_f32_16x16x32_bf16 v[32:35], a[132:135], a[20:23], v[32:35]
    v_cvt_pk_bf16_f32 v37, v22, v23
    v_mul_f32 v24, s20, v24
    v_mfma_f32_16x16x32_bf16 v[32:35], a[128:131], a[16:19], v[32:35]
    v_mul_f32 v25, s20, v25
    v_mul_f32 v26, s20, v26
    v_mfma_f32_16x16x32_bf16 v[220:223], a[144:147], v[52:55], v[220:223]
    v_exp_f32 v24, v24
    v_mfma_f32_16x16x32_bf16 v[220:223], a[148:151], v[84:87], v[220:223]
    v_exp_f32 v25, v25
    v_mfma_f32_16x16x32_bf16 v[224:227], a[156:159], v[84:87], v[224:227]
    v_mul_f32 v27, s20, v27
    v_cvt_pk_bf16_f32 v38, v24, v25
    v_mfma_f32_16x16x32_bf16 v[224:227], a[152:155], v[52:55], v[224:227]
    v_exp_f32 v26, v26
    v_mfma_f32_16x16x32_bf16 v[228:231], a[160:163], v[52:55], v[228:231]
    v_exp_f32 v27, v27
    v_mfma_f32_16x16x32_bf16 v[228:231], a[164:167], v[84:87], v[228:231]
    v_cvt_pk_bf16_f32 v39, v26, v27
    v_mul_f32 v28, s20, v28
    v_mfma_f32_16x16x32_bf16 v[232:235], a[172:175], v[84:87], v[232:235]
    v_mul_f32 v29, s20, v29
    v_mul_f32 v30, s20, v30
    v_mfma_f32_16x16x32_bf16 v[232:235], a[168:171], v[52:55], v[232:235]
    v_exp_f32 v28, v28
    v_mfma_f32_16x16x32_bf16 v[20:23], a[112:115], a[32:35], 0
    v_exp_f32 v29, v29
    v_mfma_f32_16x16x32_bf16 v[20:23], a[116:119], a[36:39], v[20:23]
    v_mul_f32 v31, s20, v31
    v_cvt_pk_bf16_f32 v40, v28, v29
    v_mfma_f32_16x16x32_bf16 v[20:23], a[120:123], a[40:43], v[20:23]
    v_exp_f32 v30, v30
    v_mfma_f32_16x16x32_bf16 v[20:23], a[124:127], a[44:47], v[20:23]
    v_exp_f32 v31, v31
    v_mfma_f32_16x16x32_bf16 v[24:27], a[140:143], a[44:47], 0
    v_cvt_pk_bf16_f32 v41, v30, v31
    v_mul_f32 v32, s20, v32
    v_mfma_f32_16x16x32_bf16 v[24:27], a[136:139], a[40:43], v[24:27]
    s_waitcnt vmcnt(12) lgkmcnt(0)
    v_mul_f32 v33, s20, v33
    v_mul_f32 v34, s20, v34
    v_mfma_f32_16x16x32_bf16 v[24:27], a[132:135], a[36:39], v[24:27]
    s_barrier
    v_mul_f32 v35, s20, v35
    v_mfma_f32_16x16x32_bf16 v[24:27], a[128:131], a[32:35], v[24:27]
    v_exp_f32 v32, v32
    v_mfma_f32_16x16x32_bf16 a[192:195], a[144:147], v[56:59], a[192:195]
    ds_read_b64_tr_b16 a[144:145], v3 offset:2048
    v_mul_f32 v20, s20, v20
    v_mfma_f32_16x16x32_bf16 a[192:195], a[148:151], v[88:91], a[192:195]
    ds_read_b64_tr_b16 a[146:147], v3 offset:10240
    v_mul_f32 v21, s20, v21
    v_mfma_f32_16x16x32_bf16 a[196:199], a[156:159], v[88:91], a[196:199]
    ds_read_b64_tr_b16 a[148:149], v3 offset:3072
    v_mul_f32 v22, s20, v22
    v_mfma_f32_16x16x32_bf16 a[196:199], a[152:155], v[56:59], a[196:199]
    ds_read_b64_tr_b16 a[150:151], v3 offset:11264
    v_mul_f32 v23, s20, v23
    v_mfma_f32_16x16x32_bf16 a[200:203], a[160:163], v[56:59], a[200:203]
    ds_read_b64_tr_b16 a[156:157], v3 offset:3080
    v_mul_f32 v24, s20, v24
    v_mfma_f32_16x16x32_bf16 a[200:203], a[164:167], v[88:91], a[200:203]
    ds_read_b64_tr_b16 a[158:159], v3 offset:11272
    v_mul_f32 v25, s20, v25
    v_mfma_f32_16x16x32_bf16 a[204:207], a[172:175], v[88:91], a[204:207]
    ds_read_b64_tr_b16 a[152:153], v3 offset:2056
    v_mul_f32 v26, s20, v26
    v_mfma_f32_16x16x32_bf16 a[204:207], a[168:171], v[56:59], a[204:207]
    ds_read_b64_tr_b16 a[154:155], v3 offset:10248
    v_mul_f32 v27, s20, v27
    v_smfmac_f32_16x16x64_bf16 a[184:187], v[16:19], v[52:59], v252
    ds_read_b64_tr_b16 a[160:161], v4 offset:2048
    v_smfmac_f32_16x16x64_bf16 a[184:187], v[16:19], v[84:91], v252
    ds_read_b64_tr_b16 a[162:163], v4 offset:10240
    v_mfma_f32_16x16x32_bf16 v[28:31], a[112:115], a[48:51], 0
    ds_read_b64_tr_b16 a[164:165], v4 offset:3072
    ds_read_b64_tr_b16 a[166:167], v4 offset:11264
    v_mfma_f32_16x16x32_bf16 v[28:31], a[116:119], a[52:55], v[28:31]
    v_exp_f32 v33, v33
    v_mfma_f32_16x16x32_bf16 v[28:31], a[120:123], a[56:59], v[28:31]
    ds_read_b64_tr_b16 a[172:173], v4 offset:3080
    v_cvt_pk_bf16_f32 v42, v32, v33
    v_mfma_f32_16x16x32_bf16 v[28:31], a[124:127], a[60:63], v[28:31]
    s_sub_u32 s32, s32, 1
    ds_read_b64_tr_b16 a[174:175], v4 offset:11272
    ds_read_b64_tr_b16 a[168:169], v4 offset:2056
    v_exp_f32 v34, v34
    v_exp_f32 v35, v35
    s_nop 0
    v_cvt_pk_bf16_f32 v43, v34, v35
    v_mfma_f32_16x16x32_bf16 v[32:35], a[140:143], a[60:63], 0
    v_exp_f32 v20, v20
    v_mfma_f32_16x16x32_bf16 v[32:35], a[136:139], a[56:59], v[32:35]
    ds_read_b64_tr_b16 a[170:171], v4 offset:10248
    v_mul_f32 v28, s20, v28
    v_mfma_f32_16x16x32_bf16 v[32:35], a[132:135], a[52:55], v[32:35]
    v_exp_f32 v21, v21
    v_mfma_f32_16x16x32_bf16 v[32:35], a[128:131], a[48:51], v[32:35]
    s_cbranch_scc0 L_bodyq6
    s_xor_b32 s28, s28, 1
    s_cbranch_scc0 L_tail6
    v_min_u32 v254, L_end_code-L_job7, v253
    v_mov_b32 v255, 0
    v_lshl_add_u64 v[254:255], v[254:255], 0, s[52:53]
    global_load_dword v0, v[254:255], off
    s_mov_b32 s32, 0
    s_branch L_bodyq6
L_job7:
    v_mfma_f32_16x16x32_bf16 v[20:23], a[112:115], a[0:3], 0
    ds_write_b128 v8, v[108:111] offset:1024
    v_mfma_f32_16x16x32_bf16 v[20:23], a[116:119], a[4:7], v[20:23]
    v_cvt_pk_bf16_f32 v220, v220, v221
    v_cvt_pk_bf16_f32 v221, v222, v223
    v_mfma_f32_16x16x32_bf16 v[20:23], a[120:123], a[8:11], v[20:23]
    v_cvt_pk_bf16_f32 v222, v224, v225
    v_cvt_pk_bf16_f32 v223, v226, v227
    v_mfma_f32_16x16x32_bf16 v[20:23], a[124:127], a[12:15], v[20:23]
    ds_write_b128 v9, v[116:119] offset:1024
    v_mfma_f32_16x16x32_bf16 v[24:27], a[140:143], a[12:15], 0
    v_cvt_pk_bf16_f32 v228, v228, v229
    v_cvt_pk_bf16_f32 v229, v230, v231
    v_mfma_f32_16x16x32_bf16 v[24:27], a[136:139], a[8:11], v[24:27]
    v_cvt_pk_bf16_f32 v230, v232, v233
    v_cvt_pk_bf16_f32 v231, v234, v235
    v_mfma_f32_16x16x32_bf16 v[24:27], a[132:135], a[4:7], v[24:27]
    ds_write_b128 v8, v[160:163] offset:20480
    v_mfma_f32_16x16x32_bf16 v[24:27], a[128:131], a[0:3], v[24:27]
    v_mul_f32 v20, s20, v20
    v_mul_f32 v21, s20, v21
    v_mfma_f32_16x16x32_bf16 v[28:31], a[112:115], a[16:19], 0
    v_exp_f32 v20, v20
    v_mfma_f32_16x16x32_bf16 v[28:31], a[116:119], a[20:23], v[28:31]
    ds_write_b128 v9, v[168:171] offset:20480
    v_mfma_f32_16x16x32_bf16 v[28:31], a[120:123], a[24:27], v[28:31]
    v_exp_f32 v21, v21
    v_mfma_f32_16x16x32_bf16 v[28:31], a[124:127], a[28:31], v[28:31]
    ds_read_b128 v[160:163], v7 offset:20480
    v_mul_f32 v22, s20, v22
    v_mul_f32 v23, s20, v23
    v_exp_f32 v22, v22
    v_exp_f32 v23, v23
    v_mfma_f32_16x16x32_bf16 v[32:35], a[140:143], a[28:31], 0
    ds_read_b128 v[168:171], v7 offset:22528
    v_cvt_pk_bf16_f32 v36, v20, v21
    v_mfma_f32_16x16x32_bf16 v[32:35], a[136:139], a[24:27], v[32:35]
    ds_write_b128 v8, v[140:143] offset:5120
    v_mfma_f32_16x16x32_bf16 v[32:35], a[132:135], a[20:23], v[32:35]
    v_cvt_pk_bf16_f32 v37, v22, v23
    v_mul_f32 v24, s20, v24
    v_mfma_f32_16x16x32_bf16 v[32:35], a[128:131], a[16:19], v[32:35]
    v_mul_f32 v25, s20, v25
    v_mul_f32 v26, s20, v26
    v_exp_f32 v24, v24
    v_exp_f32 v25, v25
    v_mul_f32 v27, s20, v27
    v_exp_f32 v26, v26
    v_exp_f32 v27, v27
    v_mfma_f32_16x16x32_bf16 v[20:23], a[112:115], a[32:35], 0
    ds_write_b128 v9, v[148:151] offset:5120
    v_mfma_f32_16x16x32_bf16 v[20:23], a[116:119], a[36:39], v[20:23]
    s_waitcnt lgkmcnt(3)
    buffer_store_dwordx4 v[160:163], v6, s[16:19], s40 offen nt
    v_cvt_pk_bf16_f32 v38, v24, v25
    v_cvt_pk_bf16_f32 v39, v26, v27
    v_mul_f32 v28, s20, v28
    v_mul_f32 v29, s20, v29
    v_mfma_f32_16x16x32_bf16 v[20:23], a[120:123], a[40:43], v[20:23]
    v_exp_f32 v28, v28
    v_mfma_f32_16x16x32_bf16 v[20:23], a[124:127], a[44:47], v[20:23]
    ds_write_b128 v8, v[192:195] offset:21504
    v_mfma_f32_16x16x32_bf16 v[24:27], a[140:143], a[44:47], 0
    s_waitcnt lgkmcnt(3)
    buffer_store_dwordx4 v[168:171], v6, s[16:19], s40 offen offset:2048 nt
    v_exp_f32 v29, v29
    v_mul_f32 v30, s20, v30
    v_mul_f32 v31, s20, v31
    v_exp_f32 v30, v30
    v_exp_f32 v31, v31
    v_mfma_f32_16x16x32_bf16 v[24:27], a[136:139], a[40:43], v[24:27]
    v_cvt_pk_bf16_f32 v40, v28, v29
    v_cvt_pk_bf16_f32 v41, v30, v31
    v_mfma_f32_16x16x32_bf16 v[24:27], a[132:135], a[36:39], v[24:27]
    ds_write_b128 v9, v[200:203] offset:21504
    v_mfma_f32_16x16x32_bf16 v[24:27], a[128:131], a[32:35], v[24:27]
    v_mul_f32 v32, s20, v32
    v_mul_f32 v33, s20, v33
    v_exp_f32 v32, v32
    v_exp_f32 v33, v33
    v_mul_f32 v34, s20, v34
    v_mul_f32 v35, s20, v35
    v_exp_f32 v34, v34
    v_exp_f32 v35, v35
    v_mfma_f32_16x16x32_bf16 v[28:31], a[112:115], a[48:51], 0
    ds_read_b128 v[192:195], v7 offset:21504
    v_cvt_pk_bf16_f32 v42, v32, v33
    v_mfma_f32_16x16x32_bf16 v[28:31], a[116:119], a[52:55], v[28:31]
    ds_read_b128 v[200:203], v7 offset:23552
    v_cvt_pk_bf16_f32 v43, v34, v35
    v_mfma_f32_16x16x32_bf16 v[28:31], a[120:123], a[56:59], v[28:31]
    ds_write_b128 v8, v[92:95]
    v_mfma_f32_16x16x32_bf16 v[28:31], a[124:127], a[60:63], v[28:31]
    v_mul_f32 v20, s20, v20
    v_mul_f32 v21, s20, v21
    v_exp_f32 v20, v20
    v_exp_f32 v21, v21
    v_mul_f32 v22, s20, v22
    v_mul_f32 v23, s20, v23
    v_exp_f32 v22, v22
    v_exp_f32 v23, v23
    v_mfma_f32_16x16x32_bf16 v[32:35], a[140:143], a[60:63], 0
    v_cvt_pk_bf16_f32 v44, v20, v21
    v_cvt_pk_bf16_f32 v45, v22, v23
    v_mfma_f32_16x16x32_bf16 v[32:35], a[136:139], a[56:59], v[32:35]
    ds_write_b128 v9, v[100:103]
    v_mfma_f32_16x16x32_bf16 v[32:35], a[132:135], a[52:55], v[32:35]
    s_waitcnt lgkmcnt(3)
    buffer_store_dwordx4 v[192:195], v6, s[16:19], s40 offen offset:128 nt
    v_mul_f32 v24, s20, v24
    v_mul_f32 v25, s20, v25
    v_exp_f32 v24, v24
    v_mfma_f32_16x16x32_bf16 v[32:35], a[128:131], a[48:51], v[32:35]
    v_exp_f32 v25, v25
    v_mul_f32 v26, s20, v26
    v_mul_f32 v27, s20, v27
    v_exp_f32 v26, v26
    v_exp_f32 v27, v27
    v_mfma_f32_16x16x32_bf16 v[20:23], a[112:115], a[64:67], 0
    ds_write_b128 v8, v[172:175] offset:9216
    v_mfma_f32_16x16x32_bf16 v[20:23], a[116:119], a[68:71], v[20:23]
    s_waitcnt lgkmcnt(3)
    buffer_store_dwordx4 v[200:203], v6, s[16:19], s40 offen offset:2176 nt
    v_cvt_pk_bf16_f32 v46, v24, v25
    v_cvt_pk_bf16_f32 v47, v26, v27
    v_mul_f32 v28, s20, v28
    v_mul_f32 v29, s20, v29
    v_mfma_f32_16x16x32_bf16 v[20:23], a[120:123], a[72:75], v[20:23]
    v_exp_f32 v28, v28
    v_mfma_f32_16x16x32_bf16 v[20:23], a[124:127], a[76:79], v[20:23]
    ds_write_b128 v9, v[180:183] offset:9216
    v_mfma_f32_16x16x32_bf16 v[24:27], a[140:143], a[76:79], 0
    v_exp_f32 v29, v29
    v_mul_f32 v30, s20, v30
    v_mul_f32 v31, s20, v31
    v_exp_f32 v30, v30
    v_exp_f32 v31, v31
    v_mfma_f32_16x16x32_bf16 v[24:27], a[136:139], a[72:75], v[24:27]
    v_cvt_pk_bf16_f32 v48, v28, v29
    v_cvt_pk_bf16_f32 v49, v30, v31
    v_mfma_f32_16x16x32_bf16 v[24:27], a[132:135], a[68:71], v[24:27]
    v_mul_f32 v32, s20, v32
    v_mul_f32 v33, s20, v33
    v_mfma_f32_16x16x32_bf16 v[24:27], a[128:131], a[64:67], v[24:27]
    v_exp_f32 v32, v32
    v_exp_f32 v33, v33
    v_mul_f32 v34, s20, v34
    v_mul_f32 v35, s20, v35
    v_exp_f32 v34, v34
    v_exp_f32 v35, v35
    v_mfma_f32_16x16x32_bf16 v[108:111], a[148:151], v[36:39], 0
    s_waitcnt vmcnt(5)
    v_cvt_pk_bf16_f32 v50, v32, v33
    v_cvt_pk_bf16_f32 v51, v34, v35
    v_mfma_f32_16x16x32_bf16 v[112:115], a[156:159], v[36:39], 0
    ds_read_b128 a[96:99], v10
    v_mul_f32 v20, s20, v20
    v_mfma_f32_16x16x32_bf16 v[116:119], a[164:167], v[36:39], 0
    ds_read_b128 a[100:103], v11
    ds_read_b128 a[104:107], v10 offset:1024
    v_mfma_f32_16x16x32_bf16 v[120:123], a[172:175], v[36:39], 0
    v_mul_f32 v21, s20, v21
    v_mul_f32 v22, s20, v22
    v_mfma_f32_16x16x32_bf16 v[28:31], a[112:115], a[80:83], 0
    ds_read_b128 a[108:111], v11 offset:1024
    v_mul_f32 v23, s20, v23
    v_mfma_f32_16x16x32_bf16 v[28:31], a[116:119], a[84:87], v[28:31]
    v_exp_f32 v20, v20
    v_mfma_f32_16x16x32_bf16 v[28:31], a[120:123], a[88:91], v[28:31]
    ds_write_b128 v8, v[204:207] offset:13312
    v_mfma_f32_16x16x32_bf16 v[28:31], a[124:127], a[92:95], v[28:31]
    s_add_u32 m0, s27, 0
    v_exp_f32 v21, v21
    v_exp_f32 v22, v22
    v_exp_f32 v23, v23
    v_mfma_f32_16x16x32_bf16 v[32:35], a[140:143], a[92:95], 0
    v_cvt_pk_bf16_f32 v52, v20, v21
    v_cvt_pk_bf16_f32 v53, v22, v23
    v_mfma_f32_16x16x32_bf16 v[32:35], a[136:139], a[88:91], v[32:35]
    v_mul_f32 v24, s20, v24
    v_mul_f32 v25, s20, v25
    v_mfma_f32_16x16x32_bf16 v[32:35], a[132:135], a[84:87], v[32:35]
    s_waitcnt lgkmcnt(1)
    buffer_load_dwordx4 v5, s[64:67], 0 offen lds
    v_mul_f32 v26, s20, v26
    v_mfma_f32_16x16x32_bf16 v[32:35], a[128:131], a[80:83], v[32:35]
    s_add_u32 m0, s27, 896
    ds_write_b128 v9, v[212:215] offset:13312
    v_mfma_f32_16x16x32_bf16 v[140:143], a[148:151], v[40:43], 0
    v_exp_f32 v24, v24
    v_exp_f32 v25, v25
    v_mul_f32 v27, s20, v27
    v_exp_f32 v26, v26
    v_exp_f32 v27, v27
    v_mfma_f32_16x16x32_bf16 v[144:147], a[156:159], v[40:43], 0
    v_cvt_pk_bf16_f32 v54, v24, v25
    v_cvt_pk_bf16_f32 v55, v26, v27
    v_mfma_f32_16x16x32_bf16 v[148:151], a[164:167], v[40:43], 0
    buffer_load_dwordx4 v5, s[64:67], 0 offen offset:128 lds
    v_mul_f32 v28, s20, v28
    v_mfma_f32_16x16x32_bf16 v[152:155], a[172:175], v[40:43], 0
    s_add_u32 m0, s27, 2048
    ds_write_b128 v8, v[236:239] offset:17408
    v_mfma_f32_16x16x32_bf16 v[20:23], a[112:115], a[96:99], 0
    v_mul_f32 v29, s20, v29
    v_mul_f32 v30, s20, v30
    v_mfma_f32_16x16x32_bf16 v[20:23], a[116:119], a[100:103], v[20:23]
    ds_read_b128 a[112:115], v1
    ds_read_b128 a[116:119], v2
    v_mfma_f32_16x16x32_bf16 v[20:23], a[120:123], a[104:107], v[20:23]
    buffer_load_dwordx4 v5, s[68:71], 0 offen lds
    v_mul_f32 v31, s20, v31
    v_mfma_f32_16x16x32_bf16 v[20:23], a[124:127], a[108:111], v[20:23]
    s_add_u32 m0, s27, 3072
    ds_write_b128 v9, v[244:247] offset:17408
    v_mfma_f32_16x16x32_bf16 v[24:27], a[140:143], a[108:111], 0
    v_exp_f32 v28, v28
    v_exp_f32 v29, v29
    v_exp_f32 v30, v30
    v_exp_f32 v31, v31
    v_mfma_f32_16x16x32_bf16 v[24:27], a[136:139], a[104:107], v[24:27]
    ds_read_b128 a[120:123], v1 offset:1024
    v_cvt_pk_bf16_f32 v56, v28, v29
    v_mfma_f32_16x16x32_bf16 v[24:27], a[132:135], a[100:103], v[24:27]
    ds_read_b128 a[124:127], v2 offset:1024
    v_cvt_pk_bf16_f32 v57, v30, v31
    v_mfma_f32_16x16x32_bf16 v[24:27], a[128:131], a[96:99], v[24:27]
    buffer_load_dwordx4 v5, s[88:91], 0 offen lds
    v_mul_f32 v32, s20, v32
    v_mul_f32 v33, s20, v33
    v_exp_f32 v32, v32
    v_exp_f32 v33, v33
    v_mul_f32 v34, s20, v34
    v_mul_f32 v35, s20, v35
    v_exp_f32 v34, v34
    v_exp_f32 v35, v35
    v_mfma_f32_16x16x32_bf16 v[172:175], a[148:151], v[44:47], 0
    s_add_u32 s27, s27, 16384
    ds_read_b128 a[140:143], v2 offset:9216
    v_cvt_pk_bf16_f32 v58, v32, v33
    v_mfma_f32_16x16x32_bf16 v[176:179], a[156:159], v[44:47], 0
    s_and_b32 s27, s27, 0xffff
    ds_write_b128 v8, v[124:127] offset:4096
    v_mfma_f32_16x16x32_bf16 v[180:183], a[164:167], v[44:47], 0
    s_mov_b64 s[68:69], s[88:89]
    v_cvt_pk_bf16_f32 v59, v34, v35
    v_mul_f32 v20, s20, v20
    v_mfma_f32_16x16x32_bf16 v[184:187], a[172:175], v[44:47], 0
    s_waitcnt lgkmcnt(2)
    ds_read_b128 a[136:139], v1 offset:9216
    ds_read_b128 v[12:15], v7
    v_mfma_f32_16x16x32_bf16 v[28:31], a[112:115], a[0:3], 0
    s_mov_b32 s70, s90
    ds_read_b128 a[132:135], v2 offset:8192
    ds_read_b128 a[128:131], v1 offset:8192
    v_mfma_f32_16x16x32_bf16 v[28:31], a[116:119], a[4:7], v[28:31]
    s_add_u32 s88, s88, 8192
    ds_write_b128 v9, v[132:135] offset:4096
    v_mfma_f32_16x16x32_bf16 v[28:31], a[120:123], a[8:11], v[28:31]
    s_addc_u32 s89, s89, 0
    v_mul_f32 v21, s20, v21
    v_mul_f32 v22, s20, v22
    v_mfma_f32_16x16x32_bf16 v[28:31], a[124:127], a[12:15], v[28:31]
    s_waitcnt lgkmcnt(1)
    ds_write_b128 v8, v[96:99] offset:20480
    v_mfma_f32_16x16x32_bf16 v[32:35], a[140:143], a[12:15], 0
    s_mov_b32 s90, s66
    v_exp_f32 v20, v20
    v_exp_f32 v21, v21
    v_mul_f32 v23, s20, v23
    v_exp_f32 v22, v22
    v_exp_f32 v23, v23
    v_mfma_f32_16x16x32_bf16 v[32:35], a[136:139], a[8:11], v[32:35]
    s_add_u32 s64, s64, 8192
    v_cvt_pk_bf16_f32 v60, v20, v21
    v_cvt_pk_bf16_f32 v61, v22, v23
    v_mfma_f32_16x16x32_bf16 v[32:35], a[132:135], a[4:7], v[32:35]
    s_addc_u32 s65, s65, 0
    ds_write_b128 v9, v[104:107] offset:20480
    v_mfma_f32_16x16x32_bf16 v[32:35], a[128:131], a[0:3], v[32:35]
    s_add_u32 s23, s23, 1
    v_mul_f32 v24, s20, v24
    v_mul_f32 v25, s20, v25
    v_exp_f32 v24, v24
    v_exp_f32 v25, v25
    v_mul_f32 v26, s20, v26
    v_mul_f32 v27, s20, v27
    v_exp_f32 v26, v26
    v_exp_f32 v27, v27
    v_mfma_f32_16x16x32_bf16 v[204:207], a[148:151], v[48:51], 0
    s_cmp_lt_u32 s23, 64
    v_cvt_pk_bf16_f32 v62, v24, v25
    v_cvt_pk_bf16_f32 v63, v26, v27
    v_mfma_f32_16x16x32_bf16 v[208:211], a[156:159], v[48:51], 0
    s_cselect_b32 s66, 8192, 0
    v_mul_f32 v28, s20, v28
    v_mul_f32 v29, s20, v29
    v_mfma_f32_16x16x32_bf16 v[212:215], a[164:167], v[48:51], 0
    buffer_store_dwordx4 v[12:15], v6, s[76:79], 0 offen nt
    v_exp_f32 v28, v28
    v_exp_f32 v29, v29
    v_mfma_f32_16x16x32_bf16 v[216:219], a[172:175], v[48:51], 0
    s_add_u32 s76, s76, s29
    ds_read_b128 v[12:15], v7 offset:1024
    v_mul_f32 v30, s20, v30
    v_mfma_f32_16x16x32_bf16 v[20:23], a[112:115], a[16:19], 0
    s_addc_u32 s77, s77, 0
    ds_write_b128 v8, v[128:131] offset:21504
    v_mfma_f32_16x16x32_bf16 v[20:23], a[116:119], a[20:23], v[20:23]
    s_mov_b32 m0, s31
    v_mul_f32 v31, s20, v31
    v_cvt_pk_bf16_f32 v68, v28, v29
    v_mfma_f32_16x16x32_bf16 v[20:23], a[120:123], a[24:27], v[20:23]
    buffer_load_dwordx4 v6, s[72:75], 0 offen nt lds
    v_mul_f32 v32, s20, v32
    v_mfma_f32_16x16x32_bf16 v[20:23], a[124:127], a[28:31], v[20:23]
    s_add_u32 s72, s72, s29
    ds_write_b128 v9, v[136:139] offset:21504
    v_mfma_f32_16x16x32_bf16 v[24:27], a[140:143], a[28:31], 0
    s_addc_u32 s73, s73, 0
    v_exp_f32 v30, v30
    v_mfma_f32_16x16x32_bf16 v[24:27], a[136:139], a[24:27], v[24:27]
    s_xor_b32 s29, s29, 0x700
    v_exp_f32 v31, v31
    v_mfma_f32_16x16x32_bf16 v[24:27], a[132:135], a[20:23], v[24:27]
    s_add_u32 s31, s31, 1024
    ds_write_b128 v8, v[156:159] offset:8192
    v_mfma_f32_16x16x32_bf16 v[24:27], a[128:131], a[16:19], v[24:27]
    s_waitcnt lgkmcnt(3)
    buffer_store_dwordx4 v[12:15], v6, s[76:79], 0 offen nt
    v_cvt_pk_bf16_f32 v69, v30, v31
    v_mul_f32 v33, s20, v33
    v_exp_f32 v32, v32
    v_exp_f32 v33, v33
    v_mul_f32 v34, s20, v34
    v_mul_f32 v35, s20, v35
    v_exp_f32 v34, v34
    v_exp_f32 v35, v35
    v_mfma_f32_16x16x32_bf16 v[236:239], a[148:151], v[52:55], 0
    s_add_u32 s76, s76, s29
    ds_read_b128 v[12:15], v7 offset:2048
    v_add_u32 v7, 3072, v7
    v_mfma_f32_16x16x32_bf16 v[240:243], a[156:159], v[52:55], 0
    s_addc_u32 s77, s77, 0
    v_cvt_pk_bf16_f32 v70, v32, v33
    v_cvt_pk_bf16_f32 v71, v34, v35
    v_mfma_f32_16x16x32_bf16 v[244:247], a[164:167], v[52:55], 0
    s_mov_b32 m0, s31
    ds_write_b128 v9, v[164:167] offset:8192
    v_mfma_f32_16x16x32_bf16 v[248:251], a[172:175], v[52:55], 0
    buffer_load_dwordx4 v6, s[72:75], 0 offen nt lds
    v_mul_f32 v20, s20, v20
    v_mfma_f32_16x16x32_bf16 v[28:31], a[112:115], a[32:35], 0
    s_add_u32 s72, s72, s29
    v_mul_f32 v21, s20, v21
    v_mul_f32 v22, s20, v22
    v_mfma_f32_16x16x32_bf16 v[28:31], a[116:119], a[36:39], v[28:31]
    s_addc_u32 s73, s73, 0
    v_exp_f32 v20, v20
    v_mfma_f32_16x16x32_bf16 v[28:31], a[120:123], a[40:43], v[28:31]
    s_xor_b32 s29, s29, 0x700
    ds_write_b128 v8, v[188:191] offset:12288
    v_mfma_f32_16x16x32_bf16 v[28:31], a[124:127], a[44:47], v[28:31]
    s_add_u32 s31, s31, 1024
    v_exp_f32 v21, v21
    v_mul_f32 v23, s20, v23
    v_exp_f32 v22, v22
    v_exp_f32 v23, v23
    v_mfma_f32_16x16x32_bf16 v[32:35], a[140:143], a[44:47], 0
    s_waitcnt lgkmcnt(2)
    buffer_store_dwordx4 v[12:15], v6, s[76:79], 0 offen nt
    v_cvt_pk_bf16_f32 v72, v20, v21
    v_cvt_pk_bf16_f32 v73, v22, v23
    v_mul_f32 v24, s20, v24
    v_mul_f32 v25, s20, v25
    v_mfma_f32_16x16x32_bf16 v[32:35], a[136:139], a[40:43], v[32:35]
    s_add_u32 s76, s76, s29
    v_exp_f32 v24, v24
    v_mfma_f32_16x16x32_bf16 v[32:35], a[132:135], a[36:39], v[32:35]
    s_addc_u32 s77, s77, 0
    ds_write_b128 v9, v[196:199] offset:12288
    v_mfma_f32_16x16x32_bf16 v[32:35], a[128:131], a[32:35], v[32:35]
    s_mov_b32 m0, s31
    v_exp_f32 v25, v25
    v_mul_f32 v26, s20, v26
    v_mul_f32 v27, s20, v27
    v_exp_f32 v26, v26
    v_exp_f32 v27, v27
    v_mfma_f32_16x16x32_bf16 a[208:211], a[148:151], v[56:59], 0
    buffer_load_dwordx4 v6, s[72:75], 0 offen nt lds
    v_cvt_pk_bf16_f32 v74, v24, v25
    v_mfma_f32_16x16x32_bf16 a[212:215], a[156:159], v[56:59], 0
    s_add_u32 s72, s72, s29
    v_cvt_pk_bf16_f32 v75, v26, v27
    v_mul_f32 v28, s20, v28
    v_mfma_f32_16x16x32_bf16 a[216:219], a[164:167], v[56:59], 0
    s_addc_u32 s73, s73, 0
    ds_write_b128 v8, v[220:223] offset:16384
    v_mfma_f32_16x16x32_bf16 a[220:223], a[172:175], v[56:59], 0
    s_xor_b32 s29, s29, 0x700
    v_mul_f32 v29, s20, v29
    v_mul_f32 v30, s20, v30
    v_mfma_f32_16x16x32_bf16 v[20:23], a[112:115], a[48:51], 0
    s_add_u32 s31, s31, 1024
    v_exp_f32 v28, v28
    v_mfma_f32_16x16x32_bf16 v[20:23], a[116:119], a[52:55], v[20:23]
    v_exp_f32 v29, v29
    v_mfma_f32_16x16x32_bf16 v[20:23], a[120:123], a[56:59], v[20:23]
    ds_write_b128 v9, v[228:231] offset:16384
    v_mfma_f32_16x16x32_bf16 v[20:23], a[124:127], a[60:63], v[20:23]
    v_mul_f32 v31, s20, v31
    v_cvt_pk_bf16_f32 v76, v28, v29
    v_exp_f32 v30, v30
    v_exp_f32 v31, v31
    v_mfma_f32_16x16x32_bf16 v[24:27], a[140:143], a[60:63], 0
    v_cvt_pk_bf16_f32 v77, v30, v31
    v_mul_f32 v32, s20, v32
    v_mfma_f32_16x16x32_bf16 v[24:27], a[136:139], a[56:59], v[24:27]
    s_waitcnt vmcnt(23) lgkmcnt(0)
    v_mul_f32 v33, s20, v33
    v_mul_f32 v34, s20, v34
    v_mfma_f32_16x16x32_bf16 v[24:27], a[132:135], a[52:55], v[24:27]
    s_barrier
    v_mul_f32 v35, s20, v35
    v_mfma_f32_16x16x32_bf16 v[24:27], a[128:131], a[48:51], v[24:27]
    v_exp_f32 v32, v32
    v_exp_f32 v33, v33
    v_exp_f32 v34, v34
    v_exp_f32 v35, v35
    v_mfma_f32_16x16x32_bf16 a[240:243], a[148:151], v[60:63], 0
    ds_read_b64_tr_b16 a[144:145], v3 offset:18432
    v_cvt_pk_bf16_f32 v78, v32, v33
    v_mfma_f32_16x16x32_bf16 a[244:247], a[156:159], v[60:63], 0
    ds_read_b64_tr_b16 a[146:147], v3 offset:26624
    v_cvt_pk_bf16_f32 v79, v34, v35
    v_mfma_f32_16x16x32_bf16 a[248:251], a[164:167], v[60:63], 0
    ds_read_b64_tr_b16 a[148:149], v3 offset:19456
    v_mul_f32 v20, s20, v20
    v_mfma_f32_16x16x32_bf16 a[252:255], a[172:175], v[60:63], 0
    ds_read_b64_tr_b16 a[150:151], v3 offset:27648
    ds_read_b64_tr_b16 a[156:157], v3 offset:19464
    v_mfma_f32_16x16x32_bf16 v[28:31], a[112:115], a[64:67], 0
    ds_read_b64_tr_b16 a[158:159], v3 offset:27656
    ds_read_b64_tr_b16 a[152:153], v3 offset:18440
    v_mfma_f32_16x16x32_bf16 v[28:31], a[116:119], a[68:71], v[28:31]
    ds_read_b64_tr_b16 a[154:155], v3 offset:26632
    ds_read_b64_tr_b16 a[160:161], v4 offset:18432
    v_mfma_f32_16x16x32_bf16 v[28:31], a[120:123], a[72:75], v[28:31]
    ds_read_b64_tr_b16 a[162:163], v4 offset:26624
    ds_read_b64_tr_b16 a[164:165], v4 offset:19456
    v_mfma_f32_16x16x32_bf16 v[28:31], a[124:127], a[76:79], v[28:31]
    v_mul_f32 v21, s20, v21
    v_mul_f32 v22, s20, v22
    v_exp_f32 v20, v20
    v_exp_f32 v21, v21
    v_mul_f32 v23, s20, v23
    v_exp_f32 v22, v22
    v_exp_f32 v23, v23
    v_mfma_f32_16x16x32_bf16 v[32:35], a[140:143], a[76:79], 0
    ds_read_b64_tr_b16 a[166:167], v4 offset:27648
    v_cvt_pk_bf16_f32 v80, v20, v21
    v_mfma_f32_16x16x32_bf16 v[32:35], a[136:139], a[72:75], v[32:35]
    ds_read_b64_tr_b16 a[172:173], v4 offset:19464
    v_cvt_pk_bf16_f32 v81, v22, v23
    v_mfma_f32_16x16x32_bf16 v[32:35], a[132:135], a[68:71], v[32:35]
    ds_read_b64_tr_b16 a[174:175], v4 offset:27656
    v_mul_f32 v24, s20, v24
    v_mfma_f32_16x16x32_bf16 v[32:35], a[128:131], a[64:67], v[32:35]
    s_waitcnt lgkmcnt(6)
    ds_read_b64_tr_b16 a[168:169], v4 offset:18440
    ds_read_b64_tr_b16 a[170:171], v4 offset:26632
    v_mfma_f32_16x16x32_bf16 v[92:95], a[144:147], v[36:39], 0
    s_add_u32 m0, s27, 0
    v_xor_b32 v3, 0x8000, v3
    v_xor_b32 v4, 0x8000, v4
    v_mfma_f32_16x16x32_bf16 v[92:95], a[148:151], v[68:71], v[92:95]
    v_mul_f32 v25, s20, v25
    v_mul_f32 v26, s20, v26
    v_mfma_f32_16x16x32_bf16 v[96:99], a[156:159], v[68:71], 0
    buffer_load_dwordx4 v5, s[64:67], 0 offen lds
    v_mul_f32 v27, s20, v27
    v_mfma_f32_16x16x32_bf16 v[96:99], a[152:155], v[36:39], v[96:99]
    s_waitcnt lgkmcnt(0)
    v_exp_f32 v24, v24
    v_mfma_f32_16x16x32_bf16 v[100:103], a[160:163], v[36:39], 0
    v_exp_f32 v25, v25
    v_mfma_f32_16x16x32_bf16 v[100:103], a[164:167], v[68:71], v[100:103]
    v_exp_f32 v26, v26
    v_mfma_f32_16x16x32_bf16 v[104:107], a[172:175], v[68:71], 0
    v_exp_f32 v27, v27
    v_mfma_f32_16x16x32_bf16 v[104:107], a[168:171], v[36:39], v[104:107]
    s_add_u32 m0, s27, 896
    v_cvt_pk_bf16_f32 v82, v24, v25
    v_cvt_pk_bf16_f32 v83, v26, v27
    v_mfma_f32_16x16x32_bf16 v[20:23], a[112:115], a[80:83], 0
    v_mul_f32 v28, s20, v28
    v_mul_f32 v29, s20, v29
    v_mfma_f32_16x16x32_bf16 v[20:23], a[116:119], a[84:87], v[20:23]
    v_exp_f32 v28, v28
    v_mfma_f32_16x16x32_bf16 v[20:23], a[120:123], a[88:91], v[20:23]
    buffer_load_dwordx4 v5, s[64:67], 0 offen offset:128 lds
    v_mul_f32 v30, s20, v30
    v_mfma_f32_16x16x32_bf16 v[20:23], a[124:127], a[92:95], v[20:23]
    v_exp_f32 v29, v29
    v_mfma_f32_16x16x32_bf16 v[24:27], a[140:143], a[92:95], 0
    v_mul_f32 v31, s20, v31
    v_cvt_pk_bf16_f32 v84, v28, v29
    v_mfma_f32_16x16x32_bf16 v[24:27], a[136:139], a[88:91], v[24:27]
    v_exp_f32 v30, v30
    v_mfma_f32_16x16x32_bf16 v[24:27], a[132:135], a[84:87], v[24:27]
    v_exp_f32 v31, v31
    v_mfma_f32_16x16x32_bf16 v[24:27], a[128:131], a[80:83], v[24:27]
    s_add_u32 m0, s27, 1920
    v_cvt_pk_bf16_f32 v85, v30, v31
    v_mul_f32 v32, s20, v32
    v_mfma_f32_16x16x32_bf16 v[124:127], a[144:147], v[40:43], 0
    v_mul_f32 v33, s20, v33
    v_mul_f32 v34, s20, v34
    v_mfma_f32_16x16x32_bf16 v[124:127], a[148:151], v[72:75], v[124:127]
    v_exp_f32 v32, v32
    v_mfma_f32_16x16x32_bf16 v[128:131], a[156:159], v[72:75], 0
    buffer_load_dwordx4 v5, s[68:71], 0 offen offset:128 lds
    v_mul_f32 v35, s20, v35
    v_mfma_f32_16x16x32_bf16 v[128:131], a[152:155], v[40:43], v[128:131]
    v_exp_f32 v33, v33
    v_mfma_f32_16x16x32_bf16 v[132:135], a[160:163], v[40:43], 0
    v_exp_f32 v34, v34
    v_mfma_f32_16x16x32_bf16 v[132:135], a[164:167], v[72:75], v[132:135]
    v_exp_f32 v35, v35
    v_mfma_f32_16x16x32_bf16 v[136:139], a[172:175], v[72:75], 0
    v_cvt_pk_bf16_f32 v86, v32, v33
    v_cvt_pk_bf16_f32 v87, v34, v35
    v_mfma_f32_16x16x32_bf16 v[136:139], a[168:171], v[40:43], v[136:139]
    s_add_u32 m0, s27, 2944
    v_mul_f32 v20, s20, v20
    v_mul_f32 v21, s20, v21
    v_smfmac_f32_16x16x64_bf16 a[176:179], v[16:19], v[36:43], v252
    v_mul_f32 v22, s20, v22
    v_smfmac_f32_16x16x64_bf16 a[176:179], v[16:19], v[68:75], v252
    v_mul_f32 v23, s20, v23
    v_mfma_f32_16x16x32_bf16 v[28:31], a[112:115], a[96:99], 0
    buffer_load_dwordx4 v5, s[88:91], 0 offen offset:128 lds
    v_mul_f32 v24, s20, v24
    v_mfma_f32_16x16x32_bf16 v[28:31], a[116:119], a[100:103], v[28:31]
    s_add_u32 s27, s27, 16384
    ds_read_b128 a[112:115], v1 offset:16384
    v_mul_f32 v25, s20, v25
    v_mfma_f32_16x16x32_bf16 v[28:31], a[120:123], a[104:107], v[28:31]
    s_and_b32 s27, s27, 0xffff
    ds_read_b128 a[116:119], v2 offset:16384
    v_mul_f32 v26, s20, v26
    v_mfma_f32_16x16x32_bf16 v[28:31], a[124:127], a[108:111], v[28:31]
    s_mov_b64 s[68:69], s[88:89]
    ds_read_b128 a[120:123], v1 offset:17408
    v_mul_f32 v27, s20, v27
    v_mfma_f32_16x16x32_bf16 v[32:35], a[140:143], a[108:111], 0
    s_mov_b32 s70, s90
    ds_read_b128 a[124:127], v2 offset:17408
    ds_read_b128 v[12:15], v7
    v_mfma_f32_16x16x32_bf16 v[32:35], a[136:139], a[104:107], v[32:35]
    s_add_u32 s88, s88, 8192
    v_exp_f32 v20, v20
    v_mfma_f32_16x16x32_bf16 v[32:35], a[132:135], a[100:103], v[32:35]
    s_addc_u32 s89, s89, 0
    ds_read_b128 a[140:143], v2 offset:25600
    v_mul_f32 v28, s20, v28
    v_mfma_f32_16x16x32_bf16 v[32:35], a[128:131], a[96:99], v[32:35]
    s_mov_b32 s90, s66
    ds_read_b128 a[136:139], v1 offset:25600
    v_mul_f32 v29, s20, v29
    v_mfma_f32_16x16x32_bf16 v[156:159], a[144:147], v[44:47], 0
    s_add_u32 s64, s64, 8192
    v_exp_f32 v21, v21
    v_mfma_f32_16x16x32_bf16 v[156:159], a[148:151], v[76:79], v[156:159]
    s_addc_u32 s65, s65, 0
    ds_read_b128 a[132:135], v2 offset:24576
    v_xor_b32 v2, 0x8000, v2
    v_mfma_f32_16x16x32_bf16 v[160:163], a[156:159], v[76:79], 0
    s_add_u32 s23, s23, 1
    ds_read_b128 a[128:131], v1 offset:24576
    v_xor_b32 v1, 0x8000, v1
    v_mfma_f32_16x16x32_bf16 v[160:163], a[152:155], v[44:47], v[160:163]
    s_cmp_lt_u32 s23, 64
    v_exp_f32 v22, v22
    v_mfma_f32_16x16x32_bf16 v[164:167], a[160:163], v[44:47], 0
    s_cselect_b32 s66, 8192, 0
    v_exp_f32 v23, v23
    v_mfma_f32_16x16x32_bf16 v[164:167], a[164:167], v[76:79], v[164:167]
    v_cvt_pk_bf16_f32 v88, v20, v21
    v_cvt_pk_bf16_f32 v89, v22, v23
    v_mfma_f32_16x16x32_bf16 v[168:171], a[172:175], v[76:79], 0
    s_waitcnt lgkmcnt(4)
    buffer_store_dwordx4 v[12:15], v6, s[76:79], 0 offen nt
    v_exp_f32 v24, v24
    v_exp_f32 v25, v25
    v_mfma_f32_16x16x32_bf16 v[168:171], a[168:171], v[44:47], v[168:171]
    s_add_u32 s76, s76, s29
    v_exp_f32 v26, v26
    v_mfma_f32_16x16x32_bf16 v[20:23], a[112:115], a[0:3], 0
    s_addc_u32 s77, s77, 0
    v_exp_f32 v27, v27
    v_mfma_f32_16x16x32_bf16 v[20:23], a[116:119], a[4:7], v[20:23]
    v_cvt_pk_bf16_f32 v90, v24, v25
    v_cvt_pk_bf16_f32 v91, v26, v27
    v_mfma_f32_16x16x32_bf16 v[20:23], a[120:123], a[8:11], v[20:23]
    v_exp_f32 v28, v28
    v_mfma_f32_16x16x32_bf16 v[20:23], a[124:127], a[12:15], v[20:23]
    s_waitcnt lgkmcnt(0)
    v_exp_f32 v29, v29
    v_mfma_f32_16x16x32_bf16 v[24:27], a[140:143], a[12:15], 0
    s_mov_b32 m0, s31
    v_mul_f32 v30, s20, v30
    v_mul_f32 v31, s20, v31
    v_mfma_f32_16x16x32_bf16 v[24:27], a[136:139], a[8:11], v[24:27]
    ds_read_b128 v[12:15], v7 offset:1024
    v_cvt_pk_bf16_f32 v64, v28, v29
    v_mfma_f32_16x16x32_bf16 v[24:27], a[132:135], a[4:7], v[24:27]
    buffer_load_dwordx4 v6, s[72:75], 0 offen nt lds
    v_mul_f32 v32, s20, v32
    v_mfma_f32_16x16x32_bf16 v[24:27], a[128:131], a[0:3], v[24:27]
    s_add_u32 s72, s72, s29
    v_exp_f32 v30, v30
    v_mfma_f32_16x16x32_bf16 v[188:191], a[144:147], v[48:51], 0
    s_addc_u32 s73, s73, 0
    v_exp_f32 v31, v31
    v_mfma_f32_16x16x32_bf16 v[188:191], a[148:151], v[80:83], v[188:191]
    s_xor_b32 s29, s29, 0x700
    v_cvt_pk_bf16_f32 v65, v30, v31
    v_mul_f32 v33, s20, v33
    v_mfma_f32_16x16x32_bf16 v[192:195], a[156:159], v[80:83], 0
    s_add_u32 s31, s31, 1024
    v_exp_f32 v32, v32
    v_mfma_f32_16x16x32_bf16 v[192:195], a[152:155], v[48:51], v[192:195]
    v_exp_f32 v33, v33
    v_mfma_f32_16x16x32_bf16 v[196:199], a[160:163], v[48:51], 0
    v_mul_f32 v34, s20, v34
    v_mul_f32 v35, s20, v35
    v_mfma_f32_16x16x32_bf16 v[196:199], a[164:167], v[80:83], v[196:199]
    v_exp_f32 v34, v34
    v_mfma_f32_16x16x32_bf16 v[200:203], a[172:175], v[80:83], 0
    s_waitcnt lgkmcnt(0)
    buffer_store_dwordx4 v[12:15], v6, s[76:79], 0 offen nt
    v_exp_f32 v35, v35
    v_cvt_pk_bf16_f32 v66, v32, v33
    v_cvt_pk_bf16_f32 v67, v34, v35
    v_mfma_f32_16x16x32_bf16 v[200:203], a[168:171], v[48:51], v[200:203]
    s_add_u32 s76, s76, s29
    v_mul_f32 v20, s20, v20
    v_mul_f32 v21, s20, v21
    v_smfmac_f32_16x16x64_bf16 a[180:183], v[16:19], v[44:51], v252
    s_addc_u32 s77, s77, 0
    v_mul_f32 v22, s20, v22
    v_smfmac_f32_16x16x64_bf16 a[180:183], v[16:19], v[76:83], v252
    v_mul_f32 v23, s20, v23
    v_mfma_f32_16x16x32_bf16 v[28:31], a[112:115], a[16:19], 0
    v_exp_f32 v20, v20
    v_mfma_f32_16x16x32_bf16 v[28:31], a[116:119], a[20:23], v[28:31]
    s_mov_b32 m0, s31
    v_exp_f32 v21, v21
    v_mfma_f32_16x16x32_bf16 v[28:31], a[120:123], a[24:27], v[28:31]
    v_exp_f32 v22, v22
    v_mfma_f32_16x16x32_bf16 v[28:31], a[124:127], a[28:31], v[28:31]
    ds_read_b128 v[12:15], v7 offset:2048
    v_add_u32 v7, 3072, v7
    v_mfma_f32_16x16x32_bf16 v[32:35], a[140:143], a[28:31], 0
    buffer_load_dwordx4 v6, s[72:75], 0 offen nt lds
    v_cvt_pk_bf16_f32 v36, v20, v21
    v_mfma_f32_16x16x32_bf16 v[32:35], a[136:139], a[24:27], v[32:35]
    s_add_u32 s72, s72, s29
    v_exp_f32 v23, v23
    v_mfma_f32_16x16x32_bf16 v[32:35], a[132:135], a[20:23], v[32:35]
    s_addc_u32 s73, s73, 0
    v_cvt_pk_bf16_f32 v37, v22, v23
    v_mul_f32 v24, s20, v24
    v_mfma_f32_16x16x32_bf16 v[32:35], a[128:131], a[16:19], v[32:35]
    s_xor_b32 s29, s29, 0x700
    v_mul_f32 v25, s20, v25
    v_mul_f32 v26, s20, v26
    v_mfma_f32_16x16x32_bf16 v[220:223], a[144:147], v[52:55], 0
    s_add_u32 s31, s31, 1024
    v_exp_f32 v24, v24
    v_mfma_f32_16x16x32_bf16 v[220:223], a[148:151], v[84:87], v[220:223]
    v_exp_f32 v25, v25
    v_mfma_f32_16x16x32_bf16 v[224:227], a[156:159], v[84:87], 0
    v_mul_f32 v27, s20, v27
    v_cvt_pk_bf16_f32 v38, v24, v25
    v_mfma_f32_16x16x32_bf16 v[224:227], a[152:155], v[52:55], v[224:227]
    v_exp_f32 v26, v26
    v_mfma_f32_16x16x32_bf16 v[228:231], a[160:163], v[52:55], 0
    s_waitcnt lgkmcnt(0)
    buffer_store_dwordx4 v[12:15], v6, s[76:79], 0 offen nt
    v_exp_f32 v27, v27
    v_mul_f32 v28, s20, v28
    v_cvt_pk_bf16_f32 v39, v26, v27
    v_mfma_f32_16x16x32_bf16 v[228:231], a[164:167], v[84:87], v[228:231]
    s_add_u32 s76, s76, s29
    v_mul_f32 v29, s20, v29
    v_mul_f32 v30, s20, v30
    v_mfma_f32_16x16x32_bf16 v[232:235], a[172:175], v[84:87], 0
    s_addc_u32 s77, s77, 0
    v_exp_f32 v28, v28
    v_mfma_f32_16x16x32_bf16 v[232:235], a[168:171], v[52:55], v[232:235]
    v_exp_f32 v29, v29
    v_mfma_f32_16x16x32_bf16 v[20:23], a[112:115], a[32:35], 0
    v_mul_f32 v31, s20, v31
    v_cvt_pk_bf16_f32 v40, v28, v29
    v_mfma_f32_16x16x32_bf16 v[20:23], a[116:119], a[36:39], v[20:23]
    s_mov_b32 m0, s31
    v_exp_f32 v30, v30
    v_mfma_f32_16x16x32_bf16 v[20:23], a[120:123], a[40:43], v[20:23]
    v_exp_f32 v31, v31
    v_mfma_f32_16x16x32_bf16 v[20:23], a[124:127], a[44:47], v[20:23]
    v_cvt_pk_bf16_f32 v41, v30, v31
    v_mul_f32 v32, s20, v32
    v_mfma_f32_16x16x32_bf16 v[24:27], a[140:143], a[44:47], 0
    buffer_load_dwordx4 v6, s[72:75], 0 offen nt lds
    v_mul_f32 v33, s20, v33
    v_mfma_f32_16x16x32_bf16 v[24:27], a[136:139], a[40:43], v[24:27]
    s_add_u32 s72, s72, s29
    v_exp_f32 v32, v32
    v_mfma_f32_16x16x32_bf16 v[24:27], a[132:135], a[36:39], v[24:27]
    s_addc_u32 s73, s73, 0
    v_exp_f32 v33, v33
    v_mfma_f32_16x16x32_bf16 v[24:27], a[128:131], a[32:35], v[24:27]
    s_xor_b32 s29, s29, 0x700
    v_mul_f32 v34, s20, v34
    v_mul_f32 v35, s20, v35
    v_mfma_f32_16x16x32_bf16 a[192:195], a[144:147], v[56:59], 0
    s_add_u32 s31, s31, 1024
    v_exp_f32 v34, v34
    v_mfma_f32_16x16x32_bf16 a[192:195], a[148:151], v[88:91], a[192:195]
    v_exp_f32 v35, v35
    v_mfma_f32_16x16x32_bf16 a[196:199], a[156:159], v[88:91], 0
    v_cvt_pk_bf16_f32 v42, v32, v33
    v_cvt_pk_bf16_f32 v43, v34, v35
    v_mfma_f32_16x16x32_bf16 a[196:199], a[152:155], v[56:59], a[196:199]
    v_mul_f32 v20, s20, v20
    v_mul_f32 v21, s20, v21
    v_mfma_f32_16x16x32_bf16 a[200:203], a[160:163], v[56:59], 0
    v_exp_f32 v20, v20
    v_mfma_f32_16x16x32_bf16 a[200:203], a[164:167], v[88:91], a[200:203]
    v_exp_f32 v21, v21
    v_mfma_f32_16x16x32_bf16 a[204:207], a[172:175], v[88:91], 0
    v_mul_f32 v22, s20, v22
    v_mul_f32 v23, s20, v23
    v_mfma_f32_16x16x32_bf16 a[204:207], a[168:171], v[56:59], a[204:207]
    v_exp_f32 v22, v22
    v_smfmac_f32_16x16x64_bf16 a[184:187], v[16:19], v[52:59], v252
    v_cvt_pk_bf16_f32 v44, v20, v21
    v_smfmac_f32_16x16x64_bf16 a[184:187], v[16:19], v[84:91], v252
    v_mul_f32 v24, s20, v24
    v_mfma_f32_16x16x32_bf16 v[28:31], a[112:115], a[48:51], 0
    v_exp_f32 v23, v23
    v_mfma_f32_16x16x32_bf16 v[28:31], a[116:119], a[52:55], v[28:31]
    v_cvt_pk_bf16_f32 v45, v22, v23
    v_mul_f32 v25, s20, v25
    v_mfma_f32_16x16x32_bf16 v[28:31], a[120:123], a[56:59], v[28:31]
    v_exp_f32 v24, v24
    v_mfma_f32_16x16x32_bf16 v[28:31], a[124:127], a[60:63], v[28:31]
    v_exp_f32 v25, v25
    v_mfma_f32_16x16x32_bf16 v[32:35], a[140:143], a[60:63], 0
    v_mul_f32 v26, s20, v26
    v_mul_f32 v27, s20, v27
    v_mfma_f32_16x16x32_bf16 v[32:35], a[136:139], a[56:59], v[32:35]
    s_waitcnt vmcnt(29) lgkmcnt(0)
    v_exp_f32 v26, v26
    v_mfma_f32_16x16x32_bf16 v[32:35], a[132:135], a[52:55], v[32:35]
    s_barrier
    v_cvt_pk_bf16_f32 v46, v24, v25
    v_mfma_f32_16x16x32_bf16 v[32:35], a[128:131], a[48:51], v[32:35]
    v_exp_f32 v27, v27
    v_mfma_f32_16x16x32_bf16 a[224:227], a[144:147], v[60:63], 0
    ds_read_b64_tr_b16 a[144:145], v3 offset:2048
    v_cvt_pk_bf16_f32 v47, v26, v27
    v_mfma_f32_16x16x32_bf16 a[224:227], a[148:151], v[64:67], a[224:227]
    ds_read_b64_tr_b16 a[146:147], v3 offset:10240
    v_mul_f32 v28, s20, v28
    v_mfma_f32_16x16x32_bf16 a[228:231], a[156:159], v[64:67], 0
    ds_read_b64_tr_b16 a[148:149], v3 offset:3072
    v_mul_f32 v29, s20, v29
    v_mfma_f32_16x16x32_bf16 a[228:231], a[152:155], v[60:63], a[228:231]
    ds_read_b64_tr_b16 a[150:151], v3 offset:11264
    v_mul_f32 v30, s20, v30
    v_mfma_f32_16x16x32_bf16 a[232:235], a[160:163], v[60:63], 0
    ds_read_b64_tr_b16 a[156:157], v3 offset:3080
    v_mul_f32 v31, s20, v31
    v_mfma_f32_16x16x32_bf16 a[232:235], a[164:167], v[64:67], a[232:235]
    ds_read_b64_tr_b16 a[158:159], v3 offset:11272
    v_mul_f32 v32, s20, v32
    v_mfma_f32_16x16x32_bf16 a[236:239], a[172:175], v[64:67], 0
    ds_read_b64_tr_b16 a[152:153], v3 offset:2056
    v_mul_f32 v33, s20, v33
    v_mfma_f32_16x16x32_bf16 a[236:239], a[168:171], v[60:63], a[236:239]
    ds_read_b64_tr_b16 a[154:155], v3 offset:10248
    v_mul_f32 v34, s20, v34
    v_smfmac_f32_16x16x64_bf16 a[188:191], v[16:19], v[60:67], v252
    ds_read_b64_tr_b16 a[160:161], v4 offset:2048
    v_mfma_f32_16x16x32_bf16 v[20:23], a[112:115], a[64:67], 0
    ds_read_b64_tr_b16 a[162:163], v4 offset:10240
    v_mul_f32 v35, s20, v35
    v_mfma_f32_16x16x32_bf16 v[20:23], a[116:119], a[68:71], v[20:23]
    ds_read_b64_tr_b16 a[164:165], v4 offset:3072
    ds_read_b64_tr_b16 a[166:167], v4 offset:11264
    v_mfma_f32_16x16x32_bf16 v[20:23], a[120:123], a[72:75], v[20:23]
    v_exp_f32 v28, v28
    v_mfma_f32_16x16x32_bf16 v[20:23], a[124:127], a[76:79], v[20:23]
    s_cmp_eq_u32 s22, 3
    ds_read_b64_tr_b16 a[172:173], v4 offset:3080
    ds_read_b64_tr_b16 a[174:175], v4 offset:11272
    v_mfma_f32_16x16x32_bf16 v[24:27], a[140:143], a[76:79], 0
    v_exp_f32 v29, v29
    v_mfma_f32_16x16x32_bf16 v[24:27], a[136:139], a[72:75], v[24:27]
    ds_read_b64_tr_b16 a[168:169], v4 offset:2056
    v_cvt_pk_bf16_f32 v48, v28, v29
    v_mfma_f32_16x16x32_bf16 v[24:27], a[132:135], a[68:71], v[24:27]
    ds_read_b64_tr_b16 a[170:171], v4 offset:10248
    v_mul_f32 v20, s20, v20
    v_mfma_f32_16x16x32_bf16 v[24:27], a[128:131], a[64:67], v[24:27]
    s_cbranch_scc1 L_close7
L_bodyoq7:
    s_waitcnt lgkmcnt(8)
    v_exp_f32 v30, v30
    v_mfma_f32_16x16x32_bf16 v[108:111], a[144:147], v[68:71], v[108:111]
    s_add_u32 m0, s27, 0
    v_exp_f32 v31, v31
    v_mfma_f32_16x16x32_bf16 v[108:111], a[148:151], v[36:39], v[108:111]
    v_cvt_pk_bf16_f32 v49, v30, v31
    v_mul_f32 v21, s20, v21
    v_mfma_f32_16x16x32_bf16 v[112:115], a[156:159], v[36:39], v[112:115]
    buffer_load_dwordx4 v5, s[64:67], 0 offen lds
    v_mul_f32 v22, s20, v22
    v_mfma_f32_16x16x32_bf16 v[112:115], a[152:155], v[68:71], v[112:115]
    s_waitcnt lgkmcnt(0)
    v_exp_f32 v32, v32
    v_mfma_f32_16x16x32_bf16 v[116:119], a[160:163], v[68:71], v[116:119]
    v_exp_f32 v33, v33
    v_mfma_f32_16x16x32_bf16 v[116:119], a[164:167], v[36:39], v[116:119]
    v_exp_f32 v34, v34
    v_mfma_f32_16x16x32_bf16 v[120:123], a[172:175], v[36:39], v[120:123]
    v_exp_f32 v35, v35
    v_mfma_f32_16x16x32_bf16 v[120:123], a[168:171], v[68:71], v[120:123]
    s_add_u32 m0, s27, 896
    v_cvt_pk_bf16_f32 v50, v32, v33
    v_cvt_pk_bf16_f32 v51, v34, v35
    v_mfma_f32_16x16x32_bf16 v[28:31], a[112:115], a[80:83], 0
    v_exp_f32 v20, v20
    v_mfma_f32_16x16x32_bf16 v[28:31], a[116:119], a[84:87], v[28:31]
    v_exp_f32 v21, v21
    v_mfma_f32_16x16x32_bf16 v[28:31], a[120:123], a[88:91], v[28:31]
    buffer_load_dwordx4 v5, s[64:67], 0 offen offset:128 lds
    v_mul_f32 v23, s20, v23
    v_mfma_f32_16x16x32_bf16 v[28:31], a[124:127], a[92:95], v[28:31]
    v_exp_f32 v22, v22
    v_mfma_f32_16x16x32_bf16 v[32:35], a[140:143], a[92:95], 0
    v_exp_f32 v23, v23
    v_mfma_f32_16x16x32_bf16 v[32:35], a[136:139], a[88:91], v[32:35]
    v_cvt_pk_bf16_f32 v52, v20, v21
    v_cvt_pk_bf16_f32 v53, v22, v23
    v_mfma_f32_16x16x32_bf16 v[32:35], a[132:135], a[84:87], v[32:35]
    v_mul_f32 v24, s20, v24
    v_mul_f32 v25, s20, v25
    v_mfma_f32_16x16x32_bf16 v[32:35], a[128:131], a[80:83], v[32:35]
    s_add_u32 m0, s27, 2048
    v_exp_f32 v24, v24
    v_mfma_f32_16x16x32_bf16 v[140:143], a[144:147], v[72:75], v[140:143]
    v_exp_f32 v25, v25
    v_mfma_f32_16x16x32_bf16 v[140:143], a[148:151], v[40:43], v[140:143]
    v_mul_f32 v26, s20, v26
    v_mul_f32 v27, s20, v27
    v_mfma_f32_16x16x32_bf16 v[144:147], a[156:159], v[40:43], v[144:147]
    buffer_load_dwordx4 v5, s[68:71], 0 offen lds
    v_cvt_pk_bf16_f32 v54, v24, v25
    v_mfma_f32_16x16x32_bf16 v[144:147], a[152:155], v[72:75], v[144:147]
    v_exp_f32 v26, v26
    v_mfma_f32_16x16x32_bf16 v[148:151], a[160:163], v[72:75], v[148:151]
    v_exp_f32 v27, v27
    v_mfma_f32_16x16x32_bf16 v[148:151], a[164:167], v[40:43], v[148:151]
    v_cvt_pk_bf16_f32 v55, v26, v27
    v_mul_f32 v28, s20, v28
    v_mfma_f32_16x16x32_bf16 v[152:155], a[172:175], v[40:43], v[152:155]
    v_mul_f32 v29, s20, v29
    v_mul_f32 v30, s20, v30
    v_mfma_f32_16x16x32_bf16 v[152:155], a[168:171], v[72:75], v[152:155]
    s_add_u32 m0, s27, 3072
    v_exp_f32 v28, v28
    v_mfma_f32_16x16x32_bf16 v[20:23], a[112:115], a[96:99], 0
    ds_read_b128 a[112:115], v1
    v_mul_f32 v31, s20, v31
    v_mfma_f32_16x16x32_bf16 v[20:23], a[116:119], a[100:103], v[20:23]
    ds_read_b128 a[116:119], v2
    v_mul_f32 v32, s20, v32
    v_mfma_f32_16x16x32_bf16 v[20:23], a[120:123], a[104:107], v[20:23]
    buffer_load_dwordx4 v5, s[88:91], 0 offen lds
    v_mul_f32 v33, s20, v33
    v_mfma_f32_16x16x32_bf16 v[20:23], a[124:127], a[108:111], v[20:23]
    s_add_u32 s27, s27, 16384
    ds_read_b128 a[120:123], v1 offset:1024
    v_mul_f32 v34, s20, v34
    v_mfma_f32_16x16x32_bf16 v[24:27], a[140:143], a[108:111], 0
    s_and_b32 s27, s27, 0xffff
    ds_read_b128 a[124:127], v2 offset:1024
    v_mul_f32 v35, s20, v35
    v_mfma_f32_16x16x32_bf16 v[24:27], a[136:139], a[104:107], v[24:27]
    s_mov_b64 s[68:69], s[88:89]
    v_exp_f32 v29, v29
    v_mfma_f32_16x16x32_bf16 v[24:27], a[132:135], a[100:103], v[24:27]
    s_mov_b32 s70, s90
    ds_read_b128 a[140:143], v2 offset:9216
    v_cvt_pk_bf16_f32 v56, v28, v29
    v_mfma_f32_16x16x32_bf16 v[24:27], a[128:131], a[96:99], v[24:27]
    s_add_u32 s88, s88, 8192
    ds_read_b128 a[136:139], v1 offset:9216
    v_mul_f32 v20, s20, v20
    v_mfma_f32_16x16x32_bf16 v[172:175], a[144:147], v[76:79], v[172:175]
    s_addc_u32 s89, s89, 0
    v_exp_f32 v30, v30
    v_mfma_f32_16x16x32_bf16 v[172:175], a[148:151], v[44:47], v[172:175]
    s_mov_b32 s90, s66
    ds_read_b128 a[132:135], v2 offset:8192
    v_mul_f32 v21, s20, v21
    v_mfma_f32_16x16x32_bf16 v[176:179], a[156:159], v[44:47], v[176:179]
    s_add_u32 s64, s64, 8192
    ds_read_b128 a[128:131], v1 offset:8192
    v_mul_f32 v22, s20, v22
    v_mfma_f32_16x16x32_bf16 v[176:179], a[152:155], v[76:79], v[176:179]
    s_addc_u32 s65, s65, 0
    v_exp_f32 v31, v31
    v_mfma_f32_16x16x32_bf16 v[180:183], a[160:163], v[76:79], v[180:183]
    s_add_u32 s23, s23, 1
    v_cvt_pk_bf16_f32 v57, v30, v31
    v_mul_f32 v23, s20, v23
    v_mfma_f32_16x16x32_bf16 v[180:183], a[164:167], v[44:47], v[180:183]
    s_cmp_lt_u32 s23, 64
    v_exp_f32 v32, v32
    v_mfma_f32_16x16x32_bf16 v[184:187], a[172:175], v[44:47], v[184:187]
    s_cselect_b32 s66, 8192, 0
    v_exp_f32 v33, v33
    v_mfma_f32_16x16x32_bf16 v[184:187], a[168:171], v[76:79], v[184:187]
    s_waitcnt lgkmcnt(4)
    v_exp_f32 v34, v34
    v_mfma_f32_16x16x32_bf16 v[28:31], a[112:115], a[0:3], 0
    v_exp_f32 v35, v35
    v_mfma_f32_16x16x32_bf16 v[28:31], a[116:119], a[4:7], v[28:31]
    v_cvt_pk_bf16_f32 v58, v32, v33
    v_cvt_pk_bf16_f32 v59, v34, v35
    v_mfma_f32_16x16x32_bf16 v[28:31], a[120:123], a[8:11], v[28:31]
    v_exp_f32 v20, v20
    v_mfma_f32_16x16x32_bf16 v[28:31], a[124:127], a[12:15], v[28:31]
    s_waitcnt lgkmcnt(0)
    v_exp_f32 v21, v21
    v_mfma_f32_16x16x32_bf16 v[32:35], a[140:143], a[12:15], 0
    v_exp_f32 v22, v22
    v_mfma_f32_16x16x32_bf16 v[32:35], a[136:139], a[8:11], v[32:35]
    v_exp_f32 v23, v23
    v_mfma_f32_16x16x32_bf16 v[32:35], a[132:135], a[4:7], v[32:35]
    v_cvt_pk_bf16_f32 v60, v20, v21
    v_cvt_pk_bf16_f32 v61, v22, v23
    v_mfma_f32_16x16x32_bf16 v[32:35], a[128:131], a[0:3], v[32:35]
    v_mul_f32 v24, s20, v24
    v_mul_f32 v25, s20, v25
    v_mfma_f32_16x16x32_bf16 v[204:207], a[144:147], v[80:83], v[204:207]
    v_exp_f32 v24, v24
    v_mfma_f32_16x16x32_bf16 v[204:207], a[148:151], v[48:51], v[204:207]
    v_exp_f32 v25, v25
    v_mfma_f32_16x16x32_bf16 v[208:211], a[156:159], v[48:51], v[208:211]
    v_mul_f32 v26, s20, v26
    v_mul_f32 v27, s20, v27
    v_mfma_f32_16x16x32_bf16 v[208:211], a[152:155], v[80:83], v[208:211]
    v_exp_f32 v26, v26
    v_mfma_f32_16x16x32_bf16 v[212:215], a[160:163], v[80:83], v[212:215]
    v_exp_f32 v27, v27
    v_mfma_f32_16x16x32_bf16 v[212:215], a[164:167], v[48:51], v[212:215]
    v_cvt_pk_bf16_f32 v62, v24, v25
    v_cvt_pk_bf16_f32 v63, v26, v27
    v_mfma_f32_16x16x32_bf16 v[216:219], a[172:175], v[48:51], v[216:219]
    v_mul_f32 v28, s20, v28
    v_mul_f32 v29, s20, v29
    v_mfma_f32_16x16x32_bf16 v[216:219], a[168:171], v[80:83], v[216:219]
    v_exp_f32 v28, v28
    v_mfma_f32_16x16x32_bf16 v[20:23], a[112:115], a[16:19], 0
    v_exp_f32 v29, v29
    v_mfma_f32_16x16x32_bf16 v[20:23], a[116:119], a[20:23], v[20:23]
    v_mul_f32 v30, s20, v30
    v_mul_f32 v31, s20, v31
    v_mfma_f32_16x16x32_bf16 v[20:23], a[120:123], a[24:27], v[20:23]
    v_exp_f32 v30, v30
    v_mfma_f32_16x16x32_bf16 v[20:23], a[124:127], a[28:31], v[20:23]
    v_exp_f32 v31, v31
    v_mfma_f32_16x16x32_bf16 v[24:27], a[140:143], a[28:31], 0
    v_cvt_pk_bf16_f32 v68, v28, v29
    v_cvt_pk_bf16_f32 v69, v30, v31
    v_mfma_f32_16x16x32_bf16 v[24:27], a[136:139], a[24:27], v[24:27]
    v_mul_f32 v32, s20, v32
    v_mul_f32 v33, s20, v33
    v_mfma_f32_16x16x32_bf16 v[24:27], a[132:135], a[20:23], v[24:27]
    v_exp_f32 v32, v32
    v_mfma_f32_16x16x32_bf16 v[24:27], a[128:131], a[16:19], v[24:27]
    v_exp_f32 v33, v33
    v_mfma_f32_16x16x32_bf16 v[236:239], a[144:147], v[84:87], v[236:239]
    v_mul_f32 v34, s20, v34
    v_mul_f32 v35, s20, v35
    v_mfma_f32_16x16x32_bf16 v[236:239], a[148:151], v[52:55], v[236:239]
    v_exp_f32 v34, v34
    v_mfma_f32_16x16x32_bf16 v[240:243], a[156:159], v[52:55], v[240:243]
    v_exp_f32 v35, v35
    v_mfma_f32_16x16x32_bf16 v[240:243], a[152:155], v[84:87], v[240:243]
    v_cvt_pk_bf16_f32 v70, v32, v33
    v_cvt_pk_bf16_f32 v71, v34, v35
    v_mfma_f32_16x16x32_bf16 v[244:247], a[160:163], v[84:87], v[244:247]
    v_mul_f32 v20, s20, v20
    v_mul_f32 v21, s20, v21
    v_mfma_f32_16x16x32_bf16 v[244:247], a[164:167], v[52:55], v[244:247]
    v_exp_f32 v20, v20
    v_mfma_f32_16x16x32_bf16 v[248:251], a[172:175], v[52:55], v[248:251]
    v_exp_f32 v21, v21
    v_mfma_f32_16x16x32_bf16 v[248:251], a[168:171], v[84:87], v[248:251]
    v_mul_f32 v22, s20, v22
    v_mul_f32 v23, s20, v23
    v_mfma_f32_16x16x32_bf16 v[28:31], a[112:115], a[32:35], 0
    v_exp_f32 v22, v22
    v_mfma_f32_16x16x32_bf16 v[28:31], a[116:119], a[36:39], v[28:31]
    v_exp_f32 v23, v23
    v_mfma_f32_16x16x32_bf16 v[28:31], a[120:123], a[40:43], v[28:31]
    v_cvt_pk_bf16_f32 v72, v20, v21
    v_cvt_pk_bf16_f32 v73, v22, v23
    v_mfma_f32_16x16x32_bf16 v[28:31], a[124:127], a[44:47], v[28:31]
    v_mul_f32 v24, s20, v24
    v_mul_f32 v25, s20, v25
    v_mfma_f32_16x16x32_bf16 v[32:35], a[140:143], a[44:47], 0
    v_exp_f32 v24, v24
    v_mfma_f32_16x16x32_bf16 v[32:35], a[136:139], a[40:43], v[32:35]
    v_exp_f32 v25, v25
    v_mfma_f32_16x16x32_bf16 v[32:35], a[132:135], a[36:39], v[32:35]
    v_mul_f32 v26, s20, v26
    v_mul_f32 v27, s20, v27
    v_mfma_f32_16x16x32_bf16 v[32:35], a[128:131], a[32:35], v[32:35]
    v_exp_f32 v26, v26
    v_mfma_f32_16x16x32_bf16 a[208:211], a[144:147], v[88:91], a[208:211]
    v_exp_f32 v27, v27
    v_mfma_f32_16x16x32_bf16 a[208:211], a[148:151], v[56:59], a[208:211]
    v_cvt_pk_bf16_f32 v74, v24, v25
    v_cvt_pk_bf16_f32 v75, v26, v27
    v_mfma_f32_16x16x32_bf16 a[212:215], a[156:159], v[56:59], a[212:215]
    v_mul_f32 v28, s20, v28
    v_mul_f32 v29, s20, v29
    v_mfma_f32_16x16x32_bf16 a[212:215], a[152:155], v[88:91], a[212:215]
    v_exp_f32 v28, v28
    v_mfma_f32_16x16x32_bf16 a[216:219], a[160:163], v[88:91], a[216:219]
    v_exp_f32 v29, v29
    v_mfma_f32_16x16x32_bf16 a[216:219], a[164:167], v[56:59], a[216:219]
    v_mul_f32 v30, s20, v30
    v_mul_f32 v31, s20, v31
    v_mfma_f32_16x16x32_bf16 a[220:223], a[172:175], v[56:59], a[220:223]
    v_exp_f32 v30, v30
    v_mfma_f32_16x16x32_bf16 a[220:223], a[168:171], v[88:91], a[220:223]
    v_exp_f32 v31, v31
    v_mfma_f32_16x16x32_bf16 v[20:23], a[112:115], a[48:51], 0
    v_cvt_pk_bf16_f32 v76, v28, v29
    v_cvt_pk_bf16_f32 v77, v30, v31
    v_mfma_f32_16x16x32_bf16 v[20:23], a[116:119], a[52:55], v[20:23]
    v_mul_f32 v32, s20, v32
    v_mul_f32 v33, s20, v33
    v_mfma_f32_16x16x32_bf16 v[20:23], a[120:123], a[56:59], v[20:23]
    v_exp_f32 v32, v32
    v_mfma_f32_16x16x32_bf16 v[20:23], a[124:127], a[60:63], v[20:23]
    v_exp_f32 v33, v33
    v_mfma_f32_16x16x32_bf16 v[24:27], a[140:143], a[60:63], 0
    v_mul_f32 v34, s20, v34
    v_mul_f32 v35, s20, v35
    v_mfma_f32_16x16x32_bf16 v[24:27], a[136:139], a[56:59], v[24:27]
    s_waitcnt vmcnt(14) lgkmcnt(0)
    v_exp_f32 v34, v34
    v_mfma_f32_16x16x32_bf16 v[24:27], a[132:135], a[52:55], v[24:27]
    s_barrier
    v_cvt_pk_bf16_f32 v78, v32, v33
    v_mfma_f32_16x16x32_bf16 v[24:27], a[128:131], a[48:51], v[24:27]
    v_exp_f32 v35, v35
    v_mfma_f32_16x16x32_bf16 a[240:243], a[144:147], v[64:67], a[240:243]
    ds_read_b64_tr_b16 a[144:145], v3 offset:18432
    v_cvt_pk_bf16_f32 v79, v34, v35
    v_mfma_f32_16x16x32_bf16 a[240:243], a[148:151], v[60:63], a[240:243]
    ds_read_b64_tr_b16 a[146:147], v3 offset:26624
    v_mul_f32 v20, s20, v20
    v_mfma_f32_16x16x32_bf16 a[244:247], a[156:159], v[60:63], a[244:247]
    ds_read_b64_tr_b16 a[148:149], v3 offset:19456
    v_mul_f32 v21, s20, v21
    v_mfma_f32_16x16x32_bf16 a[244:247], a[152:155], v[64:67], a[244:247]
    ds_read_b64_tr_b16 a[150:151], v3 offset:27648
    v_mul_f32 v22, s20, v22
    v_mfma_f32_16x16x32_bf16 a[248:251], a[160:163], v[64:67], a[248:251]
    ds_read_b64_tr_b16 a[156:157], v3 offset:19464
    v_mul_f32 v23, s20, v23
    v_mfma_f32_16x16x32_bf16 a[248:251], a[164:167], v[60:63], a[248:251]
    ds_read_b64_tr_b16 a[158:159], v3 offset:27656
    v_mul_f32 v24, s20, v24
    v_mfma_f32_16x16x32_bf16 a[252:255], a[172:175], v[60:63], a[252:255]
    ds_read_b64_tr_b16 a[152:153], v3 offset:18440
    v_mul_f32 v25, s20, v25
    v_mfma_f32_16x16x32_bf16 a[252:255], a[168:171], v[64:67], a[252:255]
    ds_read_b64_tr_b16 a[154:155], v3 offset:26632
    v_mul_f32 v26, s20, v26
    v_mfma_f32_16x16x32_bf16 v[28:31], a[112:115], a[64:67], 0
    ds_read_b64_tr_b16 a[160:161], v4 offset:18432
    v_mul_f32 v27, s20, v27
    v_mfma_f32_16x16x32_bf16 v[28:31], a[116:119], a[68:71], v[28:31]
    ds_read_b64_tr_b16 a[162:163], v4 offset:26624
    ds_read_b64_tr_b16 a[164:165], v4 offset:19456
    v_mfma_f32_16x16x32_bf16 v[28:31], a[120:123], a[72:75], v[28:31]
    v_exp_f32 v20, v20
    v_mfma_f32_16x16x32_bf16 v[28:31], a[124:127], a[76:79], v[28:31]
    ds_read_b64_tr_b16 a[166:167], v4 offset:27648
    ds_read_b64_tr_b16 a[172:173], v4 offset:19464
    v_mfma_f32_16x16x32_bf16 v[32:35], a[140:143], a[76:79], 0
    v_exp_f32 v21, v21
    v_mfma_f32_16x16x32_bf16 v[32:35], a[136:139], a[72:75], v[32:35]
    ds_read_b64_tr_b16 a[174:175], v4 offset:27656
    v_cvt_pk_bf16_f32 v80, v20, v21
    v_mfma_f32_16x16x32_bf16 v[32:35], a[132:135], a[68:71], v[32:35]
    ds_read_b64_tr_b16 a[168:169], v4 offset:18440
    v_mul_f32 v28, s20, v28
    v_mfma_f32_16x16x32_bf16 v[32:35], a[128:131], a[64:67], v[32:35]
    s_waitcnt lgkmcnt(7)
    ds_read_b64_tr_b16 a[170:171], v4 offset:26632
    v_mul_f32 v29, s20, v29
    v_mfma_f32_16x16x32_bf16 v[92:95], a[144:147], v[36:39], v[92:95]
    s_add_u32 m0, s27, 0
    v_xor_b32 v3, 0x8000, v3
    v_xor_b32 v4, 0x8000, v4
    v_mfma_f32_16x16x32_bf16 v[92:95], a[148:151], v[68:71], v[92:95]
    v_exp_f32 v22, v22
    v_mfma_f32_16x16x32_bf16 v[96:99], a[156:159], v[68:71], v[96:99]
    buffer_load_dwordx4 v5, s[64:67], 0 offen lds
    v_mul_f32 v30, s20, v30
    v_mfma_f32_16x16x32_bf16 v[96:99], a[152:155], v[36:39], v[96:99]
    s_waitcnt lgkmcnt(0)
    v_exp_f32 v23, v23
    v_mfma_f32_16x16x32_bf16 v[100:103], a[160:163], v[36:39], v[100:103]
    v_cvt_pk_bf16_f32 v81, v22, v23
    v_mul_f32 v31, s20, v31
    v_mfma_f32_16x16x32_bf16 v[100:103], a[164:167], v[68:71], v[100:103]
    v_exp_f32 v24, v24
    v_mfma_f32_16x16x32_bf16 v[104:107], a[172:175], v[68:71], v[104:107]
    v_exp_f32 v25, v25
    v_mfma_f32_16x16x32_bf16 v[104:107], a[168:171], v[36:39], v[104:107]
    s_add_u32 m0, s27, 896
    v_exp_f32 v26, v26
    v_mfma_f32_16x16x32_bf16 v[20:23], a[112:115], a[80:83], 0
    v_exp_f32 v27, v27
    v_mfma_f32_16x16x32_bf16 v[20:23], a[116:119], a[84:87], v[20:23]
    v_cvt_pk_bf16_f32 v82, v24, v25
    v_cvt_pk_bf16_f32 v83, v26, v27
    v_mfma_f32_16x16x32_bf16 v[20:23], a[120:123], a[88:91], v[20:23]
    buffer_load_dwordx4 v5, s[64:67], 0 offen offset:128 lds
    v_mul_f32 v32, s20, v32
    v_mfma_f32_16x16x32_bf16 v[20:23], a[124:127], a[92:95], v[20:23]
    v_exp_f32 v28, v28
    v_mfma_f32_16x16x32_bf16 v[24:27], a[140:143], a[92:95], 0
    v_exp_f32 v29, v29
    v_mfma_f32_16x16x32_bf16 v[24:27], a[136:139], a[88:91], v[24:27]
    v_exp_f32 v30, v30
    v_mfma_f32_16x16x32_bf16 v[24:27], a[132:135], a[84:87], v[24:27]
    v_exp_f32 v31, v31
    v_mfma_f32_16x16x32_bf16 v[24:27], a[128:131], a[80:83], v[24:27]
    s_add_u32 m0, s27, 1920
    v_cvt_pk_bf16_f32 v84, v28, v29
    v_cvt_pk_bf16_f32 v85, v30, v31
    v_mfma_f32_16x16x32_bf16 v[124:127], a[144:147], v[40:43], v[124:127]
    v_mul_f32 v33, s20, v33
    v_mul_f32 v34, s20, v34
    v_mfma_f32_16x16x32_bf16 v[124:127], a[148:151], v[72:75], v[124:127]
    v_exp_f32 v32, v32
    v_mfma_f32_16x16x32_bf16 v[128:131], a[156:159], v[72:75], v[128:131]
    buffer_load_dwordx4 v5, s[68:71], 0 offen offset:128 lds
    v_mul_f32 v35, s20, v35
    v_mfma_f32_16x16x32_bf16 v[128:131], a[152:155], v[40:43], v[128:131]
    v_exp_f32 v33, v33
    v_mfma_f32_16x16x32_bf16 v[132:135], a[160:163], v[40:43], v[132:135]
    v_exp_f32 v34, v34
    v_mfma_f32_16x16x32_bf16 v[132:135], a[164:167], v[72:75], v[132:135]
    v_exp_f32 v35, v35
    v_mfma_f32_16x16x32_bf16 v[136:139], a[172:175], v[72:75], v[136:139]
    v_cvt_pk_bf16_f32 v86, v32, v33
    v_cvt_pk_bf16_f32 v87, v34, v35
    v_mfma_f32_16x16x32_bf16 v[136:139], a[168:171], v[40:43], v[136:139]
    s_add_u32 m0, s27, 2944
    v_mul_f32 v20, s20, v20
    v_mul_f32 v21, s20, v21
    v_smfmac_f32_16x16x64_bf16 a[176:179], v[16:19], v[36:43], v252
    v_mul_f32 v22, s20, v22
    v_smfmac_f32_16x16x64_bf16 a[176:179], v[16:19], v[68:75], v252
    v_mul_f32 v23, s20, v23
    v_mfma_f32_16x16x32_bf16 v[28:31], a[112:115], a[96:99], 0
    buffer_load_dwordx4 v5, s[88:91], 0 offen offset:128 lds
    v_mul_f32 v24, s20, v24
    v_mfma_f32_16x16x32_bf16 v[28:31], a[116:119], a[100:103], v[28:31]
    s_add_u32 s27, s27, 16384
    ds_read_b128 a[112:115], v1 offset:16384
    v_mul_f32 v25, s20, v25
    v_mfma_f32_16x16x32_bf16 v[28:31], a[120:123], a[104:107], v[28:31]
    s_and_b32 s27, s27, 0xffff
    ds_read_b128 a[116:119], v2 offset:16384
    v_mul_f32 v26, s20, v26
    v_mfma_f32_16x16x32_bf16 v[28:31], a[124:127], a[108:111], v[28:31]
    s_mov_b64 s[68:69], s[88:89]
    ds_read_b128 a[120:123], v1 offset:17408
    v_mul_f32 v27, s20, v27
    v_mfma_f32_16x16x32_bf16 v[32:35], a[140:143], a[108:111], 0
    s_mov_b32 s70, s90
    ds_read_b128 a[124:127], v2 offset:17408
    ds_read_b128 v[12:15], v7
    v_mfma_f32_16x16x32_bf16 v[32:35], a[136:139], a[104:107], v[32:35]
    s_add_u32 s88, s88, 8192
    v_exp_f32 v20, v20
    v_mfma_f32_16x16x32_bf16 v[32:35], a[132:135], a[100:103], v[32:35]
    s_addc_u32 s89, s89, 0
    ds_read_b128 a[140:143], v2 offset:25600
    v_mul_f32 v28, s20, v28
    v_mfma_f32_16x16x32_bf16 v[32:35], a[128:131], a[96:99], v[32:35]
    s_mov_b32 s90, s66
    ds_read_b128 a[136:139], v1 offset:25600
    v_mul_f32 v29, s20, v29
    v_mfma_f32_16x16x32_bf16 v[156:159], a[144:147], v[44:47], v[156:159]
    s_add_u32 s64, s64, 8192
    v_exp_f32 v21, v21
    v_mfma_f32_16x16x32_bf16 v[156:159], a[148:151], v[76:79], v[156:159]
    s_addc_u32 s65, s65, 0
    ds_read_b128 a[132:135], v2 offset:24576
    v_xor_b32 v2, 0x8000, v2
    v_mfma_f32_16x16x32_bf16 v[160:163], a[156:159], v[76:79], v[160:163]
    s_add_u32 s23, s23, 1
    ds_read_b128 a[128:131], v1 offset:24576
    v_xor_b32 v1, 0x8000, v1
    v_mfma_f32_16x16x32_bf16 v[160:163], a[152:155], v[44:47], v[160:163]
    s_cmp_lt_u32 s23, 64
    v_exp_f32 v22, v22
    v_mfma_f32_16x16x32_bf16 v[164:167], a[160:163], v[44:47], v[164:167]
    s_cselect_b32 s66, 8192, 0
    v_exp_f32 v23, v23
    v_mfma_f32_16x16x32_bf16 v[164:167], a[164:167], v[76:79], v[164:167]
    v_cvt_pk_bf16_f32 v88, v20, v21
    v_cvt_pk_bf16_f32 v89, v22, v23
    v_mfma_f32_16x16x32_bf16 v[168:171], a[172:175], v[76:79], v[168:171]
    s_waitcnt lgkmcnt(4)
    buffer_store_dwordx4 v[12:15], v6, s[76:79], 0 offen nt
    v_exp_f32 v24, v24
    v_exp_f32 v25, v25
    v_mfma_f32_16x16x32_bf16 v[168:171], a[168:171], v[44:47], v[168:171]
    s_add_u32 s76, s76, s29
    v_exp_f32 v26, v26
    v_mfma_f32_16x16x32_bf16 v[20:23], a[112:115], a[0:3], 0
    s_addc_u32 s77, s77, 0
    v_exp_f32 v27, v27
    v_mfma_f32_16x16x32_bf16 v[20:23], a[116:119], a[4:7], v[20:23]
    v_cvt_pk_bf16_f32 v90, v24, v25
    v_cvt_pk_bf16_f32 v91, v26, v27
    v_mfma_f32_16x16x32_bf16 v[20:23], a[120:123], a[8:11], v[20:23]
    v_exp_f32 v28, v28
    v_mfma_f32_16x16x32_bf16 v[20:23], a[124:127], a[12:15], v[20:23]
    s_waitcnt lgkmcnt(0)
    v_exp_f32 v29, v29
    v_mfma_f32_16x16x32_bf16 v[24:27], a[140:143], a[12:15], 0
    s_mov_b32 m0, s31
    v_mul_f32 v30, s20, v30
    v_mul_f32 v31, s20, v31
    v_mfma_f32_16x16x32_bf16 v[24:27], a[136:139], a[8:11], v[24:27]
    ds_read_b128 v[12:15], v7 offset:1024
    v_cvt_pk_bf16_f32 v64, v28, v29
    v_mfma_f32_16x16x32_bf16 v[24:27], a[132:135], a[4:7], v[24:27]
    buffer_load_dwordx4 v6, s[72:75], 0 offen nt lds
    v_mul_f32 v32, s20, v32
    v_mfma_f32_16x16x32_bf16 v[24:27], a[128:131], a[0:3], v[24:27]
    s_add_u32 s72, s72, s29
    v_exp_f32 v30, v30
    v_mfma_f32_16x16x32_bf16 v[188:191], a[144:147], v[48:51], v[188:191]
    s_addc_u32 s73, s73, 0
    v_exp_f32 v31, v31
    v_mfma_f32_16x16x32_bf16 v[188:191], a[148:151], v[80:83], v[188:191]
    s_xor_b32 s29, s29, 0x700
    v_cvt_pk_bf16_f32 v65, v30, v31
    v_mul_f32 v33, s20, v33
    v_mfma_f32_16x16x32_bf16 v[192:195], a[156:159], v[80:83], v[192:195]
    s_add_u32 s31, s31, 1024
    v_exp_f32 v32, v32
    v_mfma_f32_16x16x32_bf16 v[192:195], a[152:155], v[48:51], v[192:195]
    v_exp_f32 v33, v33
    v_mfma_f32_16x16x32_bf16 v[196:199], a[160:163], v[48:51], v[196:199]
    v_mul_f32 v34, s20, v34
    v_mul_f32 v35, s20, v35
    v_mfma_f32_16x16x32_bf16 v[196:199], a[164:167], v[80:83], v[196:199]
    v_exp_f32 v34, v34
    v_mfma_f32_16x16x32_bf16 v[200:203], a[172:175], v[80:83], v[200:203]
    s_waitcnt lgkmcnt(0)
    buffer_store_dwordx4 v[12:15], v6, s[76:79], 0 offen nt
    v_exp_f32 v35, v35
    v_cvt_pk_bf16_f32 v66, v32, v33
    v_cvt_pk_bf16_f32 v67, v34, v35
    v_mfma_f32_16x16x32_bf16 v[200:203], a[168:171], v[48:51], v[200:203]
    s_add_u32 s76, s76, s29
    v_mul_f32 v20, s20, v20
    v_mul_f32 v21, s20, v21
    v_smfmac_f32_16x16x64_bf16 a[180:183], v[16:19], v[44:51], v252
    s_addc_u32 s77, s77, 0
    v_mul_f32 v22, s20, v22
    v_smfmac_f32_16x16x64_bf16 a[180:183], v[16:19], v[76:83], v252
    v_mul_f32 v23, s20, v23
    v_mfma_f32_16x16x32_bf16 v[28:31], a[112:115], a[16:19], 0
    v_exp_f32 v20, v20
    v_mfma_f32_16x16x32_bf16 v[28:31], a[116:119], a[20:23], v[28:31]
    s_mov_b32 m0, s31
    v_exp_f32 v21, v21
    v_mfma_f32_16x16x32_bf16 v[28:31], a[120:123], a[24:27], v[28:31]
    v_exp_f32 v22, v22
    v_mfma_f32_16x16x32_bf16 v[28:31], a[124:127], a[28:31], v[28:31]
    ds_read_b128 v[12:15], v7 offset:2048
    v_add_u32 v7, 3072, v7
    v_mfma_f32_16x16x32_bf16 v[32:35], a[140:143], a[28:31], 0
    buffer_load_dwordx4 v6, s[72:75], 0 offen nt lds
    v_cvt_pk_bf16_f32 v36, v20, v21
    v_mfma_f32_16x16x32_bf16 v[32:35], a[136:139], a[24:27], v[32:35]
    s_add_u32 s72, s72, s29
    v_exp_f32 v23, v23
    v_mfma_f32_16x16x32_bf16 v[32:35], a[132:135], a[20:23], v[32:35]
    s_addc_u32 s73, s73, 0
    v_cvt_pk_bf16_f32 v37, v22, v23
    v_mul_f32 v24, s20, v24
    v_mfma_f32_16x16x32_bf16 v[32:35], a[128:131], a[16:19], v[32:35]
    s_xor_b32 s29, s29, 0x700
    v_mul_f32 v25, s20, v25
    v_mul_f32 v26, s20, v26
    v_mfma_f32_16x16x32_bf16 v[220:223], a[144:147], v[52:55], v[220:223]
    s_add_u32 s31, s31, 1024
    v_exp_f32 v24, v24
    v_mfma_f32_16x16x32_bf16 v[220:223], a[148:151], v[84:87], v[220:223]
    v_exp_f32 v25, v25
    v_mfma_f32_16x16x32_bf16 v[224:227], a[156:159], v[84:87], v[224:227]
    v_mul_f32 v27, s20, v27
    v_cvt_pk_bf16_f32 v38, v24, v25
    v_mfma_f32_16x16x32_bf16 v[224:227], a[152:155], v[52:55], v[224:227]
    v_exp_f32 v26, v26
    v_mfma_f32_16x16x32_bf16 v[228:231], a[160:163], v[52:55], v[228:231]
    s_waitcnt lgkmcnt(0)
    buffer_store_dwordx4 v[12:15], v6, s[76:79], 0 offen nt
    v_exp_f32 v27, v27
    v_mul_f32 v28, s20, v28
    v_cvt_pk_bf16_f32 v39, v26, v27
    v_mfma_f32_16x16x32_bf16 v[228:231], a[164:167], v[84:87], v[228:231]
    s_add_u32 s76, s76, s29
    v_mul_f32 v29, s20, v29
    v_mul_f32 v30, s20, v30
    v_mfma_f32_16x16x32_bf16 v[232:235], a[172:175], v[84:87], v[232:235]
    s_addc_u32 s77, s77, 0
    v_exp_f32 v28, v28
    v_mfma_f32_16x16x32_bf16 v[232:235], a[168:171], v[52:55], v[232:235]
    v_exp_f32 v29, v29
    v_mfma_f32_16x16x32_bf16 v[20:23], a[112:115], a[32:35], 0
    v_mul_f32 v31, s20, v31
    v_cvt_pk_bf16_f32 v40, v28, v29
    v_mfma_f32_16x16x32_bf16 v[20:23], a[116:119], a[36:39], v[20:23]
    s_mov_b32 m0, s31
    v_exp_f32 v30, v30
    v_mfma_f32_16x16x32_bf16 v[20:23], a[120:123], a[40:43], v[20:23]
    v_exp_f32 v31, v31
    v_mfma_f32_16x16x32_bf16 v[20:23], a[124:127], a[44:47], v[20:23]
    v_cvt_pk_bf16_f32 v41, v30, v31
    v_mul_f32 v32, s20, v32
    v_mfma_f32_16x16x32_bf16 v[24:27], a[140:143], a[44:47], 0
    buffer_load_dwordx4 v6, s[72:75], 0 offen nt lds
    v_mul_f32 v33, s20, v33
    v_mfma_f32_16x16x32_bf16 v[24:27], a[136:139], a[40:43], v[24:27]
    s_add_u32 s72, s72, s29
    v_exp_f32 v32, v32
    v_mfma_f32_16x16x32_bf16 v[24:27], a[132:135], a[36:39], v[24:27]
    s_addc_u32 s73, s73, 0
    v_exp_f32 v33, v33
    v_mfma_f32_16x16x32_bf16 v[24:27], a[128:131], a[32:35], v[24:27]
    s_xor_b32 s29, s29, 0x700
    v_mul_f32 v34, s20, v34
    v_mul_f32 v35, s20, v35
    v_mfma_f32_16x16x32_bf16 a[192:195], a[144:147], v[56:59], a[192:195]
    s_add_u32 s31, s31, 1024
    v_exp_f32 v34, v34
    v_mfma_f32_16x16x32_bf16 a[192:195], a[148:151], v[88:91], a[192:195]
    v_exp_f32 v35, v35
    v_mfma_f32_16x16x32_bf16 a[196:199], a[156:159], v[88:91], a[196:199]
    v_cvt_pk_bf16_f32 v42, v32, v33
    v_cvt_pk_bf16_f32 v43, v34, v35
    v_mfma_f32_16x16x32_bf16 a[196:199], a[152:155], v[56:59], a[196:199]
    v_mul_f32 v20, s20, v20
    v_mul_f32 v21, s20, v21
    v_mfma_f32_16x16x32_bf16 a[200:203], a[160:163], v[56:59], a[200:203]
    v_exp_f32 v20, v20
    v_mfma_f32_16x16x32_bf16 a[200:203], a[164:167], v[88:91], a[200:203]
    v_exp_f32 v21, v21
    v_mfma_f32_16x16x32_bf16 a[204:207], a[172:175], v[88:91], a[204:207]
    v_mul_f32 v22, s20, v22
    v_mul_f32 v23, s20, v23
    v_mfma_f32_16x16x32_bf16 a[204:207], a[168:171], v[56:59], a[204:207]
    v_exp_f32 v22, v22
    v_smfmac_f32_16x16x64_bf16 a[184:187], v[16:19], v[52:59], v252
    v_cvt_pk_bf16_f32 v44, v20, v21
    v_smfmac_f32_16x16x64_bf16 a[184:187], v[16:19], v[84:91], v252
    v_mul_f32 v24, s20, v24
    v_mfma_f32_16x16x32_bf16 v[28:31], a[112:115], a[48:51], 0
    v_exp_f32 v23, v23
    v_mfma_f32_16x16x32_bf16 v[28:31], a[116:119], a[52:55], v[28:31]
    v_cvt_pk_bf16_f32 v45, v22, v23
    v_mul_f32 v25, s20, v25
    v_mfma_f32_16x16x32_bf16 v[28:31], a[120:123], a[56:59], v[28:31]
    v_exp_f32 v24, v24
    v_mfma_f32_16x16x32_bf16 v[28:31], a[124:127], a[60:63], v[28:31]
    v_exp_f32 v25, v25
    v_mfma_f32_16x16x32_bf16 v[32:35], a[140:143], a[60:63], 0
    v_mul_f32 v26, s20, v26
    v_mul_f32 v27, s20, v27
    v_mfma_f32_16x16x32_bf16 v[32:35], a[136:139], a[56:59], v[32:35]
    s_waitcnt vmcnt(20) lgkmcnt(0)
    v_exp_f32 v26, v26
    v_mfma_f32_16x16x32_bf16 v[32:35], a[132:135], a[52:55], v[32:35]
    s_barrier
    v_cvt_pk_bf16_f32 v46, v24, v25
    v_mfma_f32_16x16x32_bf16 v[32:35], a[128:131], a[48:51], v[32:35]
    v_exp_f32 v27, v27
    v_mfma_f32_16x16x32_bf16 a[224:227], a[144:147], v[60:63], a[224:227]
    ds_read_b64_tr_b16 a[144:145], v3 offset:2048
    v_cvt_pk_bf16_f32 v47, v26, v27
    v_mfma_f32_16x16x32_bf16 a[224:227], a[148:151], v[64:67], a[224:227]
    ds_read_b64_tr_b16 a[146:147], v3 offset:10240
    v_mul_f32 v28, s20, v28
    v_mfma_f32_16x16x32_bf16 a[228:231], a[156:159], v[64:67], a[228:231]
    ds_read_b64_tr_b16 a[148:149], v3 offset:3072
    v_mul_f32 v29, s20, v29
    v_mfma_f32_16x16x32_bf16 a[228:231], a[152:155], v[60:63], a[228:231]
    ds_read_b64_tr_b16 a[150:151], v3 offset:11264
    v_mul_f32 v30, s20, v30
    v_mfma_f32_16x16x32_bf16 a[232:235], a[160:163], v[60:63], a[232:235]
    ds_read_b64_tr_b16 a[156:157], v3 offset:3080
    v_mul_f32 v31, s20, v31
    v_mfma_f32_16x16x32_bf16 a[232:235], a[164:167], v[64:67], a[232:235]
    ds_read_b64_tr_b16 a[158:159], v3 offset:11272
    v_mul_f32 v32, s20, v32
    v_mfma_f32_16x16x32_bf16 a[236:239], a[172:175], v[64:67], a[236:239]
    ds_read_b64_tr_b16 a[152:153], v3 offset:2056
    v_mul_f32 v33, s20, v33
    v_mfma_f32_16x16x32_bf16 a[236:239], a[168:171], v[60:63], a[236:239]
    ds_read_b64_tr_b16 a[154:155], v3 offset:10248
    v_mul_f32 v34, s20, v34
    v_smfmac_f32_16x16x64_bf16 a[188:191], v[16:19], v[60:67], v252
    ds_read_b64_tr_b16 a[160:161], v4 offset:2048
    v_mfma_f32_16x16x32_bf16 v[20:23], a[112:115], a[64:67], 0
    ds_read_b64_tr_b16 a[162:163], v4 offset:10240
    v_mul_f32 v35, s20, v35
    v_mfma_f32_16x16x32_bf16 v[20:23], a[116:119], a[68:71], v[20:23]
    ds_read_b64_tr_b16 a[164:165], v4 offset:3072
    ds_read_b64_tr_b16 a[166:167], v4 offset:11264
    v_mfma_f32_16x16x32_bf16 v[20:23], a[120:123], a[72:75], v[20:23]
    v_exp_f32 v28, v28
    v_mfma_f32_16x16x32_bf16 v[20:23], a[124:127], a[76:79], v[20:23]
    s_sub_u32 s32, s32, 1
    ds_read_b64_tr_b16 a[172:173], v4 offset:3080
    ds_read_b64_tr_b16 a[174:175], v4 offset:11272
    v_mfma_f32_16x16x32_bf16 v[24:27], a[140:143], a[76:79], 0
    v_exp_f32 v29, v29
    v_mfma_f32_16x16x32_bf16 v[24:27], a[136:139], a[72:75], v[24:27]
    ds_read_b64_tr_b16 a[168:169], v4 offset:2056
    v_cvt_pk_bf16_f32 v48, v28, v29
    v_mfma_f32_16x16x32_bf16 v[24:27], a[132:135], a[68:71], v[24:27]
    ds_read_b64_tr_b16 a[170:171], v4 offset:10248
    v_mul_f32 v20, s20, v20
    v_mfma_f32_16x16x32_bf16 v[24:27], a[128:131], a[64:67], v[24:27]
    s_cbranch_scc0 L_bodyoq7
    s_nop 0
L_tail7:
    s_waitcnt lgkmcnt(8)
    v_exp_f32 v30, v30
    v_mfma_f32_16x16x32_bf16 v[108:111], a[144:147], v[68:71], v[108:111]
    s_add_u32 m0, s27, 0
    v_exp_f32 v31, v31
    v_mfma_f32_16x16x32_bf16 v[108:111], a[148:151], v[36:39], v[108:111]
    v_cvt_pk_bf16_f32 v49, v30, v31
    v_mul_f32 v21, s20, v21
    v_mfma_f32_16x16x32_bf16 v[112:115], a[156:159], v[36:39], v[112:115]
    buffer_load_dwordx4 v5, s[64:67], 0 offen lds
    v_mul_f32 v22, s20, v22
    v_mfma_f32_16x16x32_bf16 v[112:115], a[152:155], v[68:71], v[112:115]
    s_waitcnt lgkmcnt(0)
    v_exp_f32 v32, v32
    v_mfma_f32_16x16x32_bf16 v[116:119], a[160:163], v[68:71], v[116:119]
    v_exp_f32 v33, v33
    v_mfma_f32_16x16x32_bf16 v[116:119], a[164:167], v[36:39], v[116:119]
    v_exp_f32 v34, v34
    v_mfma_f32_16x16x32_bf16 v[120:123], a[172:175], v[36:39], v[120:123]
    v_exp_f32 v35, v35
    v_mfma_f32_16x16x32_bf16 v[120:123], a[168:171], v[68:71], v[120:123]
    s_add_u32 m0, s27, 896
    v_cvt_pk_bf16_f32 v50, v32, v33
    v_cvt_pk_bf16_f32 v51, v34, v35
    v_mfma_f32_16x16x32_bf16 v[28:31], a[112:115], a[80:83], 0
    v_exp_f32 v20, v20
    v_mfma_f32_16x16x32_bf16 v[28:31], a[116:119], a[84:87], v[28:31]
    v_exp_f32 v21, v21
    v_mfma_f32_16x16x32_bf16 v[28:31], a[120:123], a[88:91], v[28:31]
    buffer_load_dwordx4 v5, s[64:67], 0 offen offset:128 lds
    v_mul_f32 v23, s20, v23
    v_mfma_f32_16x16x32_bf16 v[28:31], a[124:127], a[92:95], v[28:31]
    v_exp_f32 v22, v22
    v_mfma_f32_16x16x32_bf16 v[32:35], a[140:143], a[92:95], 0
    v_exp_f32 v23, v23
    v_mfma_f32_16x16x32_bf16 v[32:35], a[136:139], a[88:91], v[32:35]
    v_cvt_pk_bf16_f32 v52, v20, v21
    v_cvt_pk_bf16_f32 v53, v22, v23
    v_mfma_f32_16x16x32_bf16 v[32:35], a[132:135], a[84:87], v[32:35]
    v_mul_f32 v24, s20, v24
    v_mul_f32 v25, s20, v25
    v_mfma_f32_16x16x32_bf16 v[32:35], a[128:131], a[80:83], v[32:35]
    s_add_u32 m0, s27, 2048
    v_exp_f32 v24, v24
    v_mfma_f32_16x16x32_bf16 v[140:143], a[144:147], v[72:75], v[140:143]
    v_exp_f32 v25, v25
    v_mfma_f32_16x16x32_bf16 v[140:143], a[148:151], v[40:43], v[140:143]
    v_mul_f32 v26, s20, v26
    v_mul_f32 v27, s20, v27
    v_mfma_f32_16x16x32_bf16 v[144:147], a[156:159], v[40:43], v[144:147]
    buffer_load_dwordx4 v5, s[68:71], 0 offen lds
    v_cvt_pk_bf16_f32 v54, v24, v25
    v_mfma_f32_16x16x32_bf16 v[144:147], a[152:155], v[72:75], v[144:147]
    v_exp_f32 v26, v26
    v_mfma_f32_16x16x32_bf16 v[148:151], a[160:163], v[72:75], v[148:151]
    v_exp_f32 v27, v27
    v_mfma_f32_16x16x32_bf16 v[148:151], a[164:167], v[40:43], v[148:151]
    v_cvt_pk_bf16_f32 v55, v26, v27
    v_mul_f32 v28, s20, v28
    v_mfma_f32_16x16x32_bf16 v[152:155], a[172:175], v[40:43], v[152:155]
    v_mul_f32 v29, s20, v29
    v_mul_f32 v30, s20, v30
    v_mfma_f32_16x16x32_bf16 v[152:155], a[168:171], v[72:75], v[152:155]
    s_add_u32 m0, s27, 3072
    v_exp_f32 v28, v28
    v_mfma_f32_16x16x32_bf16 v[20:23], a[112:115], a[96:99], 0
    ds_read_b128 a[112:115], v1
    v_mul_f32 v31, s20, v31
    v_mfma_f32_16x16x32_bf16 v[20:23], a[116:119], a[100:103], v[20:23]
    ds_read_b128 a[116:119], v2
    v_mul_f32 v32, s20, v32
    v_mfma_f32_16x16x32_bf16 v[20:23], a[120:123], a[104:107], v[20:23]
    buffer_load_dwordx4 v5, s[88:91], 0 offen lds
    v_mul_f32 v33, s20, v33
    v_mfma_f32_16x16x32_bf16 v[20:23], a[124:127], a[108:111], v[20:23]
    s_add_u32 s27, s27, 16384
    ds_read_b128 a[120:123], v1 offset:1024
    v_mul_f32 v34, s20, v34
    v_mfma_f32_16x16x32_bf16 v[24:27], a[140:143], a[108:111], 0
    s_and_b32 s27, s27, 0xffff
    ds_read_b128 a[124:127], v2 offset:1024
    v_mul_f32 v35, s20, v35
    v_mfma_f32_16x16x32_bf16 v[24:27], a[136:139], a[104:107], v[24:27]
    s_mov_b64 s[68:69], s[88:89]
    v_exp_f32 v29, v29
    v_mfma_f32_16x16x32_bf16 v[24:27], a[132:135], a[100:103], v[24:27]
    s_mov_b32 s70, s90
    ds_read_b128 a[140:143], v2 offset:9216
    v_cvt_pk_bf16_f32 v56, v28, v29
    v_mfma_f32_16x16x32_bf16 v[24:27], a[128:131], a[96:99], v[24:27]
    s_add_u32 s88, s88, 8192
    ds_read_b128 a[136:139], v1 offset:9216
    v_mul_f32 v20, s20, v20
    v_mfma_f32_16x16x32_bf16 v[172:175], a[144:147], v[76:79], v[172:175]
    s_addc_u32 s89, s89, 0
    v_exp_f32 v30, v30
    v_mfma_f32_16x16x32_bf16 v[172:175], a[148:151], v[44:47], v[172:175]
    s_mov_b32 s90, s66
    ds_read_b128 a[132:135], v2 offset:8192
    v_mul_f32 v21, s20, v21
    v_mfma_f32_16x16x32_bf16 v[176:179], a[156:159], v[44:47], v[176:179]
    s_add_u32 s64, s64, 8192
    ds_read_b128 a[128:131], v1 offset:8192
    v_mul_f32 v22, s20, v22
    v_mfma_f32_16x16x32_bf16 v[176:179], a[152:155], v[76:79], v[176:179]
    s_addc_u32 s65, s65, 0
    v_exp_f32 v31, v31
    v_mfma_f32_16x16x32_bf16 v[180:183], a[160:163], v[76:79], v[180:183]
    s_add_u32 s23, s23, 1
    v_cvt_pk_bf16_f32 v57, v30, v31
    v_mul_f32 v23, s20, v23
    v_mfma_f32_16x16x32_bf16 v[180:183], a[164:167], v[44:47], v[180:183]
    s_cmp_lt_u32 s23, 64
    v_exp_f32 v32, v32
    v_mfma_f32_16x16x32_bf16 v[184:187], a[172:175], v[44:47], v[184:187]
    s_cselect_b32 s66, 8192, 0
    v_exp_f32 v33, v33
    v_mfma_f32_16x16x32_bf16 v[184:187], a[168:171], v[76:79], v[184:187]
    s_waitcnt lgkmcnt(4)
    v_exp_f32 v34, v34
    v_mfma_f32_16x16x32_bf16 v[28:31], a[112:115], a[0:3], 0
    v_exp_f32 v35, v35
    v_mfma_f32_16x16x32_bf16 v[28:31], a[116:119], a[4:7], v[28:31]
    v_cvt_pk_bf16_f32 v58, v32, v33
    v_cvt_pk_bf16_f32 v59, v34, v35
    v_mfma_f32_16x16x32_bf16 v[28:31], a[120:123], a[8:11], v[28:31]
    v_exp_f32 v20, v20
    v_mfma_f32_16x16x32_bf16 v[28:31], a[124:127], a[12:15], v[28:31]
    s_waitcnt lgkmcnt(0)
    v_exp_f32 v21, v21
    v_mfma_f32_16x16x32_bf16 v[32:35], a[140:143], a[12:15], 0
    v_exp_f32 v22, v22
    v_mfma_f32_16x16x32_bf16 v[32:35], a[136:139], a[8:11], v[32:35]
    v_exp_f32 v23, v23
    v_mfma_f32_16x16x32_bf16 v[32:35], a[132:135], a[4:7], v[32:35]
    v_cvt_pk_bf16_f32 v60, v20, v21
    v_cvt_pk_bf16_f32 v61, v22, v23
    v_mfma_f32_16x16x32_bf16 v[32:35], a[128:131], a[0:3], v[32:35]
    v_mul_f32 v24, s20, v24
    v_mul_f32 v25, s20, v25
    v_mfma_f32_16x16x32_bf16 v[204:207], a[144:147], v[80:83], v[204:207]
    v_exp_f32 v24, v24
    v_mfma_f32_16x16x32_bf16 v[204:207], a[148:151], v[48:51], v[204:207]
    v_exp_f32 v25, v25
    v_mfma_f32_16x16x32_bf16 v[208:211], a[156:159], v[48:51], v[208:211]
    v_mul_f32 v26, s20, v26
    v_mul_f32 v27, s20, v27
    v_mfma_f32_16x16x32_bf16 v[208:211], a[152:155], v[80:83], v[208:211]
    v_exp_f32 v26, v26
    v_mfma_f32_16x16x32_bf16 v[212:215], a[160:163], v[80:83], v[212:215]
    v_exp_f32 v27, v27
    v_mfma_f32_16x16x32_bf16 v[212:215], a[164:167], v[48:51], v[212:215]
    v_cvt_pk_bf16_f32 v62, v24, v25
    v_cvt_pk_bf16_f32 v63, v26, v27
    v_mfma_f32_16x16x32_bf16 v[216:219], a[172:175], v[48:51], v[216:219]
    v_mul_f32 v28, s20, v28
    v_mul_f32 v29, s20, v29
    v_mfma_f32_16x16x32_bf16 v[216:219], a[168:171], v[80:83], v[216:219]
    v_exp_f32 v28, v28
    v_mfma_f32_16x16x32_bf16 v[20:23], a[112:115], a[16:19], 0
    v_exp_f32 v29, v29
    v_mfma_f32_16x16x32_bf16 v[20:23], a[116:119], a[20:23], v[20:23]
    v_mul_f32 v30, s20, v30
    v_mul_f32 v31, s20, v31
    v_mfma_f32_16x16x32_bf16 v[20:23], a[120:123], a[24:27], v[20:23]
    v_exp_f32 v30, v30
    v_mfma_f32_16x16x32_bf16 v[20:23], a[124:127], a[28:31], v[20:23]
    v_exp_f32 v31, v31
    v_mfma_f32_16x16x32_bf16 v[24:27], a[140:143], a[28:31], 0
    v_cvt_pk_bf16_f32 v68, v28, v29
    v_cvt_pk_bf16_f32 v69, v30, v31
    v_mfma_f32_16x16x32_bf16 v[24:27], a[136:139], a[24:27], v[24:27]
    v_mul_f32 v32, s20, v32
    v_mul_f32 v33, s20, v33
    v_mfma_f32_16x16x32_bf16 v[24:27], a[132:135], a[20:23], v[24:27]
    v_exp_f32 v32, v32
    v_mfma_f32_16x16x32_bf16 v[24:27], a[128:131], a[16:19], v[24:27]
    v_exp_f32 v33, v33
    v_mfma_f32_16x16x32_bf16 v[236:239], a[144:147], v[84:87], v[236:239]
    v_mul_f32 v34, s20, v34
    v_mul_f32 v35, s20, v35
    v_mfma_f32_16x16x32_bf16 v[236:239], a[148:151], v[52:55], v[236:239]
    v_exp_f32 v34, v34
    v_mfma_f32_16x16x32_bf16 v[240:243], a[156:159], v[52:55], v[240:243]
    v_exp_f32 v35, v35
    v_mfma_f32_16x16x32_bf16 v[240:243], a[152:155], v[84:87], v[240:243]
    v_cvt_pk_bf16_f32 v70, v32, v33
    v_cvt_pk_bf16_f32 v71, v34, v35
    v_mfma_f32_16x16x32_bf16 v[244:247], a[160:163], v[84:87], v[244:247]
    v_mul_f32 v20, s20, v20
    v_mul_f32 v21, s20, v21
    v_mfma_f32_16x16x32_bf16 v[244:247], a[164:167], v[52:55], v[244:247]
    v_exp_f32 v20, v20
    v_mfma_f32_16x16x32_bf16 v[248:251], a[172:175], v[52:55], v[248:251]
    v_exp_f32 v21, v21
    v_mfma_f32_16x16x32_bf16 v[248:251], a[168:171], v[84:87], v[248:251]
    v_mul_f32 v22, s20, v22
    v_mul_f32 v23, s20, v23
    v_mfma_f32_16x16x32_bf16 v[28:31], a[112:115], a[32:35], 0
    v_exp_f32 v22, v22
    v_mfma_f32_16x16x32_bf16 v[28:31], a[116:119], a[36:39], v[28:31]
    v_exp_f32 v23, v23
    v_mfma_f32_16x16x32_bf16 v[28:31], a[120:123], a[40:43], v[28:31]
    v_cvt_pk_bf16_f32 v72, v20, v21
    v_cvt_pk_bf16_f32 v73, v22, v23
    v_mfma_f32_16x16x32_bf16 v[28:31], a[124:127], a[44:47], v[28:31]
    v_mul_f32 v24, s20, v24
    v_mul_f32 v25, s20, v25
    v_mfma_f32_16x16x32_bf16 v[32:35], a[140:143], a[44:47], 0
    v_exp_f32 v24, v24
    v_mfma_f32_16x16x32_bf16 v[32:35], a[136:139], a[40:43], v[32:35]
    v_exp_f32 v25, v25
    v_mfma_f32_16x16x32_bf16 v[32:35], a[132:135], a[36:39], v[32:35]
    v_mul_f32 v26, s20, v26
    v_mul_f32 v27, s20, v27
    v_mfma_f32_16x16x32_bf16 v[32:35], a[128:131], a[32:35], v[32:35]
    v_exp_f32 v26, v26
    v_mfma_f32_16x16x32_bf16 a[208:211], a[144:147], v[88:91], a[208:211]
    v_exp_f32 v27, v27
    v_mfma_f32_16x16x32_bf16 a[208:211], a[148:151], v[56:59], a[208:211]
    v_cvt_pk_bf16_f32 v74, v24, v25
    v_cvt_pk_bf16_f32 v75, v26, v27
    v_mfma_f32_16x16x32_bf16 a[212:215], a[156:159], v[56:59], a[212:215]
    v_mul_f32 v28, s20, v28
    v_mul_f32 v29, s20, v29
    v_mfma_f32_16x16x32_bf16 a[212:215], a[152:155], v[88:91], a[212:215]
    v_exp_f32 v28, v28
    v_mfma_f32_16x16x32_bf16 a[216:219], a[160:163], v[88:91], a[216:219]
    v_exp_f32 v29, v29
    v_mfma_f32_16x16x32_bf16 a[216:219], a[164:167], v[56:59], a[216:219]
    v_mul_f32 v30, s20, v30
    v_mul_f32 v31, s20, v31
    v_mfma_f32_16x16x32_bf16 a[220:223], a[172:175], v[56:59], a[220:223]
    v_exp_f32 v30, v30
    v_mfma_f32_16x16x32_bf16 a[220:223], a[168:171], v[88:91], a[220:223]
    v_exp_f32 v31, v31
    v_mfma_f32_16x16x32_bf16 v[20:23], a[112:115], a[48:51], 0
    v_cvt_pk_bf16_f32 v76, v28, v29
    v_cvt_pk_bf16_f32 v77, v30, v31
    v_mfma_f32_16x16x32_bf16 v[20:23], a[116:119], a[52:55], v[20:23]
    v_mul_f32 v32, s20, v32
    v_mul_f32 v33, s20, v33
    v_mfma_f32_16x16x32_bf16 v[20:23], a[120:123], a[56:59], v[20:23]
    v_exp_f32 v32, v32
    v_mfma_f32_16x16x32_bf16 v[20:23], a[124:127], a[60:63], v[20:23]
    v_exp_f32 v33, v33
    v_mfma_f32_16x16x32_bf16 v[24:27], a[140:143], a[60:63], 0
    v_mul_f32 v34, s20, v34
    v_mul_f32 v35, s20, v35
    v_mfma_f32_16x16x32_bf16 v[24:27], a[136:139], a[56:59], v[24:27]
    s_waitcnt vmcnt(12) lgkmcnt(0)
    v_exp_f32 v34, v34
    v_mfma_f32_16x16x32_bf16 v[24:27], a[132:135], a[52:55], v[24:27]
    s_barrier
    v_cvt_pk_bf16_f32 v78, v32, v33
    v_mfma_f32_16x16x32_bf16 v[24:27], a[128:131], a[48:51], v[24:27]
    v_exp_f32 v35, v35
    v_mfma_f32_16x16x32_bf16 a[240:243], a[144:147], v[64:67], a[240:243]
    ds_read_b64_tr_b16 a[144:145], v3 offset:18432
    v_cvt_pk_bf16_f32 v79, v34, v35
    v_mfma_f32_16x16x32_bf16 a[240:243], a[148:151], v[60:63], a[240:243]
    ds_read_b64_tr_b16 a[146:147], v3 offset:26624
    v_mul_f32 v20, s20, v20
    v_mfma_f32_16x16x32_bf16 a[244:247], a[156:159], v[60:63], a[244:247]
    ds_read_b64_tr_b16 a[148:149], v3 offset:19456
    v_mul_f32 v21, s20, v21
    v_mfma_f32_16x16x32_bf16 a[244:247], a[152:155], v[64:67], a[244:247]
    ds_read_b64_tr_b16 a[150:151], v3 offset:27648
    v_mul_f32 v22, s20, v22
    v_mfma_f32_16x16x32_bf16 a[248:251], a[160:163], v[64:67], a[248:251]
    ds_read_b64_tr_b16 a[156:157], v3 offset:19464
    v_mul_f32 v23, s20, v23
    v_mfma_f32_16x16x32_bf16 a[248:251], a[164:167], v[60:63], a[248:251]
    ds_read_b64_tr_b16 a[158:159], v3 offset:27656
    v_mul_f32 v24, s20, v24
    v_mfma_f32_16x16x32_bf16 a[252:255], a[172:175], v[60:63], a[252:255]
    ds_read_b64_tr_b16 a[152:153], v3 offset:18440
    v_mul_f32 v25, s20, v25
    v_mfma_f32_16x16x32_bf16 a[252:255], a[168:171], v[64:67], a[252:255]
    ds_read_b64_tr_b16 a[154:155], v3 offset:26632
    v_mul_f32 v26, s20, v26
    v_mfma_f32_16x16x32_bf16 v[28:31], a[112:115], a[64:67], 0
    ds_read_b64_tr_b16 a[160:161], v4 offset:18432
    v_mul_f32 v27, s20, v27
    v_mfma_f32_16x16x32_bf16 v[28:31], a[116:119], a[68:71], v[28:31]
    ds_read_b64_tr_b16 a[162:163], v4 offset:26624
    ds_read_b64_tr_b16 a[164:165], v4 offset:19456
    v_mfma_f32_16x16x32_bf16 v[28:31], a[120:123], a[72:75], v[28:31]
    v_exp_f32 v20, v20
    v_mfma_f32_16x16x32_bf16 v[28:31], a[124:127], a[76:79], v[28:31]
    ds_read_b64_tr_b16 a[166:167], v4 offset:27648
    ds_read_b64_tr_b16 a[172:173], v4 offset:19464
    v_mfma_f32_16x16x32_bf16 v[32:35], a[140:143], a[76:79], 0
    v_exp_f32 v21, v21
    v_mfma_f32_16x16x32_bf16 v[32:35], a[136:139], a[72:75], v[32:35]
    ds_read_b64_tr_b16 a[174:175], v4 offset:27656
    v_cvt_pk_bf16_f32 v80, v20, v21
    v_mfma_f32_16x16x32_bf16 v[32:35], a[132:135], a[68:71], v[32:35]
    ds_read_b64_tr_b16 a[168:169], v4 offset:18440
    v_mul_f32 v28, s20, v28
    v_mfma_f32_16x16x32_bf16 v[32:35], a[128:131], a[64:67], v[32:35]
    s_waitcnt lgkmcnt(7)
    ds_read_b64_tr_b16 a[170:171], v4 offset:26632
    v_mul_f32 v29, s20, v29
    v_mfma_f32_16x16x32_bf16 v[92:95], a[144:147], v[36:39], v[92:95]
    s_waitcnt vmcnt(17)
    v_xor_b32 v3, 0x8000, v3
    v_xor_b32 v4, 0x8000, v4
    v_mfma_f32_16x16x32_bf16 v[92:95], a[148:151], v[68:71], v[92:95]
    s_add_u32 m0, s27, 0
    v_exp_f32 v22, v22
    v_mfma_f32_16x16x32_bf16 v[96:99], a[156:159], v[68:71], v[96:99]
    buffer_load_dwordx4 v5, s[64:67], 0 offen lds
    v_mul_f32 v30, s20, v30
    v_mfma_f32_16x16x32_bf16 v[96:99], a[152:155], v[36:39], v[96:99]
    s_waitcnt lgkmcnt(0)
    v_exp_f32 v23, v23
    v_mfma_f32_16x16x32_bf16 v[100:103], a[160:163], v[36:39], v[100:103]
    v_cvt_pk_bf16_f32 v81, v22, v23
    v_mul_f32 v31, s20, v31
    v_mfma_f32_16x16x32_bf16 v[100:103], a[164:167], v[68:71], v[100:103]
    v_exp_f32 v24, v24
    v_mfma_f32_16x16x32_bf16 v[104:107], a[172:175], v[68:71], v[104:107]
    v_exp_f32 v25, v25
    v_mfma_f32_16x16x32_bf16 v[104:107], a[168:171], v[36:39], v[104:107]
    s_add_u32 m0, s27, 896
    v_exp_f32 v26, v26
    v_mfma_f32_16x16x32_bf16 v[20:23], a[112:115], a[80:83], 0
    v_exp_f32 v27, v27
    v_mfma_f32_16x16x32_bf16 v[20:23], a[116:119], a[84:87], v[20:23]
    v_cvt_pk_bf16_f32 v82, v24, v25
    v_cvt_pk_bf16_f32 v83, v26, v27
    v_mfma_f32_16x16x32_bf16 v[20:23], a[120:123], a[88:91], v[20:23]
    buffer_load_dwordx4 v5, s[64:67], 0 offen offset:128 lds
    v_mul_f32 v32, s20, v32
    v_mfma_f32_16x16x32_bf16 v[20:23], a[124:127], a[92:95], v[20:23]
    v_exp_f32 v28, v28
    v_mfma_f32_16x16x32_bf16 v[24:27], a[140:143], a[92:95], 0
    v_exp_f32 v29, v29
    v_mfma_f32_16x16x32_bf16 v[24:27], a[136:139], a[88:91], v[24:27]
    v_exp_f32 v30, v30
    v_mfma_f32_16x16x32_bf16 v[24:27], a[132:135], a[84:87], v[24:27]
    v_exp_f32 v31, v31
    v_mfma_f32_16x16x32_bf16 v[24:27], a[128:131], a[80:83], v[24:27]
    s_add_u32 m0, s27, 1920
    v_cvt_pk_bf16_f32 v84, v28, v29
    v_cvt_pk_bf16_f32 v85, v30, v31
    v_mfma_f32_16x16x32_bf16 v[124:127], a[144:147], v[40:43], v[124:127]
    v_mul_f32 v33, s20, v33
    v_mul_f32 v34, s20, v34
    v_mfma_f32_16x16x32_bf16 v[124:127], a[148:151], v[72:75], v[124:127]
    v_exp_f32 v32, v32
    v_mfma_f32_16x16x32_bf16 v[128:131], a[156:159], v[72:75], v[128:131]
    buffer_load_dwordx4 v5, s[68:71], 0 offen offset:128 lds
    v_mul_f32 v35, s20, v35
    v_mfma_f32_16x16x32_bf16 v[128:131], a[152:155], v[40:43], v[128:131]
    v_exp_f32 v33, v33
    v_mfma_f32_16x16x32_bf16 v[132:135], a[160:163], v[40:43], v[132:135]
    v_exp_f32 v34, v34
    v_mfma_f32_16x16x32_bf16 v[132:135], a[164:167], v[72:75], v[132:135]
    v_exp_f32 v35, v35
    v_mfma_f32_16x16x32_bf16 v[136:139], a[172:175], v[72:75], v[136:139]
    v_cvt_pk_bf16_f32 v86, v32, v33
    v_cvt_pk_bf16_f32 v87, v34, v35
    v_mfma_f32_16x16x32_bf16 v[136:139], a[168:171], v[40:43], v[136:139]
    s_add_u32 m0, s27, 2944
    v_mul_f32 v20, s20, v20
    v_mul_f32 v21, s20, v21
    v_smfmac_f32_16x16x64_bf16 a[176:179], v[16:19], v[36:43], v252
    v_mul_f32 v22, s20, v22
    v_smfmac_f32_16x16x64_bf16 a[176:179], v[16:19], v[68:75], v252
    v_mul_f32 v23, s20, v23
    v_mfma_f32_16x16x32_bf16 v[28:31], a[112:115], a[96:99], 0
    buffer_load_dwordx4 v5, s[88:91], 0 offen offset:128 lds
    v_mul_f32 v24, s20, v24
    v_mfma_f32_16x16x32_bf16 v[28:31], a[116:119], a[100:103], v[28:31]
    s_add_u32 s27, s27, 16384
    ds_read_b128 a[112:115], v1 offset:16384
    v_mul_f32 v25, s20, v25
    v_mfma_f32_16x16x32_bf16 v[28:31], a[120:123], a[104:107], v[28:31]
    s_and_b32 s27, s27, 0xffff
    ds_read_b128 a[116:119], v2 offset:16384
    v_mul_f32 v26, s20, v26
    v_mfma_f32_16x16x32_bf16 v[28:31], a[124:127], a[108:111], v[28:31]
    s_mov_b64 s[68:69], s[88:89]
    ds_read_b128 a[120:123], v1 offset:17408
    v_mul_f32 v27, s20, v27
    v_mfma_f32_16x16x32_bf16 v[32:35], a[140:143], a[108:111], 0
    s_mov_b32 s70, s90
    ds_read_b128 a[124:127], v2 offset:17408
    v_min_u32 v254, L_final-L_end_code, v253
    v_mfma_f32_16x16x32_bf16 v[32:35], a[136:139], a[104:107], v[32:35]
    s_add_u32 s88, s88, 8192
    v_exp_f32 v20, v20
    v_mfma_f32_16x16x32_bf16 v[32:35], a[132:135], a[100:103], v[32:35]
    s_addc_u32 s89, s89, 0
    ds_read_b128 a[140:143], v2 offset:25600
    v_mul_f32 v28, s20, v28
    v_mfma_f32_16x16x32_bf16 v[32:35], a[128:131], a[96:99], v[32:35]
    s_mov_b32 s90, s66
    ds_read_b128 a[136:139], v1 offset:25600
    v_mul_f32 v29, s20, v29
    v_mfma_f32_16x16x32_bf16 v[156:159], a[144:147], v[44:47], v[156:159]
    s_add_u32 s64, s64, 8192
    v_exp_f32 v21, v21
    v_exp_f32 v22, v22
    v_exp_f32 v23, v23
    v_cvt_pk_bf16_f32 v88, v20, v21
    v_cvt_pk_bf16_f32 v89, v22, v23
    v_exp_f32 v24, v24
    v_exp_f32 v25, v25
    v_exp_f32 v26, v26
    v_exp_f32 v27, v27
    v_cvt_pk_bf16_f32 v90, v24, v25
    v_cvt_pk_bf16_f32 v91, v26, v27
    v_exp_f32 v28, v28
    v_exp_f32 v29, v29
    v_mul_f32 v30, s20, v30
    v_mul_f32 v31, s20, v31
    v_mfma_f32_16x16x32_bf16 v[156:159], a[148:151], v[76:79], v[156:159]
    s_addc_u32 s65, s65, 0
    ds_read_b128 a[132:135], v2 offset:24576
    v_xor_b32 v2, 0x8000, v2
    v_mfma_f32_16x16x32_bf16 v[160:163], a[156:159], v[76:79], v[160:163]
    s_add_u32 s23, s23, 1
    ds_read_b128 a[128:131], v1 offset:24576
    v_xor_b32 v1, 0x8000, v1
    v_mfma_f32_16x16x32_bf16 v[160:163], a[152:155], v[44:47], v[160:163]
    s_cmp_lt_u32 s23, 64
    v_exp_f32 v30, v30
    v_mfma_f32_16x16x32_bf16 v[164:167], a[160:163], v[44:47], v[164:167]
    s_cselect_b32 s66, 8192, 0
    v_exp_f32 v31, v31
    v_mfma_f32_16x16x32_bf16 v[164:167], a[164:167], v[76:79], v[164:167]
    v_cvt_pk_bf16_f32 v64, v28, v29
    v_cvt_pk_bf16_f32 v65, v30, v31
    v_mfma_f32_16x16x32_bf16 v[168:171], a[172:175], v[76:79], v[168:171]
    v_mul_f32 v32, s20, v32
    v_mul_f32 v33, s20, v33
    v_mfma_f32_16x16x32_bf16 v[168:171], a[168:171], v[44:47], v[168:171]
    v_exp_f32 v32, v32
    v_mfma_f32_16x16x32_bf16 v[188:191], a[144:147], v[48:51], v[188:191]
    v_exp_f32 v33, v33
    v_mfma_f32_16x16x32_bf16 v[188:191], a[148:151], v[80:83], v[188:191]
    v_mul_f32 v34, s20, v34
    v_mul_f32 v35, s20, v35
    v_mfma_f32_16x16x32_bf16 v[192:195], a[156:159], v[80:83], v[192:195]
    v_exp_f32 v34, v34
    v_mfma_f32_16x16x32_bf16 v[192:195], a[152:155], v[48:51], v[192:195]
    s_waitcnt vmcnt(12) lgkmcnt(0)
    v_exp_f32 v35, v35
    v_mfma_f32_16x16x32_bf16 v[196:199], a[160:163], v[48:51], v[196:199]
    s_barrier
    v_cvt_pk_bf16_f32 v66, v32, v33
    v_mfma_f32_16x16x32_bf16 v[196:199], a[164:167], v[80:83], v[196:199]
    s_mul_i32 s74, s74, s36
    v_cvt_pk_bf16_f32 v67, v34, v35
    v_mov_b32 v255, 0
    v_mfma_f32_16x16x32_bf16 v[200:203], a[172:175], v[80:83], v[200:203]
    s_add_u32 m0, s43, 49152
    ds_read_b128 a[0:3], v8
    v_lshl_add_u64 v[254:255], v[254:255], 0, s[54:55]
    v_mfma_f32_16x16x32_bf16 v[200:203], a[168:171], v[48:51], v[200:203]
    buffer_load_dwordx4 v6, s[72:75], 0 offen nt lds
    v_add_u32 v7, 0xffffa000, v7
    v_smfmac_f32_16x16x64_bf16 a[180:183], v[16:19], v[44:51], v252
    v_accvgpr_read_b32 v38, a176
    v_smfmac_f32_16x16x64_bf16 a[180:183], v[16:19], v[76:83], v252
    v_accvgpr_read_b32 v36, a177
    v_mfma_f32_16x16x32_bf16 v[220:223], a[144:147], v[52:55], v[220:223]
    buffer_load_dwordx4 v6, s[72:75], 0 offen offset:2048 nt lds
    v_add_f32 v38, v38, v36
    v_mfma_f32_16x16x32_bf16 v[220:223], a[148:151], v[84:87], v[220:223]
    s_add_u32 m0, s43, 50048
    v_rcp_f32 v36, v38
    v_mfma_f32_16x16x32_bf16 v[224:227], a[156:159], v[84:87], v[224:227]
    s_add_u32 s40, s33, 24576
    ds_read_b128 a[4:7], v9
    v_maximum3_f32 v12, v36, v36, v38
    v_mfma_f32_16x16x32_bf16 v[224:227], a[152:155], v[52:55], v[224:227]
    ds_read_b128 a[8:11], v8 offset:1024
    v_accvgpr_write_b32 a176, 0
    v_mfma_f32_16x16x32_bf16 v[228:231], a[160:163], v[52:55], v[228:231]
    buffer_load_dwordx4 v6, s[72:75], 0 offen offset:128 nt lds
    v_accvgpr_write_b32 a177, 0
    v_mfma_f32_16x16x32_bf16 v[228:231], a[164:167], v[84:87], v[228:231]
    ds_read_b128 a[12:15], v9 offset:1024
    v_accvgpr_read_b32 v42, a178
    v_mfma_f32_16x16x32_bf16 v[232:235], a[172:175], v[84:87], v[232:235]
    ds_read_b128 a[16:19], v8 offset:4096
    v_accvgpr_read_b32 v40, a179
    v_mfma_f32_16x16x32_bf16 v[232:235], a[168:171], v[52:55], v[232:235]
    ds_read_b128 a[20:23], v9 offset:4096
    v_add_f32 v42, v42, v40
    v_mfma_f32_16x16x32_bf16 a[192:195], a[144:147], v[56:59], a[192:195]
    buffer_load_dwordx4 v6, s[72:75], 0 offen offset:2176 nt lds
    v_accvgpr_write_b32 a178, 0
    v_mfma_f32_16x16x32_bf16 a[192:195], a[148:151], v[88:91], a[192:195]
    s_lshl_b32 s49, 1, s22
    v_rcp_f32 v40, v42
    v_mfma_f32_16x16x32_bf16 a[196:199], a[156:159], v[88:91], a[196:199]
    s_add_u32 s22, s22, 1
    ds_read_b128 a[24:27], v8 offset:5120
    v_maximum3_f32 v12, v12, v40, v42
    v_mfma_f32_16x16x32_bf16 a[196:199], a[152:155], v[56:59], a[196:199]
    s_mov_b32 s30, s33
    ds_read_b128 a[28:31], v9 offset:5120
    v_accvgpr_write_b32 a179, 0
    v_mfma_f32_16x16x32_bf16 a[200:203], a[160:163], v[56:59], a[200:203]
    s_mov_b32 s33, s34
    global_load_dword v0, v[254:255], off
    v_accvgpr_read_b32 v46, a180
    v_mfma_f32_16x16x32_bf16 a[200:203], a[164:167], v[88:91], a[200:203]
    s_mov_b32 s35, s36
    ds_read_b128 a[32:35], v8 offset:8192
    v_accvgpr_read_b32 v44, a181
    v_mfma_f32_16x16x32_bf16 a[204:207], a[172:175], v[88:91], a[204:207]
    s_add_u32 s41, s22, 1
    ds_read_b128 a[36:39], v9 offset:8192
    v_add_f32 v46, v46, v44
    v_mfma_f32_16x16x32_bf16 a[204:207], a[168:171], v[56:59], a[204:207]
    s_xor_b32 s42, s41, s38
    v_rcp_f32 v44, v46
    v_smfmac_f32_16x16x64_bf16 a[184:187], v[16:19], v[52:59], v252
    s_and_b32 s42, s42, 1
    v_maximum3_f32 v12, v12, v44, v46
    v_smfmac_f32_16x16x64_bf16 a[184:187], v[16:19], v[84:91], v252
    s_cselect_b32 s34, s46, s45
    v_accvgpr_write_b32 a180, 0
    v_mfma_f32_16x16x32_bf16 a[224:227], a[144:147], v[60:63], a[224:227]
    s_cselect_b32 s36, s51, s50
    ds_read_b64_tr_b16 a[144:145], v3 offset:2048
    v_accvgpr_write_b32 a181, 0
    v_mfma_f32_16x16x32_bf16 a[224:227], a[148:151], v[64:67], a[224:227]
    s_mul_i32 s41, s41, 217088
    ds_read_b64_tr_b16 a[146:147], v3 offset:10240
    v_accvgpr_read_b32 v50, a182
    v_mfma_f32_16x16x32_bf16 a[228:231], a[156:159], v[64:67], a[228:231]
    s_add_u32 s34, s34, s41
    ds_read_b128 a[40:43], v8 offset:9216
    v_accvgpr_read_b32 v48, a183
    v_mfma_f32_16x16x32_bf16 a[228:231], a[152:155], v[60:63], a[228:231]
    s_add_u32 s72, s4, s34
    ds_read_b64_tr_b16 a[152:153], v3 offset:2056
    v_add_f32 v50, v50, v48
    v_mfma_f32_16x16x32_bf16 a[232:235], a[160:163], v[60:63], a[232:235]
    s_addc_u32 s73, s5, 0
    ds_read_b64_tr_b16 a[154:155], v3 offset:10248
    v_accvgpr_write_b32 a182, 0
    v_mfma_f32_16x16x32_bf16 a[232:235], a[164:167], v[64:67], a[232:235]
    s_cmp_lt_u32 s22, 3
    ds_read_b64_tr_b16 a[160:161], v4 offset:2048
    v_accvgpr_write_b32 a183, 0
    v_mfma_f32_16x16x32_bf16 a[236:239], a[172:175], v[64:67], a[236:239]
    s_cselect_b32 s74, 4096, 0
    ds_read_b64_tr_b16 a[162:163], v4 offset:10240
    v_accvgpr_read_b32 v54, a184
    v_mfma_f32_16x16x32_bf16 a[236:239], a[168:171], v[60:63], a[236:239]
    s_add_u32 s76, s16, s30
    ds_read_b64_tr_b16 a[168:169], v4 offset:2056
    v_accvgpr_read_b32 v52, a185
    v_smfmac_f32_16x16x64_bf16 a[188:191], v[16:19], v[60:67], v252
    s_waitcnt lgkmcnt(0)
    ds_read_b64_tr_b16 a[170:171], v4 offset:10248
    v_mfma_f32_16x16x32_bf16 v[108:111], a[144:147], v[68:71], v[108:111]
    s_addc_u32 s77, s17, 0
    ds_read_b64_tr_b16 a[148:149], v3 offset:3072
    v_add_f32 v54, v54, v52
    v_mfma_f32_16x16x32_bf16 v[112:115], a[152:155], v[68:71], v[112:115]
    s_mov_b32 s29, 128
    ds_read_b64_tr_b16 a[150:151], v3 offset:11264
    v_accvgpr_write_b32 a184, 0
    v_mfma_f32_16x16x32_bf16 v[116:119], a[160:163], v[68:71], v[116:119]
    s_waitcnt lgkmcnt(2)
    ds_read_b64_tr_b16 a[156:157], v3 offset:3080
    v_accvgpr_write_b32 a185, 0
    v_mfma_f32_16x16x32_bf16 v[120:123], a[168:171], v[68:71], v[120:123]
    s_mov_b32 s31, s44
    ds_read_b64_tr_b16 a[158:159], v3 offset:11272
    v_accvgpr_read_b32 v58, a186
    v_mfma_f32_16x16x32_bf16 v[140:143], a[144:147], v[72:75], v[140:143]
    s_mov_b32 s32, 5
    ds_read_b64_tr_b16 a[164:165], v4 offset:3072
    v_accvgpr_read_b32 v56, a187
    v_mfma_f32_16x16x32_bf16 v[144:147], a[152:155], v[72:75], v[144:147]
    s_waitcnt vmcnt(13)
    ds_read_b64_tr_b16 a[166:167], v4 offset:11264
    v_add_f32 v58, v58, v56
    v_mfma_f32_16x16x32_bf16 v[148:151], a[160:163], v[72:75], v[148:151]
    ds_read_b64_tr_b16 a[172:173], v4 offset:3080
    v_accvgpr_write_b32 a186, 0
    v_mfma_f32_16x16x32_bf16 v[152:155], a[168:171], v[72:75], v[152:155]
    ds_read_b64_tr_b16 a[174:175], v4 offset:11272
    v_accvgpr_write_b32 a187, 0
    v_mfma_f32_16x16x32_bf16 v[172:175], a[144:147], v[76:79], v[172:175]
    v_rcp_f32 v48, v50
    v_mfma_f32_16x16x32_bf16 v[176:179], a[152:155], v[76:79], v[176:179]
    v_maximum3_f32 v12, v12, v48, v50
    v_accvgpr_read_b32 v62, a188
    v_mfma_f32_16x16x32_bf16 v[180:183], a[160:163], v[76:79], v[180:183]
    v_rcp_f32 v52, v54
    v_mfma_f32_16x16x32_bf16 v[184:187], a[168:171], v[76:79], v[184:187]
    v_maximum3_f32 v12, v12, v52, v54
    v_accvgpr_read_b32 v60, a189
    v_mfma_f32_16x16x32_bf16 v[204:207], a[144:147], v[80:83], v[204:207]
    v_rcp_f32 v56, v58
    v_mfma_f32_16x16x32_bf16 v[208:211], a[152:155], v[80:83], v[208:211]
    ds_read_b128 a[44:47], v9 offset:9216
    v_maximum3_f32 v12, v12, v56, v58
    v_mfma_f32_16x16x32_bf16 v[212:215], a[160:163], v[80:83], v[212:215]
    ds_read_b128 a[48:51], v8 offset:12288
    v_accvgpr_read_b32 v61, a190
    v_mfma_f32_16x16x32_bf16 v[216:219], a[168:171], v[80:83], v[216:219]
    ds_read_b128 a[52:55], v9 offset:12288
    v_accvgpr_read_b32 v63, a191
    v_mfma_f32_16x16x32_bf16 v[236:239], a[144:147], v[84:87], v[236:239]
    ds_read_b128 a[56:59], v8 offset:13312
    v_add_f32 v62, v62, v63
    v_mfma_f32_16x16x32_bf16 v[240:243], a[152:155], v[84:87], v[240:243]
    ds_read_b128 a[60:63], v9 offset:13312
    v_add_f32 v60, v60, v61
    v_mfma_f32_16x16x32_bf16 v[244:247], a[160:163], v[84:87], v[244:247]
    ds_read_b128 a[64:67], v8 offset:16384
    v_add_f32 v62, v62, v60
    v_mfma_f32_16x16x32_bf16 v[248:251], a[168:171], v[84:87], v[248:251]
    v_rcp_f32 v60, v62
    v_mfma_f32_16x16x32_bf16 a[208:211], a[144:147], v[88:91], a[208:211]
    ds_read_b128 a[68:71], v9 offset:16384
    v_maximum3_f32 v12, v12, v60, v62
    v_mfma_f32_16x16x32_bf16 a[212:215], a[152:155], v[88:91], a[212:215]
    ds_read_b128 a[72:75], v8 offset:17408
    v_accvgpr_write_b32 a188, 0
    v_mfma_f32_16x16x32_bf16 a[216:219], a[160:163], v[88:91], a[216:219]
    ds_read_b128 a[76:79], v9 offset:17408
    v_accvgpr_write_b32 a189, 0
    v_mfma_f32_16x16x32_bf16 a[220:223], a[168:171], v[88:91], a[220:223]
    ds_read_b128 a[80:83], v8 offset:20480
    v_accvgpr_write_b32 a190, 0
    v_mfma_f32_16x16x32_bf16 a[240:243], a[144:147], v[64:67], a[240:243]
    ds_read_b128 a[84:87], v9 offset:20480
    v_accvgpr_write_b32 a191, 0
    v_mfma_f32_16x16x32_bf16 a[244:247], a[152:155], v[64:67], a[244:247]
    ds_read_b128 a[88:91], v8 offset:21504
    v_cmp_ngt_f32 vcc, s48, v12
    v_mfma_f32_16x16x32_bf16 a[248:251], a[160:163], v[64:67], a[248:251]
    s_cmp_lg_u64 vcc, 0
    ds_read_b128 a[92:95], v9 offset:21504
    v_accvgpr_read_b32 v20, a224
    v_mfma_f32_16x16x32_bf16 a[252:255], a[168:171], v[64:67], a[252:255]
    s_cselect_b32 s41, s49, 0
    v_accvgpr_read_b32 v21, a225
    v_accvgpr_read_b32 v22, a226
    s_or_b32 s37, s37, s41
    v_accvgpr_read_b32 v23, a227
    v_accvgpr_read_b32 v24, a228
    v_accvgpr_read_b32 v25, a229
    v_accvgpr_read_b32 v26, a230
    v_accvgpr_read_b32 v27, a231
    v_accvgpr_read_b32 v28, a232
    v_accvgpr_read_b32 v29, a233
    v_accvgpr_read_b32 v30, a234
    v_accvgpr_read_b32 v31, a235
    v_accvgpr_read_b32 v32, a236
    v_accvgpr_read_b32 v33, a237
    v_accvgpr_read_b32 v34, a238
    v_accvgpr_read_b32 v35, a239
.p2align 3
    v_pk_mul_f32 v[92:93], v[92:93], v[36:37] op_sel_hi:[1,0]
    v_pk_mul_f32 v[94:95], v[94:95], v[36:37] op_sel_hi:[1,0]
    v_pk_mul_f32 v[96:97], v[96:97], v[36:37] op_sel_hi:[1,0]
    v_pk_mul_f32 v[98:99], v[98:99], v[36:37] op_sel_hi:[1,0]
    v_cvt_pk_bf16_f32 v92, v92, v93
    v_cvt_pk_bf16_f32 v93, v94, v95
    v_cvt_pk_bf16_f32 v94, v96, v97
    v_cvt_pk_bf16_f32 v95, v98, v99
    v_pk_mul_f32 v[100:101], v[100:101], v[36:37] op_sel_hi:[1,0]
    v_pk_mul_f32 v[102:103], v[102:103], v[36:37] op_sel_hi:[1,0]
    v_pk_mul_f32 v[104:105], v[104:105], v[36:37] op_sel_hi:[1,0]
    v_pk_mul_f32 v[106:107], v[106:107], v[36:37] op_sel_hi:[1,0]
    v_cvt_pk_bf16_f32 v100, v100, v101
    v_cvt_pk_bf16_f32 v101, v102, v103
    v_cvt_pk_bf16_f32 v102, v104, v105
    v_cvt_pk_bf16_f32 v103, v106, v107
    v_pk_mul_f32 v[108:109], v[108:109], v[36:37] op_sel_hi:[1,0]
    v_pk_mul_f32 v[110:111], v[110:111], v[36:37] op_sel_hi:[1,0]
    v_pk_mul_f32 v[112:113], v[112:113], v[36:37] op_sel_hi:[1,0]
    v_pk_mul_f32 v[114:115], v[114:115], v[36:37] op_sel_hi:[1,0]
    v_cvt_pk_bf16_f32 v108, v108, v109
    v_cvt_pk_bf16_f32 v109, v110, v111
    v_cvt_pk_bf16_f32 v110, v112, v113
    v_cvt_pk_bf16_f32 v111, v114, v115
    v_pk_mul_f32 v[116:117], v[116:117], v[36:37] op_sel_hi:[1,0]
    v_pk_mul_f32 v[118:119], v[118:119], v[36:37] op_sel_hi:[1,0]
    v_pk_mul_f32 v[120:121], v[120:121], v[36:37] op_sel_hi:[1,0]
    v_pk_mul_f32 v[122:123], v[122:123], v[36:37] op_sel_hi:[1,0]
    v_cvt_pk_bf16_f32 v116, v116, v117
    v_cvt_pk_bf16_f32 v117, v118, v119
    v_cvt_pk_bf16_f32 v118, v120, v121
    v_cvt_pk_bf16_f32 v119, v122, v123
    v_pk_mul_f32 v[124:125], v[124:125], v[40:41] op_sel_hi:[1,0]
    v_pk_mul_f32 v[126:127], v[126:127], v[40:41] op_sel_hi:[1,0]
    v_pk_mul_f32 v[128:129], v[128:129], v[40:41] op_sel_hi:[1,0]
    v_pk_mul_f32 v[130:131], v[130:131], v[40:41] op_sel_hi:[1,0]
    v_cvt_pk_bf16_f32 v124, v124, v125
    v_cvt_pk_bf16_f32 v125, v126, v127
    v_cvt_pk_bf16_f32 v126, v128, v129
    v_cvt_pk_bf16_f32 v127, v130, v131
    v_pk_mul_f32 v[132:133], v[132:133], v[40:41] op_sel_hi:[1,0]
    v_pk_mul_f32 v[134:135], v[134:135], v[40:41] op_sel_hi:[1,0]
    v_pk_mul_f32 v[136:137], v[136:137], v[40:41] op_sel_hi:[1,0]
    v_pk_mul_f32 v[138:139], v[138:139], v[40:41] op_sel_hi:[1,0]
    v_cvt_pk_bf16_f32 v132, v132, v133
    v_cvt_pk_bf16_f32 v133, v134, v135
    v_cvt_pk_bf16_f32 v134, v136, v137
    v_cvt_pk_bf16_f32 v135, v138, v139
    v_pk_mul_f32 v[140:141], v[140:141], v[40:41] op_sel_hi:[1,0]
    v_pk_mul_f32 v[142:143], v[142:143], v[40:41] op_sel_hi:[1,0]
    v_pk_mul_f32 v[144:145], v[144:145], v[40:41] op_sel_hi:[1,0]
    v_pk_mul_f32 v[146:147], v[146:147], v[40:41] op_sel_hi:[1,0]
    v_cvt_pk_bf16_f32 v140, v140, v141
    v_cvt_pk_bf16_f32 v141, v142, v143
    v_cvt_pk_bf16_f32 v142, v144, v145
    v_cvt_pk_bf16_f32 v143, v146, v147
    v_pk_mul_f32 v[148:149], v[148:149], v[40:41] op_sel_hi:[1,0]
    v_pk_mul_f32 v[150:151], v[150:151], v[40:41] op_sel_hi:[1,0]
    v_pk_mul_f32 v[152:153], v[152:153], v[40:41] op_sel_hi:[1,0]
    v_pk_mul_f32 v[154:155], v[154:155], v[40:41] op_sel_hi:[1,0]
    v_cvt_pk_bf16_f32 v148, v148, v149
    v_cvt_pk_bf16_f32 v149, v150, v151
    v_cvt_pk_bf16_f32 v150, v152, v153
    v_cvt_pk_bf16_f32 v151, v154, v155
    v_pk_mul_f32 v[156:157], v[156:157], v[44:45] op_sel_hi:[1,0]
    v_pk_mul_f32 v[158:159], v[158:159], v[44:45] op_sel_hi:[1,0]
    v_pk_mul_f32 v[160:161], v[160:161], v[44:45] op_sel_hi:[1,0]
    v_pk_mul_f32 v[162:163], v[162:163], v[44:45] op_sel_hi:[1,0]
    v_cvt_pk_bf16_f32 v156, v156, v157
    v_cvt_pk_bf16_f32 v157, v158, v159
    v_cvt_pk_bf16_f32 v158, v160, v161
    v_cvt_pk_bf16_f32 v159, v162, v163
    v_pk_mul_f32 v[164:165], v[164:165], v[44:45] op_sel_hi:[1,0]
    v_pk_mul_f32 v[166:167], v[166:167], v[44:45] op_sel_hi:[1,0]
    v_pk_mul_f32 v[168:169], v[168:169], v[44:45] op_sel_hi:[1,0]
    v_pk_mul_f32 v[170:171], v[170:171], v[44:45] op_sel_hi:[1,0]
    v_cvt_pk_bf16_f32 v164, v164, v165
    v_cvt_pk_bf16_f32 v165, v166, v167
    v_cvt_pk_bf16_f32 v166, v168, v169
    v_cvt_pk_bf16_f32 v167, v170, v171
    v_pk_mul_f32 v[172:173], v[172:173], v[44:45] op_sel_hi:[1,0]
    v_pk_mul_f32 v[174:175], v[174:175], v[44:45] op_sel_hi:[1,0]
    v_pk_mul_f32 v[176:177], v[176:177], v[44:45] op_sel_hi:[1,0]
    v_pk_mul_f32 v[178:179], v[178:179], v[44:45] op_sel_hi:[1,0]
    v_cvt_pk_bf16_f32 v172, v172, v173
    v_cvt_pk_bf16_f32 v173, v174, v175
    v_cvt_pk_bf16_f32 v174, v176, v177
    v_cvt_pk_bf16_f32 v175, v178, v179
    v_pk_mul_f32 v[180:181], v[180:181], v[44:45] op_sel_hi:[1,0]
    v_pk_mul_f32 v[182:183], v[182:183], v[44:45] op_sel_hi:[1,0]
    v_pk_mul_f32 v[184:185], v[184:185], v[44:45] op_sel_hi:[1,0]
    v_pk_mul_f32 v[186:187], v[186:187], v[44:45] op_sel_hi:[1,0]
    v_cvt_pk_bf16_f32 v180, v180, v181
    v_cvt_pk_bf16_f32 v181, v182, v183
    v_cvt_pk_bf16_f32 v182, v184, v185
    v_cvt_pk_bf16_f32 v183, v186, v187
    v_pk_mul_f32 v[188:189], v[188:189], v[48:49] op_sel_hi:[1,0]
    v_pk_mul_f32 v[190:191], v[190:191], v[48:49] op_sel_hi:[1,0]
    v_pk_mul_f32 v[192:193], v[192:193], v[48:49] op_sel_hi:[1,0]
    v_pk_mul_f32 v[194:195], v[194:195], v[48:49] op_sel_hi:[1,0]
    v_cvt_pk_bf16_f32 v188, v188, v189
    v_cvt_pk_bf16_f32 v189, v190, v191
    v_cvt_pk_bf16_f32 v190, v192, v193
    v_cvt_pk_bf16_f32 v191, v194, v195
    v_pk_mul_f32 v[196:197], v[196:197], v[48:49] op_sel_hi:[1,0]
    v_pk_mul_f32 v[198:199], v[198:199], v[48:49] op_sel_hi:[1,0]
    v_pk_mul_f32 v[200:201], v[200:201], v[48:49] op_sel_hi:[1,0]
    v_pk_mul_f32 v[202:203], v[202:203], v[48:49] op_sel_hi:[1,0]
    v_cvt_pk_bf16_f32 v196, v196, v197
    v_cvt_pk_bf16_f32 v197, v198, v199
    v_cvt_pk_bf16_f32 v198, v200, v201
    v_cvt_pk_bf16_f32 v199, v202, v203
    v_pk_mul_f32 v[204:205], v[204:205], v[48:49] op_sel_hi:[1,0]
    v_pk_mul_f32 v[206:207], v[206:207], v[48:49] op_sel_hi:[1,0]
    v_pk_mul_f32 v[208:209], v[208:209], v[48:49] op_sel_hi:[1,0]
    v_pk_mul_f32 v[210:211], v[210:211], v[48:49] op_sel_hi:[1,0]
    v_cvt_pk_bf16_f32 v204, v204, v205
    v_cvt_pk_bf16_f32 v205, v206, v207
    v_cvt_pk_bf16_f32 v206, v208, v209
    v_cvt_pk_bf16_f32 v207, v210, v211
    v_pk_mul_f32 v[212:213], v[212:213], v[48:49] op_sel_hi:[1,0]
    v_pk_mul_f32 v[214:215], v[214:215], v[48:49] op_sel_hi:[1,0]
    v_pk_mul_f32 v[216:217], v[216:217], v[48:49] op_sel_hi:[1,0]
    v_pk_mul_f32 v[218:219], v[218:219], v[48:49] op_sel_hi:[1,0]
    v_cvt_pk_bf16_f32 v212, v212, v213
    v_cvt_pk_bf16_f32 v213, v214, v215
    v_cvt_pk_bf16_f32 v214, v216, v217
    v_cvt_pk_bf16_f32 v215, v218, v219
    v_pk_mul_f32 v[220:221], v[220:221], v[52:53] op_sel_hi:[1,0]
    v_pk_mul_f32 v[222:223], v[222:223], v[52:53] op_sel_hi:[1,0]
    v_pk_mul_f32 v[224:225], v[224:225], v[52:53] op_sel_hi:[1,0]
    v_pk_mul_f32 v[226:227], v[226:227], v[52:53] op_sel_hi:[1,0]
    v_pk_mul_f32 v[228:229], v[228:229], v[52:53] op_sel_hi:[1,0]
    v_pk_mul_f32 v[230:231], v[230:231], v[52:53] op_sel_hi:[1,0]
    v_pk_mul_f32 v[232:233], v[232:233], v[52:53] op_sel_hi:[1,0]
    v_pk_mul_f32 v[234:235], v[234:235], v[52:53] op_sel_hi:[1,0]
    v_pk_mul_f32 v[236:237], v[236:237], v[52:53] op_sel_hi:[1,0]
    v_pk_mul_f32 v[238:239], v[238:239], v[52:53] op_sel_hi:[1,0]
    v_pk_mul_f32 v[240:241], v[240:241], v[52:53] op_sel_hi:[1,0]
    v_pk_mul_f32 v[242:243], v[242:243], v[52:53] op_sel_hi:[1,0]
    v_cvt_pk_bf16_f32 v236, v236, v237
    v_cvt_pk_bf16_f32 v237, v238, v239
    v_cvt_pk_bf16_f32 v238, v240, v241
    v_cvt_pk_bf16_f32 v239, v242, v243
    v_pk_mul_f32 v[244:245], v[244:245], v[52:53] op_sel_hi:[1,0]
    v_pk_mul_f32 v[246:247], v[246:247], v[52:53] op_sel_hi:[1,0]
    v_pk_mul_f32 v[248:249], v[248:249], v[52:53] op_sel_hi:[1,0]
    v_pk_mul_f32 v[250:251], v[250:251], v[52:53] op_sel_hi:[1,0]
    v_cvt_pk_bf16_f32 v244, v244, v245
    v_cvt_pk_bf16_f32 v245, v246, v247
    v_cvt_pk_bf16_f32 v246, v248, v249
    v_cvt_pk_bf16_f32 v247, v250, v251
    v_pk_mul_f32 v[20:21], v[20:21], v[60:61] op_sel_hi:[1,0]
    v_pk_mul_f32 v[22:23], v[22:23], v[60:61] op_sel_hi:[1,0]
    v_pk_mul_f32 v[24:25], v[24:25], v[60:61] op_sel_hi:[1,0]
    v_pk_mul_f32 v[26:27], v[26:27], v[60:61] op_sel_hi:[1,0]
    v_cvt_pk_bf16_f32 v160, v20, v21
    v_cvt_pk_bf16_f32 v161, v22, v23
    v_cvt_pk_bf16_f32 v162, v24, v25
    v_cvt_pk_bf16_f32 v163, v26, v27
    v_pk_mul_f32 v[28:29], v[28:29], v[60:61] op_sel_hi:[1,0]
    v_pk_mul_f32 v[30:31], v[30:31], v[60:61] op_sel_hi:[1,0]
    v_pk_mul_f32 v[32:33], v[32:33], v[60:61] op_sel_hi:[1,0]
    v_pk_mul_f32 v[34:35], v[34:35], v[60:61] op_sel_hi:[1,0]
    v_cvt_pk_bf16_f32 v168, v28, v29
    v_cvt_pk_bf16_f32 v169, v30, v31
    v_cvt_pk_bf16_f32 v170, v32, v33
    v_cvt_pk_bf16_f32 v171, v34, v35
    v_accvgpr_read_b32 v68, a240
    v_accvgpr_read_b32 v69, a241
    v_accvgpr_read_b32 v70, a242
    v_accvgpr_read_b32 v71, a243
    v_accvgpr_read_b32 v72, a244
    v_accvgpr_read_b32 v73, a245
    v_accvgpr_read_b32 v74, a246
    v_accvgpr_read_b32 v75, a247
    v_pk_mul_f32 v[68:69], v[68:69], v[60:61] op_sel_hi:[1,0]
    v_pk_mul_f32 v[70:71], v[70:71], v[60:61] op_sel_hi:[1,0]
    v_pk_mul_f32 v[72:73], v[72:73], v[60:61] op_sel_hi:[1,0]
    v_pk_mul_f32 v[74:75], v[74:75], v[60:61] op_sel_hi:[1,0]
    v_cvt_pk_bf16_f32 v192, v68, v69
    v_cvt_pk_bf16_f32 v193, v70, v71
    v_cvt_pk_bf16_f32 v194, v72, v73
    v_cvt_pk_bf16_f32 v195, v74, v75
    v_accvgpr_read_b32 v76, a248
    v_accvgpr_read_b32 v77, a249
    v_accvgpr_read_b32 v78, a250
    v_accvgpr_read_b32 v79, a251
    v_accvgpr_read_b32 v80, a252
    v_accvgpr_read_b32 v81, a253
    v_accvgpr_read_b32 v82, a254
    v_accvgpr_read_b32 v83, a255
    v_pk_mul_f32 v[76:77], v[76:77], v[60:61] op_sel_hi:[1,0]
    v_pk_mul_f32 v[78:79], v[78:79], v[60:61] op_sel_hi:[1,0]
    v_pk_mul_f32 v[80:81], v[80:81], v[60:61] op_sel_hi:[1,0]
    v_pk_mul_f32 v[82:83], v[82:83], v[60:61] op_sel_hi:[1,0]
    v_cvt_pk_bf16_f32 v200, v76, v77
    v_cvt_pk_bf16_f32 v201, v78, v79
    v_cvt_pk_bf16_f32 v202, v80, v81
    v_cvt_pk_bf16_f32 v203, v82, v83
    v_accvgpr_read_b32 v68, a192
    v_accvgpr_read_b32 v69, a193
    v_accvgpr_read_b32 v70, a194
    v_accvgpr_read_b32 v71, a195
    v_accvgpr_read_b32 v72, a196
    v_accvgpr_read_b32 v73, a197
    v_accvgpr_read_b32 v74, a198
    v_accvgpr_read_b32 v75, a199
    v_pk_mul_f32 v[68:69], v[68:69], v[56:57] op_sel_hi:[1,0]
    v_pk_mul_f32 v[70:71], v[70:71], v[56:57] op_sel_hi:[1,0]
    v_pk_mul_f32 v[72:73], v[72:73], v[56:57] op_sel_hi:[1,0]
    v_pk_mul_f32 v[74:75], v[74:75], v[56:57] op_sel_hi:[1,0]
    v_cvt_pk_bf16_f32 v96, v68, v69
    v_cvt_pk_bf16_f32 v97, v70, v71
    v_cvt_pk_bf16_f32 v98, v72, v73
    v_cvt_pk_bf16_f32 v99, v74, v75
    v_accvgpr_read_b32 v76, a200
    v_accvgpr_read_b32 v77, a201
    v_accvgpr_read_b32 v78, a202
    v_accvgpr_read_b32 v79, a203
    v_accvgpr_read_b32 v80, a204
    v_accvgpr_read_b32 v81, a205
    v_accvgpr_read_b32 v82, a206
    v_accvgpr_read_b32 v83, a207
    v_pk_mul_f32 v[76:77], v[76:77], v[56:57] op_sel_hi:[1,0]
    v_pk_mul_f32 v[78:79], v[78:79], v[56:57] op_sel_hi:[1,0]
    v_pk_mul_f32 v[80:81], v[80:81], v[56:57] op_sel_hi:[1,0]
    v_pk_mul_f32 v[82:83], v[82:83], v[56:57] op_sel_hi:[1,0]
    v_cvt_pk_bf16_f32 v104, v76, v77
    v_cvt_pk_bf16_f32 v105, v78, v79
    v_cvt_pk_bf16_f32 v106, v80, v81
    v_cvt_pk_bf16_f32 v107, v82, v83
    v_accvgpr_read_b32 v68, a208
    v_accvgpr_read_b32 v69, a209
    v_accvgpr_read_b32 v70, a210
    v_accvgpr_read_b32 v71, a211
    v_accvgpr_read_b32 v72, a212
    v_accvgpr_read_b32 v73, a213
    v_accvgpr_read_b32 v74, a214
    v_accvgpr_read_b32 v75, a215
    v_pk_mul_f32 v[68:69], v[68:69], v[56:57] op_sel_hi:[1,0]
    v_pk_mul_f32 v[70:71], v[70:71], v[56:57] op_sel_hi:[1,0]
    v_pk_mul_f32 v[72:73], v[72:73], v[56:57] op_sel_hi:[1,0]
    v_pk_mul_f32 v[74:75], v[74:75], v[56:57] op_sel_hi:[1,0]
    v_cvt_pk_bf16_f32 v128, v68, v69
    v_cvt_pk_bf16_f32 v129, v70, v71
    v_cvt_pk_bf16_f32 v130, v72, v73
    v_cvt_pk_bf16_f32 v131, v74, v75
    v_accvgpr_read_b32 v76, a216
    v_accvgpr_read_b32 v77, a217
    v_accvgpr_read_b32 v78, a218
    v_accvgpr_read_b32 v79, a219
    v_accvgpr_read_b32 v80, a220
    v_accvgpr_read_b32 v81, a221
    v_accvgpr_read_b32 v82, a222
    v_accvgpr_read_b32 v83, a223
    v_pk_mul_f32 v[76:77], v[76:77], v[56:57] op_sel_hi:[1,0]
    v_pk_mul_f32 v[78:79], v[78:79], v[56:57] op_sel_hi:[1,0]
    v_pk_mul_f32 v[80:81], v[80:81], v[56:57] op_sel_hi:[1,0]
    v_pk_mul_f32 v[82:83], v[82:83], v[56:57] op_sel_hi:[1,0]
    v_cvt_pk_bf16_f32 v136, v76, v77
    v_cvt_pk_bf16_f32 v137, v78, v79
    v_cvt_pk_bf16_f32 v138, v80, v81
    v_cvt_pk_bf16_f32 v139, v82, v83
    s_waitcnt lgkmcnt(0)
    s_cmp_eq_u32 s35, 1
    s_cbranch_scc1 L_job7
L_job6:
    v_mfma_f32_16x16x32_bf16 v[20:23], a[112:115], a[0:3], 0
    ds_write_b128 v8, v[108:111] offset:1024
    v_mfma_f32_16x16x32_bf16 v[20:23], a[116:119], a[4:7], v[20:23]
    v_cvt_pk_bf16_f32 v220, v220, v221
    v_cvt_pk_bf16_f32 v221, v222, v223
    v_mfma_f32_16x16x32_bf16 v[20:23], a[120:123], a[8:11], v[20:23]
    ds_write_b128 v9, v[116:119] offset:1024
    v_mfma_f32_16x16x32_bf16 v[20:23], a[124:127], a[12:15], v[20:23]
    v_cvt_pk_bf16_f32 v222, v224, v225
    v_cvt_pk_bf16_f32 v223, v226, v227
    v_mfma_f32_16x16x32_bf16 v[24:27], a[140:143], a[12:15], 0
    v_cvt_pk_bf16_f32 v228, v228, v229
    v_cvt_pk_bf16_f32 v229, v230, v231
    v_mfma_f32_16x16x32_bf16 v[24:27], a[136:139], a[8:11], v[24:27]
    ds_write_b128 v8, v[160:163] offset:20480
    v_mfma_f32_16x16x32_bf16 v[24:27], a[132:135], a[4:7], v[24:27]
    v_cvt_pk_bf16_f32 v230, v232, v233
    v_cvt_pk_bf16_f32 v231, v234, v235
    v_mfma_f32_16x16x32_bf16 v[24:27], a[128:131], a[0:3], v[24:27]
    ds_write_b128 v9, v[168:171] offset:20480
    v_mfma_f32_16x16x32_bf16 v[28:31], a[112:115], a[16:19], 0
    v_mul_f32 v20, s20, v20
    v_mul_f32 v21, s20, v21
    v_mfma_f32_16x16x32_bf16 v[28:31], a[116:119], a[20:23], v[28:31]
    ds_read_b128 v[160:163], v7 offset:20480
    ds_read_b128 v[168:171], v7 offset:22528
    v_mfma_f32_16x16x32_bf16 v[28:31], a[120:123], a[24:27], v[28:31]
    ds_write_b128 v8, v[140:143] offset:5120
    v_mfma_f32_16x16x32_bf16 v[28:31], a[124:127], a[28:31], v[28:31]
    v_exp_f32 v20, v20
    v_exp_f32 v21, v21
    v_mul_f32 v22, s20, v22
    v_mul_f32 v23, s20, v23
    v_exp_f32 v22, v22
    v_exp_f32 v23, v23
    v_mfma_f32_16x16x32_bf16 v[32:35], a[140:143], a[28:31], 0
    ds_write_b128 v9, v[148:151] offset:5120
    v_mfma_f32_16x16x32_bf16 v[32:35], a[136:139], a[24:27], v[32:35]
    v_cvt_pk_bf16_f32 v36, v20, v21
    v_cvt_pk_bf16_f32 v37, v22, v23
    v_mfma_f32_16x16x32_bf16 v[32:35], a[132:135], a[20:23], v[32:35]
    v_mul_f32 v24, s20, v24
    v_mul_f32 v25, s20, v25
    v_mfma_f32_16x16x32_bf16 v[32:35], a[128:131], a[16:19], v[32:35]
    s_waitcnt lgkmcnt(3)
    buffer_store_dwordx4 v[160:163], v6, s[16:19], s40 offen nt
    v_exp_f32 v24, v24
    v_exp_f32 v25, v25
    v_mul_f32 v26, s20, v26
    v_mul_f32 v27, s20, v27
    v_exp_f32 v26, v26
    v_exp_f32 v27, v27
    v_mfma_f32_16x16x32_bf16 v[20:23], a[112:115], a[32:35], 0
    ds_write_b128 v8, v[192:195] offset:21504
    v_mfma_f32_16x16x32_bf16 v[20:23], a[116:119], a[36:39], v[20:23]
    v_cvt_pk_bf16_f32 v38, v24, v25
    v_cvt_pk_bf16_f32 v39, v26, v27
    v_mfma_f32_16x16x32_bf16 v[20:23], a[120:123], a[40:43], v[20:23]
    s_waitcnt lgkmcnt(3)
    buffer_store_dwordx4 v[168:171], v6, s[16:19], s40 offen offset:2048 nt
    v_mul_f32 v28, s20, v28
    v_mul_f32 v29, s20, v29
    v_exp_f32 v28, v28
    v_mfma_f32_16x16x32_bf16 v[20:23], a[124:127], a[44:47], v[20:23]
    ds_write_b128 v9, v[200:203] offset:21504
    v_mfma_f32_16x16x32_bf16 v[24:27], a[140:143], a[44:47], 0
    v_exp_f32 v29, v29
    v_mul_f32 v30, s20, v30
    v_mul_f32 v31, s20, v31
    v_exp_f32 v30, v30
    v_exp_f32 v31, v31
    v_mfma_f32_16x16x32_bf16 v[24:27], a[136:139], a[40:43], v[24:27]
    ds_read_b128 v[192:195], v7 offset:21504
    v_cvt_pk_bf16_f32 v40, v28, v29
    v_mfma_f32_16x16x32_bf16 v[24:27], a[132:135], a[36:39], v[24:27]
    ds_read_b128 v[200:203], v7 offset:23552
    v_cvt_pk_bf16_f32 v41, v30, v31
    v_mfma_f32_16x16x32_bf16 v[24:27], a[128:131], a[32:35], v[24:27]
    ds_write_b128 v8, v[92:95]
    v_mfma_f32_16x16x32_bf16 v[28:31], a[112:115], a[48:51], 0
    v_mul_f32 v32, s20, v32
    v_mul_f32 v33, s20, v33
    v_exp_f32 v32, v32
    v_exp_f32 v33, v33
    v_mul_f32 v34, s20, v34
    v_mul_f32 v35, s20, v35
    v_exp_f32 v34, v34
    v_exp_f32 v35, v35
    v_mfma_f32_16x16x32_bf16 v[28:31], a[116:119], a[52:55], v[28:31]
    ds_write_b128 v9, v[100:103]
    v_mfma_f32_16x16x32_bf16 v[28:31], a[120:123], a[56:59], v[28:31]
    s_waitcnt lgkmcnt(3)
    buffer_store_dwordx4 v[192:195], v6, s[16:19], s40 offen offset:128 nt
    v_cvt_pk_bf16_f32 v42, v32, v33
    v_cvt_pk_bf16_f32 v43, v34, v35
    v_mul_f32 v20, s20, v20
    v_mul_f32 v21, s20, v21
    v_mfma_f32_16x16x32_bf16 v[28:31], a[124:127], a[60:63], v[28:31]
    ds_write_b128 v8, v[172:175] offset:9216
    v_mfma_f32_16x16x32_bf16 v[32:35], a[140:143], a[60:63], 0
    v_exp_f32 v20, v20
    v_exp_f32 v21, v21
    v_mul_f32 v22, s20, v22
    v_mul_f32 v23, s20, v23
    v_exp_f32 v22, v22
    v_exp_f32 v23, v23
    v_mfma_f32_16x16x32_bf16 v[32:35], a[136:139], a[56:59], v[32:35]
    ds_write_b128 v9, v[180:183] offset:9216
    v_mfma_f32_16x16x32_bf16 v[32:35], a[132:135], a[52:55], v[32:35]
    s_waitcnt lgkmcnt(4)
    buffer_store_dwordx4 v[200:203], v6, s[16:19], s40 offen offset:2176 nt
    v_cvt_pk_bf16_f32 v44, v20, v21
    v_cvt_pk_bf16_f32 v45, v22, v23
    v_mul_f32 v24, s20, v24
    v_mul_f32 v25, s20, v25
    v_mfma_f32_16x16x32_bf16 v[32:35], a[128:131], a[48:51], v[32:35]
    v_exp_f32 v24, v24
    v_exp_f32 v25, v25
    v_mul_f32 v26, s20, v26
    v_mul_f32 v27, s20, v27
    v_exp_f32 v26, v26
    v_exp_f32 v27, v27
    v_mfma_f32_16x16x32_bf16 v[108:111], a[148:151], v[36:39], 0
    s_waitcnt vmcnt(5)
    v_cvt_pk_bf16_f32 v46, v24, v25
    v_cvt_pk_bf16_f32 v47, v26, v27
    v_mfma_f32_16x16x32_bf16 v[112:115], a[156:159], v[36:39], 0
    v_mul_f32 v28, s20, v28
    v_mul_f32 v29, s20, v29
    v_mfma_f32_16x16x32_bf16 v[116:119], a[164:167], v[36:39], 0
    s_add_u32 m0, s27, 0
    v_exp_f32 v28, v28
    v_mfma_f32_16x16x32_bf16 v[120:123], a[172:175], v[36:39], 0
    v_exp_f32 v29, v29
    v_mfma_f32_16x16x32_bf16 v[20:23], a[112:115], a[64:67], 0
    v_mul_f32 v30, s20, v30
    v_mul_f32 v31, s20, v31
    v_mfma_f32_16x16x32_bf16 v[20:23], a[116:119], a[68:71], v[20:23]
    buffer_load_dwordx4 v5, s[64:67], 0 offen lds
    v_cvt_pk_bf16_f32 v48, v28, v29
    v_mfma_f32_16x16x32_bf16 v[20:23], a[120:123], a[72:75], v[20:23]
    s_add_u32 m0, s27, 896
    ds_write_b128 v8, v[204:207] offset:13312
    v_mfma_f32_16x16x32_bf16 v[20:23], a[124:127], a[76:79], v[20:23]
    v_exp_f32 v30, v30
    v_exp_f32 v31, v31
    v_mfma_f32_16x16x32_bf16 v[24:27], a[140:143], a[76:79], 0
    v_cvt_pk_bf16_f32 v49, v30, v31
    v_mul_f32 v32, s20, v32
    v_mfma_f32_16x16x32_bf16 v[24:27], a[136:139], a[72:75], v[24:27]
    buffer_load_dwordx4 v5, s[64:67], 0 offen offset:128 lds
    v_mul_f32 v33, s20, v33
    v_mfma_f32_16x16x32_bf16 v[24:27], a[132:135], a[68:71], v[24:27]
    s_add_u32 m0, s27, 2048
    ds_write_b128 v9, v[212:215] offset:13312
    v_mfma_f32_16x16x32_bf16 v[24:27], a[128:131], a[64:67], v[24:27]
    v_exp_f32 v32, v32
    v_exp_f32 v33, v33
    v_mul_f32 v34, s20, v34
    v_mul_f32 v35, s20, v35
    v_exp_f32 v34, v34
    v_exp_f32 v35, v35
    v_mfma_f32_16x16x32_bf16 v[140:143], a[148:151], v[40:43], 0
    ds_write_b128 v8, v[236:239] offset:17408
    v_mfma_f32_16x16x32_bf16 v[144:147], a[156:159], v[40:43], 0
    buffer_load_dwordx4 v5, s[68:71], 0 offen lds
    v_cvt_pk_bf16_f32 v50, v32, v33
    v_mfma_f32_16x16x32_bf16 v[148:151], a[164:167], v[40:43], 0
    s_add_u32 m0, s27, 3072
    v_cvt_pk_bf16_f32 v51, v34, v35
    v_mul_f32 v20, s20, v20
    v_mfma_f32_16x16x32_bf16 v[152:155], a[172:175], v[40:43], 0
    ds_write_b128 v9, v[244:247] offset:17408
    v_mfma_f32_16x16x32_bf16 v[28:31], a[112:115], a[80:83], 0
    v_mul_f32 v21, s20, v21
    v_mul_f32 v22, s20, v22
    v_mfma_f32_16x16x32_bf16 v[28:31], a[116:119], a[84:87], v[28:31]
    ds_read_b128 a[112:115], v1
    ds_read_b128 a[116:119], v2
    v_mfma_f32_16x16x32_bf16 v[28:31], a[120:123], a[88:91], v[28:31]
    buffer_load_dwordx4 v5, s[88:91], 0 offen lds
    v_mul_f32 v23, s20, v23
    v_mfma_f32_16x16x32_bf16 v[28:31], a[124:127], a[92:95], v[28:31]
    s_add_u32 s27, s27, 16384
    ds_read_b128 a[120:123], v1 offset:1024
    ds_read_b128 a[124:127], v2 offset:1024
    v_mfma_f32_16x16x32_bf16 v[32:35], a[140:143], a[92:95], 0
    s_and_b32 s27, s27, 0xffff
    ds_write_b128 v8, v[124:127] offset:4096
    v_mfma_f32_16x16x32_bf16 v[32:35], a[136:139], a[88:91], v[32:35]
    s_mov_b64 s[68:69], s[88:89]
    v_exp_f32 v20, v20
    v_exp_f32 v21, v21
    v_exp_f32 v22, v22
    v_exp_f32 v23, v23
    v_mfma_f32_16x16x32_bf16 v[32:35], a[132:135], a[84:87], v[32:35]
    s_mov_b32 s70, s90
    ds_read_b128 v[12:15], v7
    v_cvt_pk_bf16_f32 v52, v20, v21
    v_mfma_f32_16x16x32_bf16 v[32:35], a[128:131], a[80:83], v[32:35]
    s_add_u32 s88, s88, 8192
    ds_read_b128 a[140:143], v2 offset:9216
    v_cvt_pk_bf16_f32 v53, v22, v23
    v_mul_f32 v24, s20, v24
    v_mul_f32 v25, s20, v25
    v_exp_f32 v24, v24
    v_exp_f32 v25, v25
    v_mul_f32 v26, s20, v26
    v_mul_f32 v27, s20, v27
    v_exp_f32 v26, v26
    v_exp_f32 v27, v27
    v_mfma_f32_16x16x32_bf16 v[172:175], a[148:151], v[44:47], 0
    s_addc_u32 s89, s89, 0
    ds_write_b128 v9, v[132:135] offset:4096
    v_mfma_f32_16x16x32_bf16 v[176:179], a[156:159], v[44:47], 0
    s_mov_b32 s90, s66
    v_cvt_pk_bf16_f32 v54, v24, v25
    v_cvt_pk_bf16_f32 v55, v26, v27
    v_mfma_f32_16x16x32_bf16 v[180:183], a[164:167], v[44:47], 0
    s_add_u32 s64, s64, 8192
    ds_read_b128 a[136:139], v1 offset:9216
    v_mul_f32 v28, s20, v28
    v_mfma_f32_16x16x32_bf16 v[184:187], a[172:175], v[44:47], 0
    s_waitcnt lgkmcnt(5)
    ds_read_b128 a[132:135], v2 offset:8192
    ds_read_b128 a[128:131], v1 offset:8192
    v_mfma_f32_16x16x32_bf16 v[20:23], a[112:115], a[0:3], 0
    s_addc_u32 s65, s65, 0
    ds_write_b128 v8, v[96:99] offset:20480
    v_mfma_f32_16x16x32_bf16 v[20:23], a[116:119], a[4:7], v[20:23]
    s_add_u32 s23, s23, 1
    v_mul_f32 v29, s20, v29
    v_mul_f32 v30, s20, v30
    v_mfma_f32_16x16x32_bf16 v[20:23], a[120:123], a[8:11], v[20:23]
    s_cmp_lt_u32 s23, 64
    ds_write_b128 v9, v[104:107] offset:20480
    v_mfma_f32_16x16x32_bf16 v[20:23], a[124:127], a[12:15], v[20:23]
    s_waitcnt lgkmcnt(2)
    v_exp_f32 v28, v28
    v_exp_f32 v29, v29
    v_mul_f32 v31, s20, v31
    v_exp_f32 v30, v30
    v_exp_f32 v31, v31
    v_mfma_f32_16x16x32_bf16 v[24:27], a[140:143], a[12:15], 0
    s_cselect_b32 s66, 8192, 0
    ds_write_b128 v8, v[128:131] offset:21504
    v_mfma_f32_16x16x32_bf16 v[24:27], a[136:139], a[8:11], v[24:27]
    buffer_store_dwordx4 v[12:15], v6, s[76:79], 0 offen nt
    v_cvt_pk_bf16_f32 v56, v28, v29
    v_cvt_pk_bf16_f32 v57, v30, v31
    v_mul_f32 v32, s20, v32
    v_mul_f32 v33, s20, v33
    v_mfma_f32_16x16x32_bf16 v[24:27], a[132:135], a[4:7], v[24:27]
    s_add_u32 s76, s76, s29
    ds_read_b128 v[12:15], v7 offset:1024
    v_mul_f32 v34, s20, v34
    v_mfma_f32_16x16x32_bf16 v[24:27], a[128:131], a[0:3], v[24:27]
    s_addc_u32 s77, s77, 0
    ds_write_b128 v9, v[136:139] offset:21504
    v_mfma_f32_16x16x32_bf16 v[204:207], a[148:151], v[48:51], 0
    s_mov_b32 m0, s31
    v_exp_f32 v32, v32
    v_exp_f32 v33, v33
    v_mul_f32 v35, s20, v35
    v_exp_f32 v34, v34
    v_exp_f32 v35, v35
    v_mfma_f32_16x16x32_bf16 v[208:211], a[156:159], v[48:51], 0
    buffer_load_dwordx4 v6, s[72:75], 0 offen nt lds
    v_cvt_pk_bf16_f32 v58, v32, v33
    v_mfma_f32_16x16x32_bf16 v[212:215], a[164:167], v[48:51], 0
    s_add_u32 s72, s72, s29
    ds_write_b128 v8, v[156:159] offset:8192
    v_mfma_f32_16x16x32_bf16 v[216:219], a[172:175], v[48:51], 0
    s_addc_u32 s73, s73, 0
    v_cvt_pk_bf16_f32 v59, v34, v35
    v_mul_f32 v20, s20, v20
    v_mfma_f32_16x16x32_bf16 v[28:31], a[112:115], a[16:19], 0
    s_xor_b32 s29, s29, 0x700
    v_mul_f32 v21, s20, v21
    v_mul_f32 v22, s20, v22
    v_mfma_f32_16x16x32_bf16 v[28:31], a[116:119], a[20:23], v[28:31]
    s_add_u32 s31, s31, 1024
    ds_write_b128 v9, v[164:167] offset:8192
    v_mfma_f32_16x16x32_bf16 v[28:31], a[120:123], a[24:27], v[28:31]
    s_waitcnt lgkmcnt(3)
    buffer_store_dwordx4 v[12:15], v6, s[76:79], 0 offen nt
    v_exp_f32 v20, v20
    v_exp_f32 v21, v21
    v_mfma_f32_16x16x32_bf16 v[28:31], a[124:127], a[28:31], v[28:31]
    s_add_u32 s76, s76, s29
    ds_read_b128 v[12:15], v7 offset:2048
    v_add_u32 v7, 3072, v7
    v_mul_f32 v23, s20, v23
    v_exp_f32 v22, v22
    v_exp_f32 v23, v23
    v_mfma_f32_16x16x32_bf16 v[32:35], a[140:143], a[28:31], 0
    s_addc_u32 s77, s77, 0
    v_cvt_pk_bf16_f32 v68, v20, v21
    v_cvt_pk_bf16_f32 v69, v22, v23
    v_mfma_f32_16x16x32_bf16 v[32:35], a[136:139], a[24:27], v[32:35]
    s_mov_b32 m0, s31
    ds_write_b128 v8, v[188:191] offset:12288
    v_mfma_f32_16x16x32_bf16 v[32:35], a[132:135], a[20:23], v[32:35]
    buffer_load_dwordx4 v6, s[72:75], 0 offen nt lds
    v_mul_f32 v24, s20, v24
    v_mfma_f32_16x16x32_bf16 v[32:35], a[128:131], a[16:19], v[32:35]
    s_add_u32 s72, s72, s29
    v_mul_f32 v25, s20, v25
    v_mul_f32 v26, s20, v26
    v_exp_f32 v24, v24
    v_exp_f32 v25, v25
    v_mul_f32 v27, s20, v27
    v_exp_f32 v26, v26
    v_exp_f32 v27, v27
    v_mfma_f32_16x16x32_bf16 v[236:239], a[148:151], v[52:55], 0
    s_addc_u32 s73, s73, 0
    ds_write_b128 v9, v[196:199] offset:12288
    v_mfma_f32_16x16x32_bf16 v[240:243], a[156:159], v[52:55], 0
    s_xor_b32 s29, s29, 0x700
    v_cvt_pk_bf16_f32 v70, v24, v25
    v_cvt_pk_bf16_f32 v71, v26, v27
    v_mfma_f32_16x16x32_bf16 v[244:247], a[164:167], v[52:55], 0
    s_add_u32 s31, s31, 1024
    v_mul_f32 v28, s20, v28
    v_mul_f32 v29, s20, v29
    v_mfma_f32_16x16x32_bf16 v[248:251], a[172:175], v[52:55], 0
    s_waitcnt lgkmcnt(2)
    buffer_store_dwordx4 v[12:15], v6, s[76:79], 0 offen nt
    v_exp_f32 v28, v28
    v_exp_f32 v29, v29
    v_mfma_f32_16x16x32_bf16 v[20:23], a[112:115], a[32:35], 0
    s_add_u32 s76, s76, s29
    ds_write_b128 v8, v[220:223] offset:16384
    v_mfma_f32_16x16x32_bf16 v[20:23], a[116:119], a[36:39], v[20:23]
    s_addc_u32 s77, s77, 0
    v_mul_f32 v30, s20, v30
    v_mul_f32 v31, s20, v31
    v_mfma_f32_16x16x32_bf16 v[20:23], a[120:123], a[40:43], v[20:23]
    s_mov_b32 m0, s31
    ds_write_b128 v9, v[228:231] offset:16384
    v_mfma_f32_16x16x32_bf16 v[20:23], a[124:127], a[44:47], v[20:23]
    buffer_load_dwordx4 v6, s[72:75], 0 offen nt lds
    v_cvt_pk_bf16_f32 v72, v28, v29
    v_exp_f32 v30, v30
    v_exp_f32 v31, v31
    v_mfma_f32_16x16x32_bf16 v[24:27], a[140:143], a[44:47], 0
    s_add_u32 s72, s72, s29
    v_cvt_pk_bf16_f32 v73, v30, v31
    v_mul_f32 v32, s20, v32
    v_mfma_f32_16x16x32_bf16 v[24:27], a[136:139], a[40:43], v[24:27]
    s_addc_u32 s73, s73, 0
    v_mul_f32 v33, s20, v33
    v_mul_f32 v34, s20, v34
    v_mfma_f32_16x16x32_bf16 v[24:27], a[132:135], a[36:39], v[24:27]
    s_xor_b32 s29, s29, 0x700
    v_exp_f32 v32, v32
    v_mfma_f32_16x16x32_bf16 v[24:27], a[128:131], a[32:35], v[24:27]
    s_add_u32 s31, s31, 1024
    v_exp_f32 v33, v33
    v_mul_f32 v35, s20, v35
    v_exp_f32 v34, v34
    v_exp_f32 v35, v35
    v_mfma_f32_16x16x32_bf16 a[208:211], a[148:151], v[56:59], 0
    s_waitcnt vmcnt(23) lgkmcnt(0)
    v_cvt_pk_bf16_f32 v74, v32, v33
    v_cvt_pk_bf16_f32 v75, v34, v35
    v_mfma_f32_16x16x32_bf16 a[212:215], a[156:159], v[56:59], 0
    s_barrier
    v_mul_f32 v20, s20, v20
    v_mfma_f32_16x16x32_bf16 a[216:219], a[164:167], v[56:59], 0
    ds_read_b64_tr_b16 a[144:145], v3 offset:18432
    ds_read_b64_tr_b16 a[146:147], v3 offset:26624
    v_mfma_f32_16x16x32_bf16 a[220:223], a[172:175], v[56:59], 0
    ds_read_b64_tr_b16 a[148:149], v3 offset:19456
    ds_read_b64_tr_b16 a[150:151], v3 offset:27648
    v_mfma_f32_16x16x32_bf16 v[28:31], a[112:115], a[48:51], 0
    ds_read_b64_tr_b16 a[156:157], v3 offset:19464
    ds_read_b64_tr_b16 a[158:159], v3 offset:27656
    v_mfma_f32_16x16x32_bf16 v[28:31], a[116:119], a[52:55], v[28:31]
    ds_read_b64_tr_b16 a[152:153], v3 offset:18440
    ds_read_b64_tr_b16 a[154:155], v3 offset:26632
    v_mfma_f32_16x16x32_bf16 v[28:31], a[120:123], a[56:59], v[28:31]
    ds_read_b64_tr_b16 a[160:161], v4 offset:18432
    ds_read_b64_tr_b16 a[162:163], v4 offset:26624
    v_mfma_f32_16x16x32_bf16 v[28:31], a[124:127], a[60:63], v[28:31]
    ds_read_b64_tr_b16 a[164:165], v4 offset:19456
    ds_read_b64_tr_b16 a[166:167], v4 offset:27648
    v_mfma_f32_16x16x32_bf16 v[32:35], a[140:143], a[60:63], 0
    v_mul_f32 v21, s20, v21
    v_mul_f32 v22, s20, v22
    v_exp_f32 v20, v20
    v_exp_f32 v21, v21
    v_mul_f32 v23, s20, v23
    v_exp_f32 v22, v22
    v_exp_f32 v23, v23
    v_mfma_f32_16x16x32_bf16 v[32:35], a[136:139], a[56:59], v[32:35]
    ds_read_b64_tr_b16 a[172:173], v4 offset:19464
    v_cvt_pk_bf16_f32 v76, v20, v21
    v_mfma_f32_16x16x32_bf16 v[32:35], a[132:135], a[52:55], v[32:35]
    ds_read_b64_tr_b16 a[174:175], v4 offset:27656
    v_cvt_pk_bf16_f32 v77, v22, v23
    v_mfma_f32_16x16x32_bf16 v[32:35], a[128:131], a[48:51], v[32:35]
    s_waitcnt lgkmcnt(6)
    ds_read_b64_tr_b16 a[168:169], v4 offset:18440
    v_mul_f32 v24, s20, v24
    v_mul_f32 v25, s20, v25
    v_exp_f32 v24, v24
    v_exp_f32 v25, v25
    v_mul_f32 v26, s20, v26
    v_mul_f32 v27, s20, v27
    v_exp_f32 v26, v26
    v_exp_f32 v27, v27
    v_mfma_f32_16x16x32_bf16 v[92:95], a[144:147], v[36:39], 0
    ds_read_b64_tr_b16 a[170:171], v4 offset:26632
    v_xor_b32 v3, 0x8000, v3
    v_mfma_f32_16x16x32_bf16 v[92:95], a[148:151], v[68:71], v[92:95]
    v_xor_b32 v4, 0x8000, v4
    v_cvt_pk_bf16_f32 v78, v24, v25
    v_mfma_f32_16x16x32_bf16 v[96:99], a[156:159], v[68:71], 0
    s_add_u32 m0, s27, 0
    v_cvt_pk_bf16_f32 v79, v26, v27
    v_mul_f32 v28, s20, v28
    v_mfma_f32_16x16x32_bf16 v[96:99], a[152:155], v[36:39], v[96:99]
    s_waitcnt lgkmcnt(0)
    v_mul_f32 v29, s20, v29
    v_mul_f32 v30, s20, v30
    v_mfma_f32_16x16x32_bf16 v[100:103], a[160:163], v[36:39], 0
    v_exp_f32 v28, v28
    v_mfma_f32_16x16x32_bf16 v[100:103], a[164:167], v[68:71], v[100:103]
    buffer_load_dwordx4 v5, s[64:67], 0 offen lds
    v_mul_f32 v31, s20, v31
    v_mfma_f32_16x16x32_bf16 v[104:107], a[172:175], v[68:71], 0
    v_exp_f32 v29, v29
    v_mfma_f32_16x16x32_bf16 v[104:107], a[168:171], v[36:39], v[104:107]
    v_exp_f32 v30, v30
    v_mfma_f32_16x16x32_bf16 v[20:23], a[112:115], a[64:67], 0
    v_exp_f32 v31, v31
    v_mfma_f32_16x16x32_bf16 v[20:23], a[116:119], a[68:71], v[20:23]
    v_cvt_pk_bf16_f32 v80, v28, v29
    v_cvt_pk_bf16_f32 v81, v30, v31
    v_mfma_f32_16x16x32_bf16 v[20:23], a[120:123], a[72:75], v[20:23]
    s_add_u32 m0, s27, 896
    v_mul_f32 v32, s20, v32
    v_mul_f32 v33, s20, v33
    v_mfma_f32_16x16x32_bf16 v[20:23], a[124:127], a[76:79], v[20:23]
    v_exp_f32 v32, v32
    v_mfma_f32_16x16x32_bf16 v[24:27], a[140:143], a[76:79], 0
    v_exp_f32 v33, v33
    v_mfma_f32_16x16x32_bf16 v[24:27], a[136:139], a[72:75], v[24:27]
    buffer_load_dwordx4 v5, s[64:67], 0 offen offset:128 lds
    v_mul_f32 v34, s20, v34
    v_mfma_f32_16x16x32_bf16 v[24:27], a[132:135], a[68:71], v[24:27]
    v_mul_f32 v35, s20, v35
    v_cvt_pk_bf16_f32 v82, v32, v33
    v_mfma_f32_16x16x32_bf16 v[24:27], a[128:131], a[64:67], v[24:27]
    v_exp_f32 v34, v34
    v_mfma_f32_16x16x32_bf16 v[124:127], a[144:147], v[40:43], 0
    v_exp_f32 v35, v35
    v_mfma_f32_16x16x32_bf16 v[124:127], a[148:151], v[72:75], v[124:127]
    v_cvt_pk_bf16_f32 v83, v34, v35
    v_mul_f32 v20, s20, v20
    v_mfma_f32_16x16x32_bf16 v[128:131], a[156:159], v[72:75], 0
    s_add_u32 m0, s27, 1920
    v_mul_f32 v21, s20, v21
    v_mul_f32 v22, s20, v22
    v_mfma_f32_16x16x32_bf16 v[128:131], a[152:155], v[40:43], v[128:131]
    v_exp_f32 v20, v20
    v_mfma_f32_16x16x32_bf16 v[132:135], a[160:163], v[40:43], 0
    v_exp_f32 v21, v21
    v_mfma_f32_16x16x32_bf16 v[132:135], a[164:167], v[72:75], v[132:135]
    buffer_load_dwordx4 v5, s[68:71], 0 offen offset:128 lds
    v_mul_f32 v23, s20, v23
    v_mfma_f32_16x16x32_bf16 v[136:139], a[172:175], v[72:75], 0
    v_exp_f32 v22, v22
    v_mfma_f32_16x16x32_bf16 v[136:139], a[168:171], v[40:43], v[136:139]
    v_exp_f32 v23, v23
    v_smfmac_f32_16x16x64_bf16 a[176:179], v[16:19], v[36:43], v252
    v_cvt_pk_bf16_f32 v84, v20, v21
    v_smfmac_f32_16x16x64_bf16 a[176:179], v[16:19], v[68:75], v252
    v_cvt_pk_bf16_f32 v85, v22, v23
    v_mfma_f32_16x16x32_bf16 v[28:31], a[112:115], a[80:83], 0
    s_add_u32 m0, s27, 2944
    ds_read_b128 a[112:115], v1 offset:16384
    v_mul_f32 v24, s20, v24
    v_mfma_f32_16x16x32_bf16 v[28:31], a[116:119], a[84:87], v[28:31]
    ds_read_b128 a[116:119], v2 offset:16384
    v_mul_f32 v25, s20, v25
    v_mfma_f32_16x16x32_bf16 v[28:31], a[120:123], a[88:91], v[28:31]
    v_exp_f32 v24, v24
    v_mfma_f32_16x16x32_bf16 v[28:31], a[124:127], a[92:95], v[28:31]
    buffer_load_dwordx4 v5, s[88:91], 0 offen offset:128 lds
    v_mul_f32 v26, s20, v26
    v_mfma_f32_16x16x32_bf16 v[32:35], a[140:143], a[92:95], 0
    s_add_u32 s27, s27, 16384
    ds_read_b128 a[120:123], v1 offset:17408
    v_mul_f32 v27, s20, v27
    v_mfma_f32_16x16x32_bf16 v[32:35], a[136:139], a[88:91], v[32:35]
    s_and_b32 s27, s27, 0xffff
    ds_read_b128 a[124:127], v2 offset:17408
    v_mul_f32 v28, s20, v28
    v_mfma_f32_16x16x32_bf16 v[32:35], a[132:135], a[84:87], v[32:35]
    s_mov_b64 s[68:69], s[88:89]
    ds_read_b128 a[140:143], v2 offset:25600
    v_mul_f32 v29, s20, v29
    v_mfma_f32_16x16x32_bf16 v[32:35], a[128:131], a[80:83], v[32:35]
    s_mov_b32 s70, s90
    ds_read_b128 a[136:139], v1 offset:25600
    v_mul_f32 v30, s20, v30
    v_mfma_f32_16x16x32_bf16 v[156:159], a[144:147], v[44:47], 0
    s_add_u32 s88, s88, 8192
    ds_read_b128 v[12:15], v7
    v_mul_f32 v31, s20, v31
    v_mfma_f32_16x16x32_bf16 v[156:159], a[148:151], v[76:79], v[156:159]
    s_addc_u32 s89, s89, 0
    ds_read_b128 a[132:135], v2 offset:24576
    v_xor_b32 v2, 0x8000, v2
    v_mfma_f32_16x16x32_bf16 v[160:163], a[156:159], v[76:79], 0
    s_mov_b32 s90, s66
    ds_read_b128 a[128:131], v1 offset:24576
    v_xor_b32 v1, 0x8000, v1
    v_mfma_f32_16x16x32_bf16 v[160:163], a[152:155], v[44:47], v[160:163]
    s_add_u32 s64, s64, 8192
    v_exp_f32 v25, v25
    v_mfma_f32_16x16x32_bf16 v[164:167], a[160:163], v[44:47], 0
    s_addc_u32 s65, s65, 0
    v_exp_f32 v26, v26
    v_mfma_f32_16x16x32_bf16 v[164:167], a[164:167], v[76:79], v[164:167]
    s_add_u32 s23, s23, 1
    v_exp_f32 v27, v27
    v_mfma_f32_16x16x32_bf16 v[168:171], a[172:175], v[76:79], 0
    s_cmp_lt_u32 s23, 64
    v_cvt_pk_bf16_f32 v86, v24, v25
    v_cvt_pk_bf16_f32 v87, v26, v27
    v_mfma_f32_16x16x32_bf16 v[168:171], a[168:171], v[44:47], v[168:171]
    s_waitcnt lgkmcnt(5)
    v_exp_f32 v28, v28
    v_mfma_f32_16x16x32_bf16 v[20:23], a[112:115], a[0:3], 0
    s_cselect_b32 s66, 8192, 0
    v_exp_f32 v29, v29
    v_mfma_f32_16x16x32_bf16 v[20:23], a[116:119], a[4:7], v[20:23]
    s_waitcnt lgkmcnt(2)
    buffer_store_dwordx4 v[12:15], v6, s[76:79], 0 offen nt
    v_exp_f32 v30, v30
    v_exp_f32 v31, v31
    v_mfma_f32_16x16x32_bf16 v[20:23], a[120:123], a[8:11], v[20:23]
    s_add_u32 s76, s76, s29
    v_cvt_pk_bf16_f32 v88, v28, v29
    v_cvt_pk_bf16_f32 v89, v30, v31
    v_mfma_f32_16x16x32_bf16 v[20:23], a[124:127], a[12:15], v[20:23]
    s_addc_u32 s77, s77, 0
    v_mul_f32 v32, s20, v32
    v_mul_f32 v33, s20, v33
    v_mfma_f32_16x16x32_bf16 v[24:27], a[140:143], a[12:15], 0
    v_exp_f32 v32, v32
    v_mfma_f32_16x16x32_bf16 v[24:27], a[136:139], a[8:11], v[24:27]
    s_waitcnt lgkmcnt(0)
    v_exp_f32 v33, v33
    v_mfma_f32_16x16x32_bf16 v[24:27], a[132:135], a[4:7], v[24:27]
    s_mov_b32 m0, s31
    v_mul_f32 v34, s20, v34
    v_mul_f32 v35, s20, v35
    v_mfma_f32_16x16x32_bf16 v[24:27], a[128:131], a[0:3], v[24:27]
    v_exp_f32 v34, v34
    v_mfma_f32_16x16x32_bf16 v[188:191], a[144:147], v[48:51], 0
    ds_read_b128 v[12:15], v7 offset:1024
    v_cvt_pk_bf16_f32 v90, v32, v33
    v_mfma_f32_16x16x32_bf16 v[188:191], a[148:151], v[80:83], v[188:191]
    buffer_load_dwordx4 v6, s[72:75], 0 offen nt lds
    v_mul_f32 v20, s20, v20
    v_mfma_f32_16x16x32_bf16 v[192:195], a[156:159], v[80:83], 0
    s_add_u32 s72, s72, s29
    v_exp_f32 v35, v35
    v_mfma_f32_16x16x32_bf16 v[192:195], a[152:155], v[48:51], v[192:195]
    s_addc_u32 s73, s73, 0
    v_cvt_pk_bf16_f32 v91, v34, v35
    v_mul_f32 v21, s20, v21
    v_mfma_f32_16x16x32_bf16 v[196:199], a[160:163], v[48:51], 0
    s_xor_b32 s29, s29, 0x700
    v_exp_f32 v20, v20
    v_mfma_f32_16x16x32_bf16 v[196:199], a[164:167], v[80:83], v[196:199]
    s_add_u32 s31, s31, 1024
    v_exp_f32 v21, v21
    v_mfma_f32_16x16x32_bf16 v[200:203], a[172:175], v[80:83], 0
    v_mul_f32 v22, s20, v22
    v_mul_f32 v23, s20, v23
    v_mfma_f32_16x16x32_bf16 v[200:203], a[168:171], v[48:51], v[200:203]
    v_exp_f32 v22, v22
    v_smfmac_f32_16x16x64_bf16 a[180:183], v[16:19], v[44:51], v252
    v_cvt_pk_bf16_f32 v36, v20, v21
    v_smfmac_f32_16x16x64_bf16 a[180:183], v[16:19], v[76:83], v252
    s_waitcnt lgkmcnt(0)
    v_mul_f32 v24, s20, v24
    v_mfma_f32_16x16x32_bf16 v[28:31], a[112:115], a[16:19], 0
    buffer_store_dwordx4 v[12:15], v6, s[76:79], 0 offen nt
    v_exp_f32 v23, v23
    v_mul_f32 v25, s20, v25
    v_cvt_pk_bf16_f32 v37, v22, v23
    v_mfma_f32_16x16x32_bf16 v[28:31], a[116:119], a[20:23], v[28:31]
    s_add_u32 s76, s76, s29
    v_exp_f32 v24, v24
    v_mfma_f32_16x16x32_bf16 v[28:31], a[120:123], a[24:27], v[28:31]
    s_addc_u32 s77, s77, 0
    v_exp_f32 v25, v25
    v_mfma_f32_16x16x32_bf16 v[28:31], a[124:127], a[28:31], v[28:31]
    v_mul_f32 v26, s20, v26
    v_mul_f32 v27, s20, v27
    v_mfma_f32_16x16x32_bf16 v[32:35], a[140:143], a[28:31], 0
    s_mov_b32 m0, s31
    v_exp_f32 v26, v26
    v_mfma_f32_16x16x32_bf16 v[32:35], a[136:139], a[24:27], v[32:35]
    v_exp_f32 v27, v27
    v_mfma_f32_16x16x32_bf16 v[32:35], a[132:135], a[20:23], v[32:35]
    ds_read_b128 v[12:15], v7 offset:2048
    v_add_u32 v7, 3072, v7
    v_mfma_f32_16x16x32_bf16 v[32:35], a[128:131], a[16:19], v[32:35]
    buffer_load_dwordx4 v6, s[72:75], 0 offen nt lds
    v_cvt_pk_bf16_f32 v38, v24, v25
    v_mfma_f32_16x16x32_bf16 v[220:223], a[144:147], v[52:55], 0
    s_add_u32 s72, s72, s29
    v_cvt_pk_bf16_f32 v39, v26, v27
    v_mul_f32 v28, s20, v28
    v_mfma_f32_16x16x32_bf16 v[220:223], a[148:151], v[84:87], v[220:223]
    s_addc_u32 s73, s73, 0
    v_mul_f32 v29, s20, v29
    v_mul_f32 v30, s20, v30
    v_mfma_f32_16x16x32_bf16 v[224:227], a[156:159], v[84:87], 0
    s_xor_b32 s29, s29, 0x700
    v_exp_f32 v28, v28
    v_mfma_f32_16x16x32_bf16 v[224:227], a[152:155], v[52:55], v[224:227]
    s_add_u32 s31, s31, 1024
    v_exp_f32 v29, v29
    v_mfma_f32_16x16x32_bf16 v[228:231], a[160:163], v[52:55], 0
    v_mul_f32 v31, s20, v31
    v_cvt_pk_bf16_f32 v40, v28, v29
    v_mfma_f32_16x16x32_bf16 v[228:231], a[164:167], v[84:87], v[228:231]
    v_exp_f32 v30, v30
    v_mfma_f32_16x16x32_bf16 v[232:235], a[172:175], v[84:87], 0
    v_exp_f32 v31, v31
    v_mfma_f32_16x16x32_bf16 v[232:235], a[168:171], v[52:55], v[232:235]
    s_waitcnt lgkmcnt(0)
    buffer_store_dwordx4 v[12:15], v6, s[76:79], 0 offen nt
    v_cvt_pk_bf16_f32 v41, v30, v31
    v_mul_f32 v32, s20, v32
    v_mul_f32 v33, s20, v33
    v_mul_f32 v34, s20, v34
    v_mfma_f32_16x16x32_bf16 v[20:23], a[112:115], a[32:35], 0
    s_add_u32 s76, s76, s29
    v_exp_f32 v32, v32
    v_mfma_f32_16x16x32_bf16 v[20:23], a[116:119], a[36:39], v[20:23]
    s_addc_u32 s77, s77, 0
    v_exp_f32 v33, v33
    v_mfma_f32_16x16x32_bf16 v[20:23], a[120:123], a[40:43], v[20:23]
    v_mul_f32 v35, s20, v35
    v_cvt_pk_bf16_f32 v42, v32, v33
    v_mfma_f32_16x16x32_bf16 v[20:23], a[124:127], a[44:47], v[20:23]
    v_exp_f32 v34, v34
    v_mfma_f32_16x16x32_bf16 v[24:27], a[140:143], a[44:47], 0
    s_mov_b32 m0, s31
    v_exp_f32 v35, v35
    v_mfma_f32_16x16x32_bf16 v[24:27], a[136:139], a[40:43], v[24:27]
    s_waitcnt vmcnt(28) lgkmcnt(0)
    v_cvt_pk_bf16_f32 v43, v34, v35
    v_mfma_f32_16x16x32_bf16 v[24:27], a[132:135], a[36:39], v[24:27]
    s_barrier
    v_mul_f32 v20, s20, v20
    v_mfma_f32_16x16x32_bf16 v[24:27], a[128:131], a[32:35], v[24:27]
    buffer_load_dwordx4 v6, s[72:75], 0 offen nt lds
    v_mul_f32 v21, s20, v21
    v_mfma_f32_16x16x32_bf16 a[192:195], a[144:147], v[56:59], 0
    s_add_u32 s72, s72, s29
    ds_read_b64_tr_b16 a[144:145], v3 offset:2048
    v_mul_f32 v22, s20, v22
    v_mfma_f32_16x16x32_bf16 a[192:195], a[148:151], v[88:91], a[192:195]
    s_addc_u32 s73, s73, 0
    ds_read_b64_tr_b16 a[146:147], v3 offset:10240
    v_mul_f32 v23, s20, v23
    v_mfma_f32_16x16x32_bf16 a[196:199], a[156:159], v[88:91], 0
    s_xor_b32 s29, s29, 0x700
    ds_read_b64_tr_b16 a[148:149], v3 offset:3072
    v_mul_f32 v24, s20, v24
    v_mfma_f32_16x16x32_bf16 a[196:199], a[152:155], v[56:59], a[196:199]
    s_add_u32 s31, s31, 1024
    ds_read_b64_tr_b16 a[150:151], v3 offset:11264
    v_mul_f32 v25, s20, v25
    v_mfma_f32_16x16x32_bf16 a[200:203], a[160:163], v[56:59], 0
    ds_read_b64_tr_b16 a[156:157], v3 offset:3080
    v_mul_f32 v26, s20, v26
    v_mfma_f32_16x16x32_bf16 a[200:203], a[164:167], v[88:91], a[200:203]
    ds_read_b64_tr_b16 a[158:159], v3 offset:11272
    v_mul_f32 v27, s20, v27
    v_mfma_f32_16x16x32_bf16 a[204:207], a[172:175], v[88:91], 0
    ds_read_b64_tr_b16 a[152:153], v3 offset:2056
    ds_read_b64_tr_b16 a[154:155], v3 offset:10248
    v_mfma_f32_16x16x32_bf16 a[204:207], a[168:171], v[56:59], a[204:207]
    v_exp_f32 v20, v20
    v_smfmac_f32_16x16x64_bf16 a[184:187], v[16:19], v[52:59], v252
    ds_read_b64_tr_b16 a[160:161], v4 offset:2048
    v_smfmac_f32_16x16x64_bf16 a[184:187], v[16:19], v[84:91], v252
    ds_read_b64_tr_b16 a[162:163], v4 offset:10240
    v_mfma_f32_16x16x32_bf16 v[28:31], a[112:115], a[48:51], 0
    ds_read_b64_tr_b16 a[164:165], v4 offset:3072
    ds_read_b64_tr_b16 a[166:167], v4 offset:11264
    v_mfma_f32_16x16x32_bf16 v[28:31], a[116:119], a[52:55], v[28:31]
    v_exp_f32 v21, v21
    v_mfma_f32_16x16x32_bf16 v[28:31], a[120:123], a[56:59], v[28:31]
    ds_read_b64_tr_b16 a[172:173], v4 offset:3080
    v_mfma_f32_16x16x32_bf16 v[28:31], a[124:127], a[60:63], v[28:31]
    s_cmp_eq_u32 s22, 3
    ds_read_b64_tr_b16 a[174:175], v4 offset:11272
    v_mfma_f32_16x16x32_bf16 v[32:35], a[140:143], a[60:63], 0
    ds_read_b64_tr_b16 a[168:169], v4 offset:2056
    v_mfma_f32_16x16x32_bf16 v[32:35], a[136:139], a[56:59], v[32:35]
    ds_read_b64_tr_b16 a[170:171], v4 offset:10248
    v_mfma_f32_16x16x32_bf16 v[32:35], a[132:135], a[52:55], v[32:35]
    s_nop 0
    v_mul_f32 v28, s20, v28
    v_mfma_f32_16x16x32_bf16 v[32:35], a[128:131], a[48:51], v[32:35]
    s_nop 0
    s_cbranch_scc1 L_close6
L_bodyoq6:
    s_waitcnt lgkmcnt(8)
    v_exp_f32 v22, v22
    v_mfma_f32_16x16x32_bf16 v[108:111], a[144:147], v[68:71], v[108:111]
    v_exp_f32 v23, v23
    v_mfma_f32_16x16x32_bf16 v[108:111], a[148:151], v[36:39], v[108:111]
    v_cvt_pk_bf16_f32 v44, v20, v21
    v_cvt_pk_bf16_f32 v45, v22, v23
    v_mfma_f32_16x16x32_bf16 v[112:115], a[156:159], v[36:39], v[112:115]
    s_add_u32 m0, s27, 0
    v_exp_f32 v24, v24
    v_mfma_f32_16x16x32_bf16 v[112:115], a[152:155], v[68:71], v[112:115]
    s_waitcnt lgkmcnt(0)
    v_exp_f32 v25, v25
    v_mfma_f32_16x16x32_bf16 v[116:119], a[160:163], v[68:71], v[116:119]
    v_exp_f32 v26, v26
    v_mfma_f32_16x16x32_bf16 v[116:119], a[164:167], v[36:39], v[116:119]
    buffer_load_dwordx4 v5, s[64:67], 0 offen lds
    v_cvt_pk_bf16_f32 v46, v24, v25
    v_mfma_f32_16x16x32_bf16 v[120:123], a[172:175], v[36:39], v[120:123]
    v_exp_f32 v27, v27
    v_mfma_f32_16x16x32_bf16 v[120:123], a[168:171], v[68:71], v[120:123]
    v_cvt_pk_bf16_f32 v47, v26, v27
    v_mul_f32 v29, s20, v29
    v_mfma_f32_16x16x32_bf16 v[20:23], a[112:115], a[64:67], 0
    v_exp_f32 v28, v28
    v_mfma_f32_16x16x32_bf16 v[20:23], a[116:119], a[68:71], v[20:23]
    v_exp_f32 v29, v29
    v_mfma_f32_16x16x32_bf16 v[20:23], a[120:123], a[72:75], v[20:23]
    s_add_u32 m0, s27, 896
    v_mul_f32 v30, s20, v30
    v_mul_f32 v31, s20, v31
    v_mfma_f32_16x16x32_bf16 v[20:23], a[124:127], a[76:79], v[20:23]
    v_exp_f32 v30, v30
    v_mfma_f32_16x16x32_bf16 v[24:27], a[140:143], a[76:79], 0
    v_exp_f32 v31, v31
    v_mfma_f32_16x16x32_bf16 v[24:27], a[136:139], a[72:75], v[24:27]
    buffer_load_dwordx4 v5, s[64:67], 0 offen offset:128 lds
    v_cvt_pk_bf16_f32 v48, v28, v29
    v_mfma_f32_16x16x32_bf16 v[24:27], a[132:135], a[68:71], v[24:27]
    v_cvt_pk_bf16_f32 v49, v30, v31
    v_mul_f32 v32, s20, v32
    v_mfma_f32_16x16x32_bf16 v[24:27], a[128:131], a[64:67], v[24:27]
    v_mul_f32 v33, s20, v33
    v_mul_f32 v34, s20, v34
    v_mfma_f32_16x16x32_bf16 v[140:143], a[144:147], v[72:75], v[140:143]
    v_exp_f32 v32, v32
    v_mfma_f32_16x16x32_bf16 v[140:143], a[148:151], v[40:43], v[140:143]
    v_exp_f32 v33, v33
    v_mfma_f32_16x16x32_bf16 v[144:147], a[156:159], v[40:43], v[144:147]
    s_add_u32 m0, s27, 2048
    v_mul_f32 v35, s20, v35
    v_cvt_pk_bf16_f32 v50, v32, v33
    v_mfma_f32_16x16x32_bf16 v[144:147], a[152:155], v[72:75], v[144:147]
    v_exp_f32 v34, v34
    v_mfma_f32_16x16x32_bf16 v[148:151], a[160:163], v[72:75], v[148:151]
    v_exp_f32 v35, v35
    v_mfma_f32_16x16x32_bf16 v[148:151], a[164:167], v[40:43], v[148:151]
    buffer_load_dwordx4 v5, s[68:71], 0 offen lds
    v_cvt_pk_bf16_f32 v51, v34, v35
    v_mfma_f32_16x16x32_bf16 v[152:155], a[172:175], v[40:43], v[152:155]
    v_mul_f32 v20, s20, v20
    v_mul_f32 v21, s20, v21
    v_mfma_f32_16x16x32_bf16 v[152:155], a[168:171], v[72:75], v[152:155]
    v_exp_f32 v20, v20
    v_mfma_f32_16x16x32_bf16 v[28:31], a[112:115], a[80:83], 0
    ds_read_b128 a[112:115], v1
    v_mul_f32 v22, s20, v22
    v_mfma_f32_16x16x32_bf16 v[28:31], a[116:119], a[84:87], v[28:31]
    ds_read_b128 a[116:119], v2
    v_mul_f32 v23, s20, v23
    v_mfma_f32_16x16x32_bf16 v[28:31], a[120:123], a[88:91], v[28:31]
    s_add_u32 m0, s27, 3072
    v_exp_f32 v21, v21
    v_mfma_f32_16x16x32_bf16 v[28:31], a[124:127], a[92:95], v[28:31]
    ds_read_b128 a[120:123], v1 offset:1024
    v_cvt_pk_bf16_f32 v52, v20, v21
    v_mfma_f32_16x16x32_bf16 v[32:35], a[140:143], a[92:95], 0
    ds_read_b128 a[124:127], v2 offset:1024
    v_mul_f32 v24, s20, v24
    v_mfma_f32_16x16x32_bf16 v[32:35], a[136:139], a[88:91], v[32:35]
    buffer_load_dwordx4 v5, s[88:91], 0 offen lds
    v_mul_f32 v25, s20, v25
    v_mfma_f32_16x16x32_bf16 v[32:35], a[132:135], a[84:87], v[32:35]
    s_add_u32 s27, s27, 16384
    ds_read_b128 a[140:143], v2 offset:9216
    v_mul_f32 v26, s20, v26
    v_mfma_f32_16x16x32_bf16 v[32:35], a[128:131], a[80:83], v[32:35]
    s_and_b32 s27, s27, 0xffff
    ds_read_b128 a[136:139], v1 offset:9216
    v_mul_f32 v27, s20, v27
    v_mfma_f32_16x16x32_bf16 v[172:175], a[144:147], v[76:79], v[172:175]
    s_mov_b64 s[68:69], s[88:89]
    v_exp_f32 v22, v22
    v_mfma_f32_16x16x32_bf16 v[172:175], a[148:151], v[44:47], v[172:175]
    s_mov_b32 s70, s90
    ds_read_b128 a[132:135], v2 offset:8192
    v_mul_f32 v28, s20, v28
    v_mfma_f32_16x16x32_bf16 v[176:179], a[156:159], v[44:47], v[176:179]
    s_add_u32 s88, s88, 8192
    ds_read_b128 a[128:131], v1 offset:8192
    v_mul_f32 v29, s20, v29
    v_mfma_f32_16x16x32_bf16 v[176:179], a[152:155], v[76:79], v[176:179]
    s_addc_u32 s89, s89, 0
    v_exp_f32 v23, v23
    v_mfma_f32_16x16x32_bf16 v[180:183], a[160:163], v[76:79], v[180:183]
    s_mov_b32 s90, s66
    v_cvt_pk_bf16_f32 v53, v22, v23
    v_mul_f32 v30, s20, v30
    v_mfma_f32_16x16x32_bf16 v[180:183], a[164:167], v[44:47], v[180:183]
    s_add_u32 s64, s64, 8192
    v_exp_f32 v24, v24
    v_mfma_f32_16x16x32_bf16 v[184:187], a[172:175], v[44:47], v[184:187]
    s_addc_u32 s65, s65, 0
    v_exp_f32 v25, v25
    v_mfma_f32_16x16x32_bf16 v[184:187], a[168:171], v[76:79], v[184:187]
    s_waitcnt lgkmcnt(4)
    v_exp_f32 v26, v26
    v_mfma_f32_16x16x32_bf16 v[20:23], a[112:115], a[0:3], 0
    s_add_u32 s23, s23, 1
    v_exp_f32 v27, v27
    v_mfma_f32_16x16x32_bf16 v[20:23], a[116:119], a[4:7], v[20:23]
    s_cmp_lt_u32 s23, 64
    v_cvt_pk_bf16_f32 v54, v24, v25
    v_cvt_pk_bf16_f32 v55, v26, v27
    v_mfma_f32_16x16x32_bf16 v[20:23], a[120:123], a[8:11], v[20:23]
    s_cselect_b32 s66, 8192, 0
    v_exp_f32 v28, v28
    v_mfma_f32_16x16x32_bf16 v[20:23], a[124:127], a[12:15], v[20:23]
    s_waitcnt lgkmcnt(0)
    v_exp_f32 v29, v29
    v_mfma_f32_16x16x32_bf16 v[24:27], a[140:143], a[12:15], 0
    v_mul_f32 v31, s20, v31
    v_cvt_pk_bf16_f32 v56, v28, v29
    v_mfma_f32_16x16x32_bf16 v[24:27], a[136:139], a[8:11], v[24:27]
    v_exp_f32 v30, v30
    v_mfma_f32_16x16x32_bf16 v[24:27], a[132:135], a[4:7], v[24:27]
    v_exp_f32 v31, v31
    v_mfma_f32_16x16x32_bf16 v[24:27], a[128:131], a[0:3], v[24:27]
    v_cvt_pk_bf16_f32 v57, v30, v31
    v_mul_f32 v32, s20, v32
    v_mfma_f32_16x16x32_bf16 v[204:207], a[144:147], v[80:83], v[204:207]
    v_mul_f32 v33, s20, v33
    v_mul_f32 v34, s20, v34
    v_mfma_f32_16x16x32_bf16 v[204:207], a[148:151], v[48:51], v[204:207]
    v_exp_f32 v32, v32
    v_mfma_f32_16x16x32_bf16 v[208:211], a[156:159], v[48:51], v[208:211]
    v_exp_f32 v33, v33
    v_mfma_f32_16x16x32_bf16 v[208:211], a[152:155], v[80:83], v[208:211]
    v_mul_f32 v35, s20, v35
    v_cvt_pk_bf16_f32 v58, v32, v33
    v_mfma_f32_16x16x32_bf16 v[212:215], a[160:163], v[80:83], v[212:215]
    v_exp_f32 v34, v34
    v_mfma_f32_16x16x32_bf16 v[212:215], a[164:167], v[48:51], v[212:215]
    v_exp_f32 v35, v35
    v_mfma_f32_16x16x32_bf16 v[216:219], a[172:175], v[48:51], v[216:219]
    v_cvt_pk_bf16_f32 v59, v34, v35
    v_mul_f32 v20, s20, v20
    v_mfma_f32_16x16x32_bf16 v[216:219], a[168:171], v[80:83], v[216:219]
    v_mul_f32 v21, s20, v21
    v_mul_f32 v22, s20, v22
    v_mfma_f32_16x16x32_bf16 v[28:31], a[112:115], a[16:19], 0
    v_exp_f32 v20, v20
    v_mfma_f32_16x16x32_bf16 v[28:31], a[116:119], a[20:23], v[28:31]
    v_exp_f32 v21, v21
    v_mfma_f32_16x16x32_bf16 v[28:31], a[120:123], a[24:27], v[28:31]
    v_mul_f32 v23, s20, v23
    v_cvt_pk_bf16_f32 v68, v20, v21
    v_mfma_f32_16x16x32_bf16 v[28:31], a[124:127], a[28:31], v[28:31]
    v_exp_f32 v22, v22
    v_mfma_f32_16x16x32_bf16 v[32:35], a[140:143], a[28:31], 0
    v_exp_f32 v23, v23
    v_mfma_f32_16x16x32_bf16 v[32:35], a[136:139], a[24:27], v[32:35]
    v_cvt_pk_bf16_f32 v69, v22, v23
    v_mul_f32 v24, s20, v24
    v_mfma_f32_16x16x32_bf16 v[32:35], a[132:135], a[20:23], v[32:35]
    v_mul_f32 v25, s20, v25
    v_mul_f32 v26, s20, v26
    v_mfma_f32_16x16x32_bf16 v[32:35], a[128:131], a[16:19], v[32:35]
    v_exp_f32 v24, v24
    v_mfma_f32_16x16x32_bf16 v[236:239], a[144:147], v[84:87], v[236:239]
    v_exp_f32 v25, v25
    v_mfma_f32_16x16x32_bf16 v[236:239], a[148:151], v[52:55], v[236:239]
    v_mul_f32 v27, s20, v27
    v_cvt_pk_bf16_f32 v70, v24, v25
    v_mfma_f32_16x16x32_bf16 v[240:243], a[156:159], v[52:55], v[240:243]
    v_exp_f32 v26, v26
    v_mfma_f32_16x16x32_bf16 v[240:243], a[152:155], v[84:87], v[240:243]
    v_exp_f32 v27, v27
    v_mfma_f32_16x16x32_bf16 v[244:247], a[160:163], v[84:87], v[244:247]
    v_cvt_pk_bf16_f32 v71, v26, v27
    v_mul_f32 v28, s20, v28
    v_mfma_f32_16x16x32_bf16 v[244:247], a[164:167], v[52:55], v[244:247]
    v_mul_f32 v29, s20, v29
    v_mul_f32 v30, s20, v30
    v_mfma_f32_16x16x32_bf16 v[248:251], a[172:175], v[52:55], v[248:251]
    v_exp_f32 v28, v28
    v_mfma_f32_16x16x32_bf16 v[248:251], a[168:171], v[84:87], v[248:251]
    v_exp_f32 v29, v29
    v_mfma_f32_16x16x32_bf16 v[20:23], a[112:115], a[32:35], 0
    v_mul_f32 v31, s20, v31
    v_cvt_pk_bf16_f32 v72, v28, v29
    v_mfma_f32_16x16x32_bf16 v[20:23], a[116:119], a[36:39], v[20:23]
    v_exp_f32 v30, v30
    v_mfma_f32_16x16x32_bf16 v[20:23], a[120:123], a[40:43], v[20:23]
    v_exp_f32 v31, v31
    v_mfma_f32_16x16x32_bf16 v[20:23], a[124:127], a[44:47], v[20:23]
    v_cvt_pk_bf16_f32 v73, v30, v31
    v_mul_f32 v32, s20, v32
    v_mfma_f32_16x16x32_bf16 v[24:27], a[140:143], a[44:47], 0
    v_mul_f32 v33, s20, v33
    v_mul_f32 v34, s20, v34
    v_mfma_f32_16x16x32_bf16 v[24:27], a[136:139], a[40:43], v[24:27]
    s_waitcnt vmcnt(14) lgkmcnt(0)
    v_exp_f32 v32, v32
    v_mfma_f32_16x16x32_bf16 v[24:27], a[132:135], a[36:39], v[24:27]
    s_barrier
    v_mul_f32 v35, s20, v35
    v_mfma_f32_16x16x32_bf16 v[24:27], a[128:131], a[32:35], v[24:27]
    v_exp_f32 v33, v33
    v_mfma_f32_16x16x32_bf16 a[208:211], a[144:147], v[88:91], a[208:211]
    ds_read_b64_tr_b16 a[144:145], v3 offset:18432
    v_cvt_pk_bf16_f32 v74, v32, v33
    v_mfma_f32_16x16x32_bf16 a[208:211], a[148:151], v[56:59], a[208:211]
    ds_read_b64_tr_b16 a[146:147], v3 offset:26624
    v_mul_f32 v20, s20, v20
    v_mfma_f32_16x16x32_bf16 a[212:215], a[156:159], v[56:59], a[212:215]
    ds_read_b64_tr_b16 a[148:149], v3 offset:19456
    v_mul_f32 v21, s20, v21
    v_mfma_f32_16x16x32_bf16 a[212:215], a[152:155], v[88:91], a[212:215]
    ds_read_b64_tr_b16 a[150:151], v3 offset:27648
    v_mul_f32 v22, s20, v22
    v_mfma_f32_16x16x32_bf16 a[216:219], a[160:163], v[88:91], a[216:219]
    ds_read_b64_tr_b16 a[156:157], v3 offset:19464
    v_mul_f32 v23, s20, v23
    v_mfma_f32_16x16x32_bf16 a[216:219], a[164:167], v[56:59], a[216:219]
    ds_read_b64_tr_b16 a[158:159], v3 offset:27656
    v_mul_f32 v24, s20, v24
    v_mfma_f32_16x16x32_bf16 a[220:223], a[172:175], v[56:59], a[220:223]
    ds_read_b64_tr_b16 a[152:153], v3 offset:18440
    v_mul_f32 v25, s20, v25
    v_mfma_f32_16x16x32_bf16 a[220:223], a[168:171], v[88:91], a[220:223]
    ds_read_b64_tr_b16 a[154:155], v3 offset:26632
    v_mul_f32 v26, s20, v26
    v_mfma_f32_16x16x32_bf16 v[28:31], a[112:115], a[48:51], 0
    ds_read_b64_tr_b16 a[160:161], v4 offset:18432
    v_mul_f32 v27, s20, v27
    v_mfma_f32_16x16x32_bf16 v[28:31], a[116:119], a[52:55], v[28:31]
    ds_read_b64_tr_b16 a[162:163], v4 offset:26624
    ds_read_b64_tr_b16 a[164:165], v4 offset:19456
    v_mfma_f32_16x16x32_bf16 v[28:31], a[120:123], a[56:59], v[28:31]
    v_exp_f32 v34, v34
    v_mfma_f32_16x16x32_bf16 v[28:31], a[124:127], a[60:63], v[28:31]
    ds_read_b64_tr_b16 a[166:167], v4 offset:27648
    ds_read_b64_tr_b16 a[172:173], v4 offset:19464
    v_exp_f32 v35, v35
    s_nop 0
    v_cvt_pk_bf16_f32 v75, v34, v35
    v_mfma_f32_16x16x32_bf16 v[32:35], a[140:143], a[60:63], 0
    v_exp_f32 v20, v20
    v_mfma_f32_16x16x32_bf16 v[32:35], a[136:139], a[56:59], v[32:35]
    ds_read_b64_tr_b16 a[174:175], v4 offset:27656
    v_mul_f32 v28, s20, v28
    v_mfma_f32_16x16x32_bf16 v[32:35], a[132:135], a[52:55], v[32:35]
    ds_read_b64_tr_b16 a[168:169], v4 offset:18440
    v_mul_f32 v29, s20, v29
    v_mfma_f32_16x16x32_bf16 v[32:35], a[128:131], a[48:51], v[32:35]
    s_waitcnt lgkmcnt(7)
    ds_read_b64_tr_b16 a[170:171], v4 offset:26632
    v_mul_f32 v30, s20, v30
    v_mfma_f32_16x16x32_bf16 v[92:95], a[144:147], v[36:39], v[92:95]
    v_xor_b32 v3, 0x8000, v3
    v_xor_b32 v4, 0x8000, v4
    v_mfma_f32_16x16x32_bf16 v[92:95], a[148:151], v[68:71], v[92:95]
    v_exp_f32 v21, v21
    v_mfma_f32_16x16x32_bf16 v[96:99], a[156:159], v[68:71], v[96:99]
    s_add_u32 m0, s27, 0
    v_exp_f32 v22, v22
    v_mfma_f32_16x16x32_bf16 v[96:99], a[152:155], v[36:39], v[96:99]
    s_waitcnt lgkmcnt(0)
    v_exp_f32 v23, v23
    v_mfma_f32_16x16x32_bf16 v[100:103], a[160:163], v[36:39], v[100:103]
    v_cvt_pk_bf16_f32 v76, v20, v21
    v_cvt_pk_bf16_f32 v77, v22, v23
    v_mfma_f32_16x16x32_bf16 v[100:103], a[164:167], v[68:71], v[100:103]
    buffer_load_dwordx4 v5, s[64:67], 0 offen lds
    v_mul_f32 v31, s20, v31
    v_mfma_f32_16x16x32_bf16 v[104:107], a[172:175], v[68:71], v[104:107]
    v_exp_f32 v24, v24
    v_mfma_f32_16x16x32_bf16 v[104:107], a[168:171], v[36:39], v[104:107]
    v_exp_f32 v25, v25
    v_mfma_f32_16x16x32_bf16 v[20:23], a[112:115], a[64:67], 0
    v_exp_f32 v26, v26
    v_mfma_f32_16x16x32_bf16 v[20:23], a[116:119], a[68:71], v[20:23]
    v_exp_f32 v27, v27
    v_mfma_f32_16x16x32_bf16 v[20:23], a[120:123], a[72:75], v[20:23]
    s_add_u32 m0, s27, 896
    v_cvt_pk_bf16_f32 v78, v24, v25
    v_cvt_pk_bf16_f32 v79, v26, v27
    v_mfma_f32_16x16x32_bf16 v[20:23], a[124:127], a[76:79], v[20:23]
    v_exp_f32 v28, v28
    v_mfma_f32_16x16x32_bf16 v[24:27], a[140:143], a[76:79], 0
    v_exp_f32 v29, v29
    v_mfma_f32_16x16x32_bf16 v[24:27], a[136:139], a[72:75], v[24:27]
    buffer_load_dwordx4 v5, s[64:67], 0 offen offset:128 lds
    v_cvt_pk_bf16_f32 v80, v28, v29
    v_mfma_f32_16x16x32_bf16 v[24:27], a[132:135], a[68:71], v[24:27]
    v_exp_f32 v30, v30
    v_mfma_f32_16x16x32_bf16 v[24:27], a[128:131], a[64:67], v[24:27]
    v_exp_f32 v31, v31
    v_mfma_f32_16x16x32_bf16 v[124:127], a[144:147], v[40:43], v[124:127]
    v_cvt_pk_bf16_f32 v81, v30, v31
    v_mul_f32 v32, s20, v32
    v_mfma_f32_16x16x32_bf16 v[124:127], a[148:151], v[72:75], v[124:127]
    v_mul_f32 v33, s20, v33
    v_mul_f32 v34, s20, v34
    v_mfma_f32_16x16x32_bf16 v[128:131], a[156:159], v[72:75], v[128:131]
    s_add_u32 m0, s27, 1920
    v_exp_f32 v32, v32
    v_mfma_f32_16x16x32_bf16 v[128:131], a[152:155], v[40:43], v[128:131]
    v_exp_f32 v33, v33
    v_mfma_f32_16x16x32_bf16 v[132:135], a[160:163], v[40:43], v[132:135]
    v_mul_f32 v35, s20, v35
    v_cvt_pk_bf16_f32 v82, v32, v33
    v_mfma_f32_16x16x32_bf16 v[132:135], a[164:167], v[72:75], v[132:135]
    buffer_load_dwordx4 v5, s[68:71], 0 offen offset:128 lds
    v_mul_f32 v20, s20, v20
    v_mfma_f32_16x16x32_bf16 v[136:139], a[172:175], v[72:75], v[136:139]
    v_exp_f32 v34, v34
    v_mfma_f32_16x16x32_bf16 v[136:139], a[168:171], v[40:43], v[136:139]
    v_exp_f32 v35, v35
    v_smfmac_f32_16x16x64_bf16 a[176:179], v[16:19], v[36:43], v252
    v_cvt_pk_bf16_f32 v83, v34, v35
    v_smfmac_f32_16x16x64_bf16 a[176:179], v[16:19], v[68:75], v252
    v_mul_f32 v21, s20, v21
    v_mfma_f32_16x16x32_bf16 v[28:31], a[112:115], a[80:83], 0
    s_add_u32 m0, s27, 2944
    ds_read_b128 a[112:115], v1 offset:16384
    v_mul_f32 v22, s20, v22
    v_mfma_f32_16x16x32_bf16 v[28:31], a[116:119], a[84:87], v[28:31]
    ds_read_b128 a[116:119], v2 offset:16384
    v_mul_f32 v23, s20, v23
    v_mfma_f32_16x16x32_bf16 v[28:31], a[120:123], a[88:91], v[28:31]
    v_exp_f32 v20, v20
    v_mfma_f32_16x16x32_bf16 v[28:31], a[124:127], a[92:95], v[28:31]
    buffer_load_dwordx4 v5, s[88:91], 0 offen offset:128 lds
    v_mul_f32 v24, s20, v24
    v_mfma_f32_16x16x32_bf16 v[32:35], a[140:143], a[92:95], 0
    s_add_u32 s27, s27, 16384
    ds_read_b128 a[120:123], v1 offset:17408
    v_mul_f32 v25, s20, v25
    v_mfma_f32_16x16x32_bf16 v[32:35], a[136:139], a[88:91], v[32:35]
    s_and_b32 s27, s27, 0xffff
    ds_read_b128 a[124:127], v2 offset:17408
    v_mul_f32 v26, s20, v26
    v_mfma_f32_16x16x32_bf16 v[32:35], a[132:135], a[84:87], v[32:35]
    s_mov_b64 s[68:69], s[88:89]
    ds_read_b128 a[140:143], v2 offset:25600
    v_mul_f32 v27, s20, v27
    v_mfma_f32_16x16x32_bf16 v[32:35], a[128:131], a[80:83], v[32:35]
    s_mov_b32 s70, s90
    ds_read_b128 a[136:139], v1 offset:25600
    v_mul_f32 v28, s20, v28
    v_exp_f32 v21, v21
    v_mfma_f32_16x16x32_bf16 v[156:159], a[144:147], v[44:47], v[156:159]
    s_add_u32 s88, s88, 8192
    ds_read_b128 v[12:15], v7
    v_cvt_pk_bf16_f32 v84, v20, v21
    v_mfma_f32_16x16x32_bf16 v[156:159], a[148:151], v[76:79], v[156:159]
    s_addc_u32 s89, s89, 0
    ds_read_b128 a[132:135], v2 offset:24576
    v_xor_b32 v2, 0x8000, v2
    v_mfma_f32_16x16x32_bf16 v[160:163], a[156:159], v[76:79], v[160:163]
    s_mov_b32 s90, s66
    ds_read_b128 a[128:131], v1 offset:24576
    v_xor_b32 v1, 0x8000, v1
    v_mfma_f32_16x16x32_bf16 v[160:163], a[152:155], v[44:47], v[160:163]
    s_add_u32 s64, s64, 8192
    v_exp_f32 v22, v22
    v_mfma_f32_16x16x32_bf16 v[164:167], a[160:163], v[44:47], v[164:167]
    s_addc_u32 s65, s65, 0
    v_exp_f32 v23, v23
    v_mfma_f32_16x16x32_bf16 v[164:167], a[164:167], v[76:79], v[164:167]
    s_add_u32 s23, s23, 1
    v_cvt_pk_bf16_f32 v85, v22, v23
    v_mul_f32 v29, s20, v29
    v_mfma_f32_16x16x32_bf16 v[168:171], a[172:175], v[76:79], v[168:171]
    s_cmp_lt_u32 s23, 64
    v_exp_f32 v24, v24
    v_mfma_f32_16x16x32_bf16 v[168:171], a[168:171], v[44:47], v[168:171]
    s_waitcnt lgkmcnt(5)
    v_exp_f32 v25, v25
    v_mfma_f32_16x16x32_bf16 v[20:23], a[112:115], a[0:3], 0
    s_cselect_b32 s66, 8192, 0
    v_exp_f32 v26, v26
    v_mfma_f32_16x16x32_bf16 v[20:23], a[116:119], a[4:7], v[20:23]
    s_waitcnt lgkmcnt(2)
    buffer_store_dwordx4 v[12:15], v6, s[76:79], 0 offen nt
    v_exp_f32 v27, v27
    v_cvt_pk_bf16_f32 v86, v24, v25
    v_cvt_pk_bf16_f32 v87, v26, v27
    v_mfma_f32_16x16x32_bf16 v[20:23], a[120:123], a[8:11], v[20:23]
    s_add_u32 s76, s76, s29
    v_exp_f32 v28, v28
    v_mfma_f32_16x16x32_bf16 v[20:23], a[124:127], a[12:15], v[20:23]
    s_addc_u32 s77, s77, 0
    v_exp_f32 v29, v29
    v_mfma_f32_16x16x32_bf16 v[24:27], a[140:143], a[12:15], 0
    v_mul_f32 v30, s20, v30
    v_mul_f32 v31, s20, v31
    v_mfma_f32_16x16x32_bf16 v[24:27], a[136:139], a[8:11], v[24:27]
    s_waitcnt lgkmcnt(0)
    v_exp_f32 v30, v30
    v_mfma_f32_16x16x32_bf16 v[24:27], a[132:135], a[4:7], v[24:27]
    s_mov_b32 m0, s31
    v_exp_f32 v31, v31
    v_mfma_f32_16x16x32_bf16 v[24:27], a[128:131], a[0:3], v[24:27]
    v_cvt_pk_bf16_f32 v88, v28, v29
    v_cvt_pk_bf16_f32 v89, v30, v31
    v_mfma_f32_16x16x32_bf16 v[188:191], a[144:147], v[48:51], v[188:191]
    ds_read_b128 v[12:15], v7 offset:1024
    v_mul_f32 v32, s20, v32
    v_mfma_f32_16x16x32_bf16 v[188:191], a[148:151], v[80:83], v[188:191]
    buffer_load_dwordx4 v6, s[72:75], 0 offen nt lds
    v_mul_f32 v33, s20, v33
    v_mfma_f32_16x16x32_bf16 v[192:195], a[156:159], v[80:83], v[192:195]
    s_add_u32 s72, s72, s29
    v_exp_f32 v32, v32
    v_mfma_f32_16x16x32_bf16 v[192:195], a[152:155], v[48:51], v[192:195]
    s_addc_u32 s73, s73, 0
    v_exp_f32 v33, v33
    v_mfma_f32_16x16x32_bf16 v[196:199], a[160:163], v[48:51], v[196:199]
    s_xor_b32 s29, s29, 0x700
    v_mul_f32 v34, s20, v34
    v_mul_f32 v35, s20, v35
    v_mfma_f32_16x16x32_bf16 v[196:199], a[164:167], v[80:83], v[196:199]
    s_add_u32 s31, s31, 1024
    v_exp_f32 v34, v34
    v_mfma_f32_16x16x32_bf16 v[200:203], a[172:175], v[80:83], v[200:203]
    v_exp_f32 v35, v35
    v_mfma_f32_16x16x32_bf16 v[200:203], a[168:171], v[48:51], v[200:203]
    v_cvt_pk_bf16_f32 v90, v32, v33
    v_cvt_pk_bf16_f32 v91, v34, v35
    v_smfmac_f32_16x16x64_bf16 a[180:183], v[16:19], v[44:51], v252
    v_mul_f32 v20, s20, v20
    v_smfmac_f32_16x16x64_bf16 a[180:183], v[16:19], v[76:83], v252
    s_waitcnt lgkmcnt(0)
    v_mul_f32 v21, s20, v21
    v_mfma_f32_16x16x32_bf16 v[28:31], a[112:115], a[16:19], 0
    buffer_store_dwordx4 v[12:15], v6, s[76:79], 0 offen nt
    v_exp_f32 v20, v20
    v_exp_f32 v21, v21
    v_mfma_f32_16x16x32_bf16 v[28:31], a[116:119], a[20:23], v[28:31]
    s_add_u32 s76, s76, s29
    v_mul_f32 v22, s20, v22
    v_mul_f32 v23, s20, v23
    v_mfma_f32_16x16x32_bf16 v[28:31], a[120:123], a[24:27], v[28:31]
    s_addc_u32 s77, s77, 0
    v_exp_f32 v22, v22
    v_mfma_f32_16x16x32_bf16 v[28:31], a[124:127], a[28:31], v[28:31]
    v_exp_f32 v23, v23
    v_mfma_f32_16x16x32_bf16 v[32:35], a[140:143], a[28:31], 0
    s_mov_b32 m0, s31
    v_cvt_pk_bf16_f32 v36, v20, v21
    v_cvt_pk_bf16_f32 v37, v22, v23
    v_mfma_f32_16x16x32_bf16 v[32:35], a[136:139], a[24:27], v[32:35]
    v_mul_f32 v24, s20, v24
    v_mul_f32 v25, s20, v25
    v_mfma_f32_16x16x32_bf16 v[32:35], a[132:135], a[20:23], v[32:35]
    ds_read_b128 v[12:15], v7 offset:2048
    v_add_u32 v7, 3072, v7
    v_mfma_f32_16x16x32_bf16 v[32:35], a[128:131], a[16:19], v[32:35]
    buffer_load_dwordx4 v6, s[72:75], 0 offen nt lds
    v_mul_f32 v26, s20, v26
    v_mfma_f32_16x16x32_bf16 v[220:223], a[144:147], v[52:55], v[220:223]
    s_add_u32 s72, s72, s29
    v_exp_f32 v24, v24
    v_mfma_f32_16x16x32_bf16 v[220:223], a[148:151], v[84:87], v[220:223]
    s_addc_u32 s73, s73, 0
    v_exp_f32 v25, v25
    v_mfma_f32_16x16x32_bf16 v[224:227], a[156:159], v[84:87], v[224:227]
    s_xor_b32 s29, s29, 0x700
    v_mul_f32 v27, s20, v27
    v_cvt_pk_bf16_f32 v38, v24, v25
    v_mfma_f32_16x16x32_bf16 v[224:227], a[152:155], v[52:55], v[224:227]
    s_add_u32 s31, s31, 1024
    v_exp_f32 v26, v26
    v_mfma_f32_16x16x32_bf16 v[228:231], a[160:163], v[52:55], v[228:231]
    v_exp_f32 v27, v27
    v_mfma_f32_16x16x32_bf16 v[228:231], a[164:167], v[84:87], v[228:231]
    v_cvt_pk_bf16_f32 v39, v26, v27
    v_mul_f32 v28, s20, v28
    v_mfma_f32_16x16x32_bf16 v[232:235], a[172:175], v[84:87], v[232:235]
    v_mul_f32 v29, s20, v29
    v_mul_f32 v30, s20, v30
    v_mfma_f32_16x16x32_bf16 v[232:235], a[168:171], v[52:55], v[232:235]
    s_waitcnt lgkmcnt(0)
    buffer_store_dwordx4 v[12:15], v6, s[76:79], 0 offen nt
    v_exp_f32 v28, v28
    v_exp_f32 v29, v29
    v_mfma_f32_16x16x32_bf16 v[20:23], a[112:115], a[32:35], 0
    s_add_u32 s76, s76, s29
    v_mul_f32 v31, s20, v31
    v_cvt_pk_bf16_f32 v40, v28, v29
    v_mfma_f32_16x16x32_bf16 v[20:23], a[116:119], a[36:39], v[20:23]
    s_addc_u32 s77, s77, 0
    v_exp_f32 v30, v30
    v_mfma_f32_16x16x32_bf16 v[20:23], a[120:123], a[40:43], v[20:23]
    v_exp_f32 v31, v31
    v_mfma_f32_16x16x32_bf16 v[20:23], a[124:127], a[44:47], v[20:23]
    v_cvt_pk_bf16_f32 v41, v30, v31
    v_mul_f32 v32, s20, v32
    v_mfma_f32_16x16x32_bf16 v[24:27], a[140:143], a[44:47], 0
    s_mov_b32 m0, s31
    v_mul_f32 v33, s20, v33
    v_mul_f32 v34, s20, v34
    v_mfma_f32_16x16x32_bf16 v[24:27], a[136:139], a[40:43], v[24:27]
    s_waitcnt vmcnt(19) lgkmcnt(0)
    v_exp_f32 v32, v32
    v_mfma_f32_16x16x32_bf16 v[24:27], a[132:135], a[36:39], v[24:27]
    s_barrier
    v_mul_f32 v35, s20, v35
    v_mfma_f32_16x16x32_bf16 v[24:27], a[128:131], a[32:35], v[24:27]
    buffer_load_dwordx4 v6, s[72:75], 0 offen nt lds
    v_mul_f32 v20, s20, v20
    v_mfma_f32_16x16x32_bf16 a[192:195], a[144:147], v[56:59], a[192:195]
    s_add_u32 s72, s72, s29
    ds_read_b64_tr_b16 a[144:145], v3 offset:2048
    v_mul_f32 v21, s20, v21
    v_mfma_f32_16x16x32_bf16 a[192:195], a[148:151], v[88:91], a[192:195]
    s_addc_u32 s73, s73, 0
    ds_read_b64_tr_b16 a[146:147], v3 offset:10240
    v_mul_f32 v22, s20, v22
    v_mfma_f32_16x16x32_bf16 a[196:199], a[156:159], v[88:91], a[196:199]
    s_xor_b32 s29, s29, 0x700
    ds_read_b64_tr_b16 a[148:149], v3 offset:3072
    v_mul_f32 v23, s20, v23
    v_mfma_f32_16x16x32_bf16 a[196:199], a[152:155], v[56:59], a[196:199]
    s_add_u32 s31, s31, 1024
    ds_read_b64_tr_b16 a[150:151], v3 offset:11264
    v_mul_f32 v24, s20, v24
    v_mfma_f32_16x16x32_bf16 a[200:203], a[160:163], v[56:59], a[200:203]
    ds_read_b64_tr_b16 a[156:157], v3 offset:3080
    v_mul_f32 v25, s20, v25
    v_mfma_f32_16x16x32_bf16 a[200:203], a[164:167], v[88:91], a[200:203]
    ds_read_b64_tr_b16 a[158:159], v3 offset:11272
    v_mul_f32 v26, s20, v26
    v_mfma_f32_16x16x32_bf16 a[204:207], a[172:175], v[88:91], a[204:207]
    ds_read_b64_tr_b16 a[152:153], v3 offset:2056
    v_mul_f32 v27, s20, v27
    v_mfma_f32_16x16x32_bf16 a[204:207], a[168:171], v[56:59], a[204:207]
    ds_read_b64_tr_b16 a[154:155], v3 offset:10248
    ds_read_b64_tr_b16 a[160:161], v4 offset:2048
    v_smfmac_f32_16x16x64_bf16 a[184:187], v[16:19], v[52:59], v252
    v_smfmac_f32_16x16x64_bf16 a[184:187], v[16:19], v[84:91], v252
    ds_read_b64_tr_b16 a[162:163], v4 offset:10240
    v_mfma_f32_16x16x32_bf16 v[28:31], a[112:115], a[48:51], 0
    ds_read_b64_tr_b16 a[164:165], v4 offset:3072
    ds_read_b64_tr_b16 a[166:167], v4 offset:11264
    v_mfma_f32_16x16x32_bf16 v[28:31], a[116:119], a[52:55], v[28:31]
    v_exp_f32 v33, v33
    v_mfma_f32_16x16x32_bf16 v[28:31], a[120:123], a[56:59], v[28:31]
    ds_read_b64_tr_b16 a[172:173], v4 offset:3080
    v_cvt_pk_bf16_f32 v42, v32, v33
    v_mfma_f32_16x16x32_bf16 v[28:31], a[124:127], a[60:63], v[28:31]
    s_sub_u32 s32, s32, 1
    ds_read_b64_tr_b16 a[174:175], v4 offset:11272
    ds_read_b64_tr_b16 a[168:169], v4 offset:2056
    v_exp_f32 v34, v34
    v_exp_f32 v35, v35
    s_nop 0
    v_cvt_pk_bf16_f32 v43, v34, v35
    v_mfma_f32_16x16x32_bf16 v[32:35], a[140:143], a[60:63], 0
    v_exp_f32 v20, v20
    v_mfma_f32_16x16x32_bf16 v[32:35], a[136:139], a[56:59], v[32:35]
    ds_read_b64_tr_b16 a[170:171], v4 offset:10248
    v_mul_f32 v28, s20, v28
    v_mfma_f32_16x16x32_bf16 v[32:35], a[132:135], a[52:55], v[32:35]
    v_exp_f32 v21, v21
    v_mfma_f32_16x16x32_bf16 v[32:35], a[128:131], a[48:51], v[32:35]
    s_cbranch_scc0 L_bodyoq6
L_tail6:
    s_waitcnt lgkmcnt(8)
    v_exp_f32 v22, v22
    v_mfma_f32_16x16x32_bf16 v[108:111], a[144:147], v[68:71], v[108:111]
    v_exp_f32 v23, v23
    v_mfma_f32_16x16x32_bf16 v[108:111], a[148:151], v[36:39], v[108:111]
    v_cvt_pk_bf16_f32 v44, v20, v21
    v_cvt_pk_bf16_f32 v45, v22, v23
    v_mfma_f32_16x16x32_bf16 v[112:115], a[156:159], v[36:39], v[112:115]
    s_add_u32 m0, s27, 0
    v_exp_f32 v24, v24
    v_mfma_f32_16x16x32_bf16 v[112:115], a[152:155], v[68:71], v[112:115]
    s_waitcnt lgkmcnt(0)
    v_exp_f32 v25, v25
    v_mfma_f32_16x16x32_bf16 v[116:119], a[160:163], v[68:71], v[116:119]
    v_exp_f32 v26, v26
    v_mfma_f32_16x16x32_bf16 v[116:119], a[164:167], v[36:39], v[116:119]
    buffer_load_dwordx4 v5, s[64:67], 0 offen lds
    v_cvt_pk_bf16_f32 v46, v24, v25
    v_mfma_f32_16x16x32_bf16 v[120:123], a[172:175], v[36:39], v[120:123]
    v_exp_f32 v27, v27
    v_mfma_f32_16x16x32_bf16 v[120:123], a[168:171], v[68:71], v[120:123]
    v_cvt_pk_bf16_f32 v47, v26, v27
    v_mul_f32 v29, s20, v29
    v_mfma_f32_16x16x32_bf16 v[20:23], a[112:115], a[64:67], 0
    v_exp_f32 v28, v28
    v_mfma_f32_16x16x32_bf16 v[20:23], a[116:119], a[68:71], v[20:23]
    v_exp_f32 v29, v29
    v_mfma_f32_16x16x32_bf16 v[20:23], a[120:123], a[72:75], v[20:23]
    s_add_u32 m0, s27, 896
    v_mul_f32 v30, s20, v30
    v_mul_f32 v31, s20, v31
    v_mfma_f32_16x16x32_bf16 v[20:23], a[124:127], a[76:79], v[20:23]
    v_exp_f32 v30, v30
    v_mfma_f32_16x16x32_bf16 v[24:27], a[140:143], a[76:79], 0
    v_exp_f32 v31, v31
    v_mfma_f32_16x16x32_bf16 v[24:27], a[136:139], a[72:75], v[24:27]
    buffer_load_dwordx4 v5, s[64:67], 0 offen offset:128 lds
    v_cvt_pk_bf16_f32 v48, v28, v29
    v_mfma_f32_16x16x32_bf16 v[24:27], a[132:135], a[68:71], v[24:27]
    v_cvt_pk_bf16_f32 v49, v30, v31
    v_mul_f32 v32, s20, v32
    v_mfma_f32_16x16x32_bf16 v[24:27], a[128:131], a[64:67], v[24:27]
    v_mul_f32 v33, s20, v33
    v_mul_f32 v34, s20, v34
    v_mfma_f32_16x16x32_bf16 v[140:143], a[144:147], v[72:75], v[140:143]
    v_exp_f32 v32, v32
    v_mfma_f32_16x16x32_bf16 v[140:143], a[148:151], v[40:43], v[140:143]
    v_exp_f32 v33, v33
    v_mfma_f32_16x16x32_bf16 v[144:147], a[156:159], v[40:43], v[144:147]
    s_add_u32 m0, s27, 2048
    v_mul_f32 v35, s20, v35
    v_cvt_pk_bf16_f32 v50, v32, v33
    v_mfma_f32_16x16x32_bf16 v[144:147], a[152:155], v[72:75], v[144:147]
    v_exp_f32 v34, v34
    v_mfma_f32_16x16x32_bf16 v[148:151], a[160:163], v[72:75], v[148:151]
    v_exp_f32 v35, v35
    v_mfma_f32_16x16x32_bf16 v[148:151], a[164:167], v[40:43], v[148:151]
    buffer_load_dwordx4 v5, s[68:71], 0 offen lds
    v_cvt_pk_bf16_f32 v51, v34, v35
    v_mfma_f32_16x16x32_bf16 v[152:155], a[172:175], v[40:43], v[152:155]
    v_mul_f32 v20, s20, v20
    v_mul_f32 v21, s20, v21
    v_mfma_f32_16x16x32_bf16 v[152:155], a[168:171], v[72:75], v[152:155]
    v_exp_f32 v20, v20
    v_mfma_f32_16x16x32_bf16 v[28:31], a[112:115], a[80:83], 0
    ds_read_b128 a[112:115], v1
    v_mul_f32 v22, s20, v22
    v_mfma_f32_16x16x32_bf16 v[28:31], a[116:119], a[84:87], v[28:31]
    ds_read_b128 a[116:119], v2
    v_mul_f32 v23, s20, v23
    v_mfma_f32_16x16x32_bf16 v[28:31], a[120:123], a[88:91], v[28:31]
    s_add_u32 m0, s27, 3072
    v_exp_f32 v21, v21
    v_mfma_f32_16x16x32_bf16 v[28:31], a[124:127], a[92:95], v[28:31]
    ds_read_b128 a[120:123], v1 offset:1024
    v_cvt_pk_bf16_f32 v52, v20, v21
    v_mfma_f32_16x16x32_bf16 v[32:35], a[140:143], a[92:95], 0
    ds_read_b128 a[124:127], v2 offset:1024
    v_mul_f32 v24, s20, v24
    v_mfma_f32_16x16x32_bf16 v[32:35], a[136:139], a[88:91], v[32:35]
    buffer_load_dwordx4 v5, s[88:91], 0 offen lds
    v_mul_f32 v25, s20, v25
    v_mfma_f32_16x16x32_bf16 v[32:35], a[132:135], a[84:87], v[32:35]
    s_add_u32 s27, s27, 16384
    ds_read_b128 a[140:143], v2 offset:9216
    v_mul_f32 v26, s20, v26
    v_mfma_f32_16x16x32_bf16 v[32:35], a[128:131], a[80:83], v[32:35]
    s_and_b32 s27, s27, 0xffff
    ds_read_b128 a[136:139], v1 offset:9216
    v_mul_f32 v27, s20, v27
    v_mfma_f32_16x16x32_bf16 v[172:175], a[144:147], v[76:79], v[172:175]
    s_mov_b64 s[68:69], s[88:89]
    v_exp_f32 v22, v22
    v_mfma_f32_16x16x32_bf16 v[172:175], a[148:151], v[44:47], v[172:175]
    s_mov_b32 s70, s90
    ds_read_b128 a[132:135], v2 offset:8192
    v_mul_f32 v28, s20, v28
    v_mfma_f32_16x16x32_bf16 v[176:179], a[156:159], v[44:47], v[176:179]
    s_add_u32 s88, s88, 8192
    ds_read_b128 a[128:131], v1 offset:8192
    v_mul_f32 v29, s20, v29
    v_mfma_f32_16x16x32_bf16 v[176:179], a[152:155], v[76:79], v[176:179]
    s_addc_u32 s89, s89, 0
    v_exp_f32 v23, v23
    v_mfma_f32_16x16x32_bf16 v[180:183], a[160:163], v[76:79], v[180:183]
    s_mov_b32 s90, s66
    v_cvt_pk_bf16_f32 v53, v22, v23
    v_mul_f32 v30, s20, v30
    v_mfma_f32_16x16x32_bf16 v[180:183], a[164:167], v[44:47], v[180:183]
    s_add_u32 s64, s64, 8192
    v_exp_f32 v24, v24
    v_mfma_f32_16x16x32_bf16 v[184:187], a[172:175], v[44:47], v[184:187]
    s_addc_u32 s65, s65, 0
    v_exp_f32 v25, v25
    v_mfma_f32_16x16x32_bf16 v[184:187], a[168:171], v[76:79], v[184:187]
    s_waitcnt lgkmcnt(4)
    v_exp_f32 v26, v26
    v_mfma_f32_16x16x32_bf16 v[20:23], a[112:115], a[0:3], 0
    s_add_u32 s23, s23, 1
    v_exp_f32 v27, v27
    v_mfma_f32_16x16x32_bf16 v[20:23], a[116:119], a[4:7], v[20:23]
    s_cmp_lt_u32 s23, 64
    v_cvt_pk_bf16_f32 v54, v24, v25
    v_cvt_pk_bf16_f32 v55, v26, v27
    v_mfma_f32_16x16x32_bf16 v[20:23], a[120:123], a[8:11], v[20:23]
    s_cselect_b32 s66, 8192, 0
    v_exp_f32 v28, v28
    v_mfma_f32_16x16x32_bf16 v[20:23], a[124:127], a[12:15], v[20:23]
    s_waitcnt lgkmcnt(0)
    v_exp_f32 v29, v29
    v_mfma_f32_16x16x32_bf16 v[24:27], a[140:143], a[12:15], 0
    v_mul_f32 v31, s20, v31
    v_cvt_pk_bf16_f32 v56, v28, v29
    v_mfma_f32_16x16x32_bf16 v[24:27], a[136:139], a[8:11], v[24:27]
    v_exp_f32 v30, v30
    v_mfma_f32_16x16x32_bf16 v[24:27], a[132:135], a[4:7], v[24:27]
    v_exp_f32 v31, v31
    v_mfma_f32_16x16x32_bf16 v[24:27], a[128:131], a[0:3], v[24:27]
    v_cvt_pk_bf16_f32 v57, v30, v31
    v_mul_f32 v32, s20, v32
    v_mfma_f32_16x16x32_bf16 v[204:207], a[144:147], v[80:83], v[204:207]
    v_mul_f32 v33, s20, v33
    v_mul_f32 v34, s20, v34
    v_mfma_f32_16x16x32_bf16 v[204:207], a[148:151], v[48:51], v[204:207]
    v_exp_f32 v32, v32
    v_mfma_f32_16x16x32_bf16 v[208:211], a[156:159], v[48:51], v[208:211]
    v_exp_f32 v33, v33
    v_mfma_f32_16x16x32_bf16 v[208:211], a[152:155], v[80:83], v[208:211]
    v_mul_f32 v35, s20, v35
    v_cvt_pk_bf16_f32 v58, v32, v33
    v_mfma_f32_16x16x32_bf16 v[212:215], a[160:163], v[80:83], v[212:215]
    v_exp_f32 v34, v34
    v_mfma_f32_16x16x32_bf16 v[212:215], a[164:167], v[48:51], v[212:215]
    v_exp_f32 v35, v35
    v_mfma_f32_16x16x32_bf16 v[216:219], a[172:175], v[48:51], v[216:219]
    v_cvt_pk_bf16_f32 v59, v34, v35
    v_mul_f32 v20, s20, v20
    v_mfma_f32_16x16x32_bf16 v[216:219], a[168:171], v[80:83], v[216:219]
    v_mul_f32 v21, s20, v21
    v_mul_f32 v22, s20, v22
    v_mfma_f32_16x16x32_bf16 v[28:31], a[112:115], a[16:19], 0
    v_exp_f32 v20, v20
    v_mfma_f32_16x16x32_bf16 v[28:31], a[116:119], a[20:23], v[28:31]
    v_exp_f32 v21, v21
    v_mfma_f32_16x16x32_bf16 v[28:31], a[120:123], a[24:27], v[28:31]
    v_mul_f32 v23, s20, v23
    v_cvt_pk_bf16_f32 v68, v20, v21
    v_mfma_f32_16x16x32_bf16 v[28:31], a[124:127], a[28:31], v[28:31]
    v_exp_f32 v22, v22
    v_mfma_f32_16x16x32_bf16 v[32:35], a[140:143], a[28:31], 0
    v_exp_f32 v23, v23
    v_mfma_f32_16x16x32_bf16 v[32:35], a[136:139], a[24:27], v[32:35]
    v_cvt_pk_bf16_f32 v69, v22, v23
    v_mul_f32 v24, s20, v24
    v_mfma_f32_16x16x32_bf16 v[32:35], a[132:135], a[20:23], v[32:35]
    v_mul_f32 v25, s20, v25
    v_mul_f32 v26, s20, v26
    v_mfma_f32_16x16x32_bf16 v[32:35], a[128:131], a[16:19], v[32:35]
    v_exp_f32 v24, v24
    v_mfma_f32_16x16x32_bf16 v[236:239], a[144:147], v[84:87], v[236:239]
    v_exp_f32 v25, v25
    v_mfma_f32_16x16x32_bf16 v[236:239], a[148:151], v[52:55], v[236:239]
    v_mul_f32 v27, s20, v27
    v_cvt_pk_bf16_f32 v70, v24, v25
    v_mfma_f32_16x16x32_bf16 v[240:243], a[156:159], v[52:55], v[240:243]
    v_exp_f32 v26, v26
    v_mfma_f32_16x16x32_bf16 v[240:243], a[152:155], v[84:87], v[240:243]
    v_exp_f32 v27, v27
    v_mfma_f32_16x16x32_bf16 v[244:247], a[160:163], v[84:87], v[244:247]
    v_cvt_pk_bf16_f32 v71, v26, v27
    v_mul_f32 v28, s20, v28
    v_mfma_f32_16x16x32_bf16 v[244:247], a[164:167], v[52:55], v[244:247]
    v_mul_f32 v29, s20, v29
    v_mul_f32 v30, s20, v30
    v_mfma_f32_16x16x32_bf16 v[248:251], a[172:175], v[52:55], v[248:251]
    v_exp_f32 v28, v28
    v_mfma_f32_16x16x32_bf16 v[248:251], a[168:171], v[84:87], v[248:251]
    v_exp_f32 v29, v29
    v_mfma_f32_16x16x32_bf16 v[20:23], a[112:115], a[32:35], 0
    v_mul_f32 v31, s20, v31
    v_cvt_pk_bf16_f32 v72, v28, v29
    v_mfma_f32_16x16x32_bf16 v[20:23], a[116:119], a[36:39], v[20:23]
    v_exp_f32 v30, v30
    v_mfma_f32_16x16x32_bf16 v[20:23], a[120:123], a[40:43], v[20:23]
    v_exp_f32 v31, v31
    v_mfma_f32_16x16x32_bf16 v[20:23], a[124:127], a[44:47], v[20:23]
    v_cvt_pk_bf16_f32 v73, v30, v31
    v_mul_f32 v32, s20, v32
    v_mfma_f32_16x16x32_bf16 v[24:27], a[140:143], a[44:47], 0
    v_mul_f32 v33, s20, v33
    v_mul_f32 v34, s20, v34
    v_mfma_f32_16x16x32_bf16 v[24:27], a[136:139], a[40:43], v[24:27]
    s_waitcnt vmcnt(12) lgkmcnt(0)
    v_exp_f32 v32, v32
    v_mfma_f32_16x16x32_bf16 v[24:27], a[132:135], a[36:39], v[24:27]
    s_barrier
    v_mul_f32 v35, s20, v35
    v_mfma_f32_16x16x32_bf16 v[24:27], a[128:131], a[32:35], v[24:27]
    v_exp_f32 v33, v33
    v_mfma_f32_16x16x32_bf16 a[208:211], a[144:147], v[88:91], a[208:211]
    ds_read_b64_tr_b16 a[144:145], v3 offset:18432
    v_cvt_pk_bf16_f32 v74, v32, v33
    v_mfma_f32_16x16x32_bf16 a[208:211], a[148:151], v[56:59], a[208:211]
    ds_read_b64_tr_b16 a[146:147], v3 offset:26624
    v_mul_f32 v20, s20, v20
    v_mfma_f32_16x16x32_bf16 a[212:215], a[156:159], v[56:59], a[212:215]
    ds_read_b64_tr_b16 a[148:149], v3 offset:19456
    v_mul_f32 v21, s20, v21
    v_mfma_f32_16x16x32_bf16 a[212:215], a[152:155], v[88:91], a[212:215]
    ds_read_b64_tr_b16 a[150:151], v3 offset:27648
    v_mul_f32 v22, s20, v22
    v_mfma_f32_16x16x32_bf16 a[216:219], a[160:163], v[88:91], a[216:219]
    ds_read_b64_tr_b16 a[156:157], v3 offset:19464
    v_mul_f32 v23, s20, v23
    v_mfma_f32_16x16x32_bf16 a[216:219], a[164:167], v[56:59], a[216:219]
    ds_read_b64_tr_b16 a[158:159], v3 offset:27656
    v_mul_f32 v24, s20, v24
    v_mfma_f32_16x16x32_bf16 a[220:223], a[172:175], v[56:59], a[220:223]
    ds_read_b64_tr_b16 a[152:153], v3 offset:18440
    v_mul_f32 v25, s20, v25
    v_mfma_f32_16x16x32_bf16 a[220:223], a[168:171], v[88:91], a[220:223]
    ds_read_b64_tr_b16 a[154:155], v3 offset:26632
    v_mul_f32 v26, s20, v26
    v_mfma_f32_16x16x32_bf16 v[28:31], a[112:115], a[48:51], 0
    ds_read_b64_tr_b16 a[160:161], v4 offset:18432
    v_mul_f32 v27, s20, v27
    v_mfma_f32_16x16x32_bf16 v[28:31], a[116:119], a[52:55], v[28:31]
    ds_read_b64_tr_b16 a[162:163], v4 offset:26624
    ds_read_b64_tr_b16 a[164:165], v4 offset:19456
    v_mfma_f32_16x16x32_bf16 v[28:31], a[120:123], a[56:59], v[28:31]
    v_exp_f32 v34, v34
    v_mfma_f32_16x16x32_bf16 v[28:31], a[124:127], a[60:63], v[28:31]
    ds_read_b64_tr_b16 a[166:167], v4 offset:27648
    ds_read_b64_tr_b16 a[172:173], v4 offset:19464
    v_exp_f32 v35, v35
    s_nop 0
    v_cvt_pk_bf16_f32 v75, v34, v35
    v_mfma_f32_16x16x32_bf16 v[32:35], a[140:143], a[60:63], 0
    v_exp_f32 v20, v20
    v_mfma_f32_16x16x32_bf16 v[32:35], a[136:139], a[56:59], v[32:35]
    ds_read_b64_tr_b16 a[174:175], v4 offset:27656
    v_mul_f32 v28, s20, v28
    v_mfma_f32_16x16x32_bf16 v[32:35], a[132:135], a[52:55], v[32:35]
    ds_read_b64_tr_b16 a[168:169], v4 offset:18440
    v_mul_f32 v29, s20, v29
    v_mfma_f32_16x16x32_bf16 v[32:35], a[128:131], a[48:51], v[32:35]
    s_waitcnt lgkmcnt(7)
    ds_read_b64_tr_b16 a[170:171], v4 offset:26632
    v_mul_f32 v30, s20, v30
    v_mfma_f32_16x16x32_bf16 v[92:95], a[144:147], v[36:39], v[92:95]
    s_waitcnt vmcnt(17)
    v_xor_b32 v3, 0x8000, v3
    v_xor_b32 v4, 0x8000, v4
    v_mfma_f32_16x16x32_bf16 v[92:95], a[148:151], v[68:71], v[92:95]
    v_exp_f32 v21, v21
    v_mfma_f32_16x16x32_bf16 v[96:99], a[156:159], v[68:71], v[96:99]
    s_add_u32 m0, s27, 0
    v_exp_f32 v22, v22
    v_mfma_f32_16x16x32_bf16 v[96:99], a[152:155], v[36:39], v[96:99]
    s_waitcnt lgkmcnt(0)
    v_exp_f32 v23, v23
    v_mfma_f32_16x16x32_bf16 v[100:103], a[160:163], v[36:39], v[100:103]
    v_cvt_pk_bf16_f32 v76, v20, v21
    v_cvt_pk_bf16_f32 v77, v22, v23
    v_mfma_f32_16x16x32_bf16 v[100:103], a[164:167], v[68:71], v[100:103]
    buffer_load_dwordx4 v5, s[64:67], 0 offen lds
    v_mul_f32 v31, s20, v31
    v_mfma_f32_16x16x32_bf16 v[104:107], a[172:175], v[68:71], v[104:107]
    v_exp_f32 v24, v24
    v_mfma_f32_16x16x32_bf16 v[104:107], a[168:171], v[36:39], v[104:107]
    v_exp_f32 v25, v25
    v_mfma_f32_16x16x32_bf16 v[20:23], a[112:115], a[64:67], 0
    v_exp_f32 v26, v26
    v_mfma_f32_16x16x32_bf16 v[20:23], a[116:119], a[68:71], v[20:23]
    v_exp_f32 v27, v27
    v_mfma_f32_16x16x32_bf16 v[20:23], a[120:123], a[72:75], v[20:23]
    s_add_u32 m0, s27, 896
    v_cvt_pk_bf16_f32 v78, v24, v25
    v_cvt_pk_bf16_f32 v79, v26, v27
    v_mfma_f32_16x16x32_bf16 v[20:23], a[124:127], a[76:79], v[20:23]
    v_exp_f32 v28, v28
    v_mfma_f32_16x16x32_bf16 v[24:27], a[140:143], a[76:79], 0
    v_exp_f32 v29, v29
    v_mfma_f32_16x16x32_bf16 v[24:27], a[136:139], a[72:75], v[24:27]
    buffer_load_dwordx4 v5, s[64:67], 0 offen offset:128 lds
    v_cvt_pk_bf16_f32 v80, v28, v29
    v_mfma_f32_16x16x32_bf16 v[24:27], a[132:135], a[68:71], v[24:27]
    v_exp_f32 v30, v30
    v_mfma_f32_16x16x32_bf16 v[24:27], a[128:131], a[64:67], v[24:27]
    v_exp_f32 v31, v31
    v_mfma_f32_16x16x32_bf16 v[124:127], a[144:147], v[40:43], v[124:127]
    v_cvt_pk_bf16_f32 v81, v30, v31
    v_mul_f32 v32, s20, v32
    v_mfma_f32_16x16x32_bf16 v[124:127], a[148:151], v[72:75], v[124:127]
    v_mul_f32 v33, s20, v33
    v_mul_f32 v34, s20, v34
    v_mfma_f32_16x16x32_bf16 v[128:131], a[156:159], v[72:75], v[128:131]
    s_add_u32 m0, s27, 1920
    v_exp_f32 v32, v32
    v_mfma_f32_16x16x32_bf16 v[128:131], a[152:155], v[40:43], v[128:131]
    v_exp_f32 v33, v33
    v_mfma_f32_16x16x32_bf16 v[132:135], a[160:163], v[40:43], v[132:135]
    v_mul_f32 v35, s20, v35
    v_cvt_pk_bf16_f32 v82, v32, v33
    v_mfma_f32_16x16x32_bf16 v[132:135], a[164:167], v[72:75], v[132:135]
    buffer_load_dwordx4 v5, s[68:71], 0 offen offset:128 lds
    v_mul_f32 v20, s20, v20
    v_mfma_f32_16x16x32_bf16 v[136:139], a[172:175], v[72:75], v[136:139]
    v_exp_f32 v34, v34
    v_mfma_f32_16x16x32_bf16 v[136:139], a[168:171], v[40:43], v[136:139]
    v_exp_f32 v35, v35
    v_smfmac_f32_16x16x64_bf16 a[176:179], v[16:19], v[36:43], v252
    v_cvt_pk_bf16_f32 v83, v34, v35
    v_smfmac_f32_16x16x64_bf16 a[176:179], v[16:19], v[68:75], v252
    v_mul_f32 v21, s20, v21
    v_mfma_f32_16x16x32_bf16 v[28:31], a[112:115], a[80:83], 0
    s_add_u32 m0, s27, 2944
    ds_read_b128 a[112:115], v1 offset:16384
    v_mul_f32 v22, s20, v22
    v_mfma_f32_16x16x32_bf16 v[28:31], a[116:119], a[84:87], v[28:31]
    ds_read_b128 a[116:119], v2 offset:16384
    v_mul_f32 v23, s20, v23
    v_mfma_f32_16x16x32_bf16 v[28:31], a[120:123], a[88:91], v[28:31]
    v_exp_f32 v20, v20
    v_mfma_f32_16x16x32_bf16 v[28:31], a[124:127], a[92:95], v[28:31]
    buffer_load_dwordx4 v5, s[88:91], 0 offen offset:128 lds
    v_mul_f32 v24, s20, v24
    v_mfma_f32_16x16x32_bf16 v[32:35], a[140:143], a[92:95], 0
    s_add_u32 s27, s27, 16384
    ds_read_b128 a[120:123], v1 offset:17408
    v_mul_f32 v25, s20, v25
    v_mfma_f32_16x16x32_bf16 v[32:35], a[136:139], a[88:91], v[32:35]
    s_and_b32 s27, s27, 0xffff
    ds_read_b128 a[124:127], v2 offset:17408
    v_mul_f32 v26, s20, v26
    v_mfma_f32_16x16x32_bf16 v[32:35], a[132:135], a[84:87], v[32:35]
    s_mov_b64 s[68:69], s[88:89]
    ds_read_b128 a[140:143], v2 offset:25600
    v_mul_f32 v27, s20, v27
    v_mfma_f32_16x16x32_bf16 v[32:35], a[128:131], a[80:83], v[32:35]
    s_mov_b32 s70, s90
    ds_read_b128 a[136:139], v1 offset:25600
    v_mul_f32 v28, s20, v28
    v_exp_f32 v21, v21
    v_mfma_f32_16x16x32_bf16 v[156:159], a[144:147], v[44:47], v[156:159]
    s_add_u32 s88, s88, 8192
    v_exp_f32 v22, v22
    v_exp_f32 v23, v23
    v_cvt_pk_bf16_f32 v84, v20, v21
    v_cvt_pk_bf16_f32 v85, v22, v23
    v_exp_f32 v24, v24
    v_exp_f32 v25, v25
    v_exp_f32 v26, v26
    v_exp_f32 v27, v27
    v_cvt_pk_bf16_f32 v86, v24, v25
    v_cvt_pk_bf16_f32 v87, v26, v27
    v_mul_f32 v29, s20, v29
    v_exp_f32 v28, v28
    v_exp_f32 v29, v29
    v_mul_f32 v30, s20, v30
    v_mul_f32 v31, s20, v31
    v_mfma_f32_16x16x32_bf16 v[156:159], a[148:151], v[76:79], v[156:159]
    s_addc_u32 s89, s89, 0
    ds_read_b128 a[132:135], v2 offset:24576
    v_xor_b32 v2, 0x8000, v2
    v_mfma_f32_16x16x32_bf16 v[160:163], a[156:159], v[76:79], v[160:163]
    s_mov_b32 s90, s66
    ds_read_b128 a[128:131], v1 offset:24576
    v_xor_b32 v1, 0x8000, v1
    v_mfma_f32_16x16x32_bf16 v[160:163], a[152:155], v[44:47], v[160:163]
    s_add_u32 s64, s64, 8192
    v_exp_f32 v30, v30
    v_mfma_f32_16x16x32_bf16 v[164:167], a[160:163], v[44:47], v[164:167]
    s_addc_u32 s65, s65, 0
    v_exp_f32 v31, v31
    v_mfma_f32_16x16x32_bf16 v[164:167], a[164:167], v[76:79], v[164:167]
    s_add_u32 s23, s23, 1
    v_cvt_pk_bf16_f32 v88, v28, v29
    v_cvt_pk_bf16_f32 v89, v30, v31
    v_mfma_f32_16x16x32_bf16 v[168:171], a[172:175], v[76:79], v[168:171]
    s_cmp_lt_u32 s23, 64
    v_mul_f32 v32, s20, v32
    v_mul_f32 v33, s20, v33
    v_mfma_f32_16x16x32_bf16 v[168:171], a[168:171], v[44:47], v[168:171]
    s_cselect_b32 s66, 8192, 0
    v_exp_f32 v32, v32
    v_mfma_f32_16x16x32_bf16 v[188:191], a[144:147], v[48:51], v[188:191]
    v_exp_f32 v33, v33
    v_mfma_f32_16x16x32_bf16 v[188:191], a[148:151], v[80:83], v[188:191]
    v_mul_f32 v34, s20, v34
    v_mul_f32 v35, s20, v35
    v_mfma_f32_16x16x32_bf16 v[192:195], a[156:159], v[80:83], v[192:195]
    v_exp_f32 v34, v34
    v_mfma_f32_16x16x32_bf16 v[192:195], a[152:155], v[48:51], v[192:195]
    s_waitcnt vmcnt(12) lgkmcnt(0)
    v_exp_f32 v35, v35
    v_mfma_f32_16x16x32_bf16 v[196:199], a[160:163], v[48:51], v[196:199]
    s_barrier
    v_cvt_pk_bf16_f32 v90, v32, v33
    v_mfma_f32_16x16x32_bf16 v[196:199], a[164:167], v[80:83], v[196:199]
    s_mul_i32 s74, s74, s36
    v_cvt_pk_bf16_f32 v91, v34, v35
    v_min_u32 v254, L_final-L_end_code, v253
    v_mfma_f32_16x16x32_bf16 v[200:203], a[172:175], v[80:83], v[200:203]
    s_add_u32 m0, s43, 49152
    ds_read_b128 a[0:3], v8
    v_mov_b32 v255, 0
    v_mfma_f32_16x16x32_bf16 v[200:203], a[168:171], v[48:51], v[200:203]
    buffer_load_dwordx4 v6, s[72:75], 0 offen nt lds
    v_lshl_add_u64 v[254:255], v[254:255], 0, s[54:55]
    v_smfmac_f32_16x16x64_bf16 a[180:183], v[16:19], v[44:51], v252
    v_add_u32 v7, 0xffffa000, v7
    v_smfmac_f32_16x16x64_bf16 a[180:183], v[16:19], v[76:83], v252
    v_accvgpr_read_b32 v38, a176
    v_mfma_f32_16x16x32_bf16 v[220:223], a[144:147], v[52:55], v[220:223]
    buffer_load_dwordx4 v6, s[72:75], 0 offen offset:2048 nt lds
    v_accvgpr_read_b32 v36, a177
    v_mfma_f32_16x16x32_bf16 v[220:223], a[148:151], v[84:87], v[220:223]
    s_add_u32 m0, s43, 50048
    ds_read_b128 a[4:7], v9
    v_add_f32 v38, v38, v36
    v_mfma_f32_16x16x32_bf16 v[224:227], a[156:159], v[84:87], v[224:227]
    s_mov_b32 s40, 0x100000
    v_rcp_f32 v36, v38
    v_mfma_f32_16x16x32_bf16 v[224:227], a[152:155], v[52:55], v[224:227]
    ds_read_b128 a[8:11], v8 offset:1024
    v_maximum3_f32 v12, v36, v36, v38
    v_mfma_f32_16x16x32_bf16 v[228:231], a[160:163], v[52:55], v[228:231]
    buffer_load_dwordx4 v6, s[72:75], 0 offen offset:128 nt lds
    v_accvgpr_write_b32 a176, 0
    v_mfma_f32_16x16x32_bf16 v[228:231], a[164:167], v[84:87], v[228:231]
    ds_read_b128 a[12:15], v9 offset:1024
    v_accvgpr_write_b32 a177, 0
    v_mfma_f32_16x16x32_bf16 v[232:235], a[172:175], v[84:87], v[232:235]
    ds_read_b128 a[16:19], v8 offset:4096
    v_accvgpr_read_b32 v42, a178
    v_mfma_f32_16x16x32_bf16 v[232:235], a[168:171], v[52:55], v[232:235]
    ds_read_b128 a[20:23], v9 offset:4096
    v_accvgpr_read_b32 v40, a179
    v_mfma_f32_16x16x32_bf16 a[192:195], a[144:147], v[56:59], a[192:195]
    ds_read_b64_tr_b16 a[144:145], v3 offset:2048
    v_add_f32 v42, v42, v40
    v_mfma_f32_16x16x32_bf16 a[192:195], a[148:151], v[88:91], a[192:195]
    buffer_load_dwordx4 v6, s[72:75], 0 offen offset:2176 nt lds
    v_accvgpr_write_b32 a178, 0
    v_mfma_f32_16x16x32_bf16 a[196:199], a[156:159], v[88:91], a[196:199]
    s_lshl_b32 s49, 1, s22
    ds_read_b64_tr_b16 a[146:147], v3 offset:10240
    v_accvgpr_write_b32 a179, 0
    v_mfma_f32_16x16x32_bf16 a[196:199], a[152:155], v[56:59], a[196:199]
    s_add_u32 s22, s22, 1
    ds_read_b64_tr_b16 a[152:153], v3 offset:2056
    v_accvgpr_read_b32 v46, a180
    v_mfma_f32_16x16x32_bf16 a[200:203], a[160:163], v[56:59], a[200:203]
    s_mov_b32 s30, s33
    ds_read_b64_tr_b16 a[154:155], v3 offset:10248
    v_accvgpr_read_b32 v44, a181
    v_mfma_f32_16x16x32_bf16 a[200:203], a[164:167], v[88:91], a[200:203]
    s_mov_b32 s33, s34
    ds_read_b64_tr_b16 a[160:161], v4 offset:2048
    v_add_f32 v46, v46, v44
    v_mfma_f32_16x16x32_bf16 a[204:207], a[172:175], v[88:91], a[204:207]
    s_mov_b32 s35, s36
    global_load_dword v0, v[254:255], off
    v_accvgpr_write_b32 a180, 0
    v_mfma_f32_16x16x32_bf16 a[204:207], a[168:171], v[56:59], a[204:207]
    s_add_u32 s41, s22, 1
    ds_read_b64_tr_b16 a[162:163], v4 offset:10240
    v_accvgpr_write_b32 a181, 0
    v_smfmac_f32_16x16x64_bf16 a[184:187], v[16:19], v[52:59], v252
    s_xor_b32 s42, s41, s38
    ds_read_b64_tr_b16 a[168:169], v4 offset:2056
    v_smfmac_f32_16x16x64_bf16 a[184:187], v[16:19], v[84:91], v252
    s_waitcnt lgkmcnt(0)
    ds_read_b64_tr_b16 a[170:171], v4 offset:10248
    v_mfma_f32_16x16x32_bf16 v[108:111], a[144:147], v[68:71], v[108:111]
    s_and_b32 s42, s42, 1
    ds_read_b64_tr_b16 a[148:149], v3 offset:3072
    v_accvgpr_read_b32 v50, a182
    v_mfma_f32_16x16x32_bf16 v[112:115], a[152:155], v[68:71], v[112:115]
    s_cselect_b32 s34, s46, s45
    ds_read_b64_tr_b16 a[150:151], v3 offset:11264
    v_accvgpr_read_b32 v48, a183
    v_mfma_f32_16x16x32_bf16 v[116:119], a[160:163], v[68:71], v[116:119]
    s_waitcnt lgkmcnt(2)
    ds_read_b64_tr_b16 a[156:157], v3 offset:3080
    v_add_f32 v50, v50, v48
    v_mfma_f32_16x16x32_bf16 v[120:123], a[168:171], v[68:71], v[120:123]
    s_cselect_b32 s36, s51, s50
    ds_read_b64_tr_b16 a[158:159], v3 offset:11272
    v_accvgpr_write_b32 a182, 0
    v_mfma_f32_16x16x32_bf16 v[140:143], a[144:147], v[72:75], v[140:143]
    s_mul_i32 s41, s41, 217088
    ds_read_b64_tr_b16 a[164:165], v4 offset:3072
    v_accvgpr_write_b32 a183, 0
    v_mfma_f32_16x16x32_bf16 v[144:147], a[152:155], v[72:75], v[144:147]
    s_add_u32 s34, s34, s41
    ds_read_b64_tr_b16 a[166:167], v4 offset:11264
    v_accvgpr_read_b32 v54, a184
    v_mfma_f32_16x16x32_bf16 v[148:151], a[160:163], v[72:75], v[148:151]
    s_add_u32 s72, s4, s34
    ds_read_b64_tr_b16 a[172:173], v4 offset:3080
    v_accvgpr_read_b32 v52, a185
    v_mfma_f32_16x16x32_bf16 v[152:155], a[168:171], v[72:75], v[152:155]
    s_addc_u32 s73, s5, 0
    ds_read_b64_tr_b16 a[174:175], v4 offset:11272
    v_add_f32 v54, v54, v52
    v_mfma_f32_16x16x32_bf16 v[172:175], a[144:147], v[76:79], v[172:175]
    s_cmp_lt_u32 s22, 3
    v_rcp_f32 v40, v42
    v_mfma_f32_16x16x32_bf16 v[176:179], a[152:155], v[76:79], v[176:179]
    s_cselect_b32 s74, 4096, 0
    v_maximum3_f32 v12, v12, v40, v42
    v_accvgpr_write_b32 a184, 0
    v_mfma_f32_16x16x32_bf16 v[180:183], a[160:163], v[76:79], v[180:183]
    s_add_u32 s76, s16, s30
    v_rcp_f32 v44, v46
    v_mfma_f32_16x16x32_bf16 v[184:187], a[168:171], v[76:79], v[184:187]
    s_addc_u32 s77, s17, 0
    v_maximum3_f32 v12, v12, v44, v46
    v_accvgpr_write_b32 a185, 0
    v_mfma_f32_16x16x32_bf16 v[204:207], a[144:147], v[80:83], v[204:207]
    s_mov_b32 s29, 128
    v_rcp_f32 v48, v50
    v_mfma_f32_16x16x32_bf16 v[208:211], a[152:155], v[80:83], v[208:211]
    s_mov_b32 s31, s44
    v_maximum3_f32 v12, v12, v48, v50
    v_accvgpr_read_b32 v58, a186
    v_mfma_f32_16x16x32_bf16 v[212:215], a[160:163], v[80:83], v[212:215]
    s_mov_b32 s32, 5
    v_rcp_f32 v52, v54
    v_mfma_f32_16x16x32_bf16 v[216:219], a[168:171], v[80:83], v[216:219]
    s_waitcnt vmcnt(13)
    ds_read_b128 a[24:27], v8 offset:5120
    v_maximum3_f32 v12, v12, v52, v54
    v_mfma_f32_16x16x32_bf16 v[236:239], a[144:147], v[84:87], v[236:239]
    ds_read_b128 a[28:31], v9 offset:5120
    v_accvgpr_read_b32 v56, a187
    v_mfma_f32_16x16x32_bf16 v[240:243], a[152:155], v[84:87], v[240:243]
    ds_read_b128 a[32:35], v8 offset:8192
    v_add_f32 v58, v58, v56
    v_mfma_f32_16x16x32_bf16 v[244:247], a[160:163], v[84:87], v[244:247]
    v_rcp_f32 v56, v58
    v_mfma_f32_16x16x32_bf16 v[248:251], a[168:171], v[84:87], v[248:251]
    ds_read_b128 a[36:39], v9 offset:8192
    v_maximum3_f32 v12, v12, v56, v58
    v_mfma_f32_16x16x32_bf16 a[208:211], a[144:147], v[88:91], a[208:211]
    ds_read_b128 a[40:43], v8 offset:9216
    v_accvgpr_write_b32 a186, 0
    v_mfma_f32_16x16x32_bf16 a[212:215], a[152:155], v[88:91], a[212:215]
    ds_read_b128 a[44:47], v9 offset:9216
    v_accvgpr_write_b32 a187, 0
    v_mfma_f32_16x16x32_bf16 a[216:219], a[160:163], v[88:91], a[216:219]
    ds_read_b128 a[48:51], v8 offset:12288
    v_cmp_ngt_f32 vcc, s48, v12
    v_mfma_f32_16x16x32_bf16 a[220:223], a[168:171], v[88:91], a[220:223]
    s_cmp_lg_u64 vcc, 0
    ds_read_b128 a[52:55], v9 offset:12288
    v_accvgpr_read_b32 v20, a192
    ds_read_b128 a[56:59], v8 offset:13312
    ds_read_b128 a[60:63], v9 offset:13312
    ds_read_b128 a[64:67], v8 offset:16384
    ds_read_b128 a[68:71], v9 offset:16384
    ds_read_b128 a[72:75], v8 offset:17408
    ds_read_b128 a[76:79], v9 offset:17408
    ds_read_b128 a[80:83], v8 offset:20480
    ds_read_b128 a[84:87], v9 offset:20480
    ds_read_b128 a[88:91], v8 offset:21504
    ds_read_b128 a[92:95], v9 offset:21504
    s_cselect_b32 s41, s49, 0
    s_or_b32 s37, s37, s41
    v_accvgpr_read_b32 v21, a193
    v_accvgpr_read_b32 v22, a194
    v_accvgpr_read_b32 v23, a195
    v_accvgpr_read_b32 v24, a196
    v_accvgpr_read_b32 v25, a197
    v_accvgpr_read_b32 v26, a198
    v_accvgpr_read_b32 v27, a199
    v_accvgpr_read_b32 v28, a200
    v_accvgpr_read_b32 v29, a201
    v_accvgpr_read_b32 v30, a202
    v_accvgpr_read_b32 v31, a203
    v_accvgpr_read_b32 v32, a204
    v_accvgpr_read_b32 v33, a205
    v_accvgpr_read_b32 v34, a206
    v_accvgpr_read_b32 v35, a207
.p2align 3
    v_pk_mul_f32 v[92:93], v[92:93], v[36:37] op_sel_hi:[1,0]
    v_pk_mul_f32 v[94:95], v[94:95], v[36:37] op_sel_hi:[1,0]
    v_pk_mul_f32 v[96:97], v[96:97], v[36:37] op_sel_hi:[1,0]
    v_pk_mul_f32 v[98:99], v[98:99], v[36:37] op_sel_hi:[1,0]
    v_cvt_pk_bf16_f32 v92, v92, v93
    v_cvt_pk_bf16_f32 v93, v94, v95
    v_cvt_pk_bf16_f32 v94, v96, v97
    v_cvt_pk_bf16_f32 v95, v98, v99
    v_pk_mul_f32 v[100:101], v[100:101], v[36:37] op_sel_hi:[1,0]
    v_pk_mul_f32 v[102:103], v[102:103], v[36:37] op_sel_hi:[1,0]
    v_pk_mul_f32 v[104:105], v[104:105], v[36:37] op_sel_hi:[1,0]
    v_pk_mul_f32 v[106:107], v[106:107], v[36:37] op_sel_hi:[1,0]
    v_cvt_pk_bf16_f32 v100, v100, v101
    v_cvt_pk_bf16_f32 v101, v102, v103
    v_cvt_pk_bf16_f32 v102, v104, v105
    v_cvt_pk_bf16_f32 v103, v106, v107
    v_pk_mul_f32 v[108:109], v[108:109], v[36:37] op_sel_hi:[1,0]
    v_pk_mul_f32 v[110:111], v[110:111], v[36:37] op_sel_hi:[1,0]
    v_pk_mul_f32 v[112:113], v[112:113], v[36:37] op_sel_hi:[1,0]
    v_pk_mul_f32 v[114:115], v[114:115], v[36:37] op_sel_hi:[1,0]
    v_cvt_pk_bf16_f32 v108, v108, v109
    v_cvt_pk_bf16_f32 v109, v110, v111
    v_cvt_pk_bf16_f32 v110, v112, v113
    v_cvt_pk_bf16_f32 v111, v114, v115
    v_pk_mul_f32 v[116:117], v[116:117], v[36:37] op_sel_hi:[1,0]
    v_pk_mul_f32 v[118:119], v[118:119], v[36:37] op_sel_hi:[1,0]
    v_pk_mul_f32 v[120:121], v[120:121], v[36:37] op_sel_hi:[1,0]
    v_pk_mul_f32 v[122:123], v[122:123], v[36:37] op_sel_hi:[1,0]
    v_cvt_pk_bf16_f32 v116, v116, v117
    v_cvt_pk_bf16_f32 v117, v118, v119
    v_cvt_pk_bf16_f32 v118, v120, v121
    v_cvt_pk_bf16_f32 v119, v122, v123
    v_pk_mul_f32 v[124:125], v[124:125], v[40:41] op_sel_hi:[1,0]
    v_pk_mul_f32 v[126:127], v[126:127], v[40:41] op_sel_hi:[1,0]
    v_pk_mul_f32 v[128:129], v[128:129], v[40:41] op_sel_hi:[1,0]
    v_pk_mul_f32 v[130:131], v[130:131], v[40:41] op_sel_hi:[1,0]
    v_cvt_pk_bf16_f32 v124, v124, v125
    v_cvt_pk_bf16_f32 v125, v126, v127
    v_cvt_pk_bf16_f32 v126, v128, v129
    v_cvt_pk_bf16_f32 v127, v130, v131
    v_pk_mul_f32 v[132:133], v[132:133], v[40:41] op_sel_hi:[1,0]
    v_pk_mul_f32 v[134:135], v[134:135], v[40:41] op_sel_hi:[1,0]
    v_pk_mul_f32 v[136:137], v[136:137], v[40:41] op_sel_hi:[1,0]
    v_pk_mul_f32 v[138:139], v[138:139], v[40:41] op_sel_hi:[1,0]
    v_cvt_pk_bf16_f32 v132, v132, v133
    v_cvt_pk_bf16_f32 v133, v134, v135
    v_cvt_pk_bf16_f32 v134, v136, v137
    v_cvt_pk_bf16_f32 v135, v138, v139
    v_pk_mul_f32 v[140:141], v[140:141], v[40:41] op_sel_hi:[1,0]
    v_pk_mul_f32 v[142:143], v[142:143], v[40:41] op_sel_hi:[1,0]
    v_pk_mul_f32 v[144:145], v[144:145], v[40:41] op_sel_hi:[1,0]
    v_pk_mul_f32 v[146:147], v[146:147], v[40:41] op_sel_hi:[1,0]
    v_cvt_pk_bf16_f32 v140, v140, v141
    v_cvt_pk_bf16_f32 v141, v142, v143
    v_cvt_pk_bf16_f32 v142, v144, v145
    v_cvt_pk_bf16_f32 v143, v146, v147
    v_pk_mul_f32 v[148:149], v[148:149], v[40:41] op_sel_hi:[1,0]
    v_pk_mul_f32 v[150:151], v[150:151], v[40:41] op_sel_hi:[1,0]
    v_pk_mul_f32 v[152:153], v[152:153], v[40:41] op_sel_hi:[1,0]
    v_pk_mul_f32 v[154:155], v[154:155], v[40:41] op_sel_hi:[1,0]
    v_cvt_pk_bf16_f32 v148, v148, v149
    v_cvt_pk_bf16_f32 v149, v150, v151
    v_cvt_pk_bf16_f32 v150, v152, v153
    v_cvt_pk_bf16_f32 v151, v154, v155
    v_pk_mul_f32 v[156:157], v[156:157], v[44:45] op_sel_hi:[1,0]
    v_pk_mul_f32 v[158:159], v[158:159], v[44:45] op_sel_hi:[1,0]
    v_pk_mul_f32 v[160:161], v[160:161], v[44:45] op_sel_hi:[1,0]
    v_pk_mul_f32 v[162:163], v[162:163], v[44:45] op_sel_hi:[1,0]
    v_cvt_pk_bf16_f32 v156, v156, v157
    v_cvt_pk_bf16_f32 v157, v158, v159
    v_cvt_pk_bf16_f32 v158, v160, v161
    v_cvt_pk_bf16_f32 v159, v162, v163
    v_pk_mul_f32 v[164:165], v[164:165], v[44:45] op_sel_hi:[1,0]
    v_pk_mul_f32 v[166:167], v[166:167], v[44:45] op_sel_hi:[1,0]
    v_pk_mul_f32 v[168:169], v[168:169], v[44:45] op_sel_hi:[1,0]
    v_pk_mul_f32 v[170:171], v[170:171], v[44:45] op_sel_hi:[1,0]
    v_cvt_pk_bf16_f32 v164, v164, v165
    v_cvt_pk_bf16_f32 v165, v166, v167
    v_cvt_pk_bf16_f32 v166, v168, v169
    v_cvt_pk_bf16_f32 v167, v170, v171
    v_pk_mul_f32 v[172:173], v[172:173], v[44:45] op_sel_hi:[1,0]
    v_pk_mul_f32 v[174:175], v[174:175], v[44:45] op_sel_hi:[1,0]
    v_pk_mul_f32 v[176:177], v[176:177], v[44:45] op_sel_hi:[1,0]
    v_pk_mul_f32 v[178:179], v[178:179], v[44:45] op_sel_hi:[1,0]
    v_cvt_pk_bf16_f32 v172, v172, v173
    v_cvt_pk_bf16_f32 v173, v174, v175
    v_cvt_pk_bf16_f32 v174, v176, v177
    v_cvt_pk_bf16_f32 v175, v178, v179
    v_pk_mul_f32 v[180:181], v[180:181], v[44:45] op_sel_hi:[1,0]
    v_pk_mul_f32 v[182:183], v[182:183], v[44:45] op_sel_hi:[1,0]
    v_pk_mul_f32 v[184:185], v[184:185], v[44:45] op_sel_hi:[1,0]
    v_pk_mul_f32 v[186:187], v[186:187], v[44:45] op_sel_hi:[1,0]
    v_cvt_pk_bf16_f32 v180, v180, v181
    v_cvt_pk_bf16_f32 v181, v182, v183
    v_cvt_pk_bf16_f32 v182, v184, v185
    v_cvt_pk_bf16_f32 v183, v186, v187
    v_pk_mul_f32 v[188:189], v[188:189], v[48:49] op_sel_hi:[1,0]
    v_pk_mul_f32 v[190:191], v[190:191], v[48:49] op_sel_hi:[1,0]
    v_pk_mul_f32 v[192:193], v[192:193], v[48:49] op_sel_hi:[1,0]
    v_pk_mul_f32 v[194:195], v[194:195], v[48:49] op_sel_hi:[1,0]
    v_cvt_pk_bf16_f32 v188, v188, v189
    v_cvt_pk_bf16_f32 v189, v190, v191
    v_cvt_pk_bf16_f32 v190, v192, v193
    v_cvt_pk_bf16_f32 v191, v194, v195
    v_pk_mul_f32 v[196:197], v[196:197], v[48:49] op_sel_hi:[1,0]
    v_pk_mul_f32 v[198:199], v[198:199], v[48:49] op_sel_hi:[1,0]
    v_pk_mul_f32 v[200:201], v[200:201], v[48:49] op_sel_hi:[1,0]
    v_pk_mul_f32 v[202:203], v[202:203], v[48:49] op_sel_hi:[1,0]
    v_cvt_pk_bf16_f32 v196, v196, v197
    v_cvt_pk_bf16_f32 v197, v198, v199
    v_cvt_pk_bf16_f32 v198, v200, v201
    v_cvt_pk_bf16_f32 v199, v202, v203
    v_pk_mul_f32 v[204:205], v[204:205], v[48:49] op_sel_hi:[1,0]
    v_pk_mul_f32 v[206:207], v[206:207], v[48:49] op_sel_hi:[1,0]
    v_pk_mul_f32 v[208:209], v[208:209], v[48:49] op_sel_hi:[1,0]
    v_pk_mul_f32 v[210:211], v[210:211], v[48:49] op_sel_hi:[1,0]
    v_cvt_pk_bf16_f32 v204, v204, v205
    v_cvt_pk_bf16_f32 v205, v206, v207
    v_cvt_pk_bf16_f32 v206, v208, v209
    v_cvt_pk_bf16_f32 v207, v210, v211
    v_pk_mul_f32 v[212:213], v[212:213], v[48:49] op_sel_hi:[1,0]
    v_pk_mul_f32 v[214:215], v[214:215], v[48:49] op_sel_hi:[1,0]
    v_pk_mul_f32 v[216:217], v[216:217], v[48:49] op_sel_hi:[1,0]
    v_pk_mul_f32 v[218:219], v[218:219], v[48:49] op_sel_hi:[1,0]
    v_cvt_pk_bf16_f32 v212, v212, v213
    v_cvt_pk_bf16_f32 v213, v214, v215
    v_cvt_pk_bf16_f32 v214, v216, v217
    v_cvt_pk_bf16_f32 v215, v218, v219
    v_pk_mul_f32 v[220:221], v[220:221], v[52:53] op_sel_hi:[1,0]
    v_pk_mul_f32 v[222:223], v[222:223], v[52:53] op_sel_hi:[1,0]
    v_pk_mul_f32 v[224:225], v[224:225], v[52:53] op_sel_hi:[1,0]
    v_pk_mul_f32 v[226:227], v[226:227], v[52:53] op_sel_hi:[1,0]
    v_pk_mul_f32 v[228:229], v[228:229], v[52:53] op_sel_hi:[1,0]
    v_pk_mul_f32 v[230:231], v[230:231], v[52:53] op_sel_hi:[1,0]
    v_pk_mul_f32 v[232:233], v[232:233], v[52:53] op_sel_hi:[1,0]
    v_pk_mul_f32 v[234:235], v[234:235], v[52:53] op_sel_hi:[1,0]
    v_pk_mul_f32 v[236:237], v[236:237], v[52:53] op_sel_hi:[1,0]
    v_pk_mul_f32 v[238:239], v[238:239], v[52:53] op_sel_hi:[1,0]
    v_pk_mul_f32 v[240:241], v[240:241], v[52:53] op_sel_hi:[1,0]
    v_pk_mul_f32 v[242:243], v[242:243], v[52:53] op_sel_hi:[1,0]
    v_cvt_pk_bf16_f32 v236, v236, v237
    v_cvt_pk_bf16_f32 v237, v238, v239
    v_cvt_pk_bf16_f32 v238, v240, v241
    v_cvt_pk_bf16_f32 v239, v242, v243
    v_pk_mul_f32 v[244:245], v[244:245], v[52:53] op_sel_hi:[1,0]
    v_pk_mul_f32 v[246:247], v[246:247], v[52:53] op_sel_hi:[1,0]
    v_pk_mul_f32 v[248:249], v[248:249], v[52:53] op_sel_hi:[1,0]
    v_pk_mul_f32 v[250:251], v[250:251], v[52:53] op_sel_hi:[1,0]
    v_cvt_pk_bf16_f32 v244, v244, v245
    v_cvt_pk_bf16_f32 v245, v246, v247
    v_cvt_pk_bf16_f32 v246, v248, v249
    v_cvt_pk_bf16_f32 v247, v250, v251
    v_pk_mul_f32 v[20:21], v[20:21], v[56:57] op_sel_hi:[1,0]
    v_pk_mul_f32 v[22:23], v[22:23], v[56:57] op_sel_hi:[1,0]
    v_pk_mul_f32 v[24:25], v[24:25], v[56:57] op_sel_hi:[1,0]
    v_pk_mul_f32 v[26:27], v[26:27], v[56:57] op_sel_hi:[1,0]
    v_cvt_pk_bf16_f32 v96, v20, v21
    v_cvt_pk_bf16_f32 v97, v22, v23
    v_cvt_pk_bf16_f32 v98, v24, v25
    v_cvt_pk_bf16_f32 v99, v26, v27
    v_pk_mul_f32 v[28:29], v[28:29], v[56:57] op_sel_hi:[1,0]
    v_pk_mul_f32 v[30:31], v[30:31], v[56:57] op_sel_hi:[1,0]
    v_pk_mul_f32 v[32:33], v[32:33], v[56:57] op_sel_hi:[1,0]
    v_pk_mul_f32 v[34:35], v[34:35], v[56:57] op_sel_hi:[1,0]
    v_cvt_pk_bf16_f32 v104, v28, v29
    v_cvt_pk_bf16_f32 v105, v30, v31
    v_cvt_pk_bf16_f32 v106, v32, v33
    v_cvt_pk_bf16_f32 v107, v34, v35
    v_accvgpr_read_b32 v68, a208
    v_accvgpr_read_b32 v69, a209
    v_accvgpr_read_b32 v70, a210
    v_accvgpr_read_b32 v71, a211
    v_accvgpr_read_b32 v72, a212
    v_accvgpr_read_b32 v73, a213
    v_accvgpr_read_b32 v74, a214
    v_accvgpr_read_b32 v75, a215
    v_pk_mul_f32 v[68:69], v[68:69], v[56:57] op_sel_hi:[1,0]
    v_pk_mul_f32 v[70:71], v[70:71], v[56:57] op_sel_hi:[1,0]
    v_pk_mul_f32 v[72:73], v[72:73], v[56:57] op_sel_hi:[1,0]
    v_pk_mul_f32 v[74:75], v[74:75], v[56:57] op_sel_hi:[1,0]
    v_cvt_pk_bf16_f32 v128, v68, v69
    v_cvt_pk_bf16_f32 v129, v70, v71
    v_cvt_pk_bf16_f32 v130, v72, v73
    v_cvt_pk_bf16_f32 v131, v74, v75
    v_accvgpr_read_b32 v76, a216
    v_accvgpr_read_b32 v77, a217
    v_accvgpr_read_b32 v78, a218
    v_accvgpr_read_b32 v79, a219
    v_accvgpr_read_b32 v80, a220
    v_accvgpr_read_b32 v81, a221
    v_accvgpr_read_b32 v82, a222
    v_accvgpr_read_b32 v83, a223
    v_pk_mul_f32 v[76:77], v[76:77], v[56:57] op_sel_hi:[1,0]
    v_pk_mul_f32 v[78:79], v[78:79], v[56:57] op_sel_hi:[1,0]
    v_pk_mul_f32 v[80:81], v[80:81], v[56:57] op_sel_hi:[1,0]
    v_pk_mul_f32 v[82:83], v[82:83], v[56:57] op_sel_hi:[1,0]
    v_cvt_pk_bf16_f32 v136, v76, v77
    v_cvt_pk_bf16_f32 v137, v78, v79
    v_cvt_pk_bf16_f32 v138, v80, v81
    v_cvt_pk_bf16_f32 v139, v82, v83
    s_waitcnt lgkmcnt(0)
    s_cmp_eq_u32 s35, 1
    s_cbranch_scc1 L_job7
    s_branch L_job6
L_end_code:
L_close7:
    s_cmp_eq_u32 s38, 0
    s_cselect_b32 s72, s8, s12
    s_cselect_b32 s73, s9, s13
    s_add_u32 s72, s72, 491520
    s_addc_u32 s73, s73, 0
    s_mov_b32 s74, 32768
    s_lshl_b32 s28, s21, 10
    v_mbcnt_lo_u32_b32 v10, -1, 0
    v_mbcnt_hi_u32_b32 v10, -1, v10
    v_lshl_add_u32 v10, v10, 4, s28
    s_mov_b32 s32, 4
    s_mov_b32 s28, 0
L_bodyo7:
    s_waitcnt lgkmcnt(8)
    v_exp_f32 v30, v30
    v_mfma_f32_16x16x32_bf16 v[108:111], a[144:147], v[68:71], v[108:111]
    s_add_u32 m0, s27, 0
    v_exp_f32 v31, v31
    v_mfma_f32_16x16x32_bf16 v[108:111], a[148:151], v[36:39], v[108:111]
    v_cvt_pk_bf16_f32 v49, v30, v31
    v_mul_f32 v21, s20, v21
    v_mfma_f32_16x16x32_bf16 v[112:115], a[156:159], v[36:39], v[112:115]
    buffer_load_dwordx4 v5, s[64:67], 0 offen lds
    v_mul_f32 v22, s20, v22
    v_mfma_f32_16x16x32_bf16 v[112:115], a[152:155], v[68:71], v[112:115]
    s_waitcnt lgkmcnt(0)
    v_exp_f32 v32, v32
    v_mfma_f32_16x16x32_bf16 v[116:119], a[160:163], v[68:71], v[116:119]
    v_exp_f32 v33, v33
    v_mfma_f32_16x16x32_bf16 v[116:119], a[164:167], v[36:39], v[116:119]
    v_exp_f32 v34, v34
    v_mfma_f32_16x16x32_bf16 v[120:123], a[172:175], v[36:39], v[120:123]
    v_exp_f32 v35, v35
    v_mfma_f32_16x16x32_bf16 v[120:123], a[168:171], v[68:71], v[120:123]
    s_add_u32 m0, s27, 896
    v_cvt_pk_bf16_f32 v50, v32, v33
    v_cvt_pk_bf16_f32 v51, v34, v35
    v_mfma_f32_16x16x32_bf16 v[28:31], a[112:115], a[80:83], 0
    v_exp_f32 v20, v20
    v_mfma_f32_16x16x32_bf16 v[28:31], a[116:119], a[84:87], v[28:31]
    v_exp_f32 v21, v21
    v_mfma_f32_16x16x32_bf16 v[28:31], a[120:123], a[88:91], v[28:31]
    buffer_load_dwordx4 v5, s[64:67], 0 offen offset:128 lds
    v_mul_f32 v23, s20, v23
    v_mfma_f32_16x16x32_bf16 v[28:31], a[124:127], a[92:95], v[28:31]
    v_exp_f32 v22, v22
    v_mfma_f32_16x16x32_bf16 v[32:35], a[140:143], a[92:95], 0
    v_exp_f32 v23, v23
    v_mfma_f32_16x16x32_bf16 v[32:35], a[136:139], a[88:91], v[32:35]
    v_cvt_pk_bf16_f32 v52, v20, v21
    v_cvt_pk_bf16_f32 v53, v22, v23
    v_mfma_f32_16x16x32_bf16 v[32:35], a[132:135], a[84:87], v[32:35]
    v_mul_f32 v24, s20, v24
    v_mul_f32 v25, s20, v25
    v_mfma_f32_16x16x32_bf16 v[32:35], a[128:131], a[80:83], v[32:35]
    s_add_u32 m0, s27, 2048
    v_exp_f32 v24, v24
    v_mfma_f32_16x16x32_bf16 v[140:143], a[144:147], v[72:75], v[140:143]
    v_exp_f32 v25, v25
    v_mfma_f32_16x16x32_bf16 v[140:143], a[148:151], v[40:43], v[140:143]
    v_mul_f32 v26, s20, v26
    v_mul_f32 v27, s20, v27
    v_mfma_f32_16x16x32_bf16 v[144:147], a[156:159], v[40:43], v[144:147]
    buffer_load_dwordx4 v5, s[68:71], 0 offen lds
    v_cvt_pk_bf16_f32 v54, v24, v25
    v_mfma_f32_16x16x32_bf16 v[144:147], a[152:155], v[72:75], v[144:147]
    v_exp_f32 v26, v26
    v_mfma_f32_16x16x32_bf16 v[148:151], a[160:163], v[72:75], v[148:151]
    v_exp_f32 v27, v27
    v_mfma_f32_16x16x32_bf16 v[148:151], a[164:167], v[40:43], v[148:151]
    v_cvt_pk_bf16_f32 v55, v26, v27
    v_mul_f32 v28, s20, v28
    v_mfma_f32_16x16x32_bf16 v[152:155], a[172:175], v[40:43], v[152:155]
    v_mul_f32 v29, s20, v29
    v_mul_f32 v30, s20, v30
    v_mfma_f32_16x16x32_bf16 v[152:155], a[168:171], v[72:75], v[152:155]
    s_add_u32 m0, s27, 3072
    v_exp_f32 v28, v28
    v_mfma_f32_16x16x32_bf16 v[20:23], a[112:115], a[96:99], 0
    ds_read_b128 a[112:115], v1
    v_mul_f32 v31, s20, v31
    v_mfma_f32_16x16x32_bf16 v[20:23], a[116:119], a[100:103], v[20:23]
    ds_read_b128 a[116:119], v2
    v_mul_f32 v32, s20, v32
    v_mfma_f32_16x16x32_bf16 v[20:23], a[120:123], a[104:107], v[20:23]
    buffer_load_dwordx4 v5, s[88:91], 0 offen lds
    v_mul_f32 v33, s20, v33
    v_mfma_f32_16x16x32_bf16 v[20:23], a[124:127], a[108:111], v[20:23]
    s_add_u32 s27, s27, 16384
    ds_read_b128 a[120:123], v1 offset:1024
    v_mul_f32 v34, s20, v34
    v_mfma_f32_16x16x32_bf16 v[24:27], a[140:143], a[108:111], 0
    s_and_b32 s27, s27, 0xffff
    ds_read_b128 a[124:127], v2 offset:1024
    v_mul_f32 v35, s20, v35
    v_mfma_f32_16x16x32_bf16 v[24:27], a[136:139], a[104:107], v[24:27]
    s_mov_b64 s[68:69], s[88:89]
    v_exp_f32 v29, v29
    v_mfma_f32_16x16x32_bf16 v[24:27], a[132:135], a[100:103], v[24:27]
    s_mov_b32 s70, s90
    ds_read_b128 a[140:143], v2 offset:9216
    v_cvt_pk_bf16_f32 v56, v28, v29
    v_mfma_f32_16x16x32_bf16 v[24:27], a[128:131], a[96:99], v[24:27]
    s_add_u32 s88, s88, 8192
    ds_read_b128 a[136:139], v1 offset:9216
    v_mul_f32 v20, s20, v20
    v_mfma_f32_16x16x32_bf16 v[172:175], a[144:147], v[76:79], v[172:175]
    s_addc_u32 s89, s89, 0
    v_exp_f32 v30, v30
    v_mfma_f32_16x16x32_bf16 v[172:175], a[148:151], v[44:47], v[172:175]
    s_mov_b32 s90, s66
    ds_read_b128 a[132:135], v2 offset:8192
    v_mul_f32 v21, s20, v21
    v_mfma_f32_16x16x32_bf16 v[176:179], a[156:159], v[44:47], v[176:179]
    s_add_u32 s64, s64, 8192
    ds_read_b128 a[128:131], v1 offset:8192
    v_mul_f32 v22, s20, v22
    v_mfma_f32_16x16x32_bf16 v[176:179], a[152:155], v[76:79], v[176:179]
    s_addc_u32 s65, s65, 0
    v_exp_f32 v31, v31
    v_mfma_f32_16x16x32_bf16 v[180:183], a[160:163], v[76:79], v[180:183]
    s_add_u32 s23, s23, 1
    v_cvt_pk_bf16_f32 v57, v30, v31
    v_mul_f32 v23, s20, v23
    v_mfma_f32_16x16x32_bf16 v[180:183], a[164:167], v[44:47], v[180:183]
    s_cmp_lt_u32 s23, 64
    v_exp_f32 v32, v32
    v_mfma_f32_16x16x32_bf16 v[184:187], a[172:175], v[44:47], v[184:187]
    s_cselect_b32 s66, 8192, 0
    v_exp_f32 v33, v33
    v_mfma_f32_16x16x32_bf16 v[184:187], a[168:171], v[76:79], v[184:187]
    s_waitcnt lgkmcnt(4)
    v_exp_f32 v34, v34
    v_mfma_f32_16x16x32_bf16 v[28:31], a[112:115], a[0:3], 0
    v_exp_f32 v35, v35
    v_mfma_f32_16x16x32_bf16 v[28:31], a[116:119], a[4:7], v[28:31]
    v_cvt_pk_bf16_f32 v58, v32, v33
    v_cvt_pk_bf16_f32 v59, v34, v35
    v_mfma_f32_16x16x32_bf16 v[28:31], a[120:123], a[8:11], v[28:31]
    v_exp_f32 v20, v20
    v_mfma_f32_16x16x32_bf16 v[28:31], a[124:127], a[12:15], v[28:31]
    s_waitcnt lgkmcnt(0)
    v_exp_f32 v21, v21
    v_mfma_f32_16x16x32_bf16 v[32:35], a[140:143], a[12:15], 0
    v_exp_f32 v22, v22
    v_mfma_f32_16x16x32_bf16 v[32:35], a[136:139], a[8:11], v[32:35]
    v_exp_f32 v23, v23
    v_mfma_f32_16x16x32_bf16 v[32:35], a[132:135], a[4:7], v[32:35]
    v_cvt_pk_bf16_f32 v60, v20, v21
    v_cvt_pk_bf16_f32 v61, v22, v23
    v_mfma_f32_16x16x32_bf16 v[32:35], a[128:131], a[0:3], v[32:35]
    v_mul_f32 v24, s20, v24
    v_mul_f32 v25, s20, v25
    v_mfma_f32_16x16x32_bf16 v[204:207], a[144:147], v[80:83], v[204:207]
    v_exp_f32 v24, v24
    v_mfma_f32_16x16x32_bf16 v[204:207], a[148:151], v[48:51], v[204:207]
    v_exp_f32 v25, v25
    v_mfma_f32_16x16x32_bf16 v[208:211], a[156:159], v[48:51], v[208:211]
    v_mul_f32 v26, s20, v26
    v_mul_f32 v27, s20, v27
    v_mfma_f32_16x16x32_bf16 v[208:211], a[152:155], v[80:83], v[208:211]
    v_exp_f32 v26, v26
    v_mfma_f32_16x16x32_bf16 v[212:215], a[160:163], v[80:83], v[212:215]
    v_exp_f32 v27, v27
    v_mfma_f32_16x16x32_bf16 v[212:215], a[164:167], v[48:51], v[212:215]
    v_cvt_pk_bf16_f32 v62, v24, v25
    v_cvt_pk_bf16_f32 v63, v26, v27
    v_mfma_f32_16x16x32_bf16 v[216:219], a[172:175], v[48:51], v[216:219]
    v_mul_f32 v28, s20, v28
    v_mul_f32 v29, s20, v29
    v_mfma_f32_16x16x32_bf16 v[216:219], a[168:171], v[80:83], v[216:219]
    v_exp_f32 v28, v28
    v_mfma_f32_16x16x32_bf16 v[20:23], a[112:115], a[16:19], 0
    v_exp_f32 v29, v29
    v_mfma_f32_16x16x32_bf16 v[20:23], a[116:119], a[20:23], v[20:23]
    v_mul_f32 v30, s20, v30
    v_mul_f32 v31, s20, v31
    v_mfma_f32_16x16x32_bf16 v[20:23], a[120:123], a[24:27], v[20:23]
    v_exp_f32 v30, v30
    v_mfma_f32_16x16x32_bf16 v[20:23], a[124:127], a[28:31], v[20:23]
    v_exp_f32 v31, v31
    v_mfma_f32_16x16x32_bf16 v[24:27], a[140:143], a[28:31], 0
    v_cvt_pk_bf16_f32 v68, v28, v29
    v_cvt_pk_bf16_f32 v69, v30, v31
    v_mfma_f32_16x16x32_bf16 v[24:27], a[136:139], a[24:27], v[24:27]
    v_mul_f32 v32, s20, v32
    v_mul_f32 v33, s20, v33
    v_mfma_f32_16x16x32_bf16 v[24:27], a[132:135], a[20:23], v[24:27]
    v_exp_f32 v32, v32
    v_mfma_f32_16x16x32_bf16 v[24:27], a[128:131], a[16:19], v[24:27]
    v_exp_f32 v33, v33
    v_mfma_f32_16x16x32_bf16 v[236:239], a[144:147], v[84:87], v[236:239]
    v_mul_f32 v34, s20, v34
    v_mul_f32 v35, s20, v35
    v_mfma_f32_16x16x32_bf16 v[236:239], a[148:151], v[52:55], v[236:239]
    v_exp_f32 v34, v34
    v_mfma_f32_16x16x32_bf16 v[240:243], a[156:159], v[52:55], v[240:243]
    v_exp_f32 v35, v35
    v_mfma_f32_16x16x32_bf16 v[240:243], a[152:155], v[84:87], v[240:243]
    v_cvt_pk_bf16_f32 v70, v32, v33
    v_cvt_pk_bf16_f32 v71, v34, v35
    v_mfma_f32_16x16x32_bf16 v[244:247], a[160:163], v[84:87], v[244:247]
    v_mul_f32 v20, s20, v20
    v_mul_f32 v21, s20, v21
    v_mfma_f32_16x16x32_bf16 v[244:247], a[164:167], v[52:55], v[244:247]
    v_exp_f32 v20, v20
    v_mfma_f32_16x16x32_bf16 v[248:251], a[172:175], v[52:55], v[248:251]
    v_exp_f32 v21, v21
    v_mfma_f32_16x16x32_bf16 v[248:251], a[168:171], v[84:87], v[248:251]
    v_mul_f32 v22, s20, v22
    v_mul_f32 v23, s20, v23
    v_mfma_f32_16x16x32_bf16 v[28:31], a[112:115], a[32:35], 0
    v_exp_f32 v22, v22
    v_mfma_f32_16x16x32_bf16 v[28:31], a[116:119], a[36:39], v[28:31]
    v_exp_f32 v23, v23
    v_mfma_f32_16x16x32_bf16 v[28:31], a[120:123], a[40:43], v[28:31]
    v_cvt_pk_bf16_f32 v72, v20, v21
    v_cvt_pk_bf16_f32 v73, v22, v23
    v_mfma_f32_16x16x32_bf16 v[28:31], a[124:127], a[44:47], v[28:31]
    v_mul_f32 v24, s20, v24
    v_mul_f32 v25, s20, v25
    v_mfma_f32_16x16x32_bf16 v[32:35], a[140:143], a[44:47], 0
    v_exp_f32 v24, v24
    v_mfma_f32_16x16x32_bf16 v[32:35], a[136:139], a[40:43], v[32:35]
    v_exp_f32 v25, v25
    v_mfma_f32_16x16x32_bf16 v[32:35], a[132:135], a[36:39], v[32:35]
    v_mul_f32 v26, s20, v26
    v_mul_f32 v27, s20, v27
    v_mfma_f32_16x16x32_bf16 v[32:35], a[128:131], a[32:35], v[32:35]
    v_exp_f32 v26, v26
    v_mfma_f32_16x16x32_bf16 a[208:211], a[144:147], v[88:91], a[208:211]
    v_exp_f32 v27, v27
    v_mfma_f32_16x16x32_bf16 a[208:211], a[148:151], v[56:59], a[208:211]
    v_cvt_pk_bf16_f32 v74, v24, v25
    v_cvt_pk_bf16_f32 v75, v26, v27
    v_mfma_f32_16x16x32_bf16 a[212:215], a[156:159], v[56:59], a[212:215]
    v_mul_f32 v28, s20, v28
    v_mul_f32 v29, s20, v29
    v_mfma_f32_16x16x32_bf16 a[212:215], a[152:155], v[88:91], a[212:215]
    v_exp_f32 v28, v28
    v_mfma_f32_16x16x32_bf16 a[216:219], a[160:163], v[88:91], a[216:219]
    v_exp_f32 v29, v29
    v_mfma_f32_16x16x32_bf16 a[216:219], a[164:167], v[56:59], a[216:219]
    v_mul_f32 v30, s20, v30
    v_mul_f32 v31, s20, v31
    v_mfma_f32_16x16x32_bf16 a[220:223], a[172:175], v[56:59], a[220:223]
    v_exp_f32 v30, v30
    v_mfma_f32_16x16x32_bf16 a[220:223], a[168:171], v[88:91], a[220:223]
    v_exp_f32 v31, v31
    v_mfma_f32_16x16x32_bf16 v[20:23], a[112:115], a[48:51], 0
    v_cvt_pk_bf16_f32 v76, v28, v29
    v_cvt_pk_bf16_f32 v77, v30, v31
    v_mfma_f32_16x16x32_bf16 v[20:23], a[116:119], a[52:55], v[20:23]
    v_mul_f32 v32, s20, v32
    v_mul_f32 v33, s20, v33
    v_mfma_f32_16x16x32_bf16 v[20:23], a[120:123], a[56:59], v[20:23]
    v_exp_f32 v32, v32
    v_mfma_f32_16x16x32_bf16 v[20:23], a[124:127], a[60:63], v[20:23]
    v_exp_f32 v33, v33
    v_mfma_f32_16x16x32_bf16 v[24:27], a[140:143], a[60:63], 0
    v_mul_f32 v34, s20, v34
    v_mul_f32 v35, s20, v35
    v_mfma_f32_16x16x32_bf16 v[24:27], a[136:139], a[56:59], v[24:27]
    s_waitcnt vmcnt(14) lgkmcnt(0)
    v_exp_f32 v34, v34
    v_mfma_f32_16x16x32_bf16 v[24:27], a[132:135], a[52:55], v[24:27]
    s_barrier
    v_cvt_pk_bf16_f32 v78, v32, v33
    v_mfma_f32_16x16x32_bf16 v[24:27], a[128:131], a[48:51], v[24:27]
    v_exp_f32 v35, v35
    v_mfma_f32_16x16x32_bf16 a[240:243], a[144:147], v[64:67], a[240:243]
    ds_read_b64_tr_b16 a[144:145], v3 offset:18432
    v_cvt_pk_bf16_f32 v79, v34, v35
    v_mfma_f32_16x16x32_bf16 a[240:243], a[148:151], v[60:63], a[240:243]
    ds_read_b64_tr_b16 a[146:147], v3 offset:26624
    v_mul_f32 v20, s20, v20
    v_mfma_f32_16x16x32_bf16 a[244:247], a[156:159], v[60:63], a[244:247]
    ds_read_b64_tr_b16 a[148:149], v3 offset:19456
    v_mul_f32 v21, s20, v21
    v_mfma_f32_16x16x32_bf16 a[244:247], a[152:155], v[64:67], a[244:247]
    ds_read_b64_tr_b16 a[150:151], v3 offset:27648
    v_mul_f32 v22, s20, v22
    v_mfma_f32_16x16x32_bf16 a[248:251], a[160:163], v[64:67], a[248:251]
    ds_read_b64_tr_b16 a[156:157], v3 offset:19464
    v_mul_f32 v23, s20, v23
    v_mfma_f32_16x16x32_bf16 a[248:251], a[164:167], v[60:63], a[248:251]
    ds_read_b64_tr_b16 a[158:159], v3 offset:27656
    v_mul_f32 v24, s20, v24
    v_mfma_f32_16x16x32_bf16 a[252:255], a[172:175], v[60:63], a[252:255]
    ds_read_b64_tr_b16 a[152:153], v3 offset:18440
    v_mul_f32 v25, s20, v25
    v_mfma_f32_16x16x32_bf16 a[252:255], a[168:171], v[64:67], a[252:255]
    ds_read_b64_tr_b16 a[154:155], v3 offset:26632
    v_mul_f32 v26, s20, v26
    v_mfma_f32_16x16x32_bf16 v[28:31], a[112:115], a[64:67], 0
    ds_read_b64_tr_b16 a[160:161], v4 offset:18432
    v_mul_f32 v27, s20, v27
    v_mfma_f32_16x16x32_bf16 v[28:31], a[116:119], a[68:71], v[28:31]
    ds_read_b64_tr_b16 a[162:163], v4 offset:26624
    ds_read_b64_tr_b16 a[164:165], v4 offset:19456
    v_mfma_f32_16x16x32_bf16 v[28:31], a[120:123], a[72:75], v[28:31]
    v_exp_f32 v20, v20
    v_mfma_f32_16x16x32_bf16 v[28:31], a[124:127], a[76:79], v[28:31]
    ds_read_b64_tr_b16 a[166:167], v4 offset:27648
    ds_read_b64_tr_b16 a[172:173], v4 offset:19464
    v_mfma_f32_16x16x32_bf16 v[32:35], a[140:143], a[76:79], 0
    v_exp_f32 v21, v21
    v_mfma_f32_16x16x32_bf16 v[32:35], a[136:139], a[72:75], v[32:35]
    ds_read_b64_tr_b16 a[174:175], v4 offset:27656
    v_cvt_pk_bf16_f32 v80, v20, v21
    v_mfma_f32_16x16x32_bf16 v[32:35], a[132:135], a[68:71], v[32:35]
    ds_read_b64_tr_b16 a[168:169], v4 offset:18440
    v_mul_f32 v28, s20, v28
    v_mfma_f32_16x16x32_bf16 v[32:35], a[128:131], a[64:67], v[32:35]
    s_waitcnt lgkmcnt(7)
    ds_read_b64_tr_b16 a[170:171], v4 offset:26632
    v_mul_f32 v29, s20, v29
    v_mfma_f32_16x16x32_bf16 v[92:95], a[144:147], v[36:39], v[92:95]
    s_add_u32 m0, s27, 0
    v_xor_b32 v3, 0x8000, v3
    v_xor_b32 v4, 0x8000, v4
    v_mfma_f32_16x16x32_bf16 v[92:95], a[148:151], v[68:71], v[92:95]
    v_exp_f32 v22, v22
    v_mfma_f32_16x16x32_bf16 v[96:99], a[156:159], v[68:71], v[96:99]
    buffer_load_dwordx4 v5, s[64:67], 0 offen lds
    v_mul_f32 v30, s20, v30
    v_mfma_f32_16x16x32_bf16 v[96:99], a[152:155], v[36:39], v[96:99]
    s_waitcnt lgkmcnt(0)
    v_exp_f32 v23, v23
    v_mfma_f32_16x16x32_bf16 v[100:103], a[160:163], v[36:39], v[100:103]
    v_cvt_pk_bf16_f32 v81, v22, v23
    v_mul_f32 v31, s20, v31
    v_mfma_f32_16x16x32_bf16 v[100:103], a[164:167], v[68:71], v[100:103]
    v_exp_f32 v24, v24
    v_mfma_f32_16x16x32_bf16 v[104:107], a[172:175], v[68:71], v[104:107]
    v_exp_f32 v25, v25
    v_mfma_f32_16x16x32_bf16 v[104:107], a[168:171], v[36:39], v[104:107]
    s_add_u32 m0, s27, 896
    v_exp_f32 v26, v26
    v_mfma_f32_16x16x32_bf16 v[20:23], a[112:115], a[80:83], 0
    v_exp_f32 v27, v27
    v_mfma_f32_16x16x32_bf16 v[20:23], a[116:119], a[84:87], v[20:23]
    v_cvt_pk_bf16_f32 v82, v24, v25
    v_cvt_pk_bf16_f32 v83, v26, v27
    v_mfma_f32_16x16x32_bf16 v[20:23], a[120:123], a[88:91], v[20:23]
    buffer_load_dwordx4 v5, s[64:67], 0 offen offset:128 lds
    v_mul_f32 v32, s20, v32
    v_mfma_f32_16x16x32_bf16 v[20:23], a[124:127], a[92:95], v[20:23]
    v_exp_f32 v28, v28
    v_mfma_f32_16x16x32_bf16 v[24:27], a[140:143], a[92:95], 0
    v_exp_f32 v29, v29
    v_mfma_f32_16x16x32_bf16 v[24:27], a[136:139], a[88:91], v[24:27]
    v_exp_f32 v30, v30
    v_mfma_f32_16x16x32_bf16 v[24:27], a[132:135], a[84:87], v[24:27]
    v_exp_f32 v31, v31
    v_mfma_f32_16x16x32_bf16 v[24:27], a[128:131], a[80:83], v[24:27]
    s_add_u32 m0, s27, 1920
    v_cvt_pk_bf16_f32 v84, v28, v29
    v_cvt_pk_bf16_f32 v85, v30, v31
    v_mfma_f32_16x16x32_bf16 v[124:127], a[144:147], v[40:43], v[124:127]
    v_mul_f32 v33, s20, v33
    v_mul_f32 v34, s20, v34
    v_mfma_f32_16x16x32_bf16 v[124:127], a[148:151], v[72:75], v[124:127]
    v_exp_f32 v32, v32
    v_mfma_f32_16x16x32_bf16 v[128:131], a[156:159], v[72:75], v[128:131]
    buffer_load_dwordx4 v5, s[68:71], 0 offen offset:128 lds
    v_mul_f32 v35, s20, v35
    v_mfma_f32_16x16x32_bf16 v[128:131], a[152:155], v[40:43], v[128:131]
    v_exp_f32 v33, v33
    v_mfma_f32_16x16x32_bf16 v[132:135], a[160:163], v[40:43], v[132:135]
    v_exp_f32 v34, v34
    v_mfma_f32_16x16x32_bf16 v[132:135], a[164:167], v[72:75], v[132:135]
    v_exp_f32 v35, v35
    v_mfma_f32_16x16x32_bf16 v[136:139], a[172:175], v[72:75], v[136:139]
    v_cvt_pk_bf16_f32 v86, v32, v33
    v_cvt_pk_bf16_f32 v87, v34, v35
    v_mfma_f32_16x16x32_bf16 v[136:139], a[168:171], v[40:43], v[136:139]
    s_add_u32 m0, s27, 2944
    v_mul_f32 v20, s20, v20
    v_mul_f32 v21, s20, v21
    v_smfmac_f32_16x16x64_bf16 a[176:179], v[16:19], v[36:43], v252
    v_mul_f32 v22, s20, v22
    v_smfmac_f32_16x16x64_bf16 a[176:179], v[16:19], v[68:75], v252
    v_mul_f32 v23, s20, v23
    v_mfma_f32_16x16x32_bf16 v[28:31], a[112:115], a[96:99], 0
    buffer_load_dwordx4 v5, s[88:91], 0 offen offset:128 lds
    v_mul_f32 v24, s20, v24
    v_mfma_f32_16x16x32_bf16 v[28:31], a[116:119], a[100:103], v[28:31]
    s_add_u32 s27, s27, 16384
    ds_read_b128 a[112:115], v1 offset:16384
    v_mul_f32 v25, s20, v25
    v_mfma_f32_16x16x32_bf16 v[28:31], a[120:123], a[104:107], v[28:31]
    s_and_b32 s27, s27, 0xffff
    ds_read_b128 a[116:119], v2 offset:16384
    v_mul_f32 v26, s20, v26
    v_mfma_f32_16x16x32_bf16 v[28:31], a[124:127], a[108:111], v[28:31]
    s_mov_b64 s[68:69], s[88:89]
    ds_read_b128 a[120:123], v1 offset:17408
    v_mul_f32 v27, s20, v27
    v_mfma_f32_16x16x32_bf16 v[32:35], a[140:143], a[108:111], 0
    s_mov_b32 s70, s90
    ds_read_b128 a[124:127], v2 offset:17408
    ds_read_b128 v[12:15], v7
    v_mfma_f32_16x16x32_bf16 v[32:35], a[136:139], a[104:107], v[32:35]
    s_add_u32 s88, s88, 8192
    v_exp_f32 v20, v20
    v_mfma_f32_16x16x32_bf16 v[32:35], a[132:135], a[100:103], v[32:35]
    s_addc_u32 s89, s89, 0
    ds_read_b128 a[140:143], v2 offset:25600
    v_mul_f32 v28, s20, v28
    v_mfma_f32_16x16x32_bf16 v[32:35], a[128:131], a[96:99], v[32:35]
    s_mov_b32 s90, s66
    ds_read_b128 a[136:139], v1 offset:25600
    v_mul_f32 v29, s20, v29
    v_mfma_f32_16x16x32_bf16 v[156:159], a[144:147], v[44:47], v[156:159]
    s_add_u32 s64, s64, 8192
    v_exp_f32 v21, v21
    v_mfma_f32_16x16x32_bf16 v[156:159], a[148:151], v[76:79], v[156:159]
    s_addc_u32 s65, s65, 0
    ds_read_b128 a[132:135], v2 offset:24576
    v_xor_b32 v2, 0x8000, v2
    v_mfma_f32_16x16x32_bf16 v[160:163], a[156:159], v[76:79], v[160:163]
    s_add_u32 s23, s23, 1
    ds_read_b128 a[128:131], v1 offset:24576
    v_xor_b32 v1, 0x8000, v1
    v_mfma_f32_16x16x32_bf16 v[160:163], a[152:155], v[44:47], v[160:163]
    s_cmp_lt_u32 s23, 64
    v_exp_f32 v22, v22
    v_mfma_f32_16x16x32_bf16 v[164:167], a[160:163], v[44:47], v[164:167]
    s_cselect_b32 s66, 8192, 0
    v_exp_f32 v23, v23
    v_mfma_f32_16x16x32_bf16 v[164:167], a[164:167], v[76:79], v[164:167]
    v_cvt_pk_bf16_f32 v88, v20, v21
    v_cvt_pk_bf16_f32 v89, v22, v23
    v_mfma_f32_16x16x32_bf16 v[168:171], a[172:175], v[76:79], v[168:171]
    s_waitcnt lgkmcnt(4)
    buffer_store_dwordx4 v[12:15], v6, s[76:79], 0 offen nt
    v_exp_f32 v24, v24
    v_exp_f32 v25, v25
    v_mfma_f32_16x16x32_bf16 v[168:171], a[168:171], v[44:47], v[168:171]
    s_add_u32 s76, s76, s29
    v_exp_f32 v26, v26
    v_mfma_f32_16x16x32_bf16 v[20:23], a[112:115], a[0:3], 0
    s_addc_u32 s77, s77, 0
    v_exp_f32 v27, v27
    v_mfma_f32_16x16x32_bf16 v[20:23], a[116:119], a[4:7], v[20:23]
    s_xor_b32 s29, s29, 0x700
    v_cvt_pk_bf16_f32 v90, v24, v25
    v_cvt_pk_bf16_f32 v91, v26, v27
    v_mfma_f32_16x16x32_bf16 v[20:23], a[120:123], a[8:11], v[20:23]
    v_exp_f32 v28, v28
    v_mfma_f32_16x16x32_bf16 v[20:23], a[124:127], a[12:15], v[20:23]
    s_waitcnt lgkmcnt(0)
    v_exp_f32 v29, v29
    v_mfma_f32_16x16x32_bf16 v[24:27], a[140:143], a[12:15], 0
    v_mul_f32 v30, s20, v30
    v_mul_f32 v31, s20, v31
    v_mfma_f32_16x16x32_bf16 v[24:27], a[136:139], a[8:11], v[24:27]
    ds_read_b128 v[12:15], v7 offset:1024
    v_cvt_pk_bf16_f32 v64, v28, v29
    v_mfma_f32_16x16x32_bf16 v[24:27], a[132:135], a[4:7], v[24:27]
    buffer_load_dword v0, v10, s[72:75], 0 offen
    v_mul_f32 v32, s20, v32
    v_mfma_f32_16x16x32_bf16 v[24:27], a[128:131], a[0:3], v[24:27]
    s_add_u32 s72, s72, 4096
    v_exp_f32 v30, v30
    v_mfma_f32_16x16x32_bf16 v[188:191], a[144:147], v[48:51], v[188:191]
    s_addc_u32 s73, s73, 0
    v_exp_f32 v31, v31
    v_mfma_f32_16x16x32_bf16 v[188:191], a[148:151], v[80:83], v[188:191]
    s_max_u32 s74, s74, 4096
    v_cvt_pk_bf16_f32 v65, v30, v31
    v_mul_f32 v33, s20, v33
    v_mfma_f32_16x16x32_bf16 v[192:195], a[156:159], v[80:83], v[192:195]
    s_sub_u32 s74, s74, 4096
    v_exp_f32 v32, v32
    v_mfma_f32_16x16x32_bf16 v[192:195], a[152:155], v[48:51], v[192:195]
    v_exp_f32 v33, v33
    v_mfma_f32_16x16x32_bf16 v[196:199], a[160:163], v[48:51], v[196:199]
    v_mul_f32 v34, s20, v34
    v_mul_f32 v35, s20, v35
    v_mfma_f32_16x16x32_bf16 v[196:199], a[164:167], v[80:83], v[196:199]
    v_exp_f32 v34, v34
    v_mfma_f32_16x16x32_bf16 v[200:203], a[172:175], v[80:83], v[200:203]
    s_waitcnt lgkmcnt(0)
    buffer_store_dwordx4 v[12:15], v6, s[76:79], 0 offen nt
    v_exp_f32 v35, v35
    v_cvt_pk_bf16_f32 v66, v32, v33
    v_cvt_pk_bf16_f32 v67, v34, v35
    v_mfma_f32_16x16x32_bf16 v[200:203], a[168:171], v[48:51], v[200:203]
    s_add_u32 s76, s76, s29
    v_mul_f32 v20, s20, v20
    v_mul_f32 v21, s20, v21
    v_smfmac_f32_16x16x64_bf16 a[180:183], v[16:19], v[44:51], v252
    s_addc_u32 s77, s77, 0
    v_mul_f32 v22, s20, v22
    v_smfmac_f32_16x16x64_bf16 a[180:183], v[16:19], v[76:83], v252
    s_xor_b32 s29, s29, 0x700
    v_mul_f32 v23, s20, v23
    v_mfma_f32_16x16x32_bf16 v[28:31], a[112:115], a[16:19], 0
    v_exp_f32 v20, v20
    v_mfma_f32_16x16x32_bf16 v[28:31], a[116:119], a[20:23], v[28:31]
    v_exp_f32 v21, v21
    v_mfma_f32_16x16x32_bf16 v[28:31], a[120:123], a[24:27], v[28:31]
    v_exp_f32 v22, v22
    v_mfma_f32_16x16x32_bf16 v[28:31], a[124:127], a[28:31], v[28:31]
    ds_read_b128 v[12:15], v7 offset:2048
    v_add_u32 v7, 3072, v7
    v_mfma_f32_16x16x32_bf16 v[32:35], a[140:143], a[28:31], 0
    buffer_load_dword v0, v10, s[72:75], 0 offen
    v_cvt_pk_bf16_f32 v36, v20, v21
    v_mfma_f32_16x16x32_bf16 v[32:35], a[136:139], a[24:27], v[32:35]
    s_add_u32 s72, s72, 4096
    v_exp_f32 v23, v23
    v_mfma_f32_16x16x32_bf16 v[32:35], a[132:135], a[20:23], v[32:35]
    s_addc_u32 s73, s73, 0
    v_cvt_pk_bf16_f32 v37, v22, v23
    v_mul_f32 v24, s20, v24
    v_mfma_f32_16x16x32_bf16 v[32:35], a[128:131], a[16:19], v[32:35]
    s_max_u32 s74, s74, 4096
    v_mul_f32 v25, s20, v25
    v_mul_f32 v26, s20, v26
    v_mfma_f32_16x16x32_bf16 v[220:223], a[144:147], v[52:55], v[220:223]
    s_sub_u32 s74, s74, 4096
    v_exp_f32 v24, v24
    v_mfma_f32_16x16x32_bf16 v[220:223], a[148:151], v[84:87], v[220:223]
    v_exp_f32 v25, v25
    v_mfma_f32_16x16x32_bf16 v[224:227], a[156:159], v[84:87], v[224:227]
    v_mul_f32 v27, s20, v27
    v_cvt_pk_bf16_f32 v38, v24, v25
    v_mfma_f32_16x16x32_bf16 v[224:227], a[152:155], v[52:55], v[224:227]
    v_exp_f32 v26, v26
    v_mfma_f32_16x16x32_bf16 v[228:231], a[160:163], v[52:55], v[228:231]
    s_waitcnt lgkmcnt(0)
    buffer_store_dwordx4 v[12:15], v6, s[76:79], 0 offen nt
    v_exp_f32 v27, v27
    v_mul_f32 v28, s20, v28
    v_cvt_pk_bf16_f32 v39, v26, v27
    v_mfma_f32_16x16x32_bf16 v[228:231], a[164:167], v[84:87], v[228:231]
    s_add_u32 s76, s76, s29
    v_mul_f32 v29, s20, v29
    v_mul_f32 v30, s20, v30
    v_mfma_f32_16x16x32_bf16 v[232:235], a[172:175], v[84:87], v[232:235]
    s_addc_u32 s77, s77, 0
    v_exp_f32 v28, v28
    v_mfma_f32_16x16x32_bf16 v[232:235], a[168:171], v[52:55], v[232:235]
    s_xor_b32 s29, s29, 0x700
    v_exp_f32 v29, v29
    v_mfma_f32_16x16x32_bf16 v[20:23], a[112:115], a[32:35], 0
    v_mul_f32 v31, s20, v31
    v_cvt_pk_bf16_f32 v40, v28, v29
    v_mfma_f32_16x16x32_bf16 v[20:23], a[116:119], a[36:39], v[20:23]
    v_exp_f32 v30, v30
    v_mfma_f32_16x16x32_bf16 v[20:23], a[120:123], a[40:43], v[20:23]
    v_exp_f32 v31, v31
    v_mfma_f32_16x16x32_bf16 v[20:23], a[124:127], a[44:47], v[20:23]
    v_cvt_pk_bf16_f32 v41, v30, v31
    v_mul_f32 v32, s20, v32
    v_mfma_f32_16x16x32_bf16 v[24:27], a[140:143], a[44:47], 0
    buffer_load_dword v0, v10, s[72:75], 0 offen
    v_mul_f32 v33, s20, v33
    v_mfma_f32_16x16x32_bf16 v[24:27], a[136:139], a[40:43], v[24:27]
    s_add_u32 s72, s72, 4096
    v_exp_f32 v32, v32
    v_mfma_f32_16x16x32_bf16 v[24:27], a[132:135], a[36:39], v[24:27]
    s_addc_u32 s73, s73, 0
    v_exp_f32 v33, v33
    v_mfma_f32_16x16x32_bf16 v[24:27], a[128:131], a[32:35], v[24:27]
    s_max_u32 s74, s74, 4096
    v_mul_f32 v34, s20, v34
    v_mul_f32 v35, s20, v35
    v_mfma_f32_16x16x32_bf16 a[192:195], a[144:147], v[56:59], a[192:195]
    s_sub_u32 s74, s74, 4096
    v_exp_f32 v34, v34
    v_mfma_f32_16x16x32_bf16 a[192:195], a[148:151], v[88:91], a[192:195]
    v_exp_f32 v35, v35
    v_mfma_f32_16x16x32_bf16 a[196:199], a[156:159], v[88:91], a[196:199]
    v_cvt_pk_bf16_f32 v42, v32, v33
    v_cvt_pk_bf16_f32 v43, v34, v35
    v_mfma_f32_16x16x32_bf16 a[196:199], a[152:155], v[56:59], a[196:199]
    v_mul_f32 v20, s20, v20
    v_mul_f32 v21, s20, v21
    v_mfma_f32_16x16x32_bf16 a[200:203], a[160:163], v[56:59], a[200:203]
    v_exp_f32 v20, v20
    v_mfma_f32_16x16x32_bf16 a[200:203], a[164:167], v[88:91], a[200:203]
    v_exp_f32 v21, v21
    v_mfma_f32_16x16x32_bf16 a[204:207], a[172:175], v[88:91], a[204:207]
    v_mul_f32 v22, s20, v22
    v_mul_f32 v23, s20, v23
    v_mfma_f32_16x16x32_bf16 a[204:207], a[168:171], v[56:59], a[204:207]
    v_exp_f32 v22, v22
    v_smfmac_f32_16x16x64_bf16 a[184:187], v[16:19], v[52:59], v252
    v_cvt_pk_bf16_f32 v44, v20, v21
    v_smfmac_f32_16x16x64_bf16 a[184:187], v[16:19], v[84:91], v252
    v_mul_f32 v24, s20, v24
    v_mfma_f32_16x16x32_bf16 v[28:31], a[112:115], a[48:51], 0
    v_exp_f32 v23, v23
    v_mfma_f32_16x16x32_bf16 v[28:31], a[116:119], a[52:55], v[28:31]
    v_cvt_pk_bf16_f32 v45, v22, v23
    v_mul_f32 v25, s20, v25
    v_mfma_f32_16x16x32_bf16 v[28:31], a[120:123], a[56:59], v[28:31]
    v_exp_f32 v24, v24
    v_mfma_f32_16x16x32_bf16 v[28:31], a[124:127], a[60:63], v[28:31]
    v_exp_f32 v25, v25
    v_mfma_f32_16x16x32_bf16 v[32:35], a[140:143], a[60:63], 0
    v_mul_f32 v26, s20, v26
    v_mul_f32 v27, s20, v27
    v_mfma_f32_16x16x32_bf16 v[32:35], a[136:139], a[56:59], v[32:35]
    s_waitcnt vmcnt(20) lgkmcnt(0)
    v_exp_f32 v26, v26
    v_mfma_f32_16x16x32_bf16 v[32:35], a[132:135], a[52:55], v[32:35]
    s_barrier
    v_cvt_pk_bf16_f32 v46, v24, v25
    v_mfma_f32_16x16x32_bf16 v[32:35], a[128:131], a[48:51], v[32:35]
    v_exp_f32 v27, v27
    v_mfma_f32_16x16x32_bf16 a[224:227], a[144:147], v[60:63], a[224:227]
    ds_read_b64_tr_b16 a[144:145], v3 offset:2048
    v_cvt_pk_bf16_f32 v47, v26, v27
    v_mfma_f32_16x16x32_bf16 a[224:227], a[148:151], v[64:67], a[224:227]
    ds_read_b64_tr_b16 a[146:147], v3 offset:10240
    v_mul_f32 v28, s20, v28
    v_mfma_f32_16x16x32_bf16 a[228:231], a[156:159], v[64:67], a[228:231]
    ds_read_b64_tr_b16 a[148:149], v3 offset:3072
    v_mul_f32 v29, s20, v29
    v_mfma_f32_16x16x32_bf16 a[228:231], a[152:155], v[60:63], a[228:231]
    ds_read_b64_tr_b16 a[150:151], v3 offset:11264
    v_mul_f32 v30, s20, v30
    v_mfma_f32_16x16x32_bf16 a[232:235], a[160:163], v[60:63], a[232:235]
    ds_read_b64_tr_b16 a[156:157], v3 offset:3080
    v_mul_f32 v31, s20, v31
    v_mfma_f32_16x16x32_bf16 a[232:235], a[164:167], v[64:67], a[232:235]
    ds_read_b64_tr_b16 a[158:159], v3 offset:11272
    v_mul_f32 v32, s20, v32
    v_mfma_f32_16x16x32_bf16 a[236:239], a[172:175], v[64:67], a[236:239]
    ds_read_b64_tr_b16 a[152:153], v3 offset:2056
    v_mul_f32 v33, s20, v33
    v_mfma_f32_16x16x32_bf16 a[236:239], a[168:171], v[60:63], a[236:239]
    ds_read_b64_tr_b16 a[154:155], v3 offset:10248
    v_mul_f32 v34, s20, v34
    v_smfmac_f32_16x16x64_bf16 a[188:191], v[16:19], v[60:67], v252
    ds_read_b64_tr_b16 a[160:161], v4 offset:2048
    v_mfma_f32_16x16x32_bf16 v[20:23], a[112:115], a[64:67], 0
    ds_read_b64_tr_b16 a[162:163], v4 offset:10240
    v_mul_f32 v35, s20, v35
    v_mfma_f32_16x16x32_bf16 v[20:23], a[116:119], a[68:71], v[20:23]
    ds_read_b64_tr_b16 a[164:165], v4 offset:3072
    ds_read_b64_tr_b16 a[166:167], v4 offset:11264
    v_mfma_f32_16x16x32_bf16 v[20:23], a[120:123], a[72:75], v[20:23]
    v_exp_f32 v28, v28
    v_mfma_f32_16x16x32_bf16 v[20:23], a[124:127], a[76:79], v[20:23]
    s_sub_u32 s32, s32, 1
    ds_read_b64_tr_b16 a[172:173], v4 offset:3080
    ds_read_b64_tr_b16 a[174:175], v4 offset:11272
    v_mfma_f32_16x16x32_bf16 v[24:27], a[140:143], a[76:79], 0
    v_exp_f32 v29, v29
    v_mfma_f32_16x16x32_bf16 v[24:27], a[136:139], a[72:75], v[24:27]
    ds_read_b64_tr_b16 a[168:169], v4 offset:2056
    v_cvt_pk_bf16_f32 v48, v28, v29
    v_mfma_f32_16x16x32_bf16 v[24:27], a[132:135], a[68:71], v[24:27]
    ds_read_b64_tr_b16 a[170:171], v4 offset:10248
    v_mul_f32 v20, s20, v20
    v_mfma_f32_16x16x32_bf16 v[24:27], a[128:131], a[64:67], v[24:27]
    s_cbranch_scc0 L_bodyo7
    s_xor_b32 s28, s28, 1
    s_cbranch_scc0 L_last7
    v_min_u32 v254, L_final-L_end_code, v253
    v_mov_b32 v255, 0
    v_lshl_add_u64 v[254:255], v[254:255], 0, s[54:55]
    global_load_dword v0, v[254:255], off
    s_mov_b32 s32, 0
    s_branch L_bodyo7
    s_nop 0
L_last7:
    s_waitcnt lgkmcnt(8)
    v_exp_f32 v30, v30
    v_mfma_f32_16x16x32_bf16 v[108:111], a[144:147], v[68:71], v[108:111]
    v_exp_f32 v31, v31
    v_mfma_f32_16x16x32_bf16 v[108:111], a[148:151], v[36:39], v[108:111]
    v_cvt_pk_bf16_f32 v49, v30, v31
    v_mul_f32 v21, s20, v21
    v_mfma_f32_16x16x32_bf16 v[112:115], a[156:159], v[36:39], v[112:115]
    v_exp_f32 v32, v32
    v_mfma_f32_16x16x32_bf16 v[112:115], a[152:155], v[68:71], v[112:115]
    s_waitcnt lgkmcnt(0)
    v_exp_f32 v33, v33
    v_mfma_f32_16x16x32_bf16 v[116:119], a[160:163], v[68:71], v[116:119]
    v_exp_f32 v34, v34
    v_mfma_f32_16x16x32_bf16 v[116:119], a[164:167], v[36:39], v[116:119]
    v_exp_f32 v35, v35
    v_mfma_f32_16x16x32_bf16 v[120:123], a[172:175], v[36:39], v[120:123]
    v_cvt_pk_bf16_f32 v50, v32, v33
    v_cvt_pk_bf16_f32 v51, v34, v35
    v_mfma_f32_16x16x32_bf16 v[120:123], a[168:171], v[68:71], v[120:123]
    v_exp_f32 v20, v20
    v_mfma_f32_16x16x32_bf16 v[28:31], a[112:115], a[80:83], 0
    v_exp_f32 v21, v21
    v_mfma_f32_16x16x32_bf16 v[28:31], a[116:119], a[84:87], v[28:31]
    v_mul_f32 v22, s20, v22
    v_mul_f32 v23, s20, v23
    v_mfma_f32_16x16x32_bf16 v[28:31], a[120:123], a[88:91], v[28:31]
    v_exp_f32 v22, v22
    v_mfma_f32_16x16x32_bf16 v[28:31], a[124:127], a[92:95], v[28:31]
    v_exp_f32 v23, v23
    v_mfma_f32_16x16x32_bf16 v[32:35], a[140:143], a[92:95], 0
    v_cvt_pk_bf16_f32 v52, v20, v21
    v_cvt_pk_bf16_f32 v53, v22, v23
    v_mfma_f32_16x16x32_bf16 v[32:35], a[136:139], a[88:91], v[32:35]
    v_mul_f32 v24, s20, v24
    v_mul_f32 v25, s20, v25
    v_mfma_f32_16x16x32_bf16 v[32:35], a[132:135], a[84:87], v[32:35]
    v_exp_f32 v24, v24
    v_mfma_f32_16x16x32_bf16 v[32:35], a[128:131], a[80:83], v[32:35]
    v_exp_f32 v25, v25
    v_mfma_f32_16x16x32_bf16 v[140:143], a[144:147], v[72:75], v[140:143]
    v_mul_f32 v26, s20, v26
    v_mul_f32 v27, s20, v27
    v_mfma_f32_16x16x32_bf16 v[140:143], a[148:151], v[40:43], v[140:143]
    v_exp_f32 v26, v26
    v_mfma_f32_16x16x32_bf16 v[144:147], a[156:159], v[40:43], v[144:147]
    v_exp_f32 v27, v27
    v_mfma_f32_16x16x32_bf16 v[144:147], a[152:155], v[72:75], v[144:147]
    v_cvt_pk_bf16_f32 v54, v24, v25
    v_cvt_pk_bf16_f32 v55, v26, v27
    v_mfma_f32_16x16x32_bf16 v[148:151], a[160:163], v[72:75], v[148:151]
    v_mul_f32 v28, s20, v28
    v_mul_f32 v29, s20, v29
    v_mfma_f32_16x16x32_bf16 v[148:151], a[164:167], v[40:43], v[148:151]
    v_exp_f32 v28, v28
    v_mfma_f32_16x16x32_bf16 v[152:155], a[172:175], v[40:43], v[152:155]
    v_exp_f32 v29, v29
    v_mfma_f32_16x16x32_bf16 v[152:155], a[168:171], v[72:75], v[152:155]
    v_mul_f32 v30, s20, v30
    v_mul_f32 v31, s20, v31
    v_mfma_f32_16x16x32_bf16 v[20:23], a[112:115], a[96:99], 0
    ds_read_b128 a[112:115], v1
    v_cvt_pk_bf16_f32 v56, v28, v29
    v_mfma_f32_16x16x32_bf16 v[20:23], a[116:119], a[100:103], v[20:23]
    ds_read_b128 a[116:119], v2
    v_mul_f32 v32, s20, v32
    v_mfma_f32_16x16x32_bf16 v[20:23], a[120:123], a[104:107], v[20:23]
    ds_read_b128 a[120:123], v1 offset:1024
    v_mul_f32 v33, s20, v33
    v_mfma_f32_16x16x32_bf16 v[20:23], a[124:127], a[108:111], v[20:23]
    ds_read_b128 a[124:127], v2 offset:1024
    v_mul_f32 v34, s20, v34
    v_mfma_f32_16x16x32_bf16 v[24:27], a[140:143], a[108:111], 0
    ds_read_b128 a[140:143], v2 offset:9216
    v_mul_f32 v35, s20, v35
    v_mfma_f32_16x16x32_bf16 v[24:27], a[136:139], a[104:107], v[24:27]
    ds_read_b128 a[136:139], v1 offset:9216
    v_mfma_f32_16x16x32_bf16 v[24:27], a[132:135], a[100:103], v[24:27]
    ds_read_b128 a[132:135], v2 offset:8192
    v_mul_f32 v20, s20, v20
    v_mfma_f32_16x16x32_bf16 v[24:27], a[128:131], a[96:99], v[24:27]
    ds_read_b128 a[128:131], v1 offset:8192
    v_mul_f32 v21, s20, v21
    v_mfma_f32_16x16x32_bf16 v[172:175], a[144:147], v[76:79], v[172:175]
    v_exp_f32 v30, v30
    v_mfma_f32_16x16x32_bf16 v[172:175], a[148:151], v[44:47], v[172:175]
    v_exp_f32 v31, v31
    v_mfma_f32_16x16x32_bf16 v[176:179], a[156:159], v[44:47], v[176:179]
    v_cvt_pk_bf16_f32 v57, v30, v31
    v_mul_f32 v22, s20, v22
    v_mfma_f32_16x16x32_bf16 v[176:179], a[152:155], v[76:79], v[176:179]
    v_exp_f32 v32, v32
    v_mfma_f32_16x16x32_bf16 v[180:183], a[160:163], v[76:79], v[180:183]
    v_exp_f32 v33, v33
    v_mfma_f32_16x16x32_bf16 v[180:183], a[164:167], v[44:47], v[180:183]
    v_exp_f32 v34, v34
    v_mfma_f32_16x16x32_bf16 v[184:187], a[172:175], v[44:47], v[184:187]
    v_exp_f32 v35, v35
    v_mfma_f32_16x16x32_bf16 v[184:187], a[168:171], v[76:79], v[184:187]
    s_waitcnt lgkmcnt(4)
    v_cvt_pk_bf16_f32 v58, v32, v33
    v_cvt_pk_bf16_f32 v59, v34, v35
    v_mfma_f32_16x16x32_bf16 v[28:31], a[112:115], a[0:3], 0
    v_exp_f32 v20, v20
    v_mfma_f32_16x16x32_bf16 v[28:31], a[116:119], a[4:7], v[28:31]
    v_exp_f32 v21, v21
    v_mfma_f32_16x16x32_bf16 v[28:31], a[120:123], a[8:11], v[28:31]
    v_mul_f32 v23, s20, v23
    v_cvt_pk_bf16_f32 v60, v20, v21
    v_mfma_f32_16x16x32_bf16 v[28:31], a[124:127], a[12:15], v[28:31]
    s_waitcnt lgkmcnt(0)
    v_exp_f32 v22, v22
    v_mfma_f32_16x16x32_bf16 v[32:35], a[140:143], a[12:15], 0
    s_waitcnt vmcnt(10)
    v_exp_f32 v23, v23
    v_mfma_f32_16x16x32_bf16 v[32:35], a[136:139], a[8:11], v[32:35]
    s_barrier
    v_cvt_pk_bf16_f32 v61, v22, v23
    v_mfma_f32_16x16x32_bf16 v[32:35], a[132:135], a[4:7], v[32:35]
    v_mul_f32 v24, s20, v24
    v_mul_f32 v25, s20, v25
    v_mfma_f32_16x16x32_bf16 v[32:35], a[128:131], a[0:3], v[32:35]
    ds_read_b64_tr_b16 a[0:1], v3 offset:18432
    ds_read_b64_tr_b16 a[2:3], v3 offset:26624
    v_mfma_f32_16x16x32_bf16 v[20:23], a[112:115], a[16:19], 0
    ds_read_b64_tr_b16 a[4:5], v3 offset:19456
    ds_read_b64_tr_b16 a[6:7], v3 offset:27648
    v_mfma_f32_16x16x32_bf16 v[20:23], a[116:119], a[20:23], v[20:23]
    ds_read_b64_tr_b16 a[12:13], v3 offset:19464
    ds_read_b64_tr_b16 a[14:15], v3 offset:27656
    v_mfma_f32_16x16x32_bf16 v[20:23], a[120:123], a[24:27], v[20:23]
    ds_read_b64_tr_b16 a[8:9], v3 offset:18440
    v_mul_f32 v26, s20, v26
    v_mfma_f32_16x16x32_bf16 v[20:23], a[124:127], a[28:31], v[20:23]
    ds_read_b64_tr_b16 a[10:11], v3 offset:26632
    v_xor_b32 v3, 0x8000, v3
    v_exp_f32 v24, v24
    v_exp_f32 v25, v25
    v_mul_f32 v27, s20, v27
    v_exp_f32 v26, v26
    v_exp_f32 v27, v27
    v_cvt_pk_bf16_f32 v62, v24, v25
    v_cvt_pk_bf16_f32 v63, v26, v27
    v_mfma_f32_16x16x32_bf16 v[24:27], a[140:143], a[28:31], 0
    v_mul_f32 v28, s20, v28
    v_mul_f32 v29, s20, v29
    v_mfma_f32_16x16x32_bf16 v[24:27], a[136:139], a[24:27], v[24:27]
    v_exp_f32 v28, v28
    v_mfma_f32_16x16x32_bf16 v[24:27], a[132:135], a[20:23], v[24:27]
    v_exp_f32 v29, v29
    v_mfma_f32_16x16x32_bf16 v[24:27], a[128:131], a[16:19], v[24:27]
    ds_read_b64_tr_b16 a[16:17], v4 offset:18432
    v_mul_f32 v30, s20, v30
    v_mul_f32 v31, s20, v31
    v_exp_f32 v30, v30
    v_exp_f32 v31, v31
    v_cvt_pk_bf16_f32 v68, v28, v29
    v_cvt_pk_bf16_f32 v69, v30, v31
    v_mfma_f32_16x16x32_bf16 v[28:31], a[112:115], a[32:35], 0
    ds_read_b64_tr_b16 a[18:19], v4 offset:26624
    v_mul_f32 v32, s20, v32
    v_mfma_f32_16x16x32_bf16 v[28:31], a[116:119], a[36:39], v[28:31]
    ds_read_b64_tr_b16 a[20:21], v4 offset:19456
    v_mul_f32 v33, s20, v33
    v_mfma_f32_16x16x32_bf16 v[28:31], a[120:123], a[40:43], v[28:31]
    ds_read_b64_tr_b16 a[22:23], v4 offset:27648
    v_mul_f32 v34, s20, v34
    v_mfma_f32_16x16x32_bf16 v[28:31], a[124:127], a[44:47], v[28:31]
    ds_read_b64_tr_b16 a[28:29], v4 offset:19464
    v_mul_f32 v35, s20, v35
    v_exp_f32 v32, v32
    v_exp_f32 v33, v33
    v_exp_f32 v34, v34
    v_exp_f32 v35, v35
    v_cvt_pk_bf16_f32 v70, v32, v33
    v_cvt_pk_bf16_f32 v71, v34, v35
    v_mfma_f32_16x16x32_bf16 v[32:35], a[140:143], a[44:47], 0
    s_waitcnt vmcnt(6)
    ds_read_b64_tr_b16 a[30:31], v4 offset:27656
    v_mul_f32 v20, s20, v20
    v_mfma_f32_16x16x32_bf16 v[32:35], a[136:139], a[40:43], v[32:35]
    s_add_u32 s39, s33, 0
    ds_read_b64_tr_b16 a[24:25], v4 offset:18440
    v_mul_f32 v21, s20, v21
    v_mfma_f32_16x16x32_bf16 v[32:35], a[132:135], a[36:39], v[32:35]
    s_add_u32 s40, s33, 4096
    ds_read_b64_tr_b16 a[26:27], v4 offset:26632
    v_xor_b32 v4, 0x8000, v4
    v_mfma_f32_16x16x32_bf16 v[32:35], a[128:131], a[32:35], v[32:35]
    s_waitcnt lgkmcnt(8)
    v_exp_f32 v20, v20
    v_exp_f32 v21, v21
    v_mul_f32 v22, s20, v22
    v_mul_f32 v23, s20, v23
    v_exp_f32 v22, v22
    v_exp_f32 v23, v23
    v_mfma_f32_16x16x32_bf16 v[92:95], a[0:3], v[36:39], v[92:95]
    s_barrier
    v_cvt_pk_bf16_f32 v72, v20, v21
    v_mfma_f32_16x16x32_bf16 v[92:95], a[4:7], v[68:71], v[92:95]
    s_add_u32 s41, s33, 8192
    ds_read_b64_tr_b16 a[32:33], v3 offset:2048
    v_cvt_pk_bf16_f32 v73, v22, v23
    v_mfma_f32_16x16x32_bf16 v[96:99], a[12:15], v[68:71], v[96:99]
    s_add_u32 s42, s33, 12288
    ds_read_b64_tr_b16 a[34:35], v3 offset:10240
    v_mul_f32 v24, s20, v24
    v_mfma_f32_16x16x32_bf16 v[96:99], a[8:11], v[36:39], v[96:99]
    s_waitcnt lgkmcnt(2)
    ds_read_b64_tr_b16 a[36:37], v3 offset:2056
    v_mul_f32 v25, s20, v25
    v_mfma_f32_16x16x32_bf16 v[100:103], a[16:19], v[36:39], v[100:103]
    s_add_u32 s24, s33, 16384
    ds_read_b64_tr_b16 a[38:39], v3 offset:10248
    v_mul_f32 v26, s20, v26
    v_mfma_f32_16x16x32_bf16 v[100:103], a[20:23], v[68:71], v[100:103]
    s_add_u32 s25, s33, 20480
    ds_read_b64_tr_b16 a[40:41], v4 offset:2048
    v_mul_f32 v27, s20, v27
    v_mfma_f32_16x16x32_bf16 v[104:107], a[28:31], v[68:71], v[104:107]
    s_add_u32 s26, s33, 24576
    ds_read_b64_tr_b16 a[42:43], v4 offset:10240
    v_mul_f32 v28, s20, v28
    v_mfma_f32_16x16x32_bf16 v[104:107], a[24:27], v[36:39], v[104:107]
    ds_read_b64_tr_b16 a[44:45], v4 offset:2056
    ds_read_b64_tr_b16 a[46:47], v4 offset:10248
    v_mfma_f32_16x16x32_bf16 v[124:127], a[0:3], v[40:43], v[124:127]
    v_exp_f32 v24, v24
    v_exp_f32 v25, v25
    s_nop 0
    v_cvt_pk_bf16_f32 v74, v24, v25
    v_exp_f32 v26, v26
    v_exp_f32 v27, v27
    s_nop 0
    v_cvt_pk_bf16_f32 v75, v26, v27
    s_nop 1
    v_mfma_f32_16x16x32_bf16 v[124:127], a[4:7], v[72:75], v[124:127]
    v_mul_f32 v29, s20, v29
    v_mul_f32 v30, s20, v30
    v_mfma_f32_16x16x32_bf16 v[128:131], a[12:15], v[72:75], v[128:131]
    v_exp_f32 v28, v28
    v_mfma_f32_16x16x32_bf16 v[128:131], a[8:11], v[40:43], v[128:131]
    v_exp_f32 v29, v29
    v_mfma_f32_16x16x32_bf16 v[132:135], a[16:19], v[40:43], v[132:135]
    v_mul_f32 v31, s20, v31
    v_cvt_pk_bf16_f32 v76, v28, v29
    v_mfma_f32_16x16x32_bf16 v[132:135], a[20:23], v[72:75], v[132:135]
    v_exp_f32 v30, v30
    v_mfma_f32_16x16x32_bf16 v[136:139], a[28:31], v[72:75], v[136:139]
    v_exp_f32 v31, v31
    v_mfma_f32_16x16x32_bf16 v[136:139], a[24:27], v[40:43], v[136:139]
    v_cvt_pk_bf16_f32 v77, v30, v31
    v_mul_f32 v32, s20, v32
    v_smfmac_f32_16x16x64_bf16 a[176:179], v[16:19], v[36:43], v252
    v_mul_f32 v33, s20, v33
    v_smfmac_f32_16x16x64_bf16 a[176:179], v[16:19], v[68:75], v252
    s_waitcnt lgkmcnt(0)
    v_mul_f32 v34, s20, v34
    v_mfma_f32_16x16x32_bf16 v[108:111], a[32:35], v[68:71], v[108:111]
    v_exp_f32 v32, v32
    v_mfma_f32_16x16x32_bf16 v[112:115], a[36:39], v[68:71], v[112:115]
    v_exp_f32 v33, v33
    v_mfma_f32_16x16x32_bf16 v[116:119], a[40:43], v[68:71], v[116:119]
    v_mul_f32 v35, s20, v35
    v_cvt_pk_bf16_f32 v78, v32, v33
    v_mfma_f32_16x16x32_bf16 v[120:123], a[44:47], v[68:71], v[120:123]
    v_exp_f32 v34, v34
    v_mfma_f32_16x16x32_bf16 v[140:143], a[32:35], v[72:75], v[140:143]
    v_exp_f32 v35, v35
    v_mfma_f32_16x16x32_bf16 v[144:147], a[36:39], v[72:75], v[144:147]
    v_cvt_pk_bf16_f32 v79, v34, v35
    v_add_u32 v7, 0xffffa000, v7
    v_mfma_f32_16x16x32_bf16 v[148:151], a[40:43], v[72:75], v[148:151]
    v_accvgpr_read_b32 v38, a176
    v_accvgpr_read_b32 v36, a177
    v_mfma_f32_16x16x32_bf16 v[152:155], a[44:47], v[72:75], v[152:155]
    v_add_f32 v38, v38, v36
    v_accvgpr_read_b32 v42, a178
    v_rcp_f32 v36, v38
    s_nop 0
    v_maximum3_f32 v12, v36, v36, v38
    v_accvgpr_read_b32 v40, a179
    v_add_f32 v42, v42, v40
    v_rcp_f32 v40, v42
    s_nop 0
    v_maximum3_f32 v12, v12, v40, v42
.p2align 3
    v_pk_mul_f32 v[92:93], v[92:93], v[36:37] op_sel_hi:[1,0]
    v_pk_mul_f32 v[94:95], v[94:95], v[36:37] op_sel_hi:[1,0]
    v_pk_mul_f32 v[96:97], v[96:97], v[36:37] op_sel_hi:[1,0]
    v_pk_mul_f32 v[98:99], v[98:99], v[36:37] op_sel_hi:[1,0]
    v_cvt_pk_bf16_f32 v92, v92, v93
    v_cvt_pk_bf16_f32 v93, v94, v95
    v_cvt_pk_bf16_f32 v94, v96, v97
    v_cvt_pk_bf16_f32 v95, v98, v99
    v_pk_mul_f32 v[100:101], v[100:101], v[36:37] op_sel_hi:[1,0]
    v_pk_mul_f32 v[102:103], v[102:103], v[36:37] op_sel_hi:[1,0]
    v_pk_mul_f32 v[104:105], v[104:105], v[36:37] op_sel_hi:[1,0]
    v_pk_mul_f32 v[106:107], v[106:107], v[36:37] op_sel_hi:[1,0]
    v_cvt_pk_bf16_f32 v100, v100, v101
    v_cvt_pk_bf16_f32 v101, v102, v103
    v_cvt_pk_bf16_f32 v102, v104, v105
    v_cvt_pk_bf16_f32 v103, v106, v107
    v_pk_mul_f32 v[108:109], v[108:109], v[36:37] op_sel_hi:[1,0]
    v_pk_mul_f32 v[110:111], v[110:111], v[36:37] op_sel_hi:[1,0]
    v_pk_mul_f32 v[112:113], v[112:113], v[36:37] op_sel_hi:[1,0]
    v_pk_mul_f32 v[114:115], v[114:115], v[36:37] op_sel_hi:[1,0]
    v_pk_mul_f32 v[116:117], v[116:117], v[36:37] op_sel_hi:[1,0]
    v_pk_mul_f32 v[118:119], v[118:119], v[36:37] op_sel_hi:[1,0]
    v_pk_mul_f32 v[120:121], v[120:121], v[36:37] op_sel_hi:[1,0]
    v_pk_mul_f32 v[122:123], v[122:123], v[36:37] op_sel_hi:[1,0]
    v_pk_mul_f32 v[124:125], v[124:125], v[40:41] op_sel_hi:[1,0]
    v_pk_mul_f32 v[126:127], v[126:127], v[40:41] op_sel_hi:[1,0]
    v_pk_mul_f32 v[128:129], v[128:129], v[40:41] op_sel_hi:[1,0]
    v_pk_mul_f32 v[130:131], v[130:131], v[40:41] op_sel_hi:[1,0]
    v_pk_mul_f32 v[132:133], v[132:133], v[40:41] op_sel_hi:[1,0]
    v_pk_mul_f32 v[134:135], v[134:135], v[40:41] op_sel_hi:[1,0]
    v_pk_mul_f32 v[136:137], v[136:137], v[40:41] op_sel_hi:[1,0]
    v_pk_mul_f32 v[138:139], v[138:139], v[40:41] op_sel_hi:[1,0]
    v_pk_mul_f32 v[140:141], v[140:141], v[40:41] op_sel_hi:[1,0]
    v_pk_mul_f32 v[142:143], v[142:143], v[40:41] op_sel_hi:[1,0]
    v_pk_mul_f32 v[144:145], v[144:145], v[40:41] op_sel_hi:[1,0]
    v_pk_mul_f32 v[146:147], v[146:147], v[40:41] op_sel_hi:[1,0]
    v_pk_mul_f32 v[148:149], v[148:149], v[40:41] op_sel_hi:[1,0]
    v_pk_mul_f32 v[150:151], v[150:151], v[40:41] op_sel_hi:[1,0]
    v_pk_mul_f32 v[152:153], v[152:153], v[40:41] op_sel_hi:[1,0]
    v_pk_mul_f32 v[154:155], v[154:155], v[40:41] op_sel_hi:[1,0]
    v_mfma_f32_16x16x32_bf16 v[204:207], a[144:147], v[80:83], v[204:207]
    ds_write_b128 v8, v[92:95]
    v_mfma_f32_16x16x32_bf16 v[204:207], a[148:151], v[48:51], v[204:207]
    v_cvt_pk_bf16_f32 v108, v108, v109
    v_cvt_pk_bf16_f32 v109, v110, v111
    v_mfma_f32_16x16x32_bf16 v[208:211], a[156:159], v[48:51], v[208:211]
    v_cvt_pk_bf16_f32 v110, v112, v113
    v_cvt_pk_bf16_f32 v111, v114, v115
    v_mfma_f32_16x16x32_bf16 v[208:211], a[152:155], v[80:83], v[208:211]
    ds_write_b128 v9, v[100:103]
    v_mfma_f32_16x16x32_bf16 v[212:215], a[160:163], v[80:83], v[212:215]
    v_cvt_pk_bf16_f32 v116, v116, v117
    v_cvt_pk_bf16_f32 v117, v118, v119
    v_mfma_f32_16x16x32_bf16 v[212:215], a[164:167], v[48:51], v[212:215]
    v_cvt_pk_bf16_f32 v118, v120, v121
    v_cvt_pk_bf16_f32 v119, v122, v123
    v_mfma_f32_16x16x32_bf16 v[216:219], a[172:175], v[48:51], v[216:219]
    ds_read_b128 v[96:99], v7
    v_cvt_pk_bf16_f32 v124, v124, v125
    v_mfma_f32_16x16x32_bf16 v[216:219], a[168:171], v[80:83], v[216:219]
    ds_read_b128 v[104:107], v7 offset:2048
    v_cvt_pk_bf16_f32 v125, v126, v127
    v_mfma_f32_16x16x32_bf16 v[20:23], a[112:115], a[48:51], 0
    ds_write_b128 v8, v[108:111] offset:1024
    v_mfma_f32_16x16x32_bf16 v[20:23], a[116:119], a[52:55], v[20:23]
    v_cvt_pk_bf16_f32 v126, v128, v129
    v_cvt_pk_bf16_f32 v127, v130, v131
    v_mfma_f32_16x16x32_bf16 v[20:23], a[120:123], a[56:59], v[20:23]
    v_cvt_pk_bf16_f32 v132, v132, v133
    v_cvt_pk_bf16_f32 v133, v134, v135
    v_mfma_f32_16x16x32_bf16 v[20:23], a[124:127], a[60:63], v[20:23]
    ds_write_b128 v9, v[116:119] offset:1024
    v_mfma_f32_16x16x32_bf16 v[24:27], a[140:143], a[60:63], 0
    s_waitcnt lgkmcnt(3)
    buffer_store_dwordx4 v[96:99], v6, s[16:19], s39 offen nt
    v_cvt_pk_bf16_f32 v134, v136, v137
    v_cvt_pk_bf16_f32 v135, v138, v139
    v_cvt_pk_bf16_f32 v140, v140, v141
    v_cvt_pk_bf16_f32 v141, v142, v143
    v_mfma_f32_16x16x32_bf16 v[24:27], a[136:139], a[56:59], v[24:27]
    v_cvt_pk_bf16_f32 v142, v144, v145
    v_cvt_pk_bf16_f32 v143, v146, v147
    v_mfma_f32_16x16x32_bf16 v[24:27], a[132:135], a[52:55], v[24:27]
    s_waitcnt lgkmcnt(2)
    buffer_store_dwordx4 v[104:107], v6, s[16:19], s39 offen offset:2048 nt
    v_cvt_pk_bf16_f32 v148, v148, v149
    v_cvt_pk_bf16_f32 v149, v150, v151
    v_cvt_pk_bf16_f32 v150, v152, v153
    v_cvt_pk_bf16_f32 v151, v154, v155
    v_mfma_f32_16x16x32_bf16 v[24:27], a[128:131], a[48:51], v[24:27]
    ds_read_b128 v[112:115], v7 offset:1024
    v_mul_f32 v20, s20, v20
    v_mfma_f32_16x16x32_bf16 v[156:159], a[0:3], v[44:47], v[156:159]
    ds_read_b128 v[120:123], v7 offset:3072
    v_mul_f32 v21, s20, v21
    v_mfma_f32_16x16x32_bf16 v[156:159], a[4:7], v[76:79], v[156:159]
    ds_write_b128 v8, v[124:127] offset:4096
    v_mfma_f32_16x16x32_bf16 v[160:163], a[12:15], v[76:79], v[160:163]
    v_exp_f32 v20, v20
    v_mfma_f32_16x16x32_bf16 v[160:163], a[8:11], v[44:47], v[160:163]
    ds_write_b128 v9, v[132:135] offset:4096
    v_mfma_f32_16x16x32_bf16 v[164:167], a[16:19], v[44:47], v[164:167]
    s_waitcnt lgkmcnt(3)
    buffer_store_dwordx4 v[112:115], v6, s[16:19], s39 offen offset:128 nt
    v_exp_f32 v21, v21
    v_mul_f32 v22, s20, v22
    v_mul_f32 v23, s20, v23
    v_mfma_f32_16x16x32_bf16 v[164:167], a[20:23], v[76:79], v[164:167]
    v_exp_f32 v22, v22
    v_mfma_f32_16x16x32_bf16 v[168:171], a[28:31], v[76:79], v[168:171]
    s_waitcnt lgkmcnt(2)
    buffer_store_dwordx4 v[120:123], v6, s[16:19], s39 offen offset:2176 nt
    v_exp_f32 v23, v23
    v_cvt_pk_bf16_f32 v80, v20, v21
    v_cvt_pk_bf16_f32 v81, v22, v23
    v_mfma_f32_16x16x32_bf16 v[168:171], a[24:27], v[44:47], v[168:171]
    ds_read_b128 v[128:131], v7 offset:4096
    v_mul_f32 v24, s20, v24
    v_mfma_f32_16x16x32_bf16 v[188:191], a[0:3], v[48:51], v[188:191]
    ds_read_b128 v[136:139], v7 offset:6144
    v_mul_f32 v25, s20, v25
    v_exp_f32 v24, v24
    v_exp_f32 v25, v25
    s_nop 0
    v_cvt_pk_bf16_f32 v82, v24, v25
    v_mul_f32 v26, s20, v26
    v_exp_f32 v26, v26
    v_mul_f32 v27, s20, v27
    v_exp_f32 v27, v27
    s_nop 0
    v_cvt_pk_bf16_f32 v83, v26, v27
    s_nop 1
    v_mfma_f32_16x16x32_bf16 v[188:191], a[4:7], v[80:83], v[188:191]
    ds_write_b128 v8, v[140:143] offset:5120
    v_mfma_f32_16x16x32_bf16 v[192:195], a[12:15], v[80:83], v[192:195]
    v_mfma_f32_16x16x32_bf16 v[192:195], a[8:11], v[48:51], v[192:195]
    ds_write_b128 v9, v[148:151] offset:5120
    v_mfma_f32_16x16x32_bf16 v[196:199], a[16:19], v[48:51], v[196:199]
    s_waitcnt lgkmcnt(3)
    buffer_store_dwordx4 v[128:131], v6, s[16:19], s40 offen nt
    v_mfma_f32_16x16x32_bf16 v[196:199], a[20:23], v[80:83], v[196:199]
    v_mfma_f32_16x16x32_bf16 v[200:203], a[28:31], v[80:83], v[200:203]
    s_waitcnt lgkmcnt(2)
    buffer_store_dwordx4 v[136:139], v6, s[16:19], s40 offen offset:2048 nt
    v_mfma_f32_16x16x32_bf16 v[200:203], a[24:27], v[48:51], v[200:203]
    ds_read_b128 v[144:147], v7 offset:5120
    v_smfmac_f32_16x16x64_bf16 a[180:183], v[16:19], v[44:51], v252
    ds_read_b128 v[152:155], v7 offset:7168
    v_smfmac_f32_16x16x64_bf16 a[180:183], v[16:19], v[76:83], v252
    s_nop 2
    v_mfma_f32_16x16x32_bf16 v[172:175], a[32:35], v[76:79], v[172:175]
    s_nop 2
    v_mfma_f32_16x16x32_bf16 v[176:179], a[36:39], v[76:79], v[176:179]
    v_accvgpr_read_b32 v46, a180
    v_accvgpr_read_b32 v44, a181
    v_mfma_f32_16x16x32_bf16 v[180:183], a[40:43], v[76:79], v[180:183]
    s_waitcnt lgkmcnt(1)
    buffer_store_dwordx4 v[144:147], v6, s[16:19], s40 offen offset:128 nt
    v_add_f32 v46, v46, v44
    v_rcp_f32 v44, v46
    v_accvgpr_read_b32 v50, a182
    v_mfma_f32_16x16x32_bf16 v[184:187], a[44:47], v[76:79], v[184:187]
    v_maximum3_f32 v12, v12, v44, v46
    v_accvgpr_read_b32 v48, a183
    v_mfma_f32_16x16x32_bf16 v[204:207], a[32:35], v[80:83], v[204:207]
    s_waitcnt lgkmcnt(0)
    buffer_store_dwordx4 v[152:155], v6, s[16:19], s40 offen offset:2176 nt
    v_add_f32 v50, v50, v48
    v_rcp_f32 v48, v50
    v_mfma_f32_16x16x32_bf16 v[208:211], a[36:39], v[80:83], v[208:211]
    v_maximum3_f32 v12, v12, v48, v50
    v_mfma_f32_16x16x32_bf16 v[212:215], a[40:43], v[80:83], v[212:215]
    v_mfma_f32_16x16x32_bf16 v[216:219], a[44:47], v[80:83], v[216:219]
.p2align 3
    v_pk_mul_f32 v[156:157], v[156:157], v[44:45] op_sel_hi:[1,0]
    v_pk_mul_f32 v[158:159], v[158:159], v[44:45] op_sel_hi:[1,0]
    v_pk_mul_f32 v[160:161], v[160:161], v[44:45] op_sel_hi:[1,0]
    v_pk_mul_f32 v[162:163], v[162:163], v[44:45] op_sel_hi:[1,0]
    v_cvt_pk_bf16_f32 v156, v156, v157
    v_cvt_pk_bf16_f32 v157, v158, v159
    v_cvt_pk_bf16_f32 v158, v160, v161
    v_cvt_pk_bf16_f32 v159, v162, v163
    v_pk_mul_f32 v[164:165], v[164:165], v[44:45] op_sel_hi:[1,0]
    v_pk_mul_f32 v[166:167], v[166:167], v[44:45] op_sel_hi:[1,0]
    v_pk_mul_f32 v[168:169], v[168:169], v[44:45] op_sel_hi:[1,0]
    v_pk_mul_f32 v[170:171], v[170:171], v[44:45] op_sel_hi:[1,0]
    v_cvt_pk_bf16_f32 v164, v164, v165
    v_cvt_pk_bf16_f32 v165, v166, v167
    v_cvt_pk_bf16_f32 v166, v168, v169
    v_cvt_pk_bf16_f32 v167, v170, v171
    v_pk_mul_f32 v[172:173], v[172:173], v[44:45] op_sel_hi:[1,0]
    v_pk_mul_f32 v[174:175], v[174:175], v[44:45] op_sel_hi:[1,0]
    v_pk_mul_f32 v[176:177], v[176:177], v[44:45] op_sel_hi:[1,0]
    v_pk_mul_f32 v[178:179], v[178:179], v[44:45] op_sel_hi:[1,0]
    v_pk_mul_f32 v[180:181], v[180:181], v[44:45] op_sel_hi:[1,0]
    v_pk_mul_f32 v[182:183], v[182:183], v[44:45] op_sel_hi:[1,0]
    v_pk_mul_f32 v[184:185], v[184:185], v[44:45] op_sel_hi:[1,0]
    v_pk_mul_f32 v[186:187], v[186:187], v[44:45] op_sel_hi:[1,0]
    v_pk_mul_f32 v[188:189], v[188:189], v[48:49] op_sel_hi:[1,0]
    v_pk_mul_f32 v[190:191], v[190:191], v[48:49] op_sel_hi:[1,0]
    v_pk_mul_f32 v[192:193], v[192:193], v[48:49] op_sel_hi:[1,0]
    v_pk_mul_f32 v[194:195], v[194:195], v[48:49] op_sel_hi:[1,0]
    v_pk_mul_f32 v[196:197], v[196:197], v[48:49] op_sel_hi:[1,0]
    v_pk_mul_f32 v[198:199], v[198:199], v[48:49] op_sel_hi:[1,0]
    v_pk_mul_f32 v[200:201], v[200:201], v[48:49] op_sel_hi:[1,0]
    v_pk_mul_f32 v[202:203], v[202:203], v[48:49] op_sel_hi:[1,0]
    v_pk_mul_f32 v[204:205], v[204:205], v[48:49] op_sel_hi:[1,0]
    v_pk_mul_f32 v[206:207], v[206:207], v[48:49] op_sel_hi:[1,0]
    v_pk_mul_f32 v[208:209], v[208:209], v[48:49] op_sel_hi:[1,0]
    v_pk_mul_f32 v[210:211], v[210:211], v[48:49] op_sel_hi:[1,0]
    v_pk_mul_f32 v[212:213], v[212:213], v[48:49] op_sel_hi:[1,0]
    v_pk_mul_f32 v[214:215], v[214:215], v[48:49] op_sel_hi:[1,0]
    v_pk_mul_f32 v[216:217], v[216:217], v[48:49] op_sel_hi:[1,0]
    v_pk_mul_f32 v[218:219], v[218:219], v[48:49] op_sel_hi:[1,0]
    v_mfma_f32_16x16x32_bf16 v[236:239], a[144:147], v[84:87], v[236:239]
    ds_write_b128 v8, v[156:159] offset:8192
    v_mfma_f32_16x16x32_bf16 v[236:239], a[148:151], v[52:55], v[236:239]
    v_cvt_pk_bf16_f32 v172, v172, v173
    v_cvt_pk_bf16_f32 v173, v174, v175
    v_mfma_f32_16x16x32_bf16 v[240:243], a[156:159], v[52:55], v[240:243]
    v_cvt_pk_bf16_f32 v174, v176, v177
    v_cvt_pk_bf16_f32 v175, v178, v179
    v_mfma_f32_16x16x32_bf16 v[240:243], a[152:155], v[84:87], v[240:243]
    ds_write_b128 v9, v[164:167] offset:8192
    v_mfma_f32_16x16x32_bf16 v[244:247], a[160:163], v[84:87], v[244:247]
    v_cvt_pk_bf16_f32 v180, v180, v181
    v_cvt_pk_bf16_f32 v181, v182, v183
    v_mfma_f32_16x16x32_bf16 v[244:247], a[164:167], v[52:55], v[244:247]
    v_cvt_pk_bf16_f32 v182, v184, v185
    v_cvt_pk_bf16_f32 v183, v186, v187
    v_mfma_f32_16x16x32_bf16 v[248:251], a[172:175], v[52:55], v[248:251]
    ds_read_b128 v[160:163], v7 offset:8192
    v_cvt_pk_bf16_f32 v188, v188, v189
    v_mfma_f32_16x16x32_bf16 v[248:251], a[168:171], v[84:87], v[248:251]
    ds_read_b128 v[168:171], v7 offset:10240
    v_cvt_pk_bf16_f32 v189, v190, v191
    v_mfma_f32_16x16x32_bf16 v[28:31], a[112:115], a[64:67], 0
    v_cvt_pk_bf16_f32 v190, v192, v193
    v_cvt_pk_bf16_f32 v191, v194, v195
    v_mfma_f32_16x16x32_bf16 v[28:31], a[116:119], a[68:71], v[28:31]
    v_cvt_pk_bf16_f32 v196, v196, v197
    v_cvt_pk_bf16_f32 v197, v198, v199
    v_mfma_f32_16x16x32_bf16 v[28:31], a[120:123], a[72:75], v[28:31]
    v_cvt_pk_bf16_f32 v198, v200, v201
    v_cvt_pk_bf16_f32 v199, v202, v203
    v_mfma_f32_16x16x32_bf16 v[28:31], a[124:127], a[76:79], v[28:31]
    v_cvt_pk_bf16_f32 v204, v204, v205
    v_cvt_pk_bf16_f32 v205, v206, v207
    v_mfma_f32_16x16x32_bf16 v[32:35], a[140:143], a[76:79], 0
    s_waitcnt lgkmcnt(1)
    buffer_store_dwordx4 v[160:163], v6, s[16:19], s41 offen nt
    v_cvt_pk_bf16_f32 v206, v208, v209
    v_cvt_pk_bf16_f32 v207, v210, v211
    v_cvt_pk_bf16_f32 v212, v212, v213
    v_cvt_pk_bf16_f32 v213, v214, v215
    v_mfma_f32_16x16x32_bf16 v[32:35], a[136:139], a[72:75], v[32:35]
    ds_write_b128 v8, v[172:175] offset:9216
    v_mfma_f32_16x16x32_bf16 v[32:35], a[132:135], a[68:71], v[32:35]
    s_waitcnt lgkmcnt(1)
    buffer_store_dwordx4 v[168:171], v6, s[16:19], s41 offen offset:2048 nt
    v_cvt_pk_bf16_f32 v214, v216, v217
    v_cvt_pk_bf16_f32 v215, v218, v219
    v_mul_f32 v28, s20, v28
    v_mul_f32 v29, s20, v29
    v_mfma_f32_16x16x32_bf16 v[32:35], a[128:131], a[64:67], v[32:35]
    ds_write_b128 v9, v[180:183] offset:9216
    v_mfma_f32_16x16x32_bf16 a[208:211], a[144:147], v[88:91], a[208:211]
    v_exp_f32 v28, v28
    v_mfma_f32_16x16x32_bf16 a[208:211], a[148:151], v[56:59], a[208:211]
    v_exp_f32 v29, v29
    v_mfma_f32_16x16x32_bf16 a[212:215], a[156:159], v[56:59], a[212:215]
    ds_read_b128 v[176:179], v7 offset:9216
    v_mul_f32 v30, s20, v30
    v_mfma_f32_16x16x32_bf16 a[212:215], a[152:155], v[88:91], a[212:215]
    ds_read_b128 v[184:187], v7 offset:11264
    v_mul_f32 v31, s20, v31
    v_mfma_f32_16x16x32_bf16 a[216:219], a[160:163], v[88:91], a[216:219]
    v_exp_f32 v30, v30
    v_mfma_f32_16x16x32_bf16 a[216:219], a[164:167], v[56:59], a[216:219]
    v_exp_f32 v31, v31
    v_mfma_f32_16x16x32_bf16 a[220:223], a[172:175], v[56:59], a[220:223]
    v_cvt_pk_bf16_f32 v84, v28, v29
    v_cvt_pk_bf16_f32 v85, v30, v31
    v_mfma_f32_16x16x32_bf16 a[220:223], a[168:171], v[88:91], a[220:223]
    v_mul_f32 v32, s20, v32
    v_mul_f32 v33, s20, v33
    v_mfma_f32_16x16x32_bf16 v[20:23], a[112:115], a[80:83], 0
    s_waitcnt lgkmcnt(1)
    buffer_store_dwordx4 v[176:179], v6, s[16:19], s41 offen offset:128 nt
    v_exp_f32 v32, v32
    v_exp_f32 v33, v33
    v_mfma_f32_16x16x32_bf16 v[20:23], a[116:119], a[84:87], v[20:23]
    ds_write_b128 v8, v[188:191] offset:12288
    v_mfma_f32_16x16x32_bf16 v[20:23], a[120:123], a[88:91], v[20:23]
    s_waitcnt lgkmcnt(1)
    buffer_store_dwordx4 v[184:187], v6, s[16:19], s41 offen offset:2176 nt
    v_mul_f32 v34, s20, v34
    v_mul_f32 v35, s20, v35
    v_exp_f32 v34, v34
    v_mfma_f32_16x16x32_bf16 v[20:23], a[124:127], a[92:95], v[20:23]
    ds_write_b128 v9, v[196:199] offset:12288
    v_mfma_f32_16x16x32_bf16 v[24:27], a[140:143], a[92:95], 0
    v_exp_f32 v35, v35
    v_mfma_f32_16x16x32_bf16 v[24:27], a[136:139], a[88:91], v[24:27]
    v_cvt_pk_bf16_f32 v86, v32, v33
    v_cvt_pk_bf16_f32 v87, v34, v35
    v_mfma_f32_16x16x32_bf16 v[24:27], a[132:135], a[84:87], v[24:27]
    ds_read_b128 v[192:195], v7 offset:12288
    v_mul_f32 v20, s20, v20
    v_mfma_f32_16x16x32_bf16 v[24:27], a[128:131], a[80:83], v[24:27]
    ds_read_b128 v[200:203], v7 offset:14336
    v_mul_f32 v21, s20, v21
    v_mfma_f32_16x16x32_bf16 v[220:223], a[0:3], v[52:55], v[220:223]
    v_exp_f32 v20, v20
    v_mfma_f32_16x16x32_bf16 v[220:223], a[4:7], v[84:87], v[220:223]
    v_exp_f32 v21, v21
    v_mfma_f32_16x16x32_bf16 v[224:227], a[12:15], v[84:87], v[224:227]
    v_mul_f32 v22, s20, v22
    v_mul_f32 v23, s20, v23
    v_mfma_f32_16x16x32_bf16 v[224:227], a[8:11], v[52:55], v[224:227]
    v_exp_f32 v22, v22
    v_mfma_f32_16x16x32_bf16 v[228:231], a[16:19], v[52:55], v[228:231]
    s_waitcnt lgkmcnt(1)
    buffer_store_dwordx4 v[192:195], v6, s[16:19], s42 offen nt
    v_exp_f32 v23, v23
    v_cvt_pk_bf16_f32 v88, v20, v21
    v_cvt_pk_bf16_f32 v89, v22, v23
    v_mfma_f32_16x16x32_bf16 v[228:231], a[20:23], v[84:87], v[228:231]
    ds_write_b128 v8, v[204:207] offset:13312
    v_mfma_f32_16x16x32_bf16 v[232:235], a[28:31], v[84:87], v[232:235]
    s_waitcnt lgkmcnt(1)
    buffer_store_dwordx4 v[200:203], v6, s[16:19], s42 offen offset:2048 nt
    v_mul_f32 v24, s20, v24
    v_mul_f32 v25, s20, v25
    v_exp_f32 v24, v24
    v_mfma_f32_16x16x32_bf16 v[232:235], a[24:27], v[52:55], v[232:235]
    ds_write_b128 v9, v[212:215] offset:13312
    v_mfma_f32_16x16x32_bf16 a[192:195], a[0:3], v[56:59], a[192:195]
    v_exp_f32 v25, v25
    s_nop 0
    v_cvt_pk_bf16_f32 v90, v24, v25
    v_mul_f32 v26, s20, v26
    v_exp_f32 v26, v26
    v_mul_f32 v27, s20, v27
    v_exp_f32 v27, v27
    s_nop 0
    v_cvt_pk_bf16_f32 v91, v26, v27
    s_nop 1
    v_mfma_f32_16x16x32_bf16 a[192:195], a[4:7], v[88:91], a[192:195]
    s_nop 2
    v_mfma_f32_16x16x32_bf16 a[196:199], a[12:15], v[88:91], a[196:199]
    ds_read_b128 v[208:211], v7 offset:13312
    v_mfma_f32_16x16x32_bf16 a[196:199], a[8:11], v[56:59], a[196:199]
    ds_read_b128 v[216:219], v7 offset:15360
    v_mfma_f32_16x16x32_bf16 a[200:203], a[16:19], v[56:59], a[200:203]
    v_accvgpr_read_b32 v92, a192
    v_accvgpr_read_b32 v93, a193
    v_mfma_f32_16x16x32_bf16 a[200:203], a[20:23], v[88:91], a[200:203]
    v_accvgpr_read_b32 v94, a194
    v_accvgpr_read_b32 v95, a195
    v_mfma_f32_16x16x32_bf16 a[204:207], a[28:31], v[88:91], a[204:207]
    v_accvgpr_read_b32 v96, a196
    v_accvgpr_read_b32 v97, a197
    v_mfma_f32_16x16x32_bf16 a[204:207], a[24:27], v[56:59], a[204:207]
    v_accvgpr_read_b32 v98, a198
    v_accvgpr_read_b32 v99, a199
    v_smfmac_f32_16x16x64_bf16 a[184:187], v[16:19], v[52:59], v252
    s_waitcnt lgkmcnt(1)
    v_accvgpr_read_b32 v100, a200
    v_smfmac_f32_16x16x64_bf16 a[184:187], v[16:19], v[84:91], v252
    v_accvgpr_read_b32 v101, a201
    v_mfma_f32_16x16x32_bf16 v[236:239], a[32:35], v[84:87], v[236:239]
    buffer_store_dwordx4 v[208:211], v6, s[16:19], s42 offen offset:128 nt
    v_accvgpr_read_b32 v102, a202
    v_accvgpr_read_b32 v103, a203
    v_accvgpr_read_b32 v104, a204
    v_accvgpr_read_b32 v105, a205
    v_mfma_f32_16x16x32_bf16 v[240:243], a[36:39], v[84:87], v[240:243]
    s_waitcnt lgkmcnt(0)
    buffer_store_dwordx4 v[216:219], v6, s[16:19], s42 offen offset:2176 nt
    v_accvgpr_read_b32 v54, a184
    v_accvgpr_read_b32 v52, a185
    v_add_f32 v54, v54, v52
    v_accvgpr_read_b32 v58, a186
    v_mfma_f32_16x16x32_bf16 v[244:247], a[40:43], v[84:87], v[244:247]
    v_rcp_f32 v52, v54
    v_mfma_f32_16x16x32_bf16 v[248:251], a[44:47], v[84:87], v[248:251]
    v_maximum3_f32 v12, v12, v52, v54
    v_accvgpr_read_b32 v56, a187
    v_mfma_f32_16x16x32_bf16 a[208:211], a[32:35], v[88:91], a[208:211]
    v_add_f32 v58, v58, v56
    v_accvgpr_read_b32 v106, a206
    v_mfma_f32_16x16x32_bf16 a[212:215], a[36:39], v[88:91], a[212:215]
    v_rcp_f32 v56, v58
    v_mfma_f32_16x16x32_bf16 a[216:219], a[40:43], v[88:91], a[216:219]
    v_maximum3_f32 v12, v12, v56, v58
    v_accvgpr_read_b32 v107, a207
    v_mfma_f32_16x16x32_bf16 a[220:223], a[44:47], v[88:91], a[220:223]
    v_accvgpr_read_b32 v108, a208
    v_accvgpr_read_b32 v109, a209
.p2align 3
    v_pk_mul_f32 v[220:221], v[220:221], v[52:53] op_sel_hi:[1,0]
    v_pk_mul_f32 v[222:223], v[222:223], v[52:53] op_sel_hi:[1,0]
    v_pk_mul_f32 v[224:225], v[224:225], v[52:53] op_sel_hi:[1,0]
    v_pk_mul_f32 v[226:227], v[226:227], v[52:53] op_sel_hi:[1,0]
    v_cvt_pk_bf16_f32 v220, v220, v221
    v_cvt_pk_bf16_f32 v221, v222, v223
    v_cvt_pk_bf16_f32 v222, v224, v225
    v_cvt_pk_bf16_f32 v223, v226, v227
    v_pk_mul_f32 v[228:229], v[228:229], v[52:53] op_sel_hi:[1,0]
    v_pk_mul_f32 v[230:231], v[230:231], v[52:53] op_sel_hi:[1,0]
    v_pk_mul_f32 v[232:233], v[232:233], v[52:53] op_sel_hi:[1,0]
    v_pk_mul_f32 v[234:235], v[234:235], v[52:53] op_sel_hi:[1,0]
    v_cvt_pk_bf16_f32 v228, v228, v229
    v_cvt_pk_bf16_f32 v229, v230, v231
    v_cvt_pk_bf16_f32 v230, v232, v233
    v_cvt_pk_bf16_f32 v231, v234, v235
    v_pk_mul_f32 v[236:237], v[236:237], v[52:53] op_sel_hi:[1,0]
    v_pk_mul_f32 v[238:239], v[238:239], v[52:53] op_sel_hi:[1,0]
    v_pk_mul_f32 v[240:241], v[240:241], v[52:53] op_sel_hi:[1,0]
    v_pk_mul_f32 v[242:243], v[242:243], v[52:53] op_sel_hi:[1,0]
    v_pk_mul_f32 v[244:245], v[244:245], v[52:53] op_sel_hi:[1,0]
    v_pk_mul_f32 v[246:247], v[246:247], v[52:53] op_sel_hi:[1,0]
    v_pk_mul_f32 v[248:249], v[248:249], v[52:53] op_sel_hi:[1,0]
    v_pk_mul_f32 v[250:251], v[250:251], v[52:53] op_sel_hi:[1,0]
    v_pk_mul_f32 v[92:93], v[92:93], v[56:57] op_sel_hi:[1,0]
    v_pk_mul_f32 v[94:95], v[94:95], v[56:57] op_sel_hi:[1,0]
    v_pk_mul_f32 v[96:97], v[96:97], v[56:57] op_sel_hi:[1,0]
    v_pk_mul_f32 v[98:99], v[98:99], v[56:57] op_sel_hi:[1,0]
    v_pk_mul_f32 v[100:101], v[100:101], v[56:57] op_sel_hi:[1,0]
    v_pk_mul_f32 v[102:103], v[102:103], v[56:57] op_sel_hi:[1,0]
    v_pk_mul_f32 v[104:105], v[104:105], v[56:57] op_sel_hi:[1,0]
    v_pk_mul_f32 v[106:107], v[106:107], v[56:57] op_sel_hi:[1,0]
    v_accvgpr_read_b32 v110, a210
    v_accvgpr_read_b32 v111, a211
    v_accvgpr_read_b32 v112, a212
    v_accvgpr_read_b32 v113, a213
    v_accvgpr_read_b32 v114, a214
    v_accvgpr_read_b32 v115, a215
    v_pk_mul_f32 v[108:109], v[108:109], v[56:57] op_sel_hi:[1,0]
    v_pk_mul_f32 v[110:111], v[110:111], v[56:57] op_sel_hi:[1,0]
    v_pk_mul_f32 v[112:113], v[112:113], v[56:57] op_sel_hi:[1,0]
    v_pk_mul_f32 v[114:115], v[114:115], v[56:57] op_sel_hi:[1,0]
    v_accvgpr_read_b32 v116, a216
    v_accvgpr_read_b32 v117, a217
    v_accvgpr_read_b32 v118, a218
    v_accvgpr_read_b32 v119, a219
    v_accvgpr_read_b32 v120, a220
    v_accvgpr_read_b32 v121, a221
    v_accvgpr_read_b32 v122, a222
    v_accvgpr_read_b32 v123, a223
    v_pk_mul_f32 v[116:117], v[116:117], v[56:57] op_sel_hi:[1,0]
    v_pk_mul_f32 v[118:119], v[118:119], v[56:57] op_sel_hi:[1,0]
    v_pk_mul_f32 v[120:121], v[120:121], v[56:57] op_sel_hi:[1,0]
    v_pk_mul_f32 v[122:123], v[122:123], v[56:57] op_sel_hi:[1,0]
    v_mfma_f32_16x16x32_bf16 a[240:243], a[144:147], v[64:67], a[240:243]
    ds_write_b128 v8, v[220:223] offset:16384
    v_mfma_f32_16x16x32_bf16 a[240:243], a[148:151], v[60:63], a[240:243]
    v_cvt_pk_bf16_f32 v236, v236, v237
    v_cvt_pk_bf16_f32 v237, v238, v239
    v_mfma_f32_16x16x32_bf16 a[244:247], a[156:159], v[60:63], a[244:247]
    v_cvt_pk_bf16_f32 v238, v240, v241
    v_cvt_pk_bf16_f32 v239, v242, v243
    v_mfma_f32_16x16x32_bf16 a[244:247], a[152:155], v[64:67], a[244:247]
    ds_write_b128 v9, v[228:231] offset:16384
    v_mfma_f32_16x16x32_bf16 a[248:251], a[160:163], v[64:67], a[248:251]
    v_cvt_pk_bf16_f32 v244, v244, v245
    v_cvt_pk_bf16_f32 v245, v246, v247
    v_mfma_f32_16x16x32_bf16 a[248:251], a[164:167], v[60:63], a[248:251]
    ds_write_b128 v8, v[236:239] offset:17408
    v_mfma_f32_16x16x32_bf16 a[252:255], a[172:175], v[60:63], a[252:255]
    v_cvt_pk_bf16_f32 v246, v248, v249
    v_cvt_pk_bf16_f32 v247, v250, v251
    v_mfma_f32_16x16x32_bf16 a[252:255], a[168:171], v[64:67], a[252:255]
    ds_read_b128 v[224:227], v7 offset:16384
    v_cvt_pk_bf16_f32 v92, v92, v93
    v_mfma_f32_16x16x32_bf16 v[28:31], a[112:115], a[96:99], 0
    ds_read_b128 v[232:235], v7 offset:18432
    v_cvt_pk_bf16_f32 v93, v94, v95
    v_mfma_f32_16x16x32_bf16 v[28:31], a[116:119], a[100:103], v[28:31]
    ds_write_b128 v9, v[244:247] offset:17408
    v_mfma_f32_16x16x32_bf16 v[28:31], a[120:123], a[104:107], v[28:31]
    v_cvt_pk_bf16_f32 v94, v96, v97
    v_cvt_pk_bf16_f32 v95, v98, v99
    v_mfma_f32_16x16x32_bf16 v[28:31], a[124:127], a[108:111], v[28:31]
    ds_write_b128 v8, v[92:95] offset:20480
    v_mfma_f32_16x16x32_bf16 v[32:35], a[140:143], a[108:111], 0
    s_waitcnt lgkmcnt(3)
    buffer_store_dwordx4 v[224:227], v6, s[16:19], s24 offen nt
    v_cvt_pk_bf16_f32 v100, v100, v101
    v_cvt_pk_bf16_f32 v101, v102, v103
    v_cvt_pk_bf16_f32 v102, v104, v105
    v_cvt_pk_bf16_f32 v103, v106, v107
    v_mfma_f32_16x16x32_bf16 v[32:35], a[136:139], a[104:107], v[32:35]
    ds_read_b128 v[240:243], v7 offset:17408
    v_cvt_pk_bf16_f32 v108, v108, v109
    v_mfma_f32_16x16x32_bf16 v[32:35], a[132:135], a[100:103], v[32:35]
    ds_read_b128 v[248:251], v7 offset:19456
    v_cvt_pk_bf16_f32 v109, v110, v111
    v_mfma_f32_16x16x32_bf16 v[32:35], a[128:131], a[96:99], v[32:35]
    ds_write_b128 v9, v[100:103] offset:20480
    v_mfma_f32_16x16x32_bf16 a[224:227], a[0:3], v[60:63], a[224:227]
    s_waitcnt lgkmcnt(5)
    buffer_store_dwordx4 v[232:235], v6, s[16:19], s24 offen offset:2048 nt
    v_cvt_pk_bf16_f32 v110, v112, v113
    v_cvt_pk_bf16_f32 v111, v114, v115
    v_cvt_pk_bf16_f32 v116, v116, v117
    v_cvt_pk_bf16_f32 v117, v118, v119
    v_mul_f32 v28, s20, v28
    v_exp_f32 v28, v28
    v_mul_f32 v29, s20, v29
    v_exp_f32 v29, v29
    s_nop 0
    v_cvt_pk_bf16_f32 v64, v28, v29
    v_mul_f32 v30, s20, v30
    v_exp_f32 v30, v30
    v_mul_f32 v31, s20, v31
    v_exp_f32 v31, v31
    s_nop 0
    v_cvt_pk_bf16_f32 v65, v30, v31
    v_mul_f32 v32, s20, v32
    v_exp_f32 v32, v32
    v_mul_f32 v33, s20, v33
    v_exp_f32 v33, v33
    s_nop 0
    v_cvt_pk_bf16_f32 v66, v32, v33
    v_mul_f32 v34, s20, v34
    v_exp_f32 v34, v34
    v_mul_f32 v35, s20, v35
    v_exp_f32 v35, v35
    s_nop 0
    v_cvt_pk_bf16_f32 v67, v34, v35
    s_nop 1
    v_mfma_f32_16x16x32_bf16 a[224:227], a[4:7], v[64:67], a[224:227]
    ds_write_b128 v8, v[108:111] offset:21504
    v_mfma_f32_16x16x32_bf16 a[228:231], a[12:15], v[64:67], a[228:231]
    s_waitcnt lgkmcnt(3)
    buffer_store_dwordx4 v[240:243], v6, s[16:19], s24 offen offset:128 nt
    v_cvt_pk_bf16_f32 v118, v120, v121
    v_cvt_pk_bf16_f32 v119, v122, v123
    v_mfma_f32_16x16x32_bf16 a[228:231], a[8:11], v[60:63], a[228:231]
    ds_read_b128 v[96:99], v7 offset:20480
    v_accvgpr_read_b32 v124, a224
    v_mfma_f32_16x16x32_bf16 a[232:235], a[16:19], v[60:63], a[232:235]
    ds_read_b128 v[104:107], v7 offset:22528
    v_accvgpr_read_b32 v125, a225
    v_mfma_f32_16x16x32_bf16 a[232:235], a[20:23], v[64:67], a[232:235]
    ds_write_b128 v9, v[116:119] offset:21504
    v_mfma_f32_16x16x32_bf16 a[236:239], a[28:31], v[64:67], a[236:239]
    s_waitcnt lgkmcnt(5)
    buffer_store_dwordx4 v[248:251], v6, s[16:19], s24 offen offset:2176 nt
    v_accvgpr_read_b32 v126, a226
    v_accvgpr_read_b32 v127, a227
    v_accvgpr_read_b32 v128, a228
    v_accvgpr_read_b32 v129, a229
    v_mfma_f32_16x16x32_bf16 a[236:239], a[24:27], v[60:63], a[236:239]
    ds_read_b128 v[112:115], v7 offset:21504
    v_accvgpr_read_b32 v130, a230
    v_smfmac_f32_16x16x64_bf16 a[188:191], v[16:19], v[60:67], v252
    s_waitcnt lgkmcnt(3)
    v_accvgpr_read_b32 v131, a231
    v_mfma_f32_16x16x32_bf16 a[240:243], a[32:35], v[64:67], a[240:243]
    buffer_store_dwordx4 v[96:99], v6, s[16:19], s25 offen nt
    v_accvgpr_read_b32 v132, a232
    v_accvgpr_read_b32 v133, a233
    v_accvgpr_read_b32 v134, a234
    v_accvgpr_read_b32 v135, a235
    v_mfma_f32_16x16x32_bf16 a[244:247], a[36:39], v[64:67], a[244:247]
    ds_read_b128 v[120:123], v7 offset:23552
    v_accvgpr_read_b32 v62, a188
    v_mfma_f32_16x16x32_bf16 a[248:251], a[40:43], v[64:67], a[248:251]
    s_waitcnt lgkmcnt(3)
    buffer_store_dwordx4 v[104:107], v6, s[16:19], s25 offen offset:2048 nt
    v_accvgpr_read_b32 v60, a189
    v_accvgpr_read_b32 v61, a190
    v_accvgpr_read_b32 v63, a191
    v_add_f32 v62, v62, v63
    v_mfma_f32_16x16x32_bf16 a[252:255], a[44:47], v[64:67], a[252:255]
    s_waitcnt lgkmcnt(1)
    buffer_store_dwordx4 v[112:115], v6, s[16:19], s25 offen offset:128 nt
    v_add_f32 v60, v60, v61
    v_add_f32 v62, v62, v60
    v_rcp_f32 v60, v62
    s_waitcnt lgkmcnt(0)
    buffer_store_dwordx4 v[120:123], v6, s[16:19], s25 offen offset:2176 nt
    v_maximum3_f32 v12, v12, v60, v62
    v_cmp_ngt_f32 vcc, s48, v12
    s_cmp_lg_u64 vcc, 0
    s_cselect_b32 s49, 8, 0
    s_or_b32 s37, s37, s49
.p2align 3
    v_pk_mul_f32 v[124:125], v[124:125], v[60:61] op_sel_hi:[1,0]
    v_pk_mul_f32 v[126:127], v[126:127], v[60:61] op_sel_hi:[1,0]
    v_pk_mul_f32 v[128:129], v[128:129], v[60:61] op_sel_hi:[1,0]
    v_pk_mul_f32 v[130:131], v[130:131], v[60:61] op_sel_hi:[1,0]
    v_cvt_pk_bf16_f32 v124, v124, v125
    v_cvt_pk_bf16_f32 v125, v126, v127
    v_cvt_pk_bf16_f32 v126, v128, v129
    v_cvt_pk_bf16_f32 v127, v130, v131
    ds_write_b128 v8, v[124:127]
    v_accvgpr_read_b32 v136, a236
    v_accvgpr_read_b32 v137, a237
    v_accvgpr_read_b32 v138, a238
    v_accvgpr_read_b32 v139, a239
    v_pk_mul_f32 v[132:133], v[132:133], v[60:61] op_sel_hi:[1,0]
    v_pk_mul_f32 v[134:135], v[134:135], v[60:61] op_sel_hi:[1,0]
    v_pk_mul_f32 v[136:137], v[136:137], v[60:61] op_sel_hi:[1,0]
    v_pk_mul_f32 v[138:139], v[138:139], v[60:61] op_sel_hi:[1,0]
    v_cvt_pk_bf16_f32 v132, v132, v133
    v_cvt_pk_bf16_f32 v133, v134, v135
    v_cvt_pk_bf16_f32 v134, v136, v137
    v_cvt_pk_bf16_f32 v135, v138, v139
    ds_write_b128 v9, v[132:135]
    ds_read_b128 v[128:131], v7
    ds_read_b128 v[136:139], v7 offset:2048
    v_accvgpr_read_b32 v140, a240
    v_accvgpr_read_b32 v141, a241
    v_accvgpr_read_b32 v142, a242
    v_accvgpr_read_b32 v143, a243
    v_accvgpr_read_b32 v144, a244
    v_accvgpr_read_b32 v145, a245
    v_accvgpr_read_b32 v146, a246
    v_accvgpr_read_b32 v147, a247
    v_pk_mul_f32 v[140:141], v[140:141], v[60:61] op_sel_hi:[1,0]
    v_pk_mul_f32 v[142:143], v[142:143], v[60:61] op_sel_hi:[1,0]
    v_pk_mul_f32 v[144:145], v[144:145], v[60:61] op_sel_hi:[1,0]
    v_pk_mul_f32 v[146:147], v[146:147], v[60:61] op_sel_hi:[1,0]
    v_cvt_pk_bf16_f32 v140, v140, v141
    v_cvt_pk_bf16_f32 v141, v142, v143
    v_cvt_pk_bf16_f32 v142, v144, v145
    v_cvt_pk_bf16_f32 v143, v146, v147
    ds_write_b128 v8, v[140:143] offset:1024
    v_accvgpr_read_b32 v148, a248
    v_accvgpr_read_b32 v149, a249
    v_accvgpr_read_b32 v150, a250
    v_accvgpr_read_b32 v151, a251
    v_accvgpr_read_b32 v152, a252
    v_accvgpr_read_b32 v153, a253
    v_accvgpr_read_b32 v154, a254
    v_accvgpr_read_b32 v155, a255
    v_pk_mul_f32 v[148:149], v[148:149], v[60:61] op_sel_hi:[1,0]
    v_pk_mul_f32 v[150:151], v[150:151], v[60:61] op_sel_hi:[1,0]
    v_pk_mul_f32 v[152:153], v[152:153], v[60:61] op_sel_hi:[1,0]
    v_pk_mul_f32 v[154:155], v[154:155], v[60:61] op_sel_hi:[1,0]
    v_cvt_pk_bf16_f32 v148, v148, v149
    v_cvt_pk_bf16_f32 v149, v150, v151
    v_cvt_pk_bf16_f32 v150, v152, v153
    v_cvt_pk_bf16_f32 v151, v154, v155
    ds_write_b128 v9, v[148:151] offset:1024
    ds_read_b128 v[144:147], v7 offset:1024
    ds_read_b128 v[152:155], v7 offset:3072
    s_waitcnt lgkmcnt(4)
    s_nop 0
    buffer_store_dwordx4 v[128:131], v6, s[16:19], s26 offen nt
    buffer_store_dwordx4 v[136:139], v6, s[16:19], s26 offen offset:2048 nt
    s_waitcnt lgkmcnt(0)
    s_nop 0
    buffer_store_dwordx4 v[144:147], v6, s[16:19], s26 offen offset:128 nt
    buffer_store_dwordx4 v[152:155], v6, s[16:19], s26 offen offset:2176 nt
    s_branch L_final
L_close6:
    s_cmp_eq_u32 s38, 0
    s_cselect_b32 s72, s8, s12
    s_cselect_b32 s73, s9, s13
    s_add_u32 s72, s72, 491520
    s_addc_u32 s73, s73, 0
    s_mov_b32 s74, 32768
    s_lshl_b32 s28, s21, 10
    v_mbcnt_lo_u32_b32 v10, -1, 0
    v_mbcnt_hi_u32_b32 v10, -1, v10
    v_lshl_add_u32 v10, v10, 4, s28
    s_mov_b32 s32, 4
    s_mov_b32 s28, 0
L_bodyo6:
    s_waitcnt lgkmcnt(8)
    v_exp_f32 v22, v22
    v_mfma_f32_16x16x32_bf16 v[108:111], a[144:147], v[68:71], v[108:111]
    v_exp_f32 v23, v23
    v_mfma_f32_16x16x32_bf16 v[108:111], a[148:151], v[36:39], v[108:111]
    v_cvt_pk_bf16_f32 v44, v20, v21
    v_cvt_pk_bf16_f32 v45, v22, v23
    v_mfma_f32_16x16x32_bf16 v[112:115], a[156:159], v[36:39], v[112:115]
    s_add_u32 m0, s27, 0
    v_exp_f32 v24, v24
    v_mfma_f32_16x16x32_bf16 v[112:115], a[152:155], v[68:71], v[112:115]
    s_waitcnt lgkmcnt(0)
    v_exp_f32 v25, v25
    v_mfma_f32_16x16x32_bf16 v[116:119], a[160:163], v[68:71], v[116:119]
    v_exp_f32 v26, v26
    v_mfma_f32_16x16x32_bf16 v[116:119], a[164:167], v[36:39], v[116:119]
    buffer_load_dwordx4 v5, s[64:67], 0 offen lds
    v_cvt_pk_bf16_f32 v46, v24, v25
    v_mfma_f32_16x16x32_bf16 v[120:123], a[172:175], v[36:39], v[120:123]
    v_exp_f32 v27, v27
    v_mfma_f32_16x16x32_bf16 v[120:123], a[168:171], v[68:71], v[120:123]
    v_cvt_pk_bf16_f32 v47, v26, v27
    v_mul_f32 v29, s20, v29
    v_mfma_f32_16x16x32_bf16 v[20:23], a[112:115], a[64:67], 0
    v_exp_f32 v28, v28
    v_mfma_f32_16x16x32_bf16 v[20:23], a[116:119], a[68:71], v[20:23]
    v_exp_f32 v29, v29
    v_mfma_f32_16x16x32_bf16 v[20:23], a[120:123], a[72:75], v[20:23]
    s_add_u32 m0, s27, 896
    v_mul_f32 v30, s20, v30
    v_mul_f32 v31, s20, v31
    v_mfma_f32_16x16x32_bf16 v[20:23], a[124:127], a[76:79], v[20:23]
    v_exp_f32 v30, v30
    v_mfma_f32_16x16x32_bf16 v[24:27], a[140:143], a[76:79], 0
    v_exp_f32 v31, v31
    v_mfma_f32_16x16x32_bf16 v[24:27], a[136:139], a[72:75], v[24:27]
    buffer_load_dwordx4 v5, s[64:67], 0 offen offset:128 lds
    v_cvt_pk_bf16_f32 v48, v28, v29
    v_mfma_f32_16x16x32_bf16 v[24:27], a[132:135], a[68:71], v[24:27]
    v_cvt_pk_bf16_f32 v49, v30, v31
    v_mul_f32 v32, s20, v32
    v_mfma_f32_16x16x32_bf16 v[24:27], a[128:131], a[64:67], v[24:27]
    v_mul_f32 v33, s20, v33
    v_mul_f32 v34, s20, v34
    v_mfma_f32_16x16x32_bf16 v[140:143], a[144:147], v[72:75], v[140:143]
    v_exp_f32 v32, v32
    v_mfma_f32_16x16x32_bf16 v[140:143], a[148:151], v[40:43], v[140:143]
    v_exp_f32 v33, v33
    v_mfma_f32_16x16x32_bf16 v[144:147], a[156:159], v[40:43], v[144:147]
    s_add_u32 m0, s27, 2048
    v_mul_f32 v35, s20, v35
    v_cvt_pk_bf16_f32 v50, v32, v33
    v_mfma_f32_16x16x32_bf16 v[144:147], a[152:155], v[72:75], v[144:147]
    v_exp_f32 v34, v34
    v_mfma_f32_16x16x32_bf16 v[148:151], a[160:163], v[72:75], v[148:151]
    v_exp_f32 v35, v35
    v_mfma_f32_16x16x32_bf16 v[148:151], a[164:167], v[40:43], v[148:151]
    buffer_load_dwordx4 v5, s[68:71], 0 offen lds
    v_cvt_pk_bf16_f32 v51, v34, v35
    v_mfma_f32_16x16x32_bf16 v[152:155], a[172:175], v[40:43], v[152:155]
    v_mul_f32 v20, s20, v20
    v_mul_f32 v21, s20, v21
    v_mfma_f32_16x16x32_bf16 v[152:155], a[168:171], v[72:75], v[152:155]
    v_exp_f32 v20, v20
    v_mfma_f32_16x16x32_bf16 v[28:31], a[112:115], a[80:83], 0
    ds_read_b128 a[112:115], v1
    v_mul_f32 v22, s20, v22
    v_mfma_f32_16x16x32_bf16 v[28:31], a[116:119], a[84:87], v[28:31]
    ds_read_b128 a[116:119], v2
    v_mul_f32 v23, s20, v23
    v_mfma_f32_16x16x32_bf16 v[28:31], a[120:123], a[88:91], v[28:31]
    s_add_u32 m0, s27, 3072
    v_exp_f32 v21, v21
    v_mfma_f32_16x16x32_bf16 v[28:31], a[124:127], a[92:95], v[28:31]
    ds_read_b128 a[120:123], v1 offset:1024
    v_cvt_pk_bf16_f32 v52, v20, v21
    v_mfma_f32_16x16x32_bf16 v[32:35], a[140:143], a[92:95], 0
    ds_read_b128 a[124:127], v2 offset:1024
    v_mul_f32 v24, s20, v24
    v_mfma_f32_16x16x32_bf16 v[32:35], a[136:139], a[88:91], v[32:35]
    buffer_load_dwordx4 v5, s[88:91], 0 offen lds
    v_mul_f32 v25, s20, v25
    v_mfma_f32_16x16x32_bf16 v[32:35], a[132:135], a[84:87], v[32:35]
    s_add_u32 s27, s27, 16384
    ds_read_b128 a[140:143], v2 offset:9216
    v_mul_f32 v26, s20, v26
    v_mfma_f32_16x16x32_bf16 v[32:35], a[128:131], a[80:83], v[32:35]
    s_and_b32 s27, s27, 0xffff
    ds_read_b128 a[136:139], v1 offset:9216
    v_mul_f32 v27, s20, v27
    v_mfma_f32_16x16x32_bf16 v[172:175], a[144:147], v[76:79], v[172:175]
    s_mov_b64 s[68:69], s[88:89]
    v_exp_f32 v22, v22
    v_mfma_f32_16x16x32_bf16 v[172:175], a[148:151], v[44:47], v[172:175]
    s_mov_b32 s70, s90
    ds_read_b128 a[132:135], v2 offset:8192
    v_mul_f32 v28, s20, v28
    v_mfma_f32_16x16x32_bf16 v[176:179], a[156:159], v[44:47], v[176:179]
    s_add_u32 s88, s88, 8192
    ds_read_b128 a[128:131], v1 offset:8192
    v_mul_f32 v29, s20, v29
    v_mfma_f32_16x16x32_bf16 v[176:179], a[152:155], v[76:79], v[176:179]
    s_addc_u32 s89, s89, 0
    v_exp_f32 v23, v23
    v_mfma_f32_16x16x32_bf16 v[180:183], a[160:163], v[76:79], v[180:183]
    s_mov_b32 s90, s66
    v_cvt_pk_bf16_f32 v53, v22, v23
    v_mul_f32 v30, s20, v30
    v_mfma_f32_16x16x32_bf16 v[180:183], a[164:167], v[44:47], v[180:183]
    s_add_u32 s64, s64, 8192
    v_exp_f32 v24, v24
    v_mfma_f32_16x16x32_bf16 v[184:187], a[172:175], v[44:47], v[184:187]
    s_addc_u32 s65, s65, 0
    v_exp_f32 v25, v25
    v_mfma_f32_16x16x32_bf16 v[184:187], a[168:171], v[76:79], v[184:187]
    s_waitcnt lgkmcnt(4)
    v_exp_f32 v26, v26
    v_mfma_f32_16x16x32_bf16 v[20:23], a[112:115], a[0:3], 0
    s_add_u32 s23, s23, 1
    v_exp_f32 v27, v27
    v_mfma_f32_16x16x32_bf16 v[20:23], a[116:119], a[4:7], v[20:23]
    s_cmp_lt_u32 s23, 64
    v_cvt_pk_bf16_f32 v54, v24, v25
    v_cvt_pk_bf16_f32 v55, v26, v27
    v_mfma_f32_16x16x32_bf16 v[20:23], a[120:123], a[8:11], v[20:23]
    s_cselect_b32 s66, 8192, 0
    v_exp_f32 v28, v28
    v_mfma_f32_16x16x32_bf16 v[20:23], a[124:127], a[12:15], v[20:23]
    s_waitcnt lgkmcnt(0)
    v_exp_f32 v29, v29
    v_mfma_f32_16x16x32_bf16 v[24:27], a[140:143], a[12:15], 0
    v_mul_f32 v31, s20, v31
    v_cvt_pk_bf16_f32 v56, v28, v29
    v_mfma_f32_16x16x32_bf16 v[24:27], a[136:139], a[8:11], v[24:27]
    v_exp_f32 v30, v30
    v_mfma_f32_16x16x32_bf16 v[24:27], a[132:135], a[4:7], v[24:27]
    v_exp_f32 v31, v31
    v_mfma_f32_16x16x32_bf16 v[24:27], a[128:131], a[0:3], v[24:27]
    v_cvt_pk_bf16_f32 v57, v30, v31
    v_mul_f32 v32, s20, v32
    v_mfma_f32_16x16x32_bf16 v[204:207], a[144:147], v[80:83], v[204:207]
    v_mul_f32 v33, s20, v33
    v_mul_f32 v34, s20, v34
    v_mfma_f32_16x16x32_bf16 v[204:207], a[148:151], v[48:51], v[204:207]
    v_exp_f32 v32, v32
    v_mfma_f32_16x16x32_bf16 v[208:211], a[156:159], v[48:51], v[208:211]
    v_exp_f32 v33, v33
    v_mfma_f32_16x16x32_bf16 v[208:211], a[152:155], v[80:83], v[208:211]
    v_mul_f32 v35, s20, v35
    v_cvt_pk_bf16_f32 v58, v32, v33
    v_mfma_f32_16x16x32_bf16 v[212:215], a[160:163], v[80:83], v[212:215]
    v_exp_f32 v34, v34
    v_mfma_f32_16x16x32_bf16 v[212:215], a[164:167], v[48:51], v[212:215]
    v_exp_f32 v35, v35
    v_mfma_f32_16x16x32_bf16 v[216:219], a[172:175], v[48:51], v[216:219]
    v_cvt_pk_bf16_f32 v59, v34, v35
    v_mul_f32 v20, s20, v20
    v_mfma_f32_16x16x32_bf16 v[216:219], a[168:171], v[80:83], v[216:219]
    v_mul_f32 v21, s20, v21
    v_mul_f32 v22, s20, v22
    v_mfma_f32_16x16x32_bf16 v[28:31], a[112:115], a[16:19], 0
    v_exp_f32 v20, v20
    v_mfma_f32_16x16x32_bf16 v[28:31], a[116:119], a[20:23], v[28:31]
    v_exp_f32 v21, v21
    v_mfma_f32_16x16x32_bf16 v[28:31], a[120:123], a[24:27], v[28:31]
    v_mul_f32 v23, s20, v23
    v_cvt_pk_bf16_f32 v68, v20, v21
    v_mfma_f32_16x16x32_bf16 v[28:31], a[124:127], a[28:31], v[28:31]
    v_exp_f32 v22, v22
    v_mfma_f32_16x16x32_bf16 v[32:35], a[140:143], a[28:31], 0
    v_exp_f32 v23, v23
    v_mfma_f32_16x16x32_bf16 v[32:35], a[136:139], a[24:27], v[32:35]
    v_cvt_pk_bf16_f32 v69, v22, v23
    v_mul_f32 v24, s20, v24
    v_mfma_f32_16x16x32_bf16 v[32:35], a[132:135], a[20:23], v[32:35]
    v_mul_f32 v25, s20, v25
    v_mul_f32 v26, s20, v26
    v_mfma_f32_16x16x32_bf16 v[32:35], a[128:131], a[16:19], v[32:35]
    v_exp_f32 v24, v24
    v_mfma_f32_16x16x32_bf16 v[236:239], a[144:147], v[84:87], v[236:239]
    v_exp_f32 v25, v25
    v_mfma_f32_16x16x32_bf16 v[236:239], a[148:151], v[52:55], v[236:239]
    v_mul_f32 v27, s20, v27
    v_cvt_pk_bf16_f32 v70, v24, v25
    v_mfma_f32_16x16x32_bf16 v[240:243], a[156:159], v[52:55], v[240:243]
    v_exp_f32 v26, v26
    v_mfma_f32_16x16x32_bf16 v[240:243], a[152:155], v[84:87], v[240:243]
    v_exp_f32 v27, v27
    v_mfma_f32_16x16x32_bf16 v[244:247], a[160:163], v[84:87], v[244:247]
    v_cvt_pk_bf16_f32 v71, v26, v27
    v_mul_f32 v28, s20, v28
    v_mfma_f32_16x16x32_bf16 v[244:247], a[164:167], v[52:55], v[244:247]
    v_mul_f32 v29, s20, v29
    v_mul_f32 v30, s20, v30
    v_mfma_f32_16x16x32_bf16 v[248:251], a[172:175], v[52:55], v[248:251]
    v_exp_f32 v28, v28
    v_mfma_f32_16x16x32_bf16 v[248:251], a[168:171], v[84:87], v[248:251]
    v_exp_f32 v29, v29
    v_mfma_f32_16x16x32_bf16 v[20:23], a[112:115], a[32:35], 0
    v_mul_f32 v31, s20, v31
    v_cvt_pk_bf16_f32 v72, v28, v29
    v_mfma_f32_16x16x32_bf16 v[20:23], a[116:119], a[36:39], v[20:23]
    v_exp_f32 v30, v30
    v_mfma_f32_16x16x32_bf16 v[20:23], a[120:123], a[40:43], v[20:23]
    v_exp_f32 v31, v31
    v_mfma_f32_16x16x32_bf16 v[20:23], a[124:127], a[44:47], v[20:23]
    v_cvt_pk_bf16_f32 v73, v30, v31
    v_mul_f32 v32, s20, v32
    v_mfma_f32_16x16x32_bf16 v[24:27], a[140:143], a[44:47], 0
    v_mul_f32 v33, s20, v33
    v_mul_f32 v34, s20, v34
    v_mfma_f32_16x16x32_bf16 v[24:27], a[136:139], a[40:43], v[24:27]
    s_waitcnt vmcnt(14) lgkmcnt(0)
    v_exp_f32 v32, v32
    v_mfma_f32_16x16x32_bf16 v[24:27], a[132:135], a[36:39], v[24:27]
    s_barrier
    v_mul_f32 v35, s20, v35
    v_mfma_f32_16x16x32_bf16 v[24:27], a[128:131], a[32:35], v[24:27]
    v_exp_f32 v33, v33
    v_mfma_f32_16x16x32_bf16 a[208:211], a[144:147], v[88:91], a[208:211]
    ds_read_b64_tr_b16 a[144:145], v3 offset:18432
    v_cvt_pk_bf16_f32 v74, v32, v33
    v_mfma_f32_16x16x32_bf16 a[208:211], a[148:151], v[56:59], a[208:211]
    ds_read_b64_tr_b16 a[146:147], v3 offset:26624
    v_mul_f32 v20, s20, v20
    v_mfma_f32_16x16x32_bf16 a[212:215], a[156:159], v[56:59], a[212:215]
    ds_read_b64_tr_b16 a[148:149], v3 offset:19456
    v_mul_f32 v21, s20, v21
    v_mfma_f32_16x16x32_bf16 a[212:215], a[152:155], v[88:91], a[212:215]
    ds_read_b64_tr_b16 a[150:151], v3 offset:27648
    v_mul_f32 v22, s20, v22
    v_mfma_f32_16x16x32_bf16 a[216:219], a[160:163], v[88:91], a[216:219]
    ds_read_b64_tr_b16 a[156:157], v3 offset:19464
    v_mul_f32 v23, s20, v23
    v_mfma_f32_16x16x32_bf16 a[216:219], a[164:167], v[56:59], a[216:219]
    ds_read_b64_tr_b16 a[158:159], v3 offset:27656
    v_mul_f32 v24, s20, v24
    v_mfma_f32_16x16x32_bf16 a[220:223], a[172:175], v[56:59], a[220:223]
    ds_read_b64_tr_b16 a[152:153], v3 offset:18440
    v_mul_f32 v25, s20, v25
    v_mfma_f32_16x16x32_bf16 a[220:223], a[168:171], v[88:91], a[220:223]
    ds_read_b64_tr_b16 a[154:155], v3 offset:26632
    v_mul_f32 v26, s20, v26
    v_mfma_f32_16x16x32_bf16 v[28:31], a[112:115], a[48:51], 0
    ds_read_b64_tr_b16 a[160:161], v4 offset:18432
    v_mul_f32 v27, s20, v27
    v_mfma_f32_16x16x32_bf16 v[28:31], a[116:119], a[52:55], v[28:31]
    ds_read_b64_tr_b16 a[162:163], v4 offset:26624
    ds_read_b64_tr_b16 a[164:165], v4 offset:19456
    v_mfma_f32_16x16x32_bf16 v[28:31], a[120:123], a[56:59], v[28:31]
    v_exp_f32 v34, v34
    v_mfma_f32_16x16x32_bf16 v[28:31], a[124:127], a[60:63], v[28:31]
    ds_read_b64_tr_b16 a[166:167], v4 offset:27648
    ds_read_b64_tr_b16 a[172:173], v4 offset:19464
    v_exp_f32 v35, v35
    s_nop 0
    v_cvt_pk_bf16_f32 v75, v34, v35
    v_mfma_f32_16x16x32_bf16 v[32:35], a[140:143], a[60:63], 0
    v_exp_f32 v20, v20
    v_mfma_f32_16x16x32_bf16 v[32:35], a[136:139], a[56:59], v[32:35]
    ds_read_b64_tr_b16 a[174:175], v4 offset:27656
    v_mul_f32 v28, s20, v28
    v_mfma_f32_16x16x32_bf16 v[32:35], a[132:135], a[52:55], v[32:35]
    ds_read_b64_tr_b16 a[168:169], v4 offset:18440
    v_mul_f32 v29, s20, v29
    v_mfma_f32_16x16x32_bf16 v[32:35], a[128:131], a[48:51], v[32:35]
    s_waitcnt lgkmcnt(7)
    ds_read_b64_tr_b16 a[170:171], v4 offset:26632
    v_mul_f32 v30, s20, v30
    v_mfma_f32_16x16x32_bf16 v[92:95], a[144:147], v[36:39], v[92:95]
    v_xor_b32 v3, 0x8000, v3
    v_xor_b32 v4, 0x8000, v4
    v_mfma_f32_16x16x32_bf16 v[92:95], a[148:151], v[68:71], v[92:95]
    v_exp_f32 v21, v21
    v_mfma_f32_16x16x32_bf16 v[96:99], a[156:159], v[68:71], v[96:99]
    s_add_u32 m0, s27, 0
    v_exp_f32 v22, v22
    v_mfma_f32_16x16x32_bf16 v[96:99], a[152:155], v[36:39], v[96:99]
    s_waitcnt lgkmcnt(0)
    v_exp_f32 v23, v23
    v_mfma_f32_16x16x32_bf16 v[100:103], a[160:163], v[36:39], v[100:103]
    v_cvt_pk_bf16_f32 v76, v20, v21
    v_cvt_pk_bf16_f32 v77, v22, v23
    v_mfma_f32_16x16x32_bf16 v[100:103], a[164:167], v[68:71], v[100:103]
    buffer_load_dwordx4 v5, s[64:67], 0 offen lds
    v_mul_f32 v31, s20, v31
    v_mfma_f32_16x16x32_bf16 v[104:107], a[172:175], v[68:71], v[104:107]
    v_exp_f32 v24, v24
    v_mfma_f32_16x16x32_bf16 v[104:107], a[168:171], v[36:39], v[104:107]
    v_exp_f32 v25, v25
    v_mfma_f32_16x16x32_bf16 v[20:23], a[112:115], a[64:67], 0
    v_exp_f32 v26, v26
    v_mfma_f32_16x16x32_bf16 v[20:23], a[116:119], a[68:71], v[20:23]
    v_exp_f32 v27, v27
    v_mfma_f32_16x16x32_bf16 v[20:23], a[120:123], a[72:75], v[20:23]
    s_add_u32 m0, s27, 896
    v_cvt_pk_bf16_f32 v78, v24, v25
    v_cvt_pk_bf16_f32 v79, v26, v27
    v_mfma_f32_16x16x32_bf16 v[20:23], a[124:127], a[76:79], v[20:23]
    v_exp_f32 v28, v28
    v_mfma_f32_16x16x32_bf16 v[24:27], a[140:143], a[76:79], 0
    v_exp_f32 v29, v29
    v_mfma_f32_16x16x32_bf16 v[24:27], a[136:139], a[72:75], v[24:27]
    buffer_load_dwordx4 v5, s[64:67], 0 offen offset:128 lds
    v_cvt_pk_bf16_f32 v80, v28, v29
    v_mfma_f32_16x16x32_bf16 v[24:27], a[132:135], a[68:71], v[24:27]
    v_exp_f32 v30, v30
    v_mfma_f32_16x16x32_bf16 v[24:27], a[128:131], a[64:67], v[24:27]
    v_exp_f32 v31, v31
    v_mfma_f32_16x16x32_bf16 v[124:127], a[144:147], v[40:43], v[124:127]
    v_cvt_pk_bf16_f32 v81, v30, v31
    v_mul_f32 v32, s20, v32
    v_mfma_f32_16x16x32_bf16 v[124:127], a[148:151], v[72:75], v[124:127]
    v_mul_f32 v33, s20, v33
    v_mul_f32 v34, s20, v34
    v_mfma_f32_16x16x32_bf16 v[128:131], a[156:159], v[72:75], v[128:131]
    s_add_u32 m0, s27, 1920
    v_exp_f32 v32, v32
    v_mfma_f32_16x16x32_bf16 v[128:131], a[152:155], v[40:43], v[128:131]
    v_exp_f32 v33, v33
    v_mfma_f32_16x16x32_bf16 v[132:135], a[160:163], v[40:43], v[132:135]
    v_mul_f32 v35, s20, v35
    v_cvt_pk_bf16_f32 v82, v32, v33
    v_mfma_f32_16x16x32_bf16 v[132:135], a[164:167], v[72:75], v[132:135]
    buffer_load_dwordx4 v5, s[68:71], 0 offen offset:128 lds
    v_mul_f32 v20, s20, v20
    v_mfma_f32_16x16x32_bf16 v[136:139], a[172:175], v[72:75], v[136:139]
    v_exp_f32 v34, v34
    v_mfma_f32_16x16x32_bf16 v[136:139], a[168:171], v[40:43], v[136:139]
    v_exp_f32 v35, v35
    v_smfmac_f32_16x16x64_bf16 a[176:179], v[16:19], v[36:43], v252
    v_cvt_pk_bf16_f32 v83, v34, v35
    v_smfmac_f32_16x16x64_bf16 a[176:179], v[16:19], v[68:75], v252
    v_mul_f32 v21, s20, v21
    v_mfma_f32_16x16x32_bf16 v[28:31], a[112:115], a[80:83], 0
    s_add_u32 m0, s27, 2944
    ds_read_b128 a[112:115], v1 offset:16384
    v_mul_f32 v22, s20, v22
    v_mfma_f32_16x16x32_bf16 v[28:31], a[116:119], a[84:87], v[28:31]
    ds_read_b128 a[116:119], v2 offset:16384
    v_mul_f32 v23, s20, v23
    v_mfma_f32_16x16x32_bf16 v[28:31], a[120:123], a[88:91], v[28:31]
    v_exp_f32 v20, v20
    v_mfma_f32_16x16x32_bf16 v[28:31], a[124:127], a[92:95], v[28:31]
    buffer_load_dwordx4 v5, s[88:91], 0 offen offset:128 lds
    v_mul_f32 v24, s20, v24
    v_mfma_f32_16x16x32_bf16 v[32:35], a[140:143], a[92:95], 0
    s_add_u32 s27, s27, 16384
    ds_read_b128 a[120:123], v1 offset:17408
    v_mul_f32 v25, s20, v25
    v_mfma_f32_16x16x32_bf16 v[32:35], a[136:139], a[88:91], v[32:35]
    s_and_b32 s27, s27, 0xffff
    ds_read_b128 a[124:127], v2 offset:17408
    v_mul_f32 v26, s20, v26
    v_mfma_f32_16x16x32_bf16 v[32:35], a[132:135], a[84:87], v[32:35]
    s_mov_b64 s[68:69], s[88:89]
    ds_read_b128 a[140:143], v2 offset:25600
    v_mul_f32 v27, s20, v27
    v_mfma_f32_16x16x32_bf16 v[32:35], a[128:131], a[80:83], v[32:35]
    s_mov_b32 s70, s90
    ds_read_b128 a[136:139], v1 offset:25600
    v_mul_f32 v28, s20, v28
    v_exp_f32 v21, v21
    v_mfma_f32_16x16x32_bf16 v[156:159], a[144:147], v[44:47], v[156:159]
    s_add_u32 s88, s88, 8192
    ds_read_b128 v[12:15], v7
    v_cvt_pk_bf16_f32 v84, v20, v21
    v_mfma_f32_16x16x32_bf16 v[156:159], a[148:151], v[76:79], v[156:159]
    s_addc_u32 s89, s89, 0
    ds_read_b128 a[132:135], v2 offset:24576
    v_xor_b32 v2, 0x8000, v2
    v_mfma_f32_16x16x32_bf16 v[160:163], a[156:159], v[76:79], v[160:163]
    s_mov_b32 s90, s66
    ds_read_b128 a[128:131], v1 offset:24576
    v_xor_b32 v1, 0x8000, v1
    v_mfma_f32_16x16x32_bf16 v[160:163], a[152:155], v[44:47], v[160:163]
    s_add_u32 s64, s64, 8192
    v_exp_f32 v22, v22
    v_mfma_f32_16x16x32_bf16 v[164:167], a[160:163], v[44:47], v[164:167]
    s_addc_u32 s65, s65, 0
    v_exp_f32 v23, v23
    v_mfma_f32_16x16x32_bf16 v[164:167], a[164:167], v[76:79], v[164:167]
    s_add_u32 s23, s23, 1
    v_cvt_pk_bf16_f32 v85, v22, v23
    v_mul_f32 v29, s20, v29
    v_mfma_f32_16x16x32_bf16 v[168:171], a[172:175], v[76:79], v[168:171]
    s_cmp_lt_u32 s23, 64
    v_exp_f32 v24, v24
    v_mfma_f32_16x16x32_bf16 v[168:171], a[168:171], v[44:47], v[168:171]
    s_waitcnt lgkmcnt(5)
    v_exp_f32 v25, v25
    v_mfma_f32_16x16x32_bf16 v[20:23], a[112:115], a[0:3], 0
    s_cselect_b32 s66, 8192, 0
    v_exp_f32 v26, v26
    v_mfma_f32_16x16x32_bf16 v[20:23], a[116:119], a[4:7], v[20:23]
    s_waitcnt lgkmcnt(2)
    buffer_store_dwordx4 v[12:15], v6, s[76:79], 0 offen nt
    v_exp_f32 v27, v27
    v_cvt_pk_bf16_f32 v86, v24, v25
    v_cvt_pk_bf16_f32 v87, v26, v27
    v_mfma_f32_16x16x32_bf16 v[20:23], a[120:123], a[8:11], v[20:23]
    s_add_u32 s76, s76, s29
    v_exp_f32 v28, v28
    v_mfma_f32_16x16x32_bf16 v[20:23], a[124:127], a[12:15], v[20:23]
    s_addc_u32 s77, s77, 0
    v_exp_f32 v29, v29
    v_mfma_f32_16x16x32_bf16 v[24:27], a[140:143], a[12:15], 0
    s_xor_b32 s29, s29, 0x700
    v_mul_f32 v30, s20, v30
    v_mul_f32 v31, s20, v31
    v_mfma_f32_16x16x32_bf16 v[24:27], a[136:139], a[8:11], v[24:27]
    s_waitcnt lgkmcnt(0)
    v_exp_f32 v30, v30
    v_mfma_f32_16x16x32_bf16 v[24:27], a[132:135], a[4:7], v[24:27]
    v_exp_f32 v31, v31
    v_mfma_f32_16x16x32_bf16 v[24:27], a[128:131], a[0:3], v[24:27]
    v_cvt_pk_bf16_f32 v88, v28, v29
    v_cvt_pk_bf16_f32 v89, v30, v31
    v_mfma_f32_16x16x32_bf16 v[188:191], a[144:147], v[48:51], v[188:191]
    ds_read_b128 v[12:15], v7 offset:1024
    v_mul_f32 v32, s20, v32
    v_mfma_f32_16x16x32_bf16 v[188:191], a[148:151], v[80:83], v[188:191]
    buffer_load_dword v0, v10, s[72:75], 0 offen
    v_mul_f32 v33, s20, v33
    v_mfma_f32_16x16x32_bf16 v[192:195], a[156:159], v[80:83], v[192:195]
    s_add_u32 s72, s72, 4096
    v_exp_f32 v32, v32
    v_mfma_f32_16x16x32_bf16 v[192:195], a[152:155], v[48:51], v[192:195]
    s_addc_u32 s73, s73, 0
    v_exp_f32 v33, v33
    v_mfma_f32_16x16x32_bf16 v[196:199], a[160:163], v[48:51], v[196:199]
    s_max_u32 s74, s74, 4096
    v_mul_f32 v34, s20, v34
    v_mul_f32 v35, s20, v35
    v_mfma_f32_16x16x32_bf16 v[196:199], a[164:167], v[80:83], v[196:199]
    s_sub_u32 s74, s74, 4096
    v_exp_f32 v34, v34
    v_mfma_f32_16x16x32_bf16 v[200:203], a[172:175], v[80:83], v[200:203]
    v_exp_f32 v35, v35
    v_mfma_f32_16x16x32_bf16 v[200:203], a[168:171], v[48:51], v[200:203]
    v_cvt_pk_bf16_f32 v90, v32, v33
    v_cvt_pk_bf16_f32 v91, v34, v35
    v_smfmac_f32_16x16x64_bf16 a[180:183], v[16:19], v[44:51], v252
    v_mul_f32 v20, s20, v20
    v_smfmac_f32_16x16x64_bf16 a[180:183], v[16:19], v[76:83], v252
    s_waitcnt lgkmcnt(0)
    v_mul_f32 v21, s20, v21
    v_mfma_f32_16x16x32_bf16 v[28:31], a[112:115], a[16:19], 0
    buffer_store_dwordx4 v[12:15], v6, s[76:79], 0 offen nt
    v_exp_f32 v20, v20
    v_exp_f32 v21, v21
    v_mfma_f32_16x16x32_bf16 v[28:31], a[116:119], a[20:23], v[28:31]
    s_add_u32 s76, s76, s29
    v_mul_f32 v22, s20, v22
    v_mul_f32 v23, s20, v23
    v_mfma_f32_16x16x32_bf16 v[28:31], a[120:123], a[24:27], v[28:31]
    s_addc_u32 s77, s77, 0
    v_exp_f32 v22, v22
    v_mfma_f32_16x16x32_bf16 v[28:31], a[124:127], a[28:31], v[28:31]
    s_xor_b32 s29, s29, 0x700
    v_exp_f32 v23, v23
    v_mfma_f32_16x16x32_bf16 v[32:35], a[140:143], a[28:31], 0
    v_cvt_pk_bf16_f32 v36, v20, v21
    v_cvt_pk_bf16_f32 v37, v22, v23
    v_mfma_f32_16x16x32_bf16 v[32:35], a[136:139], a[24:27], v[32:35]
    v_mul_f32 v24, s20, v24
    v_mul_f32 v25, s20, v25
    v_mfma_f32_16x16x32_bf16 v[32:35], a[132:135], a[20:23], v[32:35]
    ds_read_b128 v[12:15], v7 offset:2048
    v_add_u32 v7, 3072, v7
    v_mfma_f32_16x16x32_bf16 v[32:35], a[128:131], a[16:19], v[32:35]
    buffer_load_dword v0, v10, s[72:75], 0 offen
    v_mul_f32 v26, s20, v26
    v_mfma_f32_16x16x32_bf16 v[220:223], a[144:147], v[52:55], v[220:223]
    s_add_u32 s72, s72, 4096
    v_exp_f32 v24, v24
    v_mfma_f32_16x16x32_bf16 v[220:223], a[148:151], v[84:87], v[220:223]
    s_addc_u32 s73, s73, 0
    v_exp_f32 v25, v25
    v_mfma_f32_16x16x32_bf16 v[224:227], a[156:159], v[84:87], v[224:227]
    s_max_u32 s74, s74, 4096
    v_mul_f32 v27, s20, v27
    v_cvt_pk_bf16_f32 v38, v24, v25
    v_mfma_f32_16x16x32_bf16 v[224:227], a[152:155], v[52:55], v[224:227]
    s_sub_u32 s74, s74, 4096
    v_exp_f32 v26, v26
    v_mfma_f32_16x16x32_bf16 v[228:231], a[160:163], v[52:55], v[228:231]
    v_exp_f32 v27, v27
    v_mfma_f32_16x16x32_bf16 v[228:231], a[164:167], v[84:87], v[228:231]
    v_cvt_pk_bf16_f32 v39, v26, v27
    v_mul_f32 v28, s20, v28
    v_mfma_f32_16x16x32_bf16 v[232:235], a[172:175], v[84:87], v[232:235]
    v_mul_f32 v29, s20, v29
    v_mul_f32 v30, s20, v30
    v_mfma_f32_16x16x32_bf16 v[232:235], a[168:171], v[52:55], v[232:235]
    s_waitcnt lgkmcnt(0)
    buffer_store_dwordx4 v[12:15], v6, s[76:79], 0 offen nt
    v_exp_f32 v28, v28
    v_exp_f32 v29, v29
    v_mfma_f32_16x16x32_bf16 v[20:23], a[112:115], a[32:35], 0
    s_add_u32 s76, s76, s29
    v_mul_f32 v31, s20, v31
    v_cvt_pk_bf16_f32 v40, v28, v29
    v_mfma_f32_16x16x32_bf16 v[20:23], a[116:119], a[36:39], v[20:23]
    s_addc_u32 s77, s77, 0
    v_exp_f32 v30, v30
    v_mfma_f32_16x16x32_bf16 v[20:23], a[120:123], a[40:43], v[20:23]
    s_xor_b32 s29, s29, 0x700
    v_exp_f32 v31, v31
    v_mfma_f32_16x16x32_bf16 v[20:23], a[124:127], a[44:47], v[20:23]
    v_cvt_pk_bf16_f32 v41, v30, v31
    v_mul_f32 v32, s20, v32
    v_mfma_f32_16x16x32_bf16 v[24:27], a[140:143], a[44:47], 0
    v_mul_f32 v33, s20, v33
    v_mul_f32 v34, s20, v34
    v_mfma_f32_16x16x32_bf16 v[24:27], a[136:139], a[40:43], v[24:27]
    s_waitcnt vmcnt(19) lgkmcnt(0)
    v_exp_f32 v32, v32
    v_mfma_f32_16x16x32_bf16 v[24:27], a[132:135], a[36:39], v[24:27]
    s_barrier
    v_mul_f32 v35, s20, v35
    v_mfma_f32_16x16x32_bf16 v[24:27], a[128:131], a[32:35], v[24:27]
    buffer_load_dword v0, v10, s[72:75], 0 offen
    v_mul_f32 v20, s20, v20
    v_mfma_f32_16x16x32_bf16 a[192:195], a[144:147], v[56:59], a[192:195]
    s_add_u32 s72, s72, 4096
    ds_read_b64_tr_b16 a[144:145], v3 offset:2048
    v_mul_f32 v21, s20, v21
    v_mfma_f32_16x16x32_bf16 a[192:195], a[148:151], v[88:91], a[192:195]
    s_addc_u32 s73, s73, 0
    ds_read_b64_tr_b16 a[146:147], v3 offset:10240
    v_mul_f32 v22, s20, v22
    v_mfma_f32_16x16x32_bf16 a[196:199], a[156:159], v[88:91], a[196:199]
    s_max_u32 s74, s74, 4096
    ds_read_b64_tr_b16 a[148:149], v3 offset:3072
    v_mul_f32 v23, s20, v23
    v_mfma_f32_16x16x32_bf16 a[196:199], a[152:155], v[56:59], a[196:199]
    s_sub_u32 s74, s74, 4096
    ds_read_b64_tr_b16 a[150:151], v3 offset:11264
    v_mul_f32 v24, s20, v24
    v_mfma_f32_16x16x32_bf16 a[200:203], a[160:163], v[56:59], a[200:203]
    ds_read_b64_tr_b16 a[156:157], v3 offset:3080
    v_mul_f32 v25, s20, v25
    v_mfma_f32_16x16x32_bf16 a[200:203], a[164:167], v[88:91], a[200:203]
    ds_read_b64_tr_b16 a[158:159], v3 offset:11272
    v_mul_f32 v26, s20, v26
    v_mfma_f32_16x16x32_bf16 a[204:207], a[172:175], v[88:91], a[204:207]
    ds_read_b64_tr_b16 a[152:153], v3 offset:2056
    v_mul_f32 v27, s20, v27
    v_mfma_f32_16x16x32_bf16 a[204:207], a[168:171], v[56:59], a[204:207]
    ds_read_b64_tr_b16 a[154:155], v3 offset:10248
    ds_read_b64_tr_b16 a[160:161], v4 offset:2048
    v_smfmac_f32_16x16x64_bf16 a[184:187], v[16:19], v[52:59], v252
    v_smfmac_f32_16x16x64_bf16 a[184:187], v[16:19], v[84:91], v252
    ds_read_b64_tr_b16 a[162:163], v4 offset:10240
    v_mfma_f32_16x16x32_bf16 v[28:31], a[112:115], a[48:51], 0
    ds_read_b64_tr_b16 a[164:165], v4 offset:3072
    ds_read_b64_tr_b16 a[166:167], v4 offset:11264
    v_mfma_f32_16x16x32_bf16 v[28:31], a[116:119], a[52:55], v[28:31]
    v_exp_f32 v33, v33
    v_mfma_f32_16x16x32_bf16 v[28:31], a[120:123], a[56:59], v[28:31]
    ds_read_b64_tr_b16 a[172:173], v4 offset:3080
    v_cvt_pk_bf16_f32 v42, v32, v33
    v_mfma_f32_16x16x32_bf16 v[28:31], a[124:127], a[60:63], v[28:31]
    s_sub_u32 s32, s32, 1
    ds_read_b64_tr_b16 a[174:175], v4 offset:11272
    ds_read_b64_tr_b16 a[168:169], v4 offset:2056
    v_exp_f32 v34, v34
    v_exp_f32 v35, v35
    s_nop 0
    v_cvt_pk_bf16_f32 v43, v34, v35
    v_mfma_f32_16x16x32_bf16 v[32:35], a[140:143], a[60:63], 0
    v_exp_f32 v20, v20
    v_mfma_f32_16x16x32_bf16 v[32:35], a[136:139], a[56:59], v[32:35]
    ds_read_b64_tr_b16 a[170:171], v4 offset:10248
    v_mul_f32 v28, s20, v28
    v_mfma_f32_16x16x32_bf16 v[32:35], a[132:135], a[52:55], v[32:35]
    v_exp_f32 v21, v21
    v_mfma_f32_16x16x32_bf16 v[32:35], a[128:131], a[48:51], v[32:35]
    s_cbranch_scc0 L_bodyo6
    s_xor_b32 s28, s28, 1
    s_cbranch_scc0 L_last6
    v_min_u32 v254, L_final-L_end_code, v253
    v_mov_b32 v255, 0
    v_lshl_add_u64 v[254:255], v[254:255], 0, s[54:55]
    global_load_dword v0, v[254:255], off
    s_mov_b32 s32, 0
    s_branch L_bodyo6
L_last6:
    s_waitcnt lgkmcnt(8)
    v_exp_f32 v22, v22
    v_mfma_f32_16x16x32_bf16 v[108:111], a[144:147], v[68:71], v[108:111]
    v_exp_f32 v23, v23
    v_mfma_f32_16x16x32_bf16 v[108:111], a[148:151], v[36:39], v[108:111]
    v_cvt_pk_bf16_f32 v44, v20, v21
    v_cvt_pk_bf16_f32 v45, v22, v23
    v_mfma_f32_16x16x32_bf16 v[112:115], a[156:159], v[36:39], v[112:115]
    v_exp_f32 v24, v24
    v_mfma_f32_16x16x32_bf16 v[112:115], a[152:155], v[68:71], v[112:115]
    s_waitcnt lgkmcnt(0)
    v_exp_f32 v25, v25
    v_mfma_f32_16x16x32_bf16 v[116:119], a[160:163], v[68:71], v[116:119]
    v_exp_f32 v26, v26
    v_mfma_f32_16x16x32_bf16 v[116:119], a[164:167], v[36:39], v[116:119]
    v_exp_f32 v27, v27
    v_mfma_f32_16x16x32_bf16 v[120:123], a[172:175], v[36:39], v[120:123]
    v_cvt_pk_bf16_f32 v46, v24, v25
    v_cvt_pk_bf16_f32 v47, v26, v27
    v_mfma_f32_16x16x32_bf16 v[120:123], a[168:171], v[68:71], v[120:123]
    v_mul_f32 v29, s20, v29
    v_mul_f32 v30, s20, v30
    v_mfma_f32_16x16x32_bf16 v[20:23], a[112:115], a[64:67], 0
    v_exp_f32 v28, v28
    v_mfma_f32_16x16x32_bf16 v[20:23], a[116:119], a[68:71], v[20:23]
    v_exp_f32 v29, v29
    v_mfma_f32_16x16x32_bf16 v[20:23], a[120:123], a[72:75], v[20:23]
    v_mul_f32 v31, s20, v31
    v_cvt_pk_bf16_f32 v48, v28, v29
    v_mfma_f32_16x16x32_bf16 v[20:23], a[124:127], a[76:79], v[20:23]
    v_exp_f32 v30, v30
    v_mfma_f32_16x16x32_bf16 v[24:27], a[140:143], a[76:79], 0
    v_exp_f32 v31, v31
    v_mfma_f32_16x16x32_bf16 v[24:27], a[136:139], a[72:75], v[24:27]
    v_cvt_pk_bf16_f32 v49, v30, v31
    v_mul_f32 v32, s20, v32
    v_mfma_f32_16x16x32_bf16 v[24:27], a[132:135], a[68:71], v[24:27]
    v_mul_f32 v33, s20, v33
    v_mul_f32 v34, s20, v34
    v_mfma_f32_16x16x32_bf16 v[24:27], a[128:131], a[64:67], v[24:27]
    v_exp_f32 v32, v32
    v_mfma_f32_16x16x32_bf16 v[140:143], a[144:147], v[72:75], v[140:143]
    v_exp_f32 v33, v33
    v_mfma_f32_16x16x32_bf16 v[140:143], a[148:151], v[40:43], v[140:143]
    v_mul_f32 v35, s20, v35
    v_cvt_pk_bf16_f32 v50, v32, v33
    v_mfma_f32_16x16x32_bf16 v[144:147], a[156:159], v[40:43], v[144:147]
    v_exp_f32 v34, v34
    v_mfma_f32_16x16x32_bf16 v[144:147], a[152:155], v[72:75], v[144:147]
    v_exp_f32 v35, v35
    v_mfma_f32_16x16x32_bf16 v[148:151], a[160:163], v[72:75], v[148:151]
    v_cvt_pk_bf16_f32 v51, v34, v35
    v_mul_f32 v20, s20, v20
    v_mfma_f32_16x16x32_bf16 v[148:151], a[164:167], v[40:43], v[148:151]
    v_mul_f32 v21, s20, v21
    v_mul_f32 v22, s20, v22
    v_mfma_f32_16x16x32_bf16 v[152:155], a[172:175], v[40:43], v[152:155]
    v_exp_f32 v20, v20
    v_mfma_f32_16x16x32_bf16 v[152:155], a[168:171], v[72:75], v[152:155]
    v_exp_f32 v21, v21
    v_mfma_f32_16x16x32_bf16 v[28:31], a[112:115], a[80:83], 0
    ds_read_b128 a[112:115], v1
    v_mul_f32 v23, s20, v23
    v_mfma_f32_16x16x32_bf16 v[28:31], a[116:119], a[84:87], v[28:31]
    ds_read_b128 a[116:119], v2
    v_cvt_pk_bf16_f32 v52, v20, v21
    v_mfma_f32_16x16x32_bf16 v[28:31], a[120:123], a[88:91], v[28:31]
    ds_read_b128 a[120:123], v1 offset:1024
    v_mul_f32 v24, s20, v24
    v_mfma_f32_16x16x32_bf16 v[28:31], a[124:127], a[92:95], v[28:31]
    ds_read_b128 a[124:127], v2 offset:1024
    v_mul_f32 v25, s20, v25
    v_mfma_f32_16x16x32_bf16 v[32:35], a[140:143], a[92:95], 0
    ds_read_b128 a[140:143], v2 offset:9216
    v_mul_f32 v26, s20, v26
    v_mfma_f32_16x16x32_bf16 v[32:35], a[136:139], a[88:91], v[32:35]
    ds_read_b128 a[136:139], v1 offset:9216
    v_mul_f32 v27, s20, v27
    v_mfma_f32_16x16x32_bf16 v[32:35], a[132:135], a[84:87], v[32:35]
    ds_read_b128 a[132:135], v2 offset:8192
    v_mul_f32 v28, s20, v28
    v_mfma_f32_16x16x32_bf16 v[32:35], a[128:131], a[80:83], v[32:35]
    ds_read_b128 a[128:131], v1 offset:8192
    v_mul_f32 v29, s20, v29
    v_mfma_f32_16x16x32_bf16 v[172:175], a[144:147], v[76:79], v[172:175]
    v_exp_f32 v22, v22
    v_mfma_f32_16x16x32_bf16 v[172:175], a[148:151], v[44:47], v[172:175]
    v_exp_f32 v23, v23
    v_mfma_f32_16x16x32_bf16 v[176:179], a[156:159], v[44:47], v[176:179]
    v_cvt_pk_bf16_f32 v53, v22, v23
    v_mul_f32 v30, s20, v30
    v_mfma_f32_16x16x32_bf16 v[176:179], a[152:155], v[76:79], v[176:179]
    v_exp_f32 v24, v24
    v_mfma_f32_16x16x32_bf16 v[180:183], a[160:163], v[76:79], v[180:183]
    v_exp_f32 v25, v25
    v_mfma_f32_16x16x32_bf16 v[180:183], a[164:167], v[44:47], v[180:183]
    v_exp_f32 v26, v26
    v_mfma_f32_16x16x32_bf16 v[184:187], a[172:175], v[44:47], v[184:187]
    v_exp_f32 v27, v27
    v_mfma_f32_16x16x32_bf16 v[184:187], a[168:171], v[76:79], v[184:187]
    s_waitcnt lgkmcnt(4)
    v_cvt_pk_bf16_f32 v54, v24, v25
    v_cvt_pk_bf16_f32 v55, v26, v27
    v_mfma_f32_16x16x32_bf16 v[20:23], a[112:115], a[0:3], 0
    v_exp_f32 v28, v28
    v_mfma_f32_16x16x32_bf16 v[20:23], a[116:119], a[4:7], v[20:23]
    v_exp_f32 v29, v29
    v_mfma_f32_16x16x32_bf16 v[20:23], a[120:123], a[8:11], v[20:23]
    v_mul_f32 v31, s20, v31
    v_cvt_pk_bf16_f32 v56, v28, v29
    v_mfma_f32_16x16x32_bf16 v[20:23], a[124:127], a[12:15], v[20:23]
    s_waitcnt lgkmcnt(0)
    v_exp_f32 v30, v30
    v_mfma_f32_16x16x32_bf16 v[24:27], a[140:143], a[12:15], 0
    s_waitcnt vmcnt(10)
    v_exp_f32 v31, v31
    v_mfma_f32_16x16x32_bf16 v[24:27], a[136:139], a[8:11], v[24:27]
    s_barrier
    v_cvt_pk_bf16_f32 v57, v30, v31
    v_mfma_f32_16x16x32_bf16 v[24:27], a[132:135], a[4:7], v[24:27]
    v_mul_f32 v32, s20, v32
    v_mul_f32 v33, s20, v33
    v_mfma_f32_16x16x32_bf16 v[24:27], a[128:131], a[0:3], v[24:27]
    ds_read_b64_tr_b16 a[0:1], v3 offset:18432
    ds_read_b64_tr_b16 a[2:3], v3 offset:26624
    v_mfma_f32_16x16x32_bf16 v[28:31], a[112:115], a[16:19], 0
    ds_read_b64_tr_b16 a[4:5], v3 offset:19456
    ds_read_b64_tr_b16 a[6:7], v3 offset:27648
    v_mfma_f32_16x16x32_bf16 v[28:31], a[116:119], a[20:23], v[28:31]
    ds_read_b64_tr_b16 a[12:13], v3 offset:19464
    ds_read_b64_tr_b16 a[14:15], v3 offset:27656
    v_mfma_f32_16x16x32_bf16 v[28:31], a[120:123], a[24:27], v[28:31]
    ds_read_b64_tr_b16 a[8:9], v3 offset:18440
    v_mul_f32 v34, s20, v34
    v_mfma_f32_16x16x32_bf16 v[28:31], a[124:127], a[28:31], v[28:31]
    ds_read_b64_tr_b16 a[10:11], v3 offset:26632
    v_xor_b32 v3, 0x8000, v3
    v_exp_f32 v32, v32
    v_exp_f32 v33, v33
    v_mul_f32 v35, s20, v35
    v_exp_f32 v34, v34
    v_exp_f32 v35, v35
    v_cvt_pk_bf16_f32 v58, v32, v33
    v_cvt_pk_bf16_f32 v59, v34, v35
    v_mfma_f32_16x16x32_bf16 v[32:35], a[140:143], a[28:31], 0
    v_mul_f32 v20, s20, v20
    v_mul_f32 v21, s20, v21
    v_mfma_f32_16x16x32_bf16 v[32:35], a[136:139], a[24:27], v[32:35]
    v_exp_f32 v20, v20
    v_mfma_f32_16x16x32_bf16 v[32:35], a[132:135], a[20:23], v[32:35]
    v_exp_f32 v21, v21
    v_mfma_f32_16x16x32_bf16 v[32:35], a[128:131], a[16:19], v[32:35]
    ds_read_b64_tr_b16 a[16:17], v4 offset:18432
    v_mul_f32 v22, s20, v22
    v_mul_f32 v23, s20, v23
    v_exp_f32 v22, v22
    v_exp_f32 v23, v23
    v_cvt_pk_bf16_f32 v68, v20, v21
    v_cvt_pk_bf16_f32 v69, v22, v23
    v_mfma_f32_16x16x32_bf16 v[20:23], a[112:115], a[32:35], 0
    ds_read_b64_tr_b16 a[18:19], v4 offset:26624
    v_mul_f32 v24, s20, v24
    v_mfma_f32_16x16x32_bf16 v[20:23], a[116:119], a[36:39], v[20:23]
    ds_read_b64_tr_b16 a[20:21], v4 offset:19456
    v_mul_f32 v25, s20, v25
    v_mfma_f32_16x16x32_bf16 v[20:23], a[120:123], a[40:43], v[20:23]
    ds_read_b64_tr_b16 a[22:23], v4 offset:27648
    v_mul_f32 v26, s20, v26
    v_mfma_f32_16x16x32_bf16 v[20:23], a[124:127], a[44:47], v[20:23]
    ds_read_b64_tr_b16 a[28:29], v4 offset:19464
    v_mul_f32 v27, s20, v27
    v_exp_f32 v24, v24
    v_exp_f32 v25, v25
    v_exp_f32 v26, v26
    v_exp_f32 v27, v27
    v_cvt_pk_bf16_f32 v70, v24, v25
    v_cvt_pk_bf16_f32 v71, v26, v27
    v_mfma_f32_16x16x32_bf16 v[24:27], a[140:143], a[44:47], 0
    s_waitcnt vmcnt(6)
    ds_read_b64_tr_b16 a[30:31], v4 offset:27656
    v_mul_f32 v28, s20, v28
    v_mfma_f32_16x16x32_bf16 v[24:27], a[136:139], a[40:43], v[24:27]
    s_add_u32 s39, s33, 0
    ds_read_b64_tr_b16 a[24:25], v4 offset:18440
    v_mul_f32 v29, s20, v29
    v_mfma_f32_16x16x32_bf16 v[24:27], a[132:135], a[36:39], v[24:27]
    s_add_u32 s40, s33, 4096
    ds_read_b64_tr_b16 a[26:27], v4 offset:26632
    v_xor_b32 v4, 0x8000, v4
    v_mfma_f32_16x16x32_bf16 v[24:27], a[128:131], a[32:35], v[24:27]
    s_waitcnt lgkmcnt(8)
    v_exp_f32 v28, v28
    v_exp_f32 v29, v29
    v_mul_f32 v30, s20, v30
    v_mul_f32 v31, s20, v31
    v_exp_f32 v30, v30
    v_exp_f32 v31, v31
    v_mfma_f32_16x16x32_bf16 v[92:95], a[0:3], v[36:39], v[92:95]
    s_barrier
    v_cvt_pk_bf16_f32 v72, v28, v29
    v_mfma_f32_16x16x32_bf16 v[92:95], a[4:7], v[68:71], v[92:95]
    s_add_u32 s41, s33, 8192
    ds_read_b64_tr_b16 a[32:33], v3 offset:2048
    v_cvt_pk_bf16_f32 v73, v30, v31
    v_mfma_f32_16x16x32_bf16 v[96:99], a[12:15], v[68:71], v[96:99]
    s_add_u32 s42, s33, 12288
    ds_read_b64_tr_b16 a[34:35], v3 offset:10240
    v_mul_f32 v32, s20, v32
    v_mfma_f32_16x16x32_bf16 v[96:99], a[8:11], v[36:39], v[96:99]
    s_waitcnt lgkmcnt(2)
    ds_read_b64_tr_b16 a[36:37], v3 offset:2056
    v_mul_f32 v33, s20, v33
    v_mfma_f32_16x16x32_bf16 v[100:103], a[16:19], v[36:39], v[100:103]
    s_add_u32 s24, s33, 16384
    ds_read_b64_tr_b16 a[38:39], v3 offset:10248
    v_mul_f32 v34, s20, v34
    v_mfma_f32_16x16x32_bf16 v[100:103], a[20:23], v[68:71], v[100:103]
    s_add_u32 s25, s33, 20480
    ds_read_b64_tr_b16 a[40:41], v4 offset:2048
    v_mul_f32 v35, s20, v35
    v_mfma_f32_16x16x32_bf16 v[104:107], a[28:31], v[68:71], v[104:107]
    ds_read_b64_tr_b16 a[42:43], v4 offset:10240
    v_mul_f32 v20, s20, v20
    v_mfma_f32_16x16x32_bf16 v[104:107], a[24:27], v[36:39], v[104:107]
    ds_read_b64_tr_b16 a[44:45], v4 offset:2056
    ds_read_b64_tr_b16 a[46:47], v4 offset:10248
    v_mfma_f32_16x16x32_bf16 v[124:127], a[0:3], v[40:43], v[124:127]
    v_exp_f32 v32, v32
    v_exp_f32 v33, v33
    s_nop 0
    v_cvt_pk_bf16_f32 v74, v32, v33
    v_exp_f32 v34, v34
    v_exp_f32 v35, v35
    s_nop 0
    v_cvt_pk_bf16_f32 v75, v34, v35
    s_nop 1
    v_mfma_f32_16x16x32_bf16 v[124:127], a[4:7], v[72:75], v[124:127]
    v_mul_f32 v21, s20, v21
    v_mul_f32 v22, s20, v22
    v_mfma_f32_16x16x32_bf16 v[128:131], a[12:15], v[72:75], v[128:131]
    v_exp_f32 v20, v20
    v_mfma_f32_16x16x32_bf16 v[128:131], a[8:11], v[40:43], v[128:131]
    v_exp_f32 v21, v21
    v_mfma_f32_16x16x32_bf16 v[132:135], a[16:19], v[40:43], v[132:135]
    v_mul_f32 v23, s20, v23
    v_cvt_pk_bf16_f32 v76, v20, v21
    v_mfma_f32_16x16x32_bf16 v[132:135], a[20:23], v[72:75], v[132:135]
    v_exp_f32 v22, v22
    v_mfma_f32_16x16x32_bf16 v[136:139], a[28:31], v[72:75], v[136:139]
    v_exp_f32 v23, v23
    v_mfma_f32_16x16x32_bf16 v[136:139], a[24:27], v[40:43], v[136:139]
    v_cvt_pk_bf16_f32 v77, v22, v23
    v_mul_f32 v24, s20, v24
    v_smfmac_f32_16x16x64_bf16 a[176:179], v[16:19], v[36:43], v252
    v_mul_f32 v25, s20, v25
    v_smfmac_f32_16x16x64_bf16 a[176:179], v[16:19], v[68:75], v252
    s_waitcnt lgkmcnt(0)
    v_mul_f32 v26, s20, v26
    v_mfma_f32_16x16x32_bf16 v[108:111], a[32:35], v[68:71], v[108:111]
    v_exp_f32 v24, v24
    v_mfma_f32_16x16x32_bf16 v[112:115], a[36:39], v[68:71], v[112:115]
    v_exp_f32 v25, v25
    v_mfma_f32_16x16x32_bf16 v[116:119], a[40:43], v[68:71], v[116:119]
    v_mul_f32 v27, s20, v27
    v_cvt_pk_bf16_f32 v78, v24, v25
    v_mfma_f32_16x16x32_bf16 v[120:123], a[44:47], v[68:71], v[120:123]
    v_exp_f32 v26, v26
    v_mfma_f32_16x16x32_bf16 v[140:143], a[32:35], v[72:75], v[140:143]
    v_exp_f32 v27, v27
    v_mfma_f32_16x16x32_bf16 v[144:147], a[36:39], v[72:75], v[144:147]
    v_cvt_pk_bf16_f32 v79, v26, v27
    v_add_u32 v7, 0xffffa000, v7
    v_mfma_f32_16x16x32_bf16 v[148:151], a[40:43], v[72:75], v[148:151]
    v_accvgpr_read_b32 v38, a176
    v_accvgpr_read_b32 v36, a177
    v_mfma_f32_16x16x32_bf16 v[152:155], a[44:47], v[72:75], v[152:155]
    v_add_f32 v38, v38, v36
    v_accvgpr_read_b32 v42, a178
    v_rcp_f32 v36, v38
    s_nop 0
    v_maximum3_f32 v12, v36, v36, v38
    v_accvgpr_read_b32 v40, a179
    v_add_f32 v42, v42, v40
    v_rcp_f32 v40, v42
    s_nop 0
    v_maximum3_f32 v12, v12, v40, v42
.p2align 3
    v_pk_mul_f32 v[92:93], v[92:93], v[36:37] op_sel_hi:[1,0]
    v_pk_mul_f32 v[94:95], v[94:95], v[36:37] op_sel_hi:[1,0]
    v_pk_mul_f32 v[96:97], v[96:97], v[36:37] op_sel_hi:[1,0]
    v_pk_mul_f32 v[98:99], v[98:99], v[36:37] op_sel_hi:[1,0]
    v_cvt_pk_bf16_f32 v92, v92, v93
    v_cvt_pk_bf16_f32 v93, v94, v95
    v_cvt_pk_bf16_f32 v94, v96, v97
    v_cvt_pk_bf16_f32 v95, v98, v99
    v_pk_mul_f32 v[100:101], v[100:101], v[36:37] op_sel_hi:[1,0]
    v_pk_mul_f32 v[102:103], v[102:103], v[36:37] op_sel_hi:[1,0]
    v_pk_mul_f32 v[104:105], v[104:105], v[36:37] op_sel_hi:[1,0]
    v_pk_mul_f32 v[106:107], v[106:107], v[36:37] op_sel_hi:[1,0]
    v_cvt_pk_bf16_f32 v100, v100, v101
    v_cvt_pk_bf16_f32 v101, v102, v103
    v_cvt_pk_bf16_f32 v102, v104, v105
    v_cvt_pk_bf16_f32 v103, v106, v107
    v_pk_mul_f32 v[108:109], v[108:109], v[36:37] op_sel_hi:[1,0]
    v_pk_mul_f32 v[110:111], v[110:111], v[36:37] op_sel_hi:[1,0]
    v_pk_mul_f32 v[112:113], v[112:113], v[36:37] op_sel_hi:[1,0]
    v_pk_mul_f32 v[114:115], v[114:115], v[36:37] op_sel_hi:[1,0]
    v_pk_mul_f32 v[116:117], v[116:117], v[36:37] op_sel_hi:[1,0]
    v_pk_mul_f32 v[118:119], v[118:119], v[36:37] op_sel_hi:[1,0]
    v_pk_mul_f32 v[120:121], v[120:121], v[36:37] op_sel_hi:[1,0]
    v_pk_mul_f32 v[122:123], v[122:123], v[36:37] op_sel_hi:[1,0]
    v_pk_mul_f32 v[124:125], v[124:125], v[40:41] op_sel_hi:[1,0]
    v_pk_mul_f32 v[126:127], v[126:127], v[40:41] op_sel_hi:[1,0]
    v_pk_mul_f32 v[128:129], v[128:129], v[40:41] op_sel_hi:[1,0]
    v_pk_mul_f32 v[130:131], v[130:131], v[40:41] op_sel_hi:[1,0]
    v_pk_mul_f32 v[132:133], v[132:133], v[40:41] op_sel_hi:[1,0]
    v_pk_mul_f32 v[134:135], v[134:135], v[40:41] op_sel_hi:[1,0]
    v_pk_mul_f32 v[136:137], v[136:137], v[40:41] op_sel_hi:[1,0]
    v_pk_mul_f32 v[138:139], v[138:139], v[40:41] op_sel_hi:[1,0]
    v_pk_mul_f32 v[140:141], v[140:141], v[40:41] op_sel_hi:[1,0]
    v_pk_mul_f32 v[142:143], v[142:143], v[40:41] op_sel_hi:[1,0]
    v_pk_mul_f32 v[144:145], v[144:145], v[40:41] op_sel_hi:[1,0]
    v_pk_mul_f32 v[146:147], v[146:147], v[40:41] op_sel_hi:[1,0]
    v_pk_mul_f32 v[148:149], v[148:149], v[40:41] op_sel_hi:[1,0]
    v_pk_mul_f32 v[150:151], v[150:151], v[40:41] op_sel_hi:[1,0]
    v_pk_mul_f32 v[152:153], v[152:153], v[40:41] op_sel_hi:[1,0]
    v_pk_mul_f32 v[154:155], v[154:155], v[40:41] op_sel_hi:[1,0]
    v_mfma_f32_16x16x32_bf16 v[204:207], a[144:147], v[80:83], v[204:207]
    ds_write_b128 v8, v[92:95]
    v_mfma_f32_16x16x32_bf16 v[204:207], a[148:151], v[48:51], v[204:207]
    v_cvt_pk_bf16_f32 v108, v108, v109
    v_cvt_pk_bf16_f32 v109, v110, v111
    v_mfma_f32_16x16x32_bf16 v[208:211], a[156:159], v[48:51], v[208:211]
    v_cvt_pk_bf16_f32 v110, v112, v113
    v_cvt_pk_bf16_f32 v111, v114, v115
    v_mfma_f32_16x16x32_bf16 v[208:211], a[152:155], v[80:83], v[208:211]
    ds_write_b128 v9, v[100:103]
    v_mfma_f32_16x16x32_bf16 v[212:215], a[160:163], v[80:83], v[212:215]
    v_cvt_pk_bf16_f32 v116, v116, v117
    v_cvt_pk_bf16_f32 v117, v118, v119
    v_mfma_f32_16x16x32_bf16 v[212:215], a[164:167], v[48:51], v[212:215]
    v_cvt_pk_bf16_f32 v118, v120, v121
    v_cvt_pk_bf16_f32 v119, v122, v123
    v_mfma_f32_16x16x32_bf16 v[216:219], a[172:175], v[48:51], v[216:219]
    ds_read_b128 v[96:99], v7
    v_cvt_pk_bf16_f32 v124, v124, v125
    v_mfma_f32_16x16x32_bf16 v[216:219], a[168:171], v[80:83], v[216:219]
    ds_read_b128 v[104:107], v7 offset:2048
    v_cvt_pk_bf16_f32 v125, v126, v127
    v_mfma_f32_16x16x32_bf16 v[28:31], a[112:115], a[48:51], 0
    ds_write_b128 v8, v[108:111] offset:1024
    v_mfma_f32_16x16x32_bf16 v[28:31], a[116:119], a[52:55], v[28:31]
    v_cvt_pk_bf16_f32 v126, v128, v129
    v_cvt_pk_bf16_f32 v127, v130, v131
    v_mfma_f32_16x16x32_bf16 v[28:31], a[120:123], a[56:59], v[28:31]
    v_cvt_pk_bf16_f32 v132, v132, v133
    v_cvt_pk_bf16_f32 v133, v134, v135
    v_mfma_f32_16x16x32_bf16 v[28:31], a[124:127], a[60:63], v[28:31]
    ds_write_b128 v9, v[116:119] offset:1024
    v_mfma_f32_16x16x32_bf16 v[32:35], a[140:143], a[60:63], 0
    s_waitcnt lgkmcnt(3)
    buffer_store_dwordx4 v[96:99], v6, s[16:19], s39 offen nt
    v_cvt_pk_bf16_f32 v134, v136, v137
    v_cvt_pk_bf16_f32 v135, v138, v139
    v_cvt_pk_bf16_f32 v140, v140, v141
    v_cvt_pk_bf16_f32 v141, v142, v143
    v_mfma_f32_16x16x32_bf16 v[32:35], a[136:139], a[56:59], v[32:35]
    v_cvt_pk_bf16_f32 v142, v144, v145
    v_cvt_pk_bf16_f32 v143, v146, v147
    v_mfma_f32_16x16x32_bf16 v[32:35], a[132:135], a[52:55], v[32:35]
    s_waitcnt lgkmcnt(2)
    buffer_store_dwordx4 v[104:107], v6, s[16:19], s39 offen offset:2048 nt
    v_cvt_pk_bf16_f32 v148, v148, v149
    v_cvt_pk_bf16_f32 v149, v150, v151
    v_cvt_pk_bf16_f32 v150, v152, v153
    v_cvt_pk_bf16_f32 v151, v154, v155
    v_mfma_f32_16x16x32_bf16 v[32:35], a[128:131], a[48:51], v[32:35]
    ds_read_b128 v[112:115], v7 offset:1024
    v_mul_f32 v28, s20, v28
    v_mfma_f32_16x16x32_bf16 v[156:159], a[0:3], v[44:47], v[156:159]
    ds_read_b128 v[120:123], v7 offset:3072
    v_mul_f32 v29, s20, v29
    v_mfma_f32_16x16x32_bf16 v[156:159], a[4:7], v[76:79], v[156:159]
    ds_write_b128 v8, v[124:127] offset:4096
    v_mfma_f32_16x16x32_bf16 v[160:163], a[12:15], v[76:79], v[160:163]
    v_exp_f32 v28, v28
    v_mfma_f32_16x16x32_bf16 v[160:163], a[8:11], v[44:47], v[160:163]
    ds_write_b128 v9, v[132:135] offset:4096
    v_mfma_f32_16x16x32_bf16 v[164:167], a[16:19], v[44:47], v[164:167]
    s_waitcnt lgkmcnt(3)
    buffer_store_dwordx4 v[112:115], v6, s[16:19], s39 offen offset:128 nt
    v_exp_f32 v29, v29
    v_mul_f32 v30, s20, v30
    v_mul_f32 v31, s20, v31
    v_mfma_f32_16x16x32_bf16 v[164:167], a[20:23], v[76:79], v[164:167]
    v_exp_f32 v30, v30
    v_mfma_f32_16x16x32_bf16 v[168:171], a[28:31], v[76:79], v[168:171]
    s_waitcnt lgkmcnt(2)
    buffer_store_dwordx4 v[120:123], v6, s[16:19], s39 offen offset:2176 nt
    v_exp_f32 v31, v31
    v_cvt_pk_bf16_f32 v80, v28, v29
    v_cvt_pk_bf16_f32 v81, v30, v31
    v_mfma_f32_16x16x32_bf16 v[168:171], a[24:27], v[44:47], v[168:171]
    ds_read_b128 v[128:131], v7 offset:4096
    v_mul_f32 v32, s20, v32
    v_mfma_f32_16x16x32_bf16 v[188:191], a[0:3], v[48:51], v[188:191]
    ds_read_b128 v[136:139], v7 offset:6144
    v_mul_f32 v33, s20, v33
    v_exp_f32 v32, v32
    v_exp_f32 v33, v33
    s_nop 0
    v_cvt_pk_bf16_f32 v82, v32, v33
    v_mul_f32 v34, s20, v34
    v_exp_f32 v34, v34
    v_mul_f32 v35, s20, v35
    v_exp_f32 v35, v35
    s_nop 0
    v_cvt_pk_bf16_f32 v83, v34, v35
    s_nop 1
    v_mfma_f32_16x16x32_bf16 v[188:191], a[4:7], v[80:83], v[188:191]
    ds_write_b128 v8, v[140:143] offset:5120
    v_mfma_f32_16x16x32_bf16 v[192:195], a[12:15], v[80:83], v[192:195]
    v_mfma_f32_16x16x32_bf16 v[192:195], a[8:11], v[48:51], v[192:195]
    ds_write_b128 v9, v[148:151] offset:5120
    v_mfma_f32_16x16x32_bf16 v[196:199], a[16:19], v[48:51], v[196:199]
    s_waitcnt lgkmcnt(3)
    buffer_store_dwordx4 v[128:131], v6, s[16:19], s40 offen nt
    v_mfma_f32_16x16x32_bf16 v[196:199], a[20:23], v[80:83], v[196:199]
    v_mfma_f32_16x16x32_bf16 v[200:203], a[28:31], v[80:83], v[200:203]
    s_waitcnt lgkmcnt(2)
    buffer_store_dwordx4 v[136:139], v6, s[16:19], s40 offen offset:2048 nt
    v_mfma_f32_16x16x32_bf16 v[200:203], a[24:27], v[48:51], v[200:203]
    ds_read_b128 v[144:147], v7 offset:5120
    v_smfmac_f32_16x16x64_bf16 a[180:183], v[16:19], v[44:51], v252
    ds_read_b128 v[152:155], v7 offset:7168
    v_smfmac_f32_16x16x64_bf16 a[180:183], v[16:19], v[76:83], v252
    s_nop 2
    v_mfma_f32_16x16x32_bf16 v[172:175], a[32:35], v[76:79], v[172:175]
    s_nop 2
    v_mfma_f32_16x16x32_bf16 v[176:179], a[36:39], v[76:79], v[176:179]
    v_accvgpr_read_b32 v46, a180
    v_accvgpr_read_b32 v44, a181
    v_mfma_f32_16x16x32_bf16 v[180:183], a[40:43], v[76:79], v[180:183]
    s_waitcnt lgkmcnt(1)
    buffer_store_dwordx4 v[144:147], v6, s[16:19], s40 offen offset:128 nt
    v_add_f32 v46, v46, v44
    v_rcp_f32 v44, v46
    v_accvgpr_read_b32 v50, a182
    v_mfma_f32_16x16x32_bf16 v[184:187], a[44:47], v[76:79], v[184:187]
    v_maximum3_f32 v12, v12, v44, v46
    v_accvgpr_read_b32 v48, a183
    v_mfma_f32_16x16x32_bf16 v[204:207], a[32:35], v[80:83], v[204:207]
    s_waitcnt lgkmcnt(0)
    buffer_store_dwordx4 v[152:155], v6, s[16:19], s40 offen offset:2176 nt
    v_add_f32 v50, v50, v48
    v_rcp_f32 v48, v50
    v_mfma_f32_16x16x32_bf16 v[208:211], a[36:39], v[80:83], v[208:211]
    v_maximum3_f32 v12, v12, v48, v50
    v_mfma_f32_16x16x32_bf16 v[212:215], a[40:43], v[80:83], v[212:215]
    v_mfma_f32_16x16x32_bf16 v[216:219], a[44:47], v[80:83], v[216:219]
.p2align 3
    v_pk_mul_f32 v[156:157], v[156:157], v[44:45] op_sel_hi:[1,0]
    v_pk_mul_f32 v[158:159], v[158:159], v[44:45] op_sel_hi:[1,0]
    v_pk_mul_f32 v[160:161], v[160:161], v[44:45] op_sel_hi:[1,0]
    v_pk_mul_f32 v[162:163], v[162:163], v[44:45] op_sel_hi:[1,0]
    v_cvt_pk_bf16_f32 v156, v156, v157
    v_cvt_pk_bf16_f32 v157, v158, v159
    v_cvt_pk_bf16_f32 v158, v160, v161
    v_cvt_pk_bf16_f32 v159, v162, v163
    v_pk_mul_f32 v[164:165], v[164:165], v[44:45] op_sel_hi:[1,0]
    v_pk_mul_f32 v[166:167], v[166:167], v[44:45] op_sel_hi:[1,0]
    v_pk_mul_f32 v[168:169], v[168:169], v[44:45] op_sel_hi:[1,0]
    v_pk_mul_f32 v[170:171], v[170:171], v[44:45] op_sel_hi:[1,0]
    v_cvt_pk_bf16_f32 v164, v164, v165
    v_cvt_pk_bf16_f32 v165, v166, v167
    v_cvt_pk_bf16_f32 v166, v168, v169
    v_cvt_pk_bf16_f32 v167, v170, v171
    v_pk_mul_f32 v[172:173], v[172:173], v[44:45] op_sel_hi:[1,0]
    v_pk_mul_f32 v[174:175], v[174:175], v[44:45] op_sel_hi:[1,0]
    v_pk_mul_f32 v[176:177], v[176:177], v[44:45] op_sel_hi:[1,0]
    v_pk_mul_f32 v[178:179], v[178:179], v[44:45] op_sel_hi:[1,0]
    v_pk_mul_f32 v[180:181], v[180:181], v[44:45] op_sel_hi:[1,0]
    v_pk_mul_f32 v[182:183], v[182:183], v[44:45] op_sel_hi:[1,0]
    v_pk_mul_f32 v[184:185], v[184:185], v[44:45] op_sel_hi:[1,0]
    v_pk_mul_f32 v[186:187], v[186:187], v[44:45] op_sel_hi:[1,0]
    v_pk_mul_f32 v[188:189], v[188:189], v[48:49] op_sel_hi:[1,0]
    v_pk_mul_f32 v[190:191], v[190:191], v[48:49] op_sel_hi:[1,0]
    v_pk_mul_f32 v[192:193], v[192:193], v[48:49] op_sel_hi:[1,0]
    v_pk_mul_f32 v[194:195], v[194:195], v[48:49] op_sel_hi:[1,0]
    v_pk_mul_f32 v[196:197], v[196:197], v[48:49] op_sel_hi:[1,0]
    v_pk_mul_f32 v[198:199], v[198:199], v[48:49] op_sel_hi:[1,0]
    v_pk_mul_f32 v[200:201], v[200:201], v[48:49] op_sel_hi:[1,0]
    v_pk_mul_f32 v[202:203], v[202:203], v[48:49] op_sel_hi:[1,0]
    v_pk_mul_f32 v[204:205], v[204:205], v[48:49] op_sel_hi:[1,0]
    v_pk_mul_f32 v[206:207], v[206:207], v[48:49] op_sel_hi:[1,0]
    v_pk_mul_f32 v[208:209], v[208:209], v[48:49] op_sel_hi:[1,0]
    v_pk_mul_f32 v[210:211], v[210:211], v[48:49] op_sel_hi:[1,0]
    v_pk_mul_f32 v[212:213], v[212:213], v[48:49] op_sel_hi:[1,0]
    v_pk_mul_f32 v[214:215], v[214:215], v[48:49] op_sel_hi:[1,0]
    v_pk_mul_f32 v[216:217], v[216:217], v[48:49] op_sel_hi:[1,0]
    v_pk_mul_f32 v[218:219], v[218:219], v[48:49] op_sel_hi:[1,0]
    v_mfma_f32_16x16x32_bf16 v[236:239], a[144:147], v[84:87], v[236:239]
    ds_write_b128 v8, v[156:159] offset:8192
    v_mfma_f32_16x16x32_bf16 v[236:239], a[148:151], v[52:55], v[236:239]
    v_cvt_pk_bf16_f32 v172, v172, v173
    v_cvt_pk_bf16_f32 v173, v174, v175
    v_mfma_f32_16x16x32_bf16 v[240:243], a[156:159], v[52:55], v[240:243]
    v_cvt_pk_bf16_f32 v174, v176, v177
    v_cvt_pk_bf16_f32 v175, v178, v179
    v_mfma_f32_16x16x32_bf16 v[240:243], a[152:155], v[84:87], v[240:243]
    ds_write_b128 v9, v[164:167] offset:8192
    v_mfma_f32_16x16x32_bf16 v[244:247], a[160:163], v[84:87], v[244:247]
    v_cvt_pk_bf16_f32 v180, v180, v181
    v_cvt_pk_bf16_f32 v181, v182, v183
    v_mfma_f32_16x16x32_bf16 v[244:247], a[164:167], v[52:55], v[244:247]
    v_cvt_pk_bf16_f32 v182, v184, v185
    v_cvt_pk_bf16_f32 v183, v186, v187
    v_mfma_f32_16x16x32_bf16 v[248:251], a[172:175], v[52:55], v[248:251]
    ds_read_b128 v[160:163], v7 offset:8192
    v_cvt_pk_bf16_f32 v188, v188, v189
    v_mfma_f32_16x16x32_bf16 v[248:251], a[168:171], v[84:87], v[248:251]
    ds_read_b128 v[168:171], v7 offset:10240
    v_cvt_pk_bf16_f32 v189, v190, v191
    v_mfma_f32_16x16x32_bf16 v[20:23], a[112:115], a[64:67], 0
    v_cvt_pk_bf16_f32 v190, v192, v193
    v_cvt_pk_bf16_f32 v191, v194, v195
    v_mfma_f32_16x16x32_bf16 v[20:23], a[116:119], a[68:71], v[20:23]
    v_cvt_pk_bf16_f32 v196, v196, v197
    v_cvt_pk_bf16_f32 v197, v198, v199
    v_mfma_f32_16x16x32_bf16 v[20:23], a[120:123], a[72:75], v[20:23]
    v_cvt_pk_bf16_f32 v198, v200, v201
    v_cvt_pk_bf16_f32 v199, v202, v203
    v_mfma_f32_16x16x32_bf16 v[20:23], a[124:127], a[76:79], v[20:23]
    v_cvt_pk_bf16_f32 v204, v204, v205
    v_cvt_pk_bf16_f32 v205, v206, v207
    v_mfma_f32_16x16x32_bf16 v[24:27], a[140:143], a[76:79], 0
    s_waitcnt lgkmcnt(1)
    buffer_store_dwordx4 v[160:163], v6, s[16:19], s41 offen nt
    v_cvt_pk_bf16_f32 v206, v208, v209
    v_cvt_pk_bf16_f32 v207, v210, v211
    v_cvt_pk_bf16_f32 v212, v212, v213
    v_cvt_pk_bf16_f32 v213, v214, v215
    v_mfma_f32_16x16x32_bf16 v[24:27], a[136:139], a[72:75], v[24:27]
    ds_write_b128 v8, v[172:175] offset:9216
    v_mfma_f32_16x16x32_bf16 v[24:27], a[132:135], a[68:71], v[24:27]
    s_waitcnt lgkmcnt(1)
    buffer_store_dwordx4 v[168:171], v6, s[16:19], s41 offen offset:2048 nt
    v_cvt_pk_bf16_f32 v214, v216, v217
    v_cvt_pk_bf16_f32 v215, v218, v219
    v_mul_f32 v20, s20, v20
    v_mul_f32 v21, s20, v21
    v_mfma_f32_16x16x32_bf16 v[24:27], a[128:131], a[64:67], v[24:27]
    ds_write_b128 v9, v[180:183] offset:9216
    v_mfma_f32_16x16x32_bf16 a[208:211], a[144:147], v[88:91], a[208:211]
    v_exp_f32 v20, v20
    v_mfma_f32_16x16x32_bf16 a[208:211], a[148:151], v[56:59], a[208:211]
    v_exp_f32 v21, v21
    v_mfma_f32_16x16x32_bf16 a[212:215], a[156:159], v[56:59], a[212:215]
    ds_read_b128 v[176:179], v7 offset:9216
    v_mul_f32 v22, s20, v22
    v_mfma_f32_16x16x32_bf16 a[212:215], a[152:155], v[88:91], a[212:215]
    ds_read_b128 v[184:187], v7 offset:11264
    v_mul_f32 v23, s20, v23
    v_mfma_f32_16x16x32_bf16 a[216:219], a[160:163], v[88:91], a[216:219]
    v_exp_f32 v22, v22
    v_mfma_f32_16x16x32_bf16 a[216:219], a[164:167], v[56:59], a[216:219]
    v_exp_f32 v23, v23
    v_mfma_f32_16x16x32_bf16 a[220:223], a[172:175], v[56:59], a[220:223]
    v_cvt_pk_bf16_f32 v84, v20, v21
    v_cvt_pk_bf16_f32 v85, v22, v23
    v_mfma_f32_16x16x32_bf16 a[220:223], a[168:171], v[88:91], a[220:223]
    v_mul_f32 v24, s20, v24
    v_mul_f32 v25, s20, v25
    v_mfma_f32_16x16x32_bf16 v[28:31], a[112:115], a[80:83], 0
    s_waitcnt lgkmcnt(1)
    buffer_store_dwordx4 v[176:179], v6, s[16:19], s41 offen offset:128 nt
    v_exp_f32 v24, v24
    v_exp_f32 v25, v25
    v_mfma_f32_16x16x32_bf16 v[28:31], a[116:119], a[84:87], v[28:31]
    ds_write_b128 v8, v[188:191] offset:12288
    v_mfma_f32_16x16x32_bf16 v[28:31], a[120:123], a[88:91], v[28:31]
    s_waitcnt lgkmcnt(1)
    buffer_store_dwordx4 v[184:187], v6, s[16:19], s41 offen offset:2176 nt
    v_mul_f32 v26, s20, v26
    v_mul_f32 v27, s20, v27
    v_exp_f32 v26, v26
    v_mfma_f32_16x16x32_bf16 v[28:31], a[124:127], a[92:95], v[28:31]
    ds_write_b128 v9, v[196:199] offset:12288
    v_mfma_f32_16x16x32_bf16 v[32:35], a[140:143], a[92:95], 0
    v_exp_f32 v27, v27
    v_mfma_f32_16x16x32_bf16 v[32:35], a[136:139], a[88:91], v[32:35]
    v_cvt_pk_bf16_f32 v86, v24, v25
    v_cvt_pk_bf16_f32 v87, v26, v27
    v_mfma_f32_16x16x32_bf16 v[32:35], a[132:135], a[84:87], v[32:35]
    ds_read_b128 v[192:195], v7 offset:12288
    v_mul_f32 v28, s20, v28
    v_mfma_f32_16x16x32_bf16 v[32:35], a[128:131], a[80:83], v[32:35]
    ds_read_b128 v[200:203], v7 offset:14336
    v_mul_f32 v29, s20, v29
    v_mfma_f32_16x16x32_bf16 v[220:223], a[0:3], v[52:55], v[220:223]
    v_exp_f32 v28, v28
    v_mfma_f32_16x16x32_bf16 v[220:223], a[4:7], v[84:87], v[220:223]
    v_exp_f32 v29, v29
    v_mfma_f32_16x16x32_bf16 v[224:227], a[12:15], v[84:87], v[224:227]
    v_mul_f32 v30, s20, v30
    v_mul_f32 v31, s20, v31
    v_mfma_f32_16x16x32_bf16 v[224:227], a[8:11], v[52:55], v[224:227]
    v_exp_f32 v30, v30
    v_mfma_f32_16x16x32_bf16 v[228:231], a[16:19], v[52:55], v[228:231]
    s_waitcnt lgkmcnt(1)
    buffer_store_dwordx4 v[192:195], v6, s[16:19], s42 offen nt
    v_exp_f32 v31, v31
    v_cvt_pk_bf16_f32 v88, v28, v29
    v_cvt_pk_bf16_f32 v89, v30, v31
    v_mfma_f32_16x16x32_bf16 v[228:231], a[20:23], v[84:87], v[228:231]
    ds_write_b128 v8, v[204:207] offset:13312
    v_mfma_f32_16x16x32_bf16 v[232:235], a[28:31], v[84:87], v[232:235]
    s_waitcnt lgkmcnt(1)
    buffer_store_dwordx4 v[200:203], v6, s[16:19], s42 offen offset:2048 nt
    v_mul_f32 v32, s20, v32
    v_mul_f32 v33, s20, v33
    v_exp_f32 v32, v32
    v_mfma_f32_16x16x32_bf16 v[232:235], a[24:27], v[52:55], v[232:235]
    ds_write_b128 v9, v[212:215] offset:13312
    v_mfma_f32_16x16x32_bf16 a[192:195], a[0:3], v[56:59], a[192:195]
    v_exp_f32 v33, v33
    s_nop 0
    v_cvt_pk_bf16_f32 v90, v32, v33
    v_mul_f32 v34, s20, v34
    v_exp_f32 v34, v34
    v_mul_f32 v35, s20, v35
    v_exp_f32 v35, v35
    s_nop 0
    v_cvt_pk_bf16_f32 v91, v34, v35
    s_nop 1
    v_mfma_f32_16x16x32_bf16 a[192:195], a[4:7], v[88:91], a[192:195]
    s_nop 2
    v_mfma_f32_16x16x32_bf16 a[196:199], a[12:15], v[88:91], a[196:199]
    ds_read_b128 v[208:211], v7 offset:13312
    v_mfma_f32_16x16x32_bf16 a[196:199], a[8:11], v[56:59], a[196:199]
    ds_read_b128 v[216:219], v7 offset:15360
    v_mfma_f32_16x16x32_bf16 a[200:203], a[16:19], v[56:59], a[200:203]
    v_accvgpr_read_b32 v92, a192
    v_accvgpr_read_b32 v93, a193
    v_mfma_f32_16x16x32_bf16 a[200:203], a[20:23], v[88:91], a[200:203]
    v_accvgpr_read_b32 v94, a194
    v_accvgpr_read_b32 v95, a195
    v_mfma_f32_16x16x32_bf16 a[204:207], a[28:31], v[88:91], a[204:207]
    v_accvgpr_read_b32 v96, a196
    v_accvgpr_read_b32 v97, a197
    v_mfma_f32_16x16x32_bf16 a[204:207], a[24:27], v[56:59], a[204:207]
    v_accvgpr_read_b32 v98, a198
    v_accvgpr_read_b32 v99, a199
    v_smfmac_f32_16x16x64_bf16 a[184:187], v[16:19], v[52:59], v252
    s_waitcnt lgkmcnt(1)
    v_accvgpr_read_b32 v100, a200
    v_smfmac_f32_16x16x64_bf16 a[184:187], v[16:19], v[84:91], v252
    v_accvgpr_read_b32 v101, a201
    v_mfma_f32_16x16x32_bf16 v[236:239], a[32:35], v[84:87], v[236:239]
    buffer_store_dwordx4 v[208:211], v6, s[16:19], s42 offen offset:128 nt
    v_accvgpr_read_b32 v102, a202
    v_accvgpr_read_b32 v103, a203
    v_accvgpr_read_b32 v104, a204
    v_accvgpr_read_b32 v105, a205
    v_mfma_f32_16x16x32_bf16 v[240:243], a[36:39], v[84:87], v[240:243]
    s_waitcnt lgkmcnt(0)
    buffer_store_dwordx4 v[216:219], v6, s[16:19], s42 offen offset:2176 nt
    v_accvgpr_read_b32 v54, a184
    v_accvgpr_read_b32 v52, a185
    v_add_f32 v54, v54, v52
    v_accvgpr_read_b32 v58, a186
    v_mfma_f32_16x16x32_bf16 v[244:247], a[40:43], v[84:87], v[244:247]
    v_rcp_f32 v52, v54
    v_mfma_f32_16x16x32_bf16 v[248:251], a[44:47], v[84:87], v[248:251]
    v_maximum3_f32 v12, v12, v52, v54
    v_accvgpr_read_b32 v56, a187
    v_mfma_f32_16x16x32_bf16 a[208:211], a[32:35], v[88:91], a[208:211]
    v_add_f32 v58, v58, v56
    v_accvgpr_read_b32 v106, a206
    v_mfma_f32_16x16x32_bf16 a[212:215], a[36:39], v[88:91], a[212:215]
    v_rcp_f32 v56, v58
    v_mfma_f32_16x16x32_bf16 a[216:219], a[40:43], v[88:91], a[216:219]
    v_maximum3_f32 v12, v12, v56, v58
    v_cmp_ngt_f32 vcc, s48, v12
    v_mfma_f32_16x16x32_bf16 a[220:223], a[44:47], v[88:91], a[220:223]
    s_cmp_lg_u64 vcc, 0
    v_accvgpr_read_b32 v107, a207
    v_accvgpr_read_b32 v108, a208
    s_cselect_b32 s49, 8, 0
    s_or_b32 s37, s37, s49
.p2align 3
    v_pk_mul_f32 v[220:221], v[220:221], v[52:53] op_sel_hi:[1,0]
    v_pk_mul_f32 v[222:223], v[222:223], v[52:53] op_sel_hi:[1,0]
    v_pk_mul_f32 v[224:225], v[224:225], v[52:53] op_sel_hi:[1,0]
    v_pk_mul_f32 v[226:227], v[226:227], v[52:53] op_sel_hi:[1,0]
    v_cvt_pk_bf16_f32 v220, v220, v221
    v_cvt_pk_bf16_f32 v221, v222, v223
    v_cvt_pk_bf16_f32 v222, v224, v225
    v_cvt_pk_bf16_f32 v223, v226, v227
    ds_write_b128 v8, v[220:223] offset:16384
    v_pk_mul_f32 v[228:229], v[228:229], v[52:53] op_sel_hi:[1,0]
    v_pk_mul_f32 v[230:231], v[230:231], v[52:53] op_sel_hi:[1,0]
    v_pk_mul_f32 v[232:233], v[232:233], v[52:53] op_sel_hi:[1,0]
    v_pk_mul_f32 v[234:235], v[234:235], v[52:53] op_sel_hi:[1,0]
    v_cvt_pk_bf16_f32 v228, v228, v229
    v_cvt_pk_bf16_f32 v229, v230, v231
    v_cvt_pk_bf16_f32 v230, v232, v233
    v_cvt_pk_bf16_f32 v231, v234, v235
    ds_write_b128 v9, v[228:231] offset:16384
    ds_read_b128 v[224:227], v7 offset:16384
    ds_read_b128 v[232:235], v7 offset:18432
    v_pk_mul_f32 v[92:93], v[92:93], v[56:57] op_sel_hi:[1,0]
    v_pk_mul_f32 v[94:95], v[94:95], v[56:57] op_sel_hi:[1,0]
    v_pk_mul_f32 v[96:97], v[96:97], v[56:57] op_sel_hi:[1,0]
    v_pk_mul_f32 v[98:99], v[98:99], v[56:57] op_sel_hi:[1,0]
    v_cvt_pk_bf16_f32 v92, v92, v93
    v_cvt_pk_bf16_f32 v93, v94, v95
    v_cvt_pk_bf16_f32 v94, v96, v97
    v_cvt_pk_bf16_f32 v95, v98, v99
    ds_write_b128 v8, v[92:95] offset:20480
    v_pk_mul_f32 v[100:101], v[100:101], v[56:57] op_sel_hi:[1,0]
    v_pk_mul_f32 v[102:103], v[102:103], v[56:57] op_sel_hi:[1,0]
    v_pk_mul_f32 v[104:105], v[104:105], v[56:57] op_sel_hi:[1,0]
    v_pk_mul_f32 v[106:107], v[106:107], v[56:57] op_sel_hi:[1,0]
    v_cvt_pk_bf16_f32 v100, v100, v101
    v_cvt_pk_bf16_f32 v101, v102, v103
    v_cvt_pk_bf16_f32 v102, v104, v105
    v_cvt_pk_bf16_f32 v103, v106, v107
    ds_write_b128 v9, v[100:103] offset:20480
    ds_read_b128 v[96:99], v7 offset:20480
    ds_read_b128 v[104:107], v7 offset:22528
    s_waitcnt lgkmcnt(4)
    s_nop 0
    buffer_store_dwordx4 v[224:227], v6, s[16:19], s24 offen nt
    buffer_store_dwordx4 v[232:235], v6, s[16:19], s24 offen offset:2048 nt
    v_pk_mul_f32 v[236:237], v[236:237], v[52:53] op_sel_hi:[1,0]
    v_pk_mul_f32 v[238:239], v[238:239], v[52:53] op_sel_hi:[1,0]
    v_pk_mul_f32 v[240:241], v[240:241], v[52:53] op_sel_hi:[1,0]
    v_pk_mul_f32 v[242:243], v[242:243], v[52:53] op_sel_hi:[1,0]
    v_cvt_pk_bf16_f32 v236, v236, v237
    v_cvt_pk_bf16_f32 v237, v238, v239
    v_cvt_pk_bf16_f32 v238, v240, v241
    v_cvt_pk_bf16_f32 v239, v242, v243
    ds_write_b128 v8, v[236:239] offset:17408
    v_pk_mul_f32 v[244:245], v[244:245], v[52:53] op_sel_hi:[1,0]
    v_pk_mul_f32 v[246:247], v[246:247], v[52:53] op_sel_hi:[1,0]
    v_pk_mul_f32 v[248:249], v[248:249], v[52:53] op_sel_hi:[1,0]
    v_pk_mul_f32 v[250:251], v[250:251], v[52:53] op_sel_hi:[1,0]
    v_cvt_pk_bf16_f32 v244, v244, v245
    v_cvt_pk_bf16_f32 v245, v246, v247
    v_cvt_pk_bf16_f32 v246, v248, v249
    v_cvt_pk_bf16_f32 v247, v250, v251
    ds_write_b128 v9, v[244:247] offset:17408
    ds_read_b128 v[240:243], v7 offset:17408
    ds_read_b128 v[248:251], v7 offset:19456
    s_waitcnt lgkmcnt(4)
    s_nop 0
    buffer_store_dwordx4 v[96:99], v6, s[16:19], s25 offen nt
    buffer_store_dwordx4 v[104:107], v6, s[16:19], s25 offen offset:2048 nt
    v_accvgpr_read_b32 v109, a209
    v_accvgpr_read_b32 v110, a210
    v_accvgpr_read_b32 v111, a211
    v_accvgpr_read_b32 v112, a212
    v_accvgpr_read_b32 v113, a213
    v_accvgpr_read_b32 v114, a214
    v_accvgpr_read_b32 v115, a215
    v_pk_mul_f32 v[108:109], v[108:109], v[56:57] op_sel_hi:[1,0]
    v_pk_mul_f32 v[110:111], v[110:111], v[56:57] op_sel_hi:[1,0]
    v_pk_mul_f32 v[112:113], v[112:113], v[56:57] op_sel_hi:[1,0]
    v_pk_mul_f32 v[114:115], v[114:115], v[56:57] op_sel_hi:[1,0]
    v_cvt_pk_bf16_f32 v108, v108, v109
    v_cvt_pk_bf16_f32 v109, v110, v111
    v_cvt_pk_bf16_f32 v110, v112, v113
    v_cvt_pk_bf16_f32 v111, v114, v115
    ds_write_b128 v8, v[108:111] offset:21504
    v_accvgpr_read_b32 v116, a216
    v_accvgpr_read_b32 v117, a217
    v_accvgpr_read_b32 v118, a218
    v_accvgpr_read_b32 v119, a219
    v_accvgpr_read_b32 v120, a220
    v_accvgpr_read_b32 v121, a221
    v_accvgpr_read_b32 v122, a222
    v_accvgpr_read_b32 v123, a223
    v_pk_mul_f32 v[116:117], v[116:117], v[56:57] op_sel_hi:[1,0]
    v_pk_mul_f32 v[118:119], v[118:119], v[56:57] op_sel_hi:[1,0]
    v_pk_mul_f32 v[120:121], v[120:121], v[56:57] op_sel_hi:[1,0]
    v_pk_mul_f32 v[122:123], v[122:123], v[56:57] op_sel_hi:[1,0]
    v_cvt_pk_bf16_f32 v116, v116, v117
    v_cvt_pk_bf16_f32 v117, v118, v119
    v_cvt_pk_bf16_f32 v118, v120, v121
    v_cvt_pk_bf16_f32 v119, v122, v123
    ds_write_b128 v9, v[116:119] offset:21504
    ds_read_b128 v[112:115], v7 offset:21504
    ds_read_b128 v[120:123], v7 offset:23552
    s_waitcnt lgkmcnt(4)
    s_nop 0
    buffer_store_dwordx4 v[240:243], v6, s[16:19], s24 offen offset:128 nt
    buffer_store_dwordx4 v[248:251], v6, s[16:19], s24 offen offset:2176 nt
    s_waitcnt lgkmcnt(0)
    s_nop 0
    buffer_store_dwordx4 v[112:115], v6, s[16:19], s25 offen offset:128 nt
    buffer_store_dwordx4 v[120:123], v6, s[16:19], s25 offen offset:2176 nt
L_final:
    s_cmp_eq_u32 s37, 0
    s_cbranch_scc1 L_done
    s_waitcnt vmcnt(0) lgkmcnt(0)
    v_mbcnt_lo_u32_b32 v21, -1, 0
    v_mbcnt_hi_u32_b32 v21, -1, v21
    v_and_b32 v22, 15, v21
    v_lshrrev_b32 v23, 4, v21
    v_lshlrev_b32 v253, 8, v22
    v_lshl_add_u32 v253, v23, 4, v253
    v_lshrrev_b32 v22, 2, v21
    v_and_b32 v23, 3, v21
    v_and_b32 v25, 7, v22
    v_xor_b32 v24, v25, v23
    v_lshlrev_b32 v24, 4, v24
    v_lshl_add_u32 v24, v25, 7, v24
    v_lshrrev_b32 v25, 3, v22
    v_lshl_add_u32 v112, v25, 11, v24
    v_add_u32 v112, s44, v112
    v_xor_b32 v113, 64, v112
    v_xor_b32 v114, 16, v21
    v_lshlrev_b32 v114, 2, v114
    v_xor_b32 v115, 32, v21
    v_lshlrev_b32 v115, 2, v115
    v_mov_b32 v116, 0x3f803f80
    v_mov_b32 v117, 0x3f803f80
    v_mov_b32 v118, 0x3f803f80
    v_mov_b32 v119, 0x3f803f80
    s_mov_b32 s22, -1
L_fb_job:
    s_add_u32 s41, s22, 1
    s_xor_b32 s42, s41, s38
    s_and_b32 s42, s42, 1
    s_cselect_b32 s34, s46, s45
    s_cselect_b32 s36, s51, s50
    s_mul_i32 s41, s41, 217088
    s_add_u32 s34, s34, s41
    s_add_u32 s22, s22, 1
    s_cmp_eq_u32 s22, 4
    s_cbranch_scc1 L_done
    s_lshr_b32 s24, s37, s22
    s_and_b32 s24, s24, 1
    s_cbranch_scc0 L_fb_job
    s_add_u32 s25, s36, 5
    s_mov_b32 s26, s34
L_fb_tile:
    buffer_load_dwordx4 v[20:23], v253, s[4:7], s26 offen
    buffer_load_dwordx4 v[24:27], v253, s[4:7], s26 offen offset:64
    buffer_load_dwordx4 v[28:31], v253, s[4:7], s26 offen offset:128
    buffer_load_dwordx4 v[32:35], v253, s[4:7], s26 offen offset:192
    v_mov_b32 v108, 0xff800000
    s_lshl_b32 s28, s22, 17
    s_mov_b32 s32, 31
L_fb_max:
    buffer_load_dwordx4 v[36:39], v253, s[8:11], s28 offen
    buffer_load_dwordx4 v[40:43], v253, s[8:11], s28 offen offset:64
    buffer_load_dwordx4 v[44:47], v253, s[8:11], s28 offen offset:128
    buffer_load_dwordx4 v[48:51], v253, s[8:11], s28 offen offset:192
    s_waitcnt vmcnt(0)
    v_mfma_f32_16x16x32_bf16 v[52:55], v[36:39], v[20:23], 0
    v_mfma_f32_16x16x32_bf16 v[52:55], v[40:43], v[24:27], v[52:55]
    v_mfma_f32_16x16x32_bf16 v[52:55], v[44:47], v[28:31], v[52:55]
    v_mfma_f32_16x16x32_bf16 v[52:55], v[48:51], v[32:35], v[52:55]
    s_add_u32 s28, s28, 4096
    s_nop 7
    v_max3_f32 v108, v108, v52, v53
    v_max3_f32 v108, v108, v54, v55
    s_sub_u32 s32, s32, 1
    s_cbranch_scc0 L_fb_max
    ds_bpermute_b32 v109, v114, v108
    s_waitcnt lgkmcnt(0)
    v_max_f32 v108, v108, v109
    ds_bpermute_b32 v109, v115, v108
    s_waitcnt lgkmcnt(0)
    v_max_f32 v108, v108, v109
    v_mov_b32 v72, 0
    v_mov_b32 v73, 0
    v_mov_b32 v74, 0
    v_mov_b32 v75, 0
    v_mov_b32 v76, 0
    v_mov_b32 v77, 0
    v_mov_b32 v78, 0
    v_mov_b32 v79, 0
    v_mov_b32 v80, 0
    v_mov_b32 v81, 0
    v_mov_b32 v82, 0
    v_mov_b32 v83, 0
    v_mov_b32 v84, 0
    v_mov_b32 v85, 0
    v_mov_b32 v86, 0
    v_mov_b32 v87, 0
    v_mov_b32 v88, 0
    v_mov_b32 v89, 0
    v_mov_b32 v90, 0
    v_mov_b32 v91, 0
    v_mov_b32 v92, 0
    v_mov_b32 v93, 0
    v_mov_b32 v94, 0
    v_mov_b32 v95, 0
    v_mov_b32 v96, 0
    v_mov_b32 v97, 0
    v_mov_b32 v98, 0
    v_mov_b32 v99, 0
    v_mov_b32 v100, 0
    v_mov_b32 v101, 0
    v_mov_b32 v102, 0
    v_mov_b32 v103, 0
    v_mov_b32 v104, 0
    v_mov_b32 v105, 0
    v_mov_b32 v106, 0
    v_mov_b32 v107, 0
    s_lshl_b32 s28, s22, 17
    s_mov_b32 s32, 15
L_fb_pv:
    s_add_u32 m0, s44, 0
    s_add_u32 s29, s28, 0
    buffer_load_dwordx4 v6, s[12:15], s29 offen lds
    buffer_load_dwordx4 v6, s[12:15], s29 offen offset:2048 lds
    s_add_u32 m0, s44, 896
    s_add_u32 s29, s28, 0
    buffer_load_dwordx4 v6, s[12:15], s29 offen offset:128 lds
    buffer_load_dwordx4 v6, s[12:15], s29 offen offset:2176 lds
    s_add_u32 m0, s44, 4096
    s_add_u32 s29, s28, 4096
    buffer_load_dwordx4 v6, s[12:15], s29 offen lds
    buffer_load_dwordx4 v6, s[12:15], s29 offen offset:2048 lds
    s_add_u32 m0, s44, 4992
    s_add_u32 s29, s28, 4096
    buffer_load_dwordx4 v6, s[12:15], s29 offen offset:128 lds
    buffer_load_dwordx4 v6, s[12:15], s29 offen offset:2176 lds
    buffer_load_dwordx4 v[36:39], v253, s[8:11], s28 offen
    buffer_load_dwordx4 v[40:43], v253, s[8:11], s28 offen offset:64
    buffer_load_dwordx4 v[44:47], v253, s[8:11], s28 offen offset:128
    buffer_load_dwordx4 v[48:51], v253, s[8:11], s28 offen offset:192
    s_waitcnt vmcnt(0)
    v_mfma_f32_16x16x32_bf16 v[52:55], v[36:39], v[20:23], 0
    v_mfma_f32_16x16x32_bf16 v[52:55], v[40:43], v[24:27], v[52:55]
    v_mfma_f32_16x16x32_bf16 v[52:55], v[44:47], v[28:31], v[52:55]
    v_mfma_f32_16x16x32_bf16 v[52:55], v[48:51], v[32:35], v[52:55]
    s_add_u32 s28, s28, 4096
    s_nop 7
    buffer_load_dwordx4 v[36:39], v253, s[8:11], s28 offen
    buffer_load_dwordx4 v[40:43], v253, s[8:11], s28 offen offset:64
    buffer_load_dwordx4 v[44:47], v253, s[8:11], s28 offen offset:128
    buffer_load_dwordx4 v[48:51], v253, s[8:11], s28 offen offset:192
    s_waitcnt vmcnt(0)
    v_mfma_f32_16x16x32_bf16 v[56:59], v[36:39], v[20:23], 0
    v_mfma_f32_16x16x32_bf16 v[56:59], v[40:43], v[24:27], v[56:59]
    v_mfma_f32_16x16x32_bf16 v[56:59], v[44:47], v[28:31], v[56:59]
    v_mfma_f32_16x16x32_bf16 v[56:59], v[48:51], v[32:35], v[56:59]
    s_add_u32 s28, s28, 4096
    s_nop 7
    v_sub_f32 v52, v52, v108
    v_sub_f32 v53, v53, v108
    v_sub_f32 v54, v54, v108
    v_sub_f32 v55, v55, v108
    v_sub_f32 v56, v56, v108
    v_sub_f32 v57, v57, v108
    v_sub_f32 v58, v58, v108
    v_sub_f32 v59, v59, v108
    v_mul_f32 v52, s20, v52
    v_mul_f32 v53, s20, v53
    v_mul_f32 v54, s20, v54
    v_mul_f32 v55, s20, v55
    v_mul_f32 v56, s20, v56
    v_mul_f32 v57, s20, v57
    v_mul_f32 v58, s20, v58
    v_mul_f32 v59, s20, v59
    v_exp_f32 v52, v52
    v_exp_f32 v53, v53
    v_exp_f32 v54, v54
    v_exp_f32 v55, v55
    v_exp_f32 v56, v56
    v_exp_f32 v57, v57
    v_exp_f32 v58, v58
    v_exp_f32 v59, v59
    s_nop 0
    v_cvt_pk_bf16_f32 v60, v52, v53
    v_cvt_pk_bf16_f32 v61, v54, v55
    v_cvt_pk_bf16_f32 v62, v56, v57
    v_cvt_pk_bf16_f32 v63, v58, v59
    s_nop 1
    v_mfma_f32_16x16x32_bf16 v[104:107], v[116:119], v[60:63], v[104:107]
    ds_read_b64_tr_b16 v[64:65], v112
    ds_read_b64_tr_b16 v[66:67], v112 offset:4096
    s_waitcnt lgkmcnt(0)
    v_mfma_f32_16x16x32_bf16 v[72:75], v[64:67], v[60:63], v[72:75]
    ds_read_b64_tr_b16 v[68:69], v112 offset:8
    ds_read_b64_tr_b16 v[70:71], v112 offset:4104
    s_waitcnt lgkmcnt(0)
    v_mfma_f32_16x16x32_bf16 v[76:79], v[68:71], v[60:63], v[76:79]
    ds_read_b64_tr_b16 v[64:65], v113
    ds_read_b64_tr_b16 v[66:67], v113 offset:4096
    s_waitcnt lgkmcnt(0)
    v_mfma_f32_16x16x32_bf16 v[80:83], v[64:67], v[60:63], v[80:83]
    ds_read_b64_tr_b16 v[68:69], v113 offset:8
    ds_read_b64_tr_b16 v[70:71], v113 offset:4104
    s_waitcnt lgkmcnt(0)
    v_mfma_f32_16x16x32_bf16 v[84:87], v[68:71], v[60:63], v[84:87]
    ds_read_b64_tr_b16 v[64:65], v112 offset:1024
    ds_read_b64_tr_b16 v[66:67], v112 offset:5120
    s_waitcnt lgkmcnt(0)
    v_mfma_f32_16x16x32_bf16 v[88:91], v[64:67], v[60:63], v[88:91]
    ds_read_b64_tr_b16 v[68:69], v112 offset:1032
    ds_read_b64_tr_b16 v[70:71], v112 offset:5128
    s_waitcnt lgkmcnt(0)
    v_mfma_f32_16x16x32_bf16 v[92:95], v[68:71], v[60:63], v[92:95]
    ds_read_b64_tr_b16 v[64:65], v113 offset:1024
    ds_read_b64_tr_b16 v[66:67], v113 offset:5120
    s_waitcnt lgkmcnt(0)
    v_mfma_f32_16x16x32_bf16 v[96:99], v[64:67], v[60:63], v[96:99]
    ds_read_b64_tr_b16 v[68:69], v113 offset:1032
    ds_read_b64_tr_b16 v[70:71], v113 offset:5128
    s_waitcnt lgkmcnt(0)
    v_mfma_f32_16x16x32_bf16 v[100:103], v[68:71], v[60:63], v[100:103]
    s_sub_u32 s32, s32, 1
    s_cbranch_scc0 L_fb_pv
    s_nop 7
    v_rcp_f32 v109, v104
    s_nop 0
    v_mul_f32 v72, v109, v72
    v_mul_f32 v73, v109, v73
    v_mul_f32 v74, v109, v74
    v_mul_f32 v75, v109, v75
    v_mul_f32 v76, v109, v76
    v_mul_f32 v77, v109, v77
    v_mul_f32 v78, v109, v78
    v_mul_f32 v79, v109, v79
    v_mul_f32 v80, v109, v80
    v_mul_f32 v81, v109, v81
    v_mul_f32 v82, v109, v82
    v_mul_f32 v83, v109, v83
    v_mul_f32 v84, v109, v84
    v_mul_f32 v85, v109, v85
    v_mul_f32 v86, v109, v86
    v_mul_f32 v87, v109, v87
    v_mul_f32 v88, v109, v88
    v_mul_f32 v89, v109, v89
    v_mul_f32 v90, v109, v90
    v_mul_f32 v91, v109, v91
    v_mul_f32 v92, v109, v92
    v_mul_f32 v93, v109, v93
    v_mul_f32 v94, v109, v94
    v_mul_f32 v95, v109, v95
    v_mul_f32 v96, v109, v96
    v_mul_f32 v97, v109, v97
    v_mul_f32 v98, v109, v98
    v_mul_f32 v99, v109, v99
    v_mul_f32 v100, v109, v100
    v_mul_f32 v101, v109, v101
    v_mul_f32 v102, v109, v102
    v_mul_f32 v103, v109, v103
    v_cvt_pk_bf16_f32 v72, v72, v73
    v_cvt_pk_bf16_f32 v73, v74, v75
    v_cvt_pk_bf16_f32 v74, v76, v77
    v_cvt_pk_bf16_f32 v75, v78, v79
    buffer_store_dwordx4 v[72:75], v253, s[16:19], s26 offen
    v_cvt_pk_bf16_f32 v80, v80, v81
    v_cvt_pk_bf16_f32 v81, v82, v83
    v_cvt_pk_bf16_f32 v82, v84, v85
    v_cvt_pk_bf16_f32 v83, v86, v87
    buffer_store_dwordx4 v[80:83], v253, s[16:19], s26 offen offset:64
    v_cvt_pk_bf16_f32 v88, v88, v89
    v_cvt_pk_bf16_f32 v89, v90, v91
    v_cvt_pk_bf16_f32 v90, v92, v93
    v_cvt_pk_bf16_f32 v91, v94, v95
    buffer_store_dwordx4 v[88:91], v253, s[16:19], s26 offen offset:128
    v_cvt_pk_bf16_f32 v96, v96, v97
    v_cvt_pk_bf16_f32 v97, v98, v99
    v_cvt_pk_bf16_f32 v98, v100, v101
    v_cvt_pk_bf16_f32 v99, v102, v103
    buffer_store_dwordx4 v[96:99], v253, s[16:19], s26 offen offset:192
    s_waitcnt vmcnt(0)
    s_add_u32 s26, s26, 4096
    s_sub_u32 s25, s25, 1
    s_cbranch_scc0 L_fb_tile
    s_branch L_fb_job
L_done:
L_exit:
    s_endpgm
L_code_end:
.section .rodata,"a"
.p2align 6
.amdhsa_kernel standalone__gqa_softmax__near_ridge_kernel
  .amdhsa_next_free_vgpr 512
  .amdhsa_next_free_sgpr 102
  .amdhsa_accum_offset 256
  .amdhsa_group_segment_fixed_size 0
  .amdhsa_kernarg_size 48
  .amdhsa_user_sgpr_count 2
  .amdhsa_user_sgpr_kernarg_segment_ptr 1
  .amdhsa_system_sgpr_workgroup_id_x 1
.end_amdhsa_kernel
```
